```python
import torch

def _softmax(x, axis=-1):
    return torch.softmax(x, dim=axis)
def _gelu(x):
    return torch.nn.functional.gelu(x, approximate="tanh")
def _silu(x):
    return torch.nn.functional.silu(x)
def _sigmoid(x):
    return torch.sigmoid(x)
def _layernorm(x, axis=-1, eps=1e-5):
    m = x.mean(dim=axis, keepdim=True)
    v = x.var(dim=axis, keepdim=True, unbiased=False)
    return (x - m) / torch.sqrt(v + eps)
def _scatter_add(tgt, idx, src, axis=0):
    return tgt.clone().index_add_(axis, idx, src)
def _segment_sum(src, seg, n):
    out = torch.zeros((n,) + src.shape[1:], dtype=src.dtype)
    return out.index_add_(0, seg, src)
def _pad(x, pw):
    flat = tuple(v for pair in reversed(pw) for v in pair)
    return torch.nn.functional.pad(x, flat)

kernel_name = 'interleave_layers__spectral_gfnet__ssm_conv_s4__prompt'

def setup_inputs():

    _w = (lambda a: (lambda t: t.to(torch.bfloat16) if t.is_floating_point() else t)(torch.as_tensor(a)))
    def _A_setup():
        B, S, D = 1, 2048, 512
        Df = D // 2 + 1
        return {
            "x": _w((lambda *s: torch.randn(*s, dtype=torch.bfloat16) * 0.05)(B, S, D)),
            "w_r": _w((lambda *s: torch.randn(*s, dtype=torch.bfloat16) * 1.6)(S, Df) * 0.02),
            "w_i": _w((lambda *s: torch.randn(*s, dtype=torch.bfloat16) * 1.6)(S, Df) * 0.02),
        }
    _A_in = _A_setup()

    def _B_setup():
        B, L, D, N = 1, 2048, 512, 128
        A_re = -(lambda _x: torch.exp(torch.as_tensor(_x)))((lambda *s: torch.randn(*s, dtype=torch.bfloat16) * 6.4)(D, N))
        A_im = torch.pi * (lambda *s: torch.randn(*s, dtype=torch.bfloat16) * 0.05)(D, N)
        B_re = (lambda *s: torch.randn(*s, dtype=torch.bfloat16) * 0.05)(D, N)
        B_im = (lambda *s: torch.randn(*s, dtype=torch.bfloat16) * 0.05)(D, N)
        C_re = (lambda *s: torch.randn(*s, dtype=torch.bfloat16) * 0.05)(D, N)
        C_im = (lambda *s: torch.randn(*s, dtype=torch.bfloat16) * 0.05)(D, N)
        log_dt = (lambda *s: torch.randn(*s, dtype=torch.bfloat16) * 0.05)(D) * 0.5 - 4.0
        Dskip = (lambda *s: torch.randn(*s, dtype=torch.bfloat16) * 0.05)(D)
        return {
            "u": _w((lambda *s: torch.randn(*s, dtype=torch.bfloat16) * 0.05)(B, L, D)),
            "A_re": _w(A_re),
            "A_im": _w(A_im),
            "B_re": _w(B_re),
            "B_im": _w(B_im),
            "C_re": _w(C_re),
            "C_im": _w(C_im),
            "log_dt": _w(log_dt),
            "Dskip": _w(Dskip),
        }
    _B_in = _B_setup()

    return {
        "A_x": _A_in["x"],
        "A_w_r": _A_in["w_r"],
        "A_w_i": _A_in["w_i"],
        "B_u": _B_in["u"],
        "B_A_re": _B_in["A_re"],
        "B_A_im": _B_in["A_im"],
        "B_B_re": _B_in["B_re"],
        "B_B_im": _B_in["B_im"],
        "B_C_re": _B_in["C_re"],
        "B_C_im": _B_in["C_im"],
        "B_log_dt": _B_in["log_dt"],
        "B_Dskip": _B_in["Dskip"],
    }

def reference(A_x, A_w_r, A_w_i, B_u, B_A_re, B_A_im, B_B_re, B_B_im, B_C_re, B_C_im, B_log_dt, B_Dskip):
    def _A_ref(x, w_r, w_i):
        B, S, D = x.shape
        X = (lambda x, axes=(-2,-1): torch.fft.rfft2(x.float(), dim=axes))(x, axes=(-2, -1))
        W = w_r + 1j * w_i
        X = X * W
        y = (lambda x, s, axes=(-2,-1): torch.fft.irfft2(x, s=s, dim=axes).to(torch.bfloat16))(X, (S, D), axes=(-2, -1))
        return y

    def _B_ref(u, A_re, A_im, B_re, B_im, C_re, C_im, log_dt, Dskip):
        Bsz, L, D = u.shape
        dt = torch.exp(log_dt)[:, None]
        A = A_re + 1j * A_im
        Bc = B_re + 1j * B_im
        Cc = C_re + 1j * C_im
        logdA = dt * A
        dB = dt * Bc
        l = (lambda x, dt: x.to(dt))(torch.arange(L), A_re.dtype)
        P = torch.exp(logdA[:, :, None] * l[None, None, :])
        K = torch.einsum("dn,dnl,dn->dl", Cc, P, dB).real
        L2 = 2 * L
        Kp = _pad(K, ((0, 0), (0, L)))
        up = (lambda x, *d: x.permute(*d))(u, 0, 2, 1)
        up = _pad(up, ((0, 0), (0, 0), (0, L)))
        Kf = (lambda x, axes=(-2,-1): torch.fft.rfft2(x.float(), dim=axes))(Kp[:, None, :], axes=(-2, -1))
        Uf = (lambda x, axes=(-2,-1): torch.fft.rfft2(x.float(), dim=axes))(up[:, :, None, :], axes=(-2, -1))
        Yf = Uf * Kf[None, :, :, :]
        y = (lambda x, s, axes=(-2,-1): torch.fft.irfft2(x, s=s, dim=axes).to(torch.bfloat16))(Yf, (1, L2), axes=(-2, -1))[:, :, 0, :L]
        y = (lambda x, *d: x.permute(*d))(y, 0, 2, 1) + u * Dskip[None, None, :]
        return y

    x = A_x
    x = x + _A_ref(_layernorm(x, axis=-1), A_w_r, A_w_i)
    x = x + _B_ref(_layernorm(x, axis=-1), B_A_re, B_A_im, B_B_re, B_B_im, B_C_re, B_C_im, B_log_dt, B_Dskip)
    x = x + _A_ref(_layernorm(x, axis=-1), A_w_r, A_w_i)
    x = x + _B_ref(_layernorm(x, axis=-1), B_A_re, B_A_im, B_B_re, B_B_im, B_C_re, B_C_im, B_log_dt, B_Dskip)
    return x
```

```asm
; @launch grid=(256,1,1) block=(256,1,1) lds=154624
.amdgcn_target "amdgcn-amd-amdhsa--gfx950"
.text
.globl interleave_layers__spectral_gfnet__ssm_conv_s4__prompt_kernel
.p2align 8
.type interleave_layers__spectral_gfnet__ssm_conv_s4__prompt_kernel,@function
interleave_layers__spectral_gfnet__ssm_conv_s4__prompt_kernel:
    s_cmp_ge_u32 s2, 256
    s_cbranch_scc1 L_end
    s_load_dwordx16 s[4:19], s[0:1], 0
    s_load_dwordx8 s[20:27], s[0:1], 64
    s_load_dwordx4 s[28:31], s[0:1], 96
    s_load_dwordx2 s[32:33], s[0:1], 112
    v_lshrrev_b32 v4, 6, v0
    s_and_b32 s35, s2, 7
    v_readfirstlane_b32 s34, v4
    s_lshl_b32 s35, s35, 5
    s_lshr_b32 s36, s2, 3
    s_add_u32 s35, s35, s36
    s_and_b32 s39, s35, 31
    s_lshr_b32 s40, s35, 5
    s_lshr_b32 s41, s34, 1
    v_and_b32 v1, 63, v0
    s_and_b32 s42, s34, 1
    v_and_b32 v2, 15, v0
    v_lshrrev_b32 v3, 4, v1
    s_lshl_b32 s43, s34, 4
    s_getpc_b64 s[46:47]
L_pc_here:
    s_add_u32 s48, s46, L_tables-L_pc_here
    s_addc_u32 s49, s47, 0
    v_lshlrev_b32 v5, 4, v1
    s_mov_b32 s50, s48
    s_mov_b32 s51, s49
    v_add_u32 v6, 0, v5
    global_load_dwordx4 a[0:3], v6, s[50:51] offset:0
    s_mul_i32 s36, s42, 6144
    s_add_u32 s36, s36, 21504
    s_add_u32 s52, s48, s36
    s_addc_u32 s53, s49, 0
    v_add_u32 v7, 0, v5
    s_mul_i32 s36, s34, 34816
    s_add_u32 s36, s36, 33792
    s_add_u32 s54, s48, s36
    s_addc_u32 s55, s49, 0
    global_load_dwordx4 a[84:87], v7, s[52:53] offset:0
    global_load_dwordx4 a[88:91], v7, s[52:53] offset:1024
    global_load_dwordx4 a[92:95], v7, s[52:53] offset:2048
    global_load_dwordx4 a[96:99], v7, s[52:53] offset:3072
    s_waitcnt lgkmcnt(0)
    s_mov_b32 s56, s32
    s_mov_b32 s57, s33
    s_mov_b32 s58, 0x1500000
    s_mov_b32 s59, 0x20000
    s_mov_b32 s60, s4
    s_mov_b32 s61, s5
    s_mov_b32 s62, 0x200000
    s_mov_b32 s63, 0x20000
    s_lshl_b32 s36, s40, 8
    s_add_u32 s36, s36, s39
    s_lshl_b32 s37, s34, 5
    s_add_u32 s36, s36, s37
    s_lshl_b32 s36, s36, 10
    buffer_load_dwordx4 v[6:9], v5, s[60:63], s36 offen
    s_add_u32 s37, s36, 131072
    buffer_load_dwordx4 v[10:13], v5, s[60:63], s37 offen
    s_mov_b32 s60, s30
    s_mov_b32 s61, s31
    s_mov_b32 s62, 0x100
    s_mov_b32 s63, 0x20000
    s_cmp_lg_u32 s2, 0
    s_cbranch_scc1 L_nonce_done
    s_cmp_lg_u32 s34, 0
    s_cbranch_scc1 L_nonce_done
    s_memrealtime s[48:49]
    s_waitcnt lgkmcnt(0)
    v_cmp_eq_u32 vcc, 0, v1
    v_mov_b32 v14, 0x7ffffff0
    s_or_b32 s48, s48, 1
    v_mov_b32 v15, s48
    v_cndmask_b32 v14, v14, 0, vcc
    buffer_store_dword v15, v14, s[60:63], 0 offen sc1
    s_nop 1
L_nonce_done:
    s_lshr_b32 s36, s35, 6
    s_lshl_b32 s36, s36, 9
    s_and_b32 s37, s35, 63
    s_add_u32 s45, s36, s37
    s_mul_i32 s45, s45, 514
    s_add_u32 s48, s36, s37
    v_lshlrev_b32 v56, 6, v0
    v_add_u32 v56, s48, v56
    s_add_u32 s48, s45, 0
    s_add_u32 s49, s45, 32896
    s_add_u32 s64, s45, 65792
    s_add_u32 s65, s45, 98688
    s_add_u32 s66, s45, 131584
    s_add_u32 s67, s45, 164480
    s_add_u32 s68, s45, 197376
    s_add_u32 s69, s45, 230272
    s_mov_b32 s60, s6
    s_mov_b32 s61, s7
    s_mov_b32 s62, 0x101000
    v_lshlrev_b32 v47, 1, v0
    s_mov_b32 s63, 0x20000
    buffer_load_ushort v15, v47, s[60:63], s48 offen
    v_cmp_gt_u32 vcc, 8, v0
    v_sub_u32 v57, 2048, v56
    v_mov_b32 v4, 0x7ffffff0
    buffer_load_ushort v17, v47, s[60:63], s49 offen
    v_mul_u32_u24 v56, 514, v56
    v_cndmask_b32 v56, v4, v56, vcc
    v_and_b32 v57, 2047, v57
    buffer_load_ushort v19, v47, s[60:63], s64 offen
    v_mul_u32_u24 v57, 514, v57
    v_cndmask_b32 v57, v4, v57, vcc
    v_lshlrev_b32 v14, 2, v1
    buffer_load_ushort v21, v47, s[60:63], s65 offen
    v_lshlrev_b32 v154, 10, v3
    v_lshl_add_u32 v154, v2, 4, v154
    v_lshl_add_u32 v155, v3, 6, v2
    buffer_load_ushort v23, v47, s[60:63], s66 offen
    v_lshlrev_b32 v158, 11, v3
    v_lshl_add_u32 v158, v2, 5, v158
    v_lshlrev_b32 v159, 11, v3
    buffer_load_ushort v25, v47, s[60:63], s67 offen
    v_lshl_add_u32 v159, v2, 4, v159
    v_lshrrev_b32 v153, 1, v3
    v_lshlrev_b32 v162, 9, v153
    buffer_load_ushort v27, v47, s[60:63], s68 offen
    v_lshl_add_u32 v162, v2, 4, v162
    v_and_b32 v152, 1, v3
    v_lshl_add_u32 v162, v152, 3, v162
    buffer_load_ushort v29, v47, s[60:63], s69 offen
    v_lshlrev_b32 v151, 10, v153
    v_lshl_add_u32 v156, v153, 5, v2
    v_lshl_add_u32 v151, v2, 5, v151
    buffer_load_ushort v31, v56, s[60:63], 0 offen offset:0
    v_lshlrev_b32 v156, 5, v156
    v_lshl_add_u32 v151, v152, 4, v151
    v_lshl_add_u32 v156, v152, 4, v156
    buffer_load_ushort v32, v56, s[60:63], 0 offen offset:512
    v_lshrrev_b32 v150, 1, v0
    v_lshlrev_b32 v150, 13, v150
    v_and_b32 v4, 1, v0
    buffer_load_ushort v33, v57, s[60:63], 0 offen offset:0
    v_lshl_add_u32 v150, v4, 4, v150
    v_lshrrev_b32 v160, 1, v0
    v_lshlrev_b32 v160, 4, v160
    buffer_load_ushort v34, v57, s[60:63], 0 offen offset:512
    s_mov_b32 s60, s8
    s_mov_b32 s61, s9
    s_mov_b32 s62, 0x101000
    s_mov_b32 s63, 0x20000
    buffer_load_ushort v16, v47, s[60:63], s48 offen
    s_lshl_b32 s36, s35, 9
    s_lshl_b32 s37, s41, 8
    s_add_u32 s36, s36, s37
    buffer_load_ushort v18, v47, s[60:63], s49 offen
    v_and_b32 v4, 1, v0
    v_lshl_add_u32 v160, v4, 12, v160
    v_lshrrev_b32 v4, 2, v2
    buffer_load_ushort v20, v47, s[60:63], s64 offen
    v_lshlrev_b32 v161, 9, v3
    v_lshl_add_u32 v161, v2, 4, v161
    v_mov_b32 v144, -1
    buffer_load_ushort v22, v47, s[60:63], s65 offen
    v_mov_b32 v145, -1
    v_mov_b32 v146, -1
    v_mov_b32 v147, -1
    buffer_load_ushort v24, v47, s[60:63], s66 offen
    v_lshlrev_b32 v148, 31, v2
    v_lshlrev_b32 v149, 4, v0
    buffer_load_ushort v26, v47, s[60:63], s67 offen
    buffer_load_ushort v28, v47, s[60:63], s68 offen
    buffer_load_ushort v30, v47, s[60:63], s69 offen
    buffer_load_ushort v35, v56, s[60:63], 0 offen offset:0
    buffer_load_ushort v36, v56, s[60:63], 0 offen offset:512
    buffer_load_ushort v37, v57, s[60:63], 0 offen offset:0
    buffer_load_ushort v38, v57, s[60:63], 0 offen offset:512
    s_mov_b32 s60, s12
    s_mov_b32 s61, s13
    s_mov_b32 s62, 0x20000
    s_mov_b32 s63, 0x20000
    buffer_load_dword v39, v14, s[60:63], s36 offen
    s_mov_b32 s60, s14
    s_mov_b32 s61, s15
    s_mov_b32 s62, 0x20000
    s_mov_b32 s63, 0x20000
    buffer_load_dword v40, v14, s[60:63], s36 offen
    s_mov_b32 s60, s16
    s_mov_b32 s61, s17
    s_mov_b32 s62, 0x20000
    s_mov_b32 s63, 0x20000
    buffer_load_dword v41, v14, s[60:63], s36 offen
    s_mov_b32 s60, s18
    s_mov_b32 s61, s19
    s_mov_b32 s62, 0x20000
    s_mov_b32 s63, 0x20000
    buffer_load_dword v42, v14, s[60:63], s36 offen
    s_mov_b32 s60, s20
    s_mov_b32 s61, s21
    s_mov_b32 s62, 0x20000
    s_mov_b32 s63, 0x20000
    buffer_load_dword v43, v14, s[60:63], s36 offen
    s_mov_b32 s60, s22
    s_mov_b32 s61, s23
    s_mov_b32 s62, 0x20000
    s_mov_b32 s63, 0x20000
    buffer_load_dword v44, v14, s[60:63], s36 offen
    s_mov_b32 s60, s24
    s_mov_b32 s61, s25
    s_mov_b32 s62, 0x400
    s_mov_b32 s63, 0x20000
    s_lshl_b32 s37, s35, 2
    s_lshl_b32 s36, s41, 1
    s_add_u32 s36, s36, s37
    v_mov_b32 v14, 0
    buffer_load_ushort v45, v14, s[60:63], s36 offen
    s_mov_b32 s60, s26
    s_mov_b32 s61, s27
    s_mov_b32 s62, 0x400
    s_mov_b32 s63, 0x20000
    buffer_load_dword v46, v14, s[60:63], s37 offen
    s_lshr_b32 s36, s2, 3
    s_lshl_b32 s36, s36, 2
    s_add_u32 s36, s36, s34
    s_lshl_b32 s36, s36, 11
    s_min_u32 s36, s36, L_tables_end-L_pc_here-2048
    v_add_u32 v14, s36, v5
    global_load_dwordx4 v[48:51], v14, s[46:47]
    s_lshl_b32 s37, s42, 4
    s_lshl_b32 s36, s41, 3
    v_add_u32 v154, s36, v154
    s_lshl_b32 s36, s42, 4
    v_add_u32 v155, s36, v155
    v_lshlrev_b32 v155, 5, v155
    s_lshl_b32 s36, s41, 4
    v_add_u32 v155, s36, v155
    s_lshl_b32 s36, s34, 11
    v_add_u32 v157, s36, v5
    s_lshl_b32 s36, s34, 3
    v_add_u32 v158, s36, v158
    s_lshl_b32 s36, s34, 2
    global_load_dwordx4 v[52:55], v14, s[46:47] offset:1024
    v_add_u32 v159, s36, v159
    s_lshl_b32 s36, s34, 10
    s_mov_b32 s45, 0x05040100
    s_mov_b32 s48, 0x07060302
    s_mov_b32 s49, 0xffff0000
    s_mov_b32 s64, 0x3f803f80
    v_add_u32 v162, s36, v162
    s_lshl_b32 s65, s35, 13
    s_lshl_b32 s36, s34, 11
    s_add_u32 s66, s65, s36
    s_lshl_b32 s67, s35, 5
    s_lshl_b32 s36, s34, 10
    s_add_u32 s36, s36, 32768
    v_add_u32 v152, s36, v5
    s_waitcnt vmcnt(34)
    ds_write_b128 v152, v[6:9]
    ds_write_b128 v152, v[10:13] offset:4096
    v_add_u32 v47, s37, v2
    v_lshlrev_b32 v152, 10, v4
    v_lshl_add_u32 v47, v47, 2, v3
    v_and_b32 v4, 3, v2
    v_cmp_eq_u32 vcc, 0, v47
    v_lshl_add_u32 v152, v4, 3, v152
    s_lshl_b32 s36, s34, 8
    v_lshl_add_u32 v152, v3, 5, v152
    s_add_u32 s36, s36, 32768
    v_cndmask_b32 v47, 0, 1.0, vcc
    v_add_u32 v152, s36, v152
    s_waitcnt lgkmcnt(0)
    s_barrier
    ds_read_b64_tr_b16 v[6:7], v152 offset:0
    ds_read_b64_tr_b16 v[8:9], v152 offset:4096
    ds_read_b64_tr_b16 v[10:11], v152 offset:128
    ds_read_b64_tr_b16 v[12:13], v152 offset:4224
    s_mov_b32 s60, s30
    s_mov_b32 s61, s31
    s_mov_b32 s62, 0x100
    s_mov_b32 s63, 0x20000
    s_add_u32 s74, s65, 4194304
    s_add_u32 s75, s74, 4096
    s_add_u32 s76, s65, 0
    v_accvgpr_read_b32 v56, a92
    v_accvgpr_read_b32 v57, a93
    v_accvgpr_read_b32 v58, a94
    v_accvgpr_read_b32 v59, a95
    v_accvgpr_read_b32 v60, a96
    v_accvgpr_read_b32 v61, a97
    v_accvgpr_read_b32 v62, a98
    v_accvgpr_read_b32 v63, a99
    s_add_u32 s77, s76, 4096
    s_waitcnt lgkmcnt(2)
    ds_write_b128 v157, v[6:9] offset:0
    v_mov_b32 v7, 0
    buffer_load_dword v6, v7, s[60:63], 0 offen sc1
    s_waitcnt lgkmcnt(1)
    ds_write_b128 v157, v[10:13] offset:1024
    buffer_store_dwordx4 v[144:147], v149, s[56:59], s74 offen sc1
    buffer_store_dwordx4 v[144:147], v149, s[56:59], s75 offen sc1
    s_waitcnt lgkmcnt(0)
    s_barrier
    s_add_u32 s74, s65, 8388608
    s_add_u32 s75, s65, 8392704
    ds_read_b64 v[8:9], v154 offset:0
    ds_read_b64 v[10:11], v154 offset:256
    ds_read_b64 v[12:13], v154 offset:512
    ds_read_b64 v[152:153], v154 offset:768
    ds_read_b64 v[164:165], v154 offset:4096
    ds_read_b64 v[166:167], v154 offset:4352
    ds_read_b64 v[168:169], v154 offset:4608
    ds_read_b64 v[170:171], v154 offset:4864
    buffer_store_dwordx4 v[144:147], v149, s[56:59], s74 offen sc1
    buffer_store_dwordx4 v[144:147], v149, s[56:59], s75 offen sc1
    s_waitcnt lgkmcnt(6)
    v_perm_b32 v172, v10, v8, s45
    s_waitcnt lgkmcnt(4)
    v_perm_b32 v173, v152, v12, s45
    v_perm_b32 v176, v10, v8, s48
    v_perm_b32 v177, v152, v12, s48
    v_perm_b32 v180, v11, v9, s45
    v_perm_b32 v181, v153, v13, s45
    v_perm_b32 v184, v11, v9, s48
    v_perm_b32 v185, v153, v13, s48
    v_dot2_f32_bf16 v12, v172, s64, 0
    v_dot2_f32_bf16 v13, v176, s64, 0
    v_dot2_f32_bf16 v152, v180, s64, 0
    v_dot2_f32_bf16 v153, v184, s64, 0
    s_waitcnt lgkmcnt(2)
    v_perm_b32 v174, v166, v164, s45
    v_perm_b32 v178, v166, v164, s48
    v_perm_b32 v182, v167, v165, s45
    v_perm_b32 v186, v167, v165, s48
    v_dot2c_f32_bf16 v12, s64, v173
    v_dot2c_f32_bf16 v13, s64, v177
    v_dot2c_f32_bf16 v152, s64, v181
    v_dot2c_f32_bf16 v153, s64, v185
    s_waitcnt lgkmcnt(0)
    v_perm_b32 v175, v170, v168, s45
    v_perm_b32 v179, v170, v168, s48
    v_perm_b32 v183, v171, v169, s45
    v_perm_b32 v187, v171, v169, s48
    v_dot2_f32_bf16 v163, v172, v172, 0
    v_dot2_f32_bf16 v208, v176, v176, 0
    v_dot2_f32_bf16 v209, v180, v180, 0
    v_dot2_f32_bf16 v210, v184, v184, 0
    v_dot2c_f32_bf16 v12, s64, v174
    v_dot2c_f32_bf16 v13, s64, v178
    v_dot2c_f32_bf16 v152, s64, v182
    v_dot2c_f32_bf16 v153, s64, v186
    v_dot2c_f32_bf16 v163, v173, v173
    v_dot2c_f32_bf16 v208, v177, v177
    v_dot2c_f32_bf16 v209, v181, v181
    v_dot2c_f32_bf16 v210, v185, v185
    v_dot2c_f32_bf16 v12, s64, v175
    v_dot2c_f32_bf16 v13, s64, v179
    v_dot2c_f32_bf16 v152, s64, v183
    v_dot2c_f32_bf16 v153, s64, v187
    v_dot2c_f32_bf16 v163, v174, v174
    v_dot2c_f32_bf16 v208, v178, v178
    v_dot2c_f32_bf16 v209, v182, v182
    v_dot2c_f32_bf16 v210, v186, v186
    v_dot2c_f32_bf16 v163, v175, v175
    v_dot2c_f32_bf16 v208, v179, v179
    v_dot2c_f32_bf16 v209, v183, v183
    v_dot2c_f32_bf16 v210, v187, v187
    v_permlane32_swap_b32 v12, v13
    v_permlane32_swap_b32 v152, v153
    v_add_f32 v12, v12, v13
    v_add_f32 v152, v152, v153
    v_permlane32_swap_b32 v163, v208
    v_permlane32_swap_b32 v209, v210
    v_add_f32 v163, v163, v208
    v_add_f32 v209, v209, v210
    v_permlane16_swap_b32 v12, v152
    v_add_f32 v12, v12, v152
    v_permlane16_swap_b32 v163, v209
    v_add_f32 v163, v163, v209
    v_add_f32_dpp v12, v12, v12 row_ror:8 row_mask:0xf bank_mask:0xf
    v_mfma_f32_16x16x32_bf16 v[8:11], v[172:175], a[84:87], 0
    v_add_f32_dpp v163, v163, v163 row_ror:8 row_mask:0xf bank_mask:0xf
    v_add_f32_dpp v12, v12, v12 row_ror:4 row_mask:0xf bank_mask:0xf
    v_mfma_f32_16x16x32_bf16 v[192:195], v[172:175], a[88:91], 0
    v_add_f32_dpp v163, v163, v163 row_ror:4 row_mask:0xf bank_mask:0xf
    v_add_f32_dpp v12, v12, v12 quad_perm:[2,3,0,1] row_mask:0xf bank_mask:0xf
    v_mfma_f32_16x16x32_bf16 v[164:167], v[176:179], a[84:87], 0
    v_add_f32_dpp v163, v163, v163 quad_perm:[2,3,0,1] row_mask:0xf bank_mask:0xf
    v_mov_b32_dpp v13, v12 quad_perm:[1,0,3,2] row_mask:0xf bank_mask:0xf
    v_mfma_f32_16x16x32_bf16 v[196:199], v[176:179], a[88:91], 0
    v_sub_f32 v152, v12, v13
    v_add_f32_dpp v163, v163, v163 quad_perm:[1,0,3,2] row_mask:0xf bank_mask:0xf
    v_mfma_f32_16x16x32_bf16 v[168:171], v[180:183], a[84:87], 0
    v_add_f32 v12, v12, v13
    v_mul_f32 v12, 0x3b000000, v12
    v_mfma_f32_16x16x32_bf16 v[200:203], v[180:183], a[88:91], 0
    v_mul_f32 v163, 0x3b000000, v163
    v_fma_f32 v163, -v12, v12, v163
    v_mfma_f32_16x16x32_bf16 v[188:191], v[184:187], a[84:87], 0
    v_cvt_pk_bf16_f32 v153, v12, v12
    v_max_f32 v163, 0, v163
    v_mfma_f32_16x16x32_bf16 v[204:207], v[184:187], a[88:91], 0
    v_lshlrev_b32 v12, 16, v153
    v_cvt_pk_bf16_f32 v153, v163, v163
    v_lshlrev_b32 v163, 16, v153
    v_add_f32 v163, 0x3727c5ac, v163
    v_pk_mul_f32 v[212:213], v[8:9], v[56:57]
    v_pk_mul_f32 v[228:229], v[192:193], v[56:57]
    v_pk_mul_f32 v[214:215], v[10:11], v[58:59]
    v_pk_mul_f32 v[230:231], v[194:195], v[58:59]
    v_pk_mul_f32 v[216:217], v[164:165], v[56:57]
    v_pk_mul_f32 v[232:233], v[196:197], v[56:57]
    v_pk_mul_f32 v[218:219], v[166:167], v[58:59]
    v_pk_mul_f32 v[234:235], v[198:199], v[58:59]
    v_pk_mul_f32 v[220:221], v[168:169], v[56:57]
    v_pk_mul_f32 v[236:237], v[200:201], v[56:57]
    v_pk_mul_f32 v[222:223], v[170:171], v[58:59]
    v_pk_mul_f32 v[238:239], v[202:203], v[58:59]
    v_pk_mul_f32 v[224:225], v[188:189], v[56:57]
    v_pk_mul_f32 v[240:241], v[204:205], v[56:57]
    v_pk_mul_f32 v[226:227], v[190:191], v[58:59]
    v_pk_mul_f32 v[242:243], v[206:207], v[58:59]
    v_pk_fma_f32 v[212:213], v[192:193], v[60:61], v[212:213]
    v_pk_fma_f32 v[228:229], v[8:9], v[60:61], v[228:229] neg_lo:[1,0,0] neg_hi:[1,0,0]
    v_pk_fma_f32 v[214:215], v[194:195], v[62:63], v[214:215]
    v_pk_fma_f32 v[230:231], v[10:11], v[62:63], v[230:231] neg_lo:[1,0,0] neg_hi:[1,0,0]
    v_pk_fma_f32 v[216:217], v[196:197], v[60:61], v[216:217]
    v_pk_fma_f32 v[232:233], v[164:165], v[60:61], v[232:233] neg_lo:[1,0,0] neg_hi:[1,0,0]
    v_pk_fma_f32 v[218:219], v[198:199], v[62:63], v[218:219]
    v_pk_fma_f32 v[234:235], v[166:167], v[62:63], v[234:235] neg_lo:[1,0,0] neg_hi:[1,0,0]
    v_pk_fma_f32 v[220:221], v[200:201], v[60:61], v[220:221]
    v_pk_fma_f32 v[236:237], v[168:169], v[60:61], v[236:237] neg_lo:[1,0,0] neg_hi:[1,0,0]
    v_pk_fma_f32 v[222:223], v[202:203], v[62:63], v[222:223]
    v_pk_fma_f32 v[238:239], v[170:171], v[62:63], v[238:239] neg_lo:[1,0,0] neg_hi:[1,0,0]
    v_pk_fma_f32 v[224:225], v[204:205], v[60:61], v[224:225]
    v_pk_fma_f32 v[240:241], v[188:189], v[60:61], v[240:241] neg_lo:[1,0,0] neg_hi:[1,0,0]
    v_pk_fma_f32 v[226:227], v[206:207], v[62:63], v[226:227]
    v_pk_fma_f32 v[242:243], v[190:191], v[62:63], v[242:243] neg_lo:[1,0,0] neg_hi:[1,0,0]
    v_cvt_pk_bf16_f32 v172, v212, v213
    v_cvt_pk_bf16_f32 v173, v214, v215
    v_cvt_pk_bf16_f32 v174, v228, v229
    v_cvt_pk_bf16_f32 v175, v230, v231
    v_cvt_pk_bf16_f32 v176, v216, v217
    v_cvt_pk_bf16_f32 v177, v218, v219
    v_cvt_pk_bf16_f32 v178, v232, v233
    v_cvt_pk_bf16_f32 v179, v234, v235
    v_cvt_pk_bf16_f32 v180, v220, v221
    v_cvt_pk_bf16_f32 v181, v222, v223
    v_cvt_pk_bf16_f32 v182, v236, v237
    v_cvt_pk_bf16_f32 v183, v238, v239
    v_cvt_pk_bf16_f32 v184, v224, v225
    v_cvt_pk_bf16_f32 v185, v226, v227
    v_cvt_pk_bf16_f32 v186, v240, v241
    v_cvt_pk_bf16_f32 v187, v242, v243
    v_cvt_pk_bf16_f32 v153, v163, v163
    v_lshlrev_b32 v163, 16, v153
    v_sqrt_f32 v163, v163
    v_mfma_f32_16x16x32_bf16 v[8:11], a[0:3], v[172:175], 0
    v_cvt_pk_bf16_f32 v153, v163, v163
    v_lshlrev_b32 v163, 16, v153
    v_mfma_f32_16x16x32_bf16 v[164:167], a[0:3], v[176:179], 0
    v_mul_f32 v12, 0x44000000, v12
    v_rcp_f32 v163, v163
    v_mfma_f32_16x16x32_bf16 v[168:171], a[0:3], v[180:183], 0
    v_readlane_b32 s86, v12, 0
    v_readlane_b32 s90, v152, 0
    v_mfma_f32_16x16x32_bf16 v[188:191], a[0:3], v[184:187], 0
    v_readlane_b32 s87, v12, 32
    v_readlane_b32 s91, v152, 32
    v_readlane_b32 s88, v12, 16
    v_readlane_b32 s92, v152, 16
    v_readlane_b32 s89, v12, 48
    v_readlane_b32 s93, v152, 48
    v_readlane_b32 s78, v163, 0
    v_readlane_b32 s80, v163, 32
    v_readlane_b32 s82, v163, 16
    v_readlane_b32 s84, v163, 48
    v_fma_f32 v8, -v47, s86, v8
    v_fma_f32 v9, v47, s90, v9
    v_fma_f32 v164, -v47, s87, v164
    v_fma_f32 v165, v47, s91, v165
    v_fma_f32 v168, -v47, s88, v168
    v_fma_f32 v169, v47, s92, v169
    v_fma_f32 v188, -v47, s89, v188
    v_fma_f32 v189, v47, s93, v189
    v_pk_mul_f32 v[8:9], v[8:9], s[78:79] op_sel_hi:[1,0]
    v_pk_mul_f32 v[164:165], v[164:165], s[80:81] op_sel_hi:[1,0]
    v_pk_mul_f32 v[168:169], v[168:169], s[82:83] op_sel_hi:[1,0]
    v_pk_mul_f32 v[188:189], v[188:189], s[84:85] op_sel_hi:[1,0]
    v_cvt_pk_bf16_f32 v136, v8, v164
    v_cvt_pk_bf16_f32 v137, v168, v188
    v_cvt_pk_bf16_f32 v138, v9, v165
    v_cvt_pk_bf16_f32 v139, v169, v189
    ds_write_b128 v155, v[136:139] offset:16384
    v_pk_mul_f32 v[10:11], v[10:11], s[78:79] op_sel_hi:[1,0]
    v_pk_mul_f32 v[166:167], v[166:167], s[80:81] op_sel_hi:[1,0]
    v_pk_mul_f32 v[170:171], v[170:171], s[82:83] op_sel_hi:[1,0]
    v_pk_mul_f32 v[190:191], v[190:191], s[84:85] op_sel_hi:[1,0]
    v_cvt_pk_bf16_f32 v140, v10, v166
    v_cvt_pk_bf16_f32 v141, v170, v190
    v_cvt_pk_bf16_f32 v142, v11, v167
    v_cvt_pk_bf16_f32 v143, v171, v191
    ds_write_b128 v155, v[140:143] offset:17408
    s_waitcnt lgkmcnt(0)
    s_barrier
    ds_read_b128 v[136:139], v149 offset:16384
    ds_read_b128 v[140:143], v149 offset:20480
    s_waitcnt vmcnt(37)
    v_lshl_or_b32 v164, v17, 16, v15
    s_waitcnt vmcnt(25)
    v_lshl_or_b32 v166, v18, 16, v16
    v_lshl_or_b32 v165, v21, 16, v19
    s_waitcnt vmcnt(23)
    v_lshl_or_b32 v167, v22, 16, v20
    v_lshlrev_b32 v8, 5, v0
    ds_write_b128 v8, v[164:167] offset:32768
    v_lshl_or_b32 v168, v25, 16, v23
    s_waitcnt vmcnt(21)
    v_lshl_or_b32 v170, v26, 16, v24
    v_lshl_or_b32 v169, v29, 16, v27
    s_waitcnt vmcnt(19)
    v_lshl_or_b32 v171, v30, 16, v28
    ds_write_b128 v8, v[168:171] offset:32784
    v_lshlrev_b32 v31, 16, v31
    s_waitcnt lgkmcnt(3)
    buffer_store_dwordx4 v[136:139], v149, s[56:59], s76 offen sc1
    v_lshlrev_b32 v32, 16, v32
    v_lshlrev_b32 v33, 16, v33
    v_lshlrev_b32 v34, 16, v34
    v_lshrrev_b32 v9, 2, v0
    s_waitcnt lgkmcnt(2)
    buffer_store_dwordx4 v[140:143], v149, s[56:59], s77 offen sc1
    v_add_f32 v31, v31, v33
    v_add_f32 v32, v32, v34
    v_lshlrev_b32 v9, 4, v9
    v_and_b32 v4, 3, v0
    v_cmp_gt_u32 vcc, 8, v0
    v_add_f32 v33, v31, v32
    v_lshl_add_u32 v9, v4, 1, v9
    v_mul_f32 v33, 0x3e000000, v33
    v_add_u32 v10, 8256, v9
    v_cvt_pk_bf16_f32 v33, v33, v33
    v_cndmask_b32 v10, v10, v9, vcc
    ds_write_b16 v10, v33 offset:32768
    v_sub_f32 v34, v31, v32
    v_mul_f32 v34, 0x3e000000, v34
    s_waitcnt vmcnt(20)
    v_lshlrev_b32 v35, 16, v35
    s_waitcnt vmcnt(19)
    v_lshlrev_b32 v36, 16, v36
    s_waitcnt vmcnt(18)
    v_lshlrev_b32 v37, 16, v37
    s_waitcnt vmcnt(17)
    v_lshlrev_b32 v38, 16, v38
    v_cvt_pk_bf16_f32 v34, v34, v34
    v_add_u32 v9, 8192, v9
    v_sub_f32 v35, v35, v37
    v_sub_f32 v36, v36, v38
    ds_write_b16 v9, v34 offset:32768
    v_add_f32 v37, v35, v36
    v_mul_f32 v37, 0x3e000000, v37
    v_cvt_pk_bf16_f32 v37, v37, v37
    ds_write_b16 v10, v37 offset:32776
    v_sub_f32 v38, v35, v36
    v_mul_f32 v38, 0x3e000000, v38
    v_cvt_pk_bf16_f32 v38, v38, v38
    ds_write_b16 v9, v38 offset:32776
    s_waitcnt lgkmcnt(0)
    s_barrier
    ds_read_b128 v[10:13], v149 offset:32768
    s_mul_i32 s36, s35, 8256
    s_add_u32 s36, s36, 16777216
    ds_read_b128 v[16:19], v149 offset:36864
    s_add_u32 s37, s36, 4096
    ds_read_b128 v[20:23], v149 offset:40960
    v_cmp_gt_u32 vcc, 2, v0
    v_mov_b32 v4, 0x7ffffff0
    v_add_u32 v8, 8192, v149
    v_cndmask_b32 v8, v4, v8, vcc
    s_mov_b32 s60, s30
    s_mov_b32 s61, s31
    s_mov_b32 s62, 0x100
    s_mov_b32 s63, 0x20000
    s_cmp_lg_u32 s34, 0
    s_waitcnt lgkmcnt(2)
    buffer_store_dwordx4 v[10:13], v149, s[56:59], s36 offen sc1
    s_waitcnt lgkmcnt(1)
    buffer_store_dwordx4 v[16:19], v149, s[56:59], s37 offen sc1
    s_waitcnt lgkmcnt(0)
    buffer_store_dwordx4 v[20:23], v8, s[56:59], s36 offen sc1
    s_waitcnt vmcnt(9)
    s_cbranch_scc1 L_tag_done
    s_mov_b32 s38, 131072
L_tag_poll:
    v_readfirstlane_b32 s44, v6
    s_nop 3
    s_cmp_lg_u32 s44, 0
    s_cbranch_scc1 L_tag_done
    s_sub_u32 s38, s38, 1
    s_cmp_eq_u32 s38, 0
    s_cbranch_scc1 L_tag_done
    buffer_load_dword v6, v7, s[60:63], 0 offen sc1
    s_waitcnt vmcnt(0)
    s_branch L_tag_poll
L_tag_done:
    s_waitcnt vmcnt(0)
    s_barrier
    s_cmp_lg_u32 s34, 0
    s_cbranch_scc1 L_arr_done
    v_cmp_gt_u32 vcc, 8, v1
    v_mov_b32 v4, 0x7ffffff0
    v_lshlrev_b32 v8, 10, v1
    s_lshl_b32 s37, s35, 2
    v_mov_b32 v9, s44
    v_cndmask_b32 v8, v4, v8, vcc
    s_add_u32 s36, s37, 20971520
    buffer_store_dword v9, v8, s[56:59], s36 offen sc1
L_arr_done:
    v_add_u32 v15, 0, v5
    global_load_dwordx4 a[100:103], v15, s[54:55] offset:0
    v_add_u32 v16, 4096, v5
    v_add_u32 v17, 8192, v5
    v_add_u32 v18, 0, v5
    v_add_u32 v19, 4096, v5
    v_add_u32 v20, 8192, v5
    v_add_u32 v21, 8192, v5
    v_add_u32 v22, 12288, v5
    v_add_u32 v23, 16384, v5
    v_readfirstlane_b32 s78, v46
    v_lshlrev_b32 v45, 16, v45
    v_mul_f32 v25, 0x3fb8aa00, v45
    v_exp_f32 v25, v25
    global_load_dwordx4 a[104:107], v15, s[54:55] offset:1024
    s_lshl_b32 s68, s78, 16
    v_mul_f32 v26, 0x36a407db, v45
    s_and_b32 s70, s78, 0xffff0000
    v_fma_f32 v24, v25, v26, v25
    s_cmp_eq_u32 s42, 0
    v_cvt_pk_bf16_f32 v25, v24, v24
    s_cselect_b32 s78, 1.0, 4.0
    v_lshlrev_b32 v24, 16, v25
    v_lshlrev_b32 v28, 16, v40
    v_and_b32 v175, s49, v40
    s_mov_b32 s79, 0x42000000
    v_lshlrev_b32 v27, 16, v39
    v_mul_f32 v28, v24, v28
    global_load_dwordx4 a[108:111], v15, s[54:55] offset:2048
    v_and_b32 v174, s49, v39
    v_mul_f32 v175, v24, v175
    s_cselect_b32 s79, s79, 0x43000000
    v_mul_f32 v27, v24, v27
    v_mul_f32 v28, 0x3e22f983, v28
    v_mul_f32 v174, v24, v174
    v_mul_f32 v175, 0x3e22f983, v175
    s_cselect_b32 s80, 0, 0x44000000
    v_mul_f32 v27, 0x3fb8aa3b, v27
    v_mul_f32 v174, 0x3fb8aa3b, v174
    v_mul_f32 v167, s80, v28
    v_mul_f32 v193, s80, v175
    global_load_dwordx4 a[112:115], v15, s[54:55] offset:3072
    v_mul_f32 v166, s80, v27
    v_fract_f32 v167, v167
    v_mul_f32 v192, s80, v174
    v_fract_f32 v193, v193
    v_lshlrev_b32 v29, 16, v41
    v_lshlrev_b32 v30, 16, v42
    v_and_b32 v176, s49, v41
    v_and_b32 v177, s49, v42
    v_exp_f32 v166, v166
    v_cos_f32 v164, v167
    v_sin_f32 v165, v167
    global_load_dwordx4 a[116:119], v16, s[54:55] offset:0
    v_exp_f32 v192, v192
    v_cos_f32 v190, v193
    v_sin_f32 v191, v193
    v_mul_f32 v38, s78, v28
    v_lshlrev_b32 v31, 16, v43
    v_mul_f32 v29, v24, v29
    v_mul_f32 v30, v24, v30
    v_and_b32 v178, s49, v43
    v_mul_f32 v176, v24, v176
    v_mul_f32 v177, v24, v177
    global_load_dwordx4 a[120:123], v16, s[54:55] offset:1024
    v_mul_f32 v33, s78, v27
    v_fract_f32 v38, v38
    v_lshlrev_b32 v32, 16, v44
    v_mul_f32 v34, v31, v29
    v_mul_f32 v35, v31, v30
    v_and_b32 v179, s49, v44
    v_mul_f32 v180, v178, v176
    v_mul_f32 v181, v178, v177
    v_exp_f32 v33, v33
    v_cos_f32 v36, v38
    v_sin_f32 v37, v38
    global_load_dwordx4 a[124:127], v16, s[54:55] offset:2048
    v_fma_f32 v34, -v32, v30, v34
    v_fma_f32 v35, v32, v29, v35
    v_fma_f32 v180, -v179, v177, v180
    v_fma_f32 v181, v179, v176, v181
    s_mul_i32 s36, s41, 50688
    v_mul_f32 v164, v166, v164
    v_mul_f32 v165, v166, v165
    v_mul_f32 v190, v192, v190
    v_mul_f32 v191, v192, v191
    s_mul_i32 s37, s42, 25344
    v_pk_mul_f32 v[172:173], v[34:35], v[164:165] op_sel:[0,0] op_sel_hi:[1,0]
    v_pk_mul_f32 v[198:199], v[180:181], v[190:191] op_sel:[0,0] op_sel_hi:[1,0]
    global_load_dwordx4 a[128:131], v16, s[54:55] offset:3072
    s_add_u32 s36, s36, s37
    v_pk_fma_f32 v[170:171], v[34:35], v[164:165], v[172:173] op_sel:[1,1,0] op_sel_hi:[0,1,1] neg_lo:[1,0,0]
    v_pk_fma_f32 v[196:197], v[180:181], v[190:191], v[198:199] op_sel:[1,1,0] op_sel_hi:[0,1,1] neg_lo:[1,0,0]
    v_mul_f32 v36, v33, v36
    v_mul_f32 v37, v33, v37
    s_add_u32 s36, s36, 49152
    v_lshlrev_b32 v200, 3, v1
    v_cvt_pk_bf16_f32 v32, v170, -v171
    v_cvt_pk_bf16_f32 v33, v196, -v197
    v_add_u32 v200, s36, v200
    ds_write_b64 v200, v[32:33] offset:0
    global_load_dwordx4 a[132:135], v17, s[54:55] offset:0
    v_mul_f32 v185, s78, v175
    v_mul_f32 v184, s78, v174
    v_fract_f32 v185, v185
    v_exp_f32 v184, v184
    v_cos_f32 v182, v185
    v_sin_f32 v183, v185
    v_mov_b32 v168, 1.0
    v_mov_b32 v169, 0
    v_mov_b32 v194, 1.0
    v_mov_b32 v195, 0
    global_load_dwordx4 a[136:139], v17, s[54:55] offset:1024
    v_cvt_pk_bf16_f32 v34, v168, v169
    v_cvt_pk_bf16_f32 v35, v194, v195
    ds_write_b64 v200, v[34:35] offset:8448
    v_mul_f32 v46, s79, v27
    v_mul_f32 v163, s79, v28
    v_mul_f32 v182, v184, v182
    v_mul_f32 v183, v184, v183
    v_mul_f32 v189, s79, v175
    v_fract_f32 v163, v163
    global_load_dwordx4 a[4:7], v18, s[50:51] offset:1024
    v_mul_f32 v188, s79, v174
    v_fract_f32 v189, v189
    v_pk_mul_f32 v[24:25], v[168:169], v[36:37] op_sel:[0,0] op_sel_hi:[1,0]
    v_pk_mul_f32 v[26:27], v[194:195], v[182:183] op_sel:[0,0] op_sel_hi:[1,0]
    v_exp_f32 v46, v46
    v_cos_f32 v152, v163
    v_sin_f32 v153, v163
    v_exp_f32 v188, v188
    v_cos_f32 v186, v189
    global_load_dwordx4 a[8:11], v18, s[50:51] offset:2048
    v_sin_f32 v187, v189
    v_pk_fma_f32 v[168:169], v[168:169], v[36:37], v[24:25] op_sel:[1,1,0] op_sel_hi:[0,1,1] neg_lo:[1,0,0]
    v_pk_fma_f32 v[194:195], v[194:195], v[182:183], v[26:27] op_sel:[1,1,0] op_sel_hi:[0,1,1] neg_lo:[1,0,0]
    v_cvt_pk_bf16_f32 v38, v168, v169
    v_cvt_pk_bf16_f32 v39, v194, v195
    ds_write_b64 v200, v[38:39] offset:8976
    v_mul_f32 v152, v46, v152
    global_load_dwordx4 a[12:15], v18, s[50:51] offset:3072
    v_mul_f32 v153, v46, v153
    v_mul_f32 v186, v188, v186
    v_mul_f32 v187, v188, v187
    v_pk_mul_f32 v[28:29], v[170:171], v[152:153] op_sel:[0,0] op_sel_hi:[1,0]
    v_pk_mul_f32 v[30:31], v[196:197], v[186:187] op_sel:[0,0] op_sel_hi:[1,0]
    v_pk_fma_f32 v[170:171], v[170:171], v[152:153], v[28:29] op_sel:[1,1,0] op_sel_hi:[0,1,1] neg_lo:[1,0,0]
    v_pk_fma_f32 v[196:197], v[196:197], v[186:187], v[30:31] op_sel:[1,1,0] op_sel_hi:[0,1,1] neg_lo:[1,0,0]
    v_cvt_pk_bf16_f32 v40, v170, -v171
    v_cvt_pk_bf16_f32 v41, v196, -v197
    ds_write_b64 v200, v[40:41] offset:528
    global_load_dwordx4 a[16:19], v19, s[50:51] offset:0
    v_pk_mul_f32 v[24:25], v[168:169], v[36:37] op_sel:[0,0] op_sel_hi:[1,0]
    v_pk_mul_f32 v[26:27], v[194:195], v[182:183] op_sel:[0,0] op_sel_hi:[1,0]
    v_pk_fma_f32 v[168:169], v[168:169], v[36:37], v[24:25] op_sel:[1,1,0] op_sel_hi:[0,1,1] neg_lo:[1,0,0]
    v_pk_fma_f32 v[194:195], v[194:195], v[182:183], v[26:27] op_sel:[1,1,0] op_sel_hi:[0,1,1] neg_lo:[1,0,0]
    v_cvt_pk_bf16_f32 v42, v168, v169
    v_cvt_pk_bf16_f32 v43, v194, v195
    ds_write_b64 v200, v[42:43] offset:9504
    v_pk_mul_f32 v[24:25], v[168:169], v[36:37] op_sel:[0,0] op_sel_hi:[1,0]
    global_load_dwordx4 a[20:23], v19, s[50:51] offset:1024
    v_pk_mul_f32 v[26:27], v[194:195], v[182:183] op_sel:[0,0] op_sel_hi:[1,0]
    v_pk_fma_f32 v[168:169], v[168:169], v[36:37], v[24:25] op_sel:[1,1,0] op_sel_hi:[0,1,1] neg_lo:[1,0,0]
    v_pk_fma_f32 v[194:195], v[194:195], v[182:183], v[26:27] op_sel:[1,1,0] op_sel_hi:[0,1,1] neg_lo:[1,0,0]
    v_cvt_pk_bf16_f32 v44, v168, v169
    v_cvt_pk_bf16_f32 v45, v194, v195
    ds_write_b64 v200, v[44:45] offset:10032
    v_pk_mul_f32 v[28:29], v[170:171], v[152:153] op_sel:[0,0] op_sel_hi:[1,0]
    v_pk_mul_f32 v[30:31], v[196:197], v[186:187] op_sel:[0,0] op_sel_hi:[1,0]
    global_load_dwordx4 a[24:27], v19, s[50:51] offset:2048
    v_pk_fma_f32 v[170:171], v[170:171], v[152:153], v[28:29] op_sel:[1,1,0] op_sel_hi:[0,1,1] neg_lo:[1,0,0]
    v_pk_fma_f32 v[196:197], v[196:197], v[186:187], v[30:31] op_sel:[1,1,0] op_sel_hi:[0,1,1] neg_lo:[1,0,0]
    v_cvt_pk_bf16_f32 v32, v170, -v171
    v_cvt_pk_bf16_f32 v33, v196, -v197
    ds_write_b64 v200, v[32:33] offset:1056
    v_pk_mul_f32 v[24:25], v[168:169], v[36:37] op_sel:[0,0] op_sel_hi:[1,0]
    v_pk_mul_f32 v[26:27], v[194:195], v[182:183] op_sel:[0,0] op_sel_hi:[1,0]
    v_pk_fma_f32 v[168:169], v[168:169], v[36:37], v[24:25] op_sel:[1,1,0] op_sel_hi:[0,1,1] neg_lo:[1,0,0]
    global_load_dwordx4 a[28:31], v19, s[50:51] offset:3072
    v_pk_fma_f32 v[194:195], v[194:195], v[182:183], v[26:27] op_sel:[1,1,0] op_sel_hi:[0,1,1] neg_lo:[1,0,0]
    v_cvt_pk_bf16_f32 v34, v168, v169
    v_cvt_pk_bf16_f32 v35, v194, v195
    ds_write_b64 v200, v[34:35] offset:10560
    v_pk_mul_f32 v[24:25], v[168:169], v[36:37] op_sel:[0,0] op_sel_hi:[1,0]
    v_pk_mul_f32 v[26:27], v[194:195], v[182:183] op_sel:[0,0] op_sel_hi:[1,0]
    v_pk_fma_f32 v[168:169], v[168:169], v[36:37], v[24:25] op_sel:[1,1,0] op_sel_hi:[0,1,1] neg_lo:[1,0,0]
    v_pk_fma_f32 v[194:195], v[194:195], v[182:183], v[26:27] op_sel:[1,1,0] op_sel_hi:[0,1,1] neg_lo:[1,0,0]
    global_load_dwordx4 a[32:35], v20, s[50:51] offset:0
    v_cvt_pk_bf16_f32 v38, v168, v169
    v_cvt_pk_bf16_f32 v39, v194, v195
    ds_write_b64 v200, v[38:39] offset:11088
    v_pk_mul_f32 v[28:29], v[170:171], v[152:153] op_sel:[0,0] op_sel_hi:[1,0]
    v_pk_mul_f32 v[30:31], v[196:197], v[186:187] op_sel:[0,0] op_sel_hi:[1,0]
    v_pk_fma_f32 v[170:171], v[170:171], v[152:153], v[28:29] op_sel:[1,1,0] op_sel_hi:[0,1,1] neg_lo:[1,0,0]
    v_pk_fma_f32 v[196:197], v[196:197], v[186:187], v[30:31] op_sel:[1,1,0] op_sel_hi:[0,1,1] neg_lo:[1,0,0]
    v_cvt_pk_bf16_f32 v40, v170, -v171
    global_load_dwordx4 a[36:39], v20, s[50:51] offset:1024
    v_cvt_pk_bf16_f32 v41, v196, -v197
    ds_write_b64 v200, v[40:41] offset:1584
    v_pk_mul_f32 v[24:25], v[168:169], v[36:37] op_sel:[0,0] op_sel_hi:[1,0]
    v_pk_mul_f32 v[26:27], v[194:195], v[182:183] op_sel:[0,0] op_sel_hi:[1,0]
    v_pk_fma_f32 v[168:169], v[168:169], v[36:37], v[24:25] op_sel:[1,1,0] op_sel_hi:[0,1,1] neg_lo:[1,0,0]
    v_pk_fma_f32 v[194:195], v[194:195], v[182:183], v[26:27] op_sel:[1,1,0] op_sel_hi:[0,1,1] neg_lo:[1,0,0]
    v_cvt_pk_bf16_f32 v42, v168, v169
    v_cvt_pk_bf16_f32 v43, v194, v195
    global_load_dwordx4 a[40:43], v20, s[50:51] offset:2048
    ds_write_b64 v200, v[42:43] offset:11616
    v_pk_mul_f32 v[24:25], v[168:169], v[36:37] op_sel:[0,0] op_sel_hi:[1,0]
    v_pk_mul_f32 v[26:27], v[194:195], v[182:183] op_sel:[0,0] op_sel_hi:[1,0]
    v_pk_fma_f32 v[168:169], v[168:169], v[36:37], v[24:25] op_sel:[1,1,0] op_sel_hi:[0,1,1] neg_lo:[1,0,0]
    v_pk_fma_f32 v[194:195], v[194:195], v[182:183], v[26:27] op_sel:[1,1,0] op_sel_hi:[0,1,1] neg_lo:[1,0,0]
    v_cvt_pk_bf16_f32 v44, v168, v169
    v_cvt_pk_bf16_f32 v45, v194, v195
    ds_write_b64 v200, v[44:45] offset:12144
    global_load_dwordx4 a[140:143], v21, s[54:55] offset:2048
    v_pk_mul_f32 v[28:29], v[170:171], v[152:153] op_sel:[0,0] op_sel_hi:[1,0]
    v_pk_mul_f32 v[30:31], v[196:197], v[186:187] op_sel:[0,0] op_sel_hi:[1,0]
    v_pk_fma_f32 v[170:171], v[170:171], v[152:153], v[28:29] op_sel:[1,1,0] op_sel_hi:[0,1,1] neg_lo:[1,0,0]
    v_pk_fma_f32 v[196:197], v[196:197], v[186:187], v[30:31] op_sel:[1,1,0] op_sel_hi:[0,1,1] neg_lo:[1,0,0]
    v_cvt_pk_bf16_f32 v32, v170, -v171
    v_cvt_pk_bf16_f32 v33, v196, -v197
    ds_write_b64 v200, v[32:33] offset:2112
    v_pk_mul_f32 v[24:25], v[168:169], v[36:37] op_sel:[0,0] op_sel_hi:[1,0]
    global_load_dwordx4 a[144:147], v21, s[54:55] offset:3072
    v_pk_mul_f32 v[26:27], v[194:195], v[182:183] op_sel:[0,0] op_sel_hi:[1,0]
    v_pk_fma_f32 v[168:169], v[168:169], v[36:37], v[24:25] op_sel:[1,1,0] op_sel_hi:[0,1,1] neg_lo:[1,0,0]
    v_pk_fma_f32 v[194:195], v[194:195], v[182:183], v[26:27] op_sel:[1,1,0] op_sel_hi:[0,1,1] neg_lo:[1,0,0]
    v_cvt_pk_bf16_f32 v34, v168, v169
    v_cvt_pk_bf16_f32 v35, v194, v195
    ds_write_b64 v200, v[34:35] offset:12672
    v_pk_mul_f32 v[24:25], v[168:169], v[36:37] op_sel:[0,0] op_sel_hi:[1,0]
    v_pk_mul_f32 v[26:27], v[194:195], v[182:183] op_sel:[0,0] op_sel_hi:[1,0]
    global_load_dwordx4 a[148:151], v22, s[54:55] offset:0
    v_pk_fma_f32 v[168:169], v[168:169], v[36:37], v[24:25] op_sel:[1,1,0] op_sel_hi:[0,1,1] neg_lo:[1,0,0]
    v_pk_fma_f32 v[194:195], v[194:195], v[182:183], v[26:27] op_sel:[1,1,0] op_sel_hi:[0,1,1] neg_lo:[1,0,0]
    v_cvt_pk_bf16_f32 v38, v168, v169
    v_cvt_pk_bf16_f32 v39, v194, v195
    ds_write_b64 v200, v[38:39] offset:13200
    v_pk_mul_f32 v[28:29], v[170:171], v[152:153] op_sel:[0,0] op_sel_hi:[1,0]
    v_pk_mul_f32 v[30:31], v[196:197], v[186:187] op_sel:[0,0] op_sel_hi:[1,0]
    v_pk_fma_f32 v[170:171], v[170:171], v[152:153], v[28:29] op_sel:[1,1,0] op_sel_hi:[0,1,1] neg_lo:[1,0,0]
    global_load_dwordx4 a[152:155], v22, s[54:55] offset:1024
    v_pk_fma_f32 v[196:197], v[196:197], v[186:187], v[30:31] op_sel:[1,1,0] op_sel_hi:[0,1,1] neg_lo:[1,0,0]
    v_cvt_pk_bf16_f32 v40, v170, -v171
    v_cvt_pk_bf16_f32 v41, v196, -v197
    ds_write_b64 v200, v[40:41] offset:2640
    v_pk_mul_f32 v[24:25], v[168:169], v[36:37] op_sel:[0,0] op_sel_hi:[1,0]
    v_pk_mul_f32 v[26:27], v[194:195], v[182:183] op_sel:[0,0] op_sel_hi:[1,0]
    v_pk_fma_f32 v[168:169], v[168:169], v[36:37], v[24:25] op_sel:[1,1,0] op_sel_hi:[0,1,1] neg_lo:[1,0,0]
    v_pk_fma_f32 v[194:195], v[194:195], v[182:183], v[26:27] op_sel:[1,1,0] op_sel_hi:[0,1,1] neg_lo:[1,0,0]
    global_load_dwordx4 a[156:159], v22, s[54:55] offset:2048
    v_cvt_pk_bf16_f32 v42, v168, v169
    v_cvt_pk_bf16_f32 v43, v194, v195
    ds_write_b64 v200, v[42:43] offset:13728
    v_pk_mul_f32 v[24:25], v[168:169], v[36:37] op_sel:[0,0] op_sel_hi:[1,0]
    v_pk_mul_f32 v[26:27], v[194:195], v[182:183] op_sel:[0,0] op_sel_hi:[1,0]
    v_pk_fma_f32 v[168:169], v[168:169], v[36:37], v[24:25] op_sel:[1,1,0] op_sel_hi:[0,1,1] neg_lo:[1,0,0]
    v_pk_fma_f32 v[194:195], v[194:195], v[182:183], v[26:27] op_sel:[1,1,0] op_sel_hi:[0,1,1] neg_lo:[1,0,0]
    v_cvt_pk_bf16_f32 v44, v168, v169
    global_load_dwordx4 a[160:163], v22, s[54:55] offset:3072
    v_cvt_pk_bf16_f32 v45, v194, v195
    ds_write_b64 v200, v[44:45] offset:14256
    v_pk_mul_f32 v[28:29], v[170:171], v[152:153] op_sel:[0,0] op_sel_hi:[1,0]
    v_pk_mul_f32 v[30:31], v[196:197], v[186:187] op_sel:[0,0] op_sel_hi:[1,0]
    v_pk_fma_f32 v[170:171], v[170:171], v[152:153], v[28:29] op_sel:[1,1,0] op_sel_hi:[0,1,1] neg_lo:[1,0,0]
    v_pk_fma_f32 v[196:197], v[196:197], v[186:187], v[30:31] op_sel:[1,1,0] op_sel_hi:[0,1,1] neg_lo:[1,0,0]
    v_cvt_pk_bf16_f32 v32, v170, -v171
    v_cvt_pk_bf16_f32 v33, v196, -v197
    global_load_dwordx4 a[164:167], v23, s[54:55] offset:0
    ds_write_b64 v200, v[32:33] offset:3168
    v_pk_mul_f32 v[24:25], v[168:169], v[36:37] op_sel:[0,0] op_sel_hi:[1,0]
    v_pk_mul_f32 v[26:27], v[194:195], v[182:183] op_sel:[0,0] op_sel_hi:[1,0]
    v_pk_fma_f32 v[168:169], v[168:169], v[36:37], v[24:25] op_sel:[1,1,0] op_sel_hi:[0,1,1] neg_lo:[1,0,0]
    v_pk_fma_f32 v[194:195], v[194:195], v[182:183], v[26:27] op_sel:[1,1,0] op_sel_hi:[0,1,1] neg_lo:[1,0,0]
    v_cvt_pk_bf16_f32 v34, v168, v169
    v_cvt_pk_bf16_f32 v35, v194, v195
    ds_write_b64 v200, v[34:35] offset:14784
    global_load_dwordx4 a[168:171], v23, s[54:55] offset:1024
    v_pk_mul_f32 v[24:25], v[168:169], v[36:37] op_sel:[0,0] op_sel_hi:[1,0]
    v_pk_mul_f32 v[26:27], v[194:195], v[182:183] op_sel:[0,0] op_sel_hi:[1,0]
    v_pk_fma_f32 v[168:169], v[168:169], v[36:37], v[24:25] op_sel:[1,1,0] op_sel_hi:[0,1,1] neg_lo:[1,0,0]
    v_pk_fma_f32 v[194:195], v[194:195], v[182:183], v[26:27] op_sel:[1,1,0] op_sel_hi:[0,1,1] neg_lo:[1,0,0]
    v_cvt_pk_bf16_f32 v38, v168, v169
    v_cvt_pk_bf16_f32 v39, v194, v195
    ds_write_b64 v200, v[38:39] offset:15312
    v_pk_mul_f32 v[28:29], v[170:171], v[152:153] op_sel:[0,0] op_sel_hi:[1,0]
    v_pk_mul_f32 v[30:31], v[196:197], v[186:187] op_sel:[0,0] op_sel_hi:[1,0]
    v_pk_fma_f32 v[170:171], v[170:171], v[152:153], v[28:29] op_sel:[1,1,0] op_sel_hi:[0,1,1] neg_lo:[1,0,0]
    v_pk_fma_f32 v[196:197], v[196:197], v[186:187], v[30:31] op_sel:[1,1,0] op_sel_hi:[0,1,1] neg_lo:[1,0,0]
    v_cvt_pk_bf16_f32 v40, v170, -v171
    v_cvt_pk_bf16_f32 v41, v196, -v197
    ds_write_b64 v200, v[40:41] offset:3696
    v_pk_mul_f32 v[24:25], v[168:169], v[36:37] op_sel:[0,0] op_sel_hi:[1,0]
    v_pk_mul_f32 v[26:27], v[194:195], v[182:183] op_sel:[0,0] op_sel_hi:[1,0]
    v_pk_fma_f32 v[168:169], v[168:169], v[36:37], v[24:25] op_sel:[1,1,0] op_sel_hi:[0,1,1] neg_lo:[1,0,0]
    v_pk_fma_f32 v[194:195], v[194:195], v[182:183], v[26:27] op_sel:[1,1,0] op_sel_hi:[0,1,1] neg_lo:[1,0,0]
    v_cvt_pk_bf16_f32 v42, v168, v169
    v_cvt_pk_bf16_f32 v43, v194, v195
    ds_write_b64 v200, v[42:43] offset:15840
    v_pk_mul_f32 v[24:25], v[168:169], v[36:37] op_sel:[0,0] op_sel_hi:[1,0]
    v_pk_mul_f32 v[26:27], v[194:195], v[182:183] op_sel:[0,0] op_sel_hi:[1,0]
    v_pk_fma_f32 v[168:169], v[168:169], v[36:37], v[24:25] op_sel:[1,1,0] op_sel_hi:[0,1,1] neg_lo:[1,0,0]
    v_pk_fma_f32 v[194:195], v[194:195], v[182:183], v[26:27] op_sel:[1,1,0] op_sel_hi:[0,1,1] neg_lo:[1,0,0]
    v_cvt_pk_bf16_f32 v44, v168, v169
    v_cvt_pk_bf16_f32 v45, v194, v195
    ds_write_b64 v200, v[44:45] offset:16368
    v_pk_mul_f32 v[28:29], v[170:171], v[152:153] op_sel:[0,0] op_sel_hi:[1,0]
    v_pk_mul_f32 v[30:31], v[196:197], v[186:187] op_sel:[0,0] op_sel_hi:[1,0]
    v_pk_mul_f32 v[24:25], v[168:169], v[36:37] op_sel:[0,0] op_sel_hi:[1,0]
    v_pk_mul_f32 v[26:27], v[194:195], v[182:183] op_sel:[0,0] op_sel_hi:[1,0]
    v_pk_fma_f32 v[170:171], v[170:171], v[152:153], v[28:29] op_sel:[1,1,0] op_sel_hi:[0,1,1] neg_lo:[1,0,0]
    v_pk_fma_f32 v[196:197], v[196:197], v[186:187], v[30:31] op_sel:[1,1,0] op_sel_hi:[0,1,1] neg_lo:[1,0,0]
    v_pk_fma_f32 v[168:169], v[168:169], v[36:37], v[24:25] op_sel:[1,1,0] op_sel_hi:[0,1,1] neg_lo:[1,0,0]
    v_pk_fma_f32 v[194:195], v[194:195], v[182:183], v[26:27] op_sel:[1,1,0] op_sel_hi:[0,1,1] neg_lo:[1,0,0]
    s_cmp_lg_u32 s34, 0
    s_cbranch_scc1 L_wt_done
    s_mov_b32 s38, 131072
    s_and_b32 s37, s2, 7
    s_lshl_b32 s37, s37, 10
    s_add_u32 s36, s37, 20971520
L_wtl:
    buffer_load_dwordx4 v[10:13], v5, s[56:59], s36 offen sc1
    s_sub_u32 s38, s38, 1
    s_cmp_eq_u32 s38, 0
    s_cbranch_scc1 L_wt_done
    s_waitcnt vmcnt(0)
    v_xor_b32 v10, s44, v10
    v_xor_b32 v11, s44, v11
    v_xor_b32 v12, s44, v12
    v_or3_b32 v10, v10, v11, v12
    v_xor_b32 v13, s44, v13
    v_or_b32 v10, v10, v13
    v_cmp_ne_u32 vcc, 0, v10
    s_nop 0
    s_cbranch_vccnz L_wtl
L_wt_done:
    s_waitcnt lgkmcnt(0)
    s_barrier
    s_add_u32 s72, s67, 0
    s_add_u32 s73, s67, 1048576
    s_waitcnt vmcnt(0)
    v_accvgpr_read_b32 v56, a140
    v_accvgpr_read_b32 v57, a141
    v_accvgpr_read_b32 v58, a142
    v_accvgpr_read_b32 v59, a143
    v_accvgpr_read_b32 v60, a144
    v_accvgpr_read_b32 v61, a145
    v_accvgpr_read_b32 v62, a146
    v_accvgpr_read_b32 v63, a147
    v_accvgpr_read_b32 v64, a148
    v_accvgpr_read_b32 v65, a149
    v_accvgpr_read_b32 v66, a150
    v_accvgpr_read_b32 v67, a151
    v_accvgpr_read_b32 v68, a152
    v_accvgpr_read_b32 v69, a153
    v_accvgpr_read_b32 v70, a154
    v_accvgpr_read_b32 v71, a155
    v_accvgpr_read_b32 v72, a156
    v_accvgpr_read_b32 v73, a157
    v_accvgpr_read_b32 v74, a158
    v_accvgpr_read_b32 v75, a159
    v_accvgpr_read_b32 v76, a160
    v_accvgpr_read_b32 v77, a161
    v_accvgpr_read_b32 v78, a162
    v_accvgpr_read_b32 v79, a163
    v_accvgpr_read_b32 v80, a164
    v_accvgpr_read_b32 v81, a165
    v_accvgpr_read_b32 v82, a166
    v_accvgpr_read_b32 v83, a167
    v_accvgpr_read_b32 v84, a168
    v_accvgpr_read_b32 v85, a169
    v_accvgpr_read_b32 v86, a170
    v_accvgpr_read_b32 v87, a171
    s_nop 0
    buffer_load_dwordx4 v[48:51], v150, s[56:59], s72 offen sc1
    s_add_u32 s74, s65, 8388608
    v_lshrrev_b32 v15, 1, v0
    s_add_u32 s75, s65, 8392704
    v_mul_u32_u24 v15, 8256, v15
    v_and_b32 v4, 1, v0
    s_add_u32 s76, s66, 4194304
    v_lshl_add_u32 v15, v4, 4, v15
    s_add_u32 s36, s67, 16777216
    s_add_u32 s37, s36, 1056768
    s_cmp_lg_u32 s35, 0
    buffer_load_dwordx4 v[52:55], v150, s[56:59], s73 offen sc1
    buffer_load_dwordx4 v[6:9], v15, s[56:59], s36 offen sc1
    buffer_load_dwordx4 v[10:13], v15, s[56:59], s37 offen sc1
    s_cbranch_scc1 L_no256
    s_mov_b32 s36, 16785408
    buffer_load_dwordx4 v[32:35], v15, s[56:59], s36 offen sc1
    s_mov_b32 s37, 17842176
    buffer_load_dwordx4 v[38:41], v15, s[56:59], s37 offen sc1
    s_nop 0
L_no256:
    v_cvt_pk_bf16_f32 v172, v170, -v171
    v_cvt_pk_bf16_f32 v173, v196, -v197
    ds_write_b64 v200, v[172:173] offset:4224
    v_cvt_pk_bf16_f32 v174, v168, v169
    v_cvt_pk_bf16_f32 v175, v194, v195
    ds_write_b64 v200, v[174:175] offset:16896
    v_pk_mul_f32 v[42:43], v[168:169], v[36:37] op_sel:[0,0] op_sel_hi:[1,0]
    v_pk_mul_f32 v[44:45], v[194:195], v[182:183] op_sel:[0,0] op_sel_hi:[1,0]
    v_pk_fma_f32 v[168:169], v[168:169], v[36:37], v[42:43] op_sel:[1,1,0] op_sel_hi:[0,1,1] neg_lo:[1,0,0]
    v_pk_fma_f32 v[194:195], v[194:195], v[182:183], v[44:45] op_sel:[1,1,0] op_sel_hi:[0,1,1] neg_lo:[1,0,0]
    v_cvt_pk_bf16_f32 v176, v168, v169
    v_cvt_pk_bf16_f32 v177, v194, v195
    ds_write_b64 v200, v[176:177] offset:17424
    v_pk_mul_f32 v[164:165], v[170:171], v[152:153] op_sel:[0,0] op_sel_hi:[1,0]
    v_pk_mul_f32 v[166:167], v[196:197], v[186:187] op_sel:[0,0] op_sel_hi:[1,0]
    v_pk_fma_f32 v[170:171], v[170:171], v[152:153], v[164:165] op_sel:[1,1,0] op_sel_hi:[0,1,1] neg_lo:[1,0,0]
    v_pk_fma_f32 v[196:197], v[196:197], v[186:187], v[166:167] op_sel:[1,1,0] op_sel_hi:[0,1,1] neg_lo:[1,0,0]
    v_cvt_pk_bf16_f32 v178, v170, -v171
    v_cvt_pk_bf16_f32 v179, v196, -v197
    ds_write_b64 v200, v[178:179] offset:4752
    v_pk_mul_f32 v[42:43], v[168:169], v[36:37] op_sel:[0,0] op_sel_hi:[1,0]
    v_pk_mul_f32 v[44:45], v[194:195], v[182:183] op_sel:[0,0] op_sel_hi:[1,0]
    v_pk_fma_f32 v[168:169], v[168:169], v[36:37], v[42:43] op_sel:[1,1,0] op_sel_hi:[0,1,1] neg_lo:[1,0,0]
    v_pk_fma_f32 v[194:195], v[194:195], v[182:183], v[44:45] op_sel:[1,1,0] op_sel_hi:[0,1,1] neg_lo:[1,0,0]
    v_cvt_pk_bf16_f32 v180, v168, v169
    v_cvt_pk_bf16_f32 v181, v194, v195
    ds_write_b64 v200, v[180:181] offset:17952
    v_pk_mul_f32 v[42:43], v[168:169], v[36:37] op_sel:[0,0] op_sel_hi:[1,0]
    v_pk_mul_f32 v[44:45], v[194:195], v[182:183] op_sel:[0,0] op_sel_hi:[1,0]
    v_pk_fma_f32 v[168:169], v[168:169], v[36:37], v[42:43] op_sel:[1,1,0] op_sel_hi:[0,1,1] neg_lo:[1,0,0]
    v_pk_fma_f32 v[194:195], v[194:195], v[182:183], v[44:45] op_sel:[1,1,0] op_sel_hi:[0,1,1] neg_lo:[1,0,0]
    v_cvt_pk_bf16_f32 v184, v168, v169
    v_cvt_pk_bf16_f32 v185, v194, v195
    ds_write_b64 v200, v[184:185] offset:18480
    v_pk_mul_f32 v[164:165], v[170:171], v[152:153] op_sel:[0,0] op_sel_hi:[1,0]
    v_pk_mul_f32 v[166:167], v[196:197], v[186:187] op_sel:[0,0] op_sel_hi:[1,0]
    v_pk_fma_f32 v[170:171], v[170:171], v[152:153], v[164:165] op_sel:[1,1,0] op_sel_hi:[0,1,1] neg_lo:[1,0,0]
    v_pk_fma_f32 v[196:197], v[196:197], v[186:187], v[166:167] op_sel:[1,1,0] op_sel_hi:[0,1,1] neg_lo:[1,0,0]
    v_cvt_pk_bf16_f32 v172, v170, -v171
    v_cvt_pk_bf16_f32 v173, v196, -v197
    ds_write_b64 v200, v[172:173] offset:5280
    v_pk_mul_f32 v[42:43], v[168:169], v[36:37] op_sel:[0,0] op_sel_hi:[1,0]
    v_pk_mul_f32 v[44:45], v[194:195], v[182:183] op_sel:[0,0] op_sel_hi:[1,0]
    v_pk_fma_f32 v[168:169], v[168:169], v[36:37], v[42:43] op_sel:[1,1,0] op_sel_hi:[0,1,1] neg_lo:[1,0,0]
    v_pk_fma_f32 v[194:195], v[194:195], v[182:183], v[44:45] op_sel:[1,1,0] op_sel_hi:[0,1,1] neg_lo:[1,0,0]
    v_cvt_pk_bf16_f32 v174, v168, v169
    v_cvt_pk_bf16_f32 v175, v194, v195
    ds_write_b64 v200, v[174:175] offset:19008
    v_pk_mul_f32 v[42:43], v[168:169], v[36:37] op_sel:[0,0] op_sel_hi:[1,0]
    v_pk_mul_f32 v[44:45], v[194:195], v[182:183] op_sel:[0,0] op_sel_hi:[1,0]
    v_pk_fma_f32 v[168:169], v[168:169], v[36:37], v[42:43] op_sel:[1,1,0] op_sel_hi:[0,1,1] neg_lo:[1,0,0]
    v_pk_fma_f32 v[194:195], v[194:195], v[182:183], v[44:45] op_sel:[1,1,0] op_sel_hi:[0,1,1] neg_lo:[1,0,0]
    v_cvt_pk_bf16_f32 v176, v168, v169
    v_cvt_pk_bf16_f32 v177, v194, v195
    ds_write_b64 v200, v[176:177] offset:19536
    v_pk_mul_f32 v[164:165], v[170:171], v[152:153] op_sel:[0,0] op_sel_hi:[1,0]
    v_pk_mul_f32 v[166:167], v[196:197], v[186:187] op_sel:[0,0] op_sel_hi:[1,0]
    v_pk_fma_f32 v[170:171], v[170:171], v[152:153], v[164:165] op_sel:[1,1,0] op_sel_hi:[0,1,1] neg_lo:[1,0,0]
    v_pk_fma_f32 v[196:197], v[196:197], v[186:187], v[166:167] op_sel:[1,1,0] op_sel_hi:[0,1,1] neg_lo:[1,0,0]
    v_cvt_pk_bf16_f32 v178, v170, -v171
    v_cvt_pk_bf16_f32 v179, v196, -v197
    ds_write_b64 v200, v[178:179] offset:5808
    v_pk_mul_f32 v[42:43], v[168:169], v[36:37] op_sel:[0,0] op_sel_hi:[1,0]
    v_pk_mul_f32 v[44:45], v[194:195], v[182:183] op_sel:[0,0] op_sel_hi:[1,0]
    v_pk_fma_f32 v[168:169], v[168:169], v[36:37], v[42:43] op_sel:[1,1,0] op_sel_hi:[0,1,1] neg_lo:[1,0,0]
    v_pk_fma_f32 v[194:195], v[194:195], v[182:183], v[44:45] op_sel:[1,1,0] op_sel_hi:[0,1,1] neg_lo:[1,0,0]
    v_cvt_pk_bf16_f32 v180, v168, v169
    v_cvt_pk_bf16_f32 v181, v194, v195
    ds_write_b64 v200, v[180:181] offset:20064
    v_pk_mul_f32 v[42:43], v[168:169], v[36:37] op_sel:[0,0] op_sel_hi:[1,0]
    v_pk_mul_f32 v[44:45], v[194:195], v[182:183] op_sel:[0,0] op_sel_hi:[1,0]
    v_pk_fma_f32 v[168:169], v[168:169], v[36:37], v[42:43] op_sel:[1,1,0] op_sel_hi:[0,1,1] neg_lo:[1,0,0]
    v_pk_fma_f32 v[194:195], v[194:195], v[182:183], v[44:45] op_sel:[1,1,0] op_sel_hi:[0,1,1] neg_lo:[1,0,0]
    v_cvt_pk_bf16_f32 v184, v168, v169
    v_cvt_pk_bf16_f32 v185, v194, v195
    ds_write_b64 v200, v[184:185] offset:20592
    v_pk_mul_f32 v[164:165], v[170:171], v[152:153] op_sel:[0,0] op_sel_hi:[1,0]
    v_pk_mul_f32 v[166:167], v[196:197], v[186:187] op_sel:[0,0] op_sel_hi:[1,0]
    v_pk_fma_f32 v[170:171], v[170:171], v[152:153], v[164:165] op_sel:[1,1,0] op_sel_hi:[0,1,1] neg_lo:[1,0,0]
    v_pk_fma_f32 v[196:197], v[196:197], v[186:187], v[166:167] op_sel:[1,1,0] op_sel_hi:[0,1,1] neg_lo:[1,0,0]
    v_cvt_pk_bf16_f32 v172, v170, -v171
    v_cvt_pk_bf16_f32 v173, v196, -v197
    ds_write_b64 v200, v[172:173] offset:6336
    v_pk_mul_f32 v[42:43], v[168:169], v[36:37] op_sel:[0,0] op_sel_hi:[1,0]
    v_pk_mul_f32 v[44:45], v[194:195], v[182:183] op_sel:[0,0] op_sel_hi:[1,0]
    v_pk_fma_f32 v[168:169], v[168:169], v[36:37], v[42:43] op_sel:[1,1,0] op_sel_hi:[0,1,1] neg_lo:[1,0,0]
    v_pk_fma_f32 v[194:195], v[194:195], v[182:183], v[44:45] op_sel:[1,1,0] op_sel_hi:[0,1,1] neg_lo:[1,0,0]
    v_cvt_pk_bf16_f32 v174, v168, v169
    v_cvt_pk_bf16_f32 v175, v194, v195
    ds_write_b64 v200, v[174:175] offset:21120
    v_pk_mul_f32 v[42:43], v[168:169], v[36:37] op_sel:[0,0] op_sel_hi:[1,0]
    v_pk_mul_f32 v[44:45], v[194:195], v[182:183] op_sel:[0,0] op_sel_hi:[1,0]
    v_pk_fma_f32 v[168:169], v[168:169], v[36:37], v[42:43] op_sel:[1,1,0] op_sel_hi:[0,1,1] neg_lo:[1,0,0]
    v_pk_fma_f32 v[194:195], v[194:195], v[182:183], v[44:45] op_sel:[1,1,0] op_sel_hi:[0,1,1] neg_lo:[1,0,0]
    v_cvt_pk_bf16_f32 v176, v168, v169
    v_cvt_pk_bf16_f32 v177, v194, v195
    ds_write_b64 v200, v[176:177] offset:21648
    v_pk_mul_f32 v[164:165], v[170:171], v[152:153] op_sel:[0,0] op_sel_hi:[1,0]
    v_pk_mul_f32 v[166:167], v[196:197], v[186:187] op_sel:[0,0] op_sel_hi:[1,0]
    v_pk_fma_f32 v[170:171], v[170:171], v[152:153], v[164:165] op_sel:[1,1,0] op_sel_hi:[0,1,1] neg_lo:[1,0,0]
    v_pk_fma_f32 v[196:197], v[196:197], v[186:187], v[166:167] op_sel:[1,1,0] op_sel_hi:[0,1,1] neg_lo:[1,0,0]
    v_cvt_pk_bf16_f32 v178, v170, -v171
    v_cvt_pk_bf16_f32 v179, v196, -v197
    ds_write_b64 v200, v[178:179] offset:6864
    v_pk_mul_f32 v[42:43], v[168:169], v[36:37] op_sel:[0,0] op_sel_hi:[1,0]
    v_pk_mul_f32 v[44:45], v[194:195], v[182:183] op_sel:[0,0] op_sel_hi:[1,0]
    v_pk_fma_f32 v[168:169], v[168:169], v[36:37], v[42:43] op_sel:[1,1,0] op_sel_hi:[0,1,1] neg_lo:[1,0,0]
    v_pk_fma_f32 v[194:195], v[194:195], v[182:183], v[44:45] op_sel:[1,1,0] op_sel_hi:[0,1,1] neg_lo:[1,0,0]
    v_cvt_pk_bf16_f32 v180, v168, v169
    v_cvt_pk_bf16_f32 v181, v194, v195
    ds_write_b64 v200, v[180:181] offset:22176
    v_pk_mul_f32 v[42:43], v[168:169], v[36:37] op_sel:[0,0] op_sel_hi:[1,0]
    v_pk_mul_f32 v[44:45], v[194:195], v[182:183] op_sel:[0,0] op_sel_hi:[1,0]
    v_pk_fma_f32 v[168:169], v[168:169], v[36:37], v[42:43] op_sel:[1,1,0] op_sel_hi:[0,1,1] neg_lo:[1,0,0]
    v_pk_fma_f32 v[194:195], v[194:195], v[182:183], v[44:45] op_sel:[1,1,0] op_sel_hi:[0,1,1] neg_lo:[1,0,0]
    v_cvt_pk_bf16_f32 v184, v168, v169
    v_cvt_pk_bf16_f32 v185, v194, v195
    ds_write_b64 v200, v[184:185] offset:22704
    v_pk_mul_f32 v[164:165], v[170:171], v[152:153] op_sel:[0,0] op_sel_hi:[1,0]
    v_pk_mul_f32 v[166:167], v[196:197], v[186:187] op_sel:[0,0] op_sel_hi:[1,0]
    v_pk_fma_f32 v[170:171], v[170:171], v[152:153], v[164:165] op_sel:[1,1,0] op_sel_hi:[0,1,1] neg_lo:[1,0,0]
    v_pk_fma_f32 v[196:197], v[196:197], v[186:187], v[166:167] op_sel:[1,1,0] op_sel_hi:[0,1,1] neg_lo:[1,0,0]
    v_cvt_pk_bf16_f32 v172, v170, -v171
    v_cvt_pk_bf16_f32 v173, v196, -v197
    ds_write_b64 v200, v[172:173] offset:7392
    v_pk_mul_f32 v[42:43], v[168:169], v[36:37] op_sel:[0,0] op_sel_hi:[1,0]
    v_pk_mul_f32 v[44:45], v[194:195], v[182:183] op_sel:[0,0] op_sel_hi:[1,0]
    v_pk_fma_f32 v[168:169], v[168:169], v[36:37], v[42:43] op_sel:[1,1,0] op_sel_hi:[0,1,1] neg_lo:[1,0,0]
    v_pk_fma_f32 v[194:195], v[194:195], v[182:183], v[44:45] op_sel:[1,1,0] op_sel_hi:[0,1,1] neg_lo:[1,0,0]
    v_cvt_pk_bf16_f32 v174, v168, v169
    v_cvt_pk_bf16_f32 v175, v194, v195
    ds_write_b64 v200, v[174:175] offset:23232
    v_pk_mul_f32 v[42:43], v[168:169], v[36:37] op_sel:[0,0] op_sel_hi:[1,0]
    v_pk_mul_f32 v[44:45], v[194:195], v[182:183] op_sel:[0,0] op_sel_hi:[1,0]
    v_pk_fma_f32 v[168:169], v[168:169], v[36:37], v[42:43] op_sel:[1,1,0] op_sel_hi:[0,1,1] neg_lo:[1,0,0]
    v_pk_fma_f32 v[194:195], v[194:195], v[182:183], v[44:45] op_sel:[1,1,0] op_sel_hi:[0,1,1] neg_lo:[1,0,0]
    v_cvt_pk_bf16_f32 v176, v168, v169
    v_cvt_pk_bf16_f32 v177, v194, v195
    ds_write_b64 v200, v[176:177] offset:23760
    v_pk_mul_f32 v[164:165], v[170:171], v[152:153] op_sel:[0,0] op_sel_hi:[1,0]
    v_pk_mul_f32 v[166:167], v[196:197], v[186:187] op_sel:[0,0] op_sel_hi:[1,0]
    v_pk_fma_f32 v[170:171], v[170:171], v[152:153], v[164:165] op_sel:[1,1,0] op_sel_hi:[0,1,1] neg_lo:[1,0,0]
    v_pk_fma_f32 v[196:197], v[196:197], v[186:187], v[166:167] op_sel:[1,1,0] op_sel_hi:[0,1,1] neg_lo:[1,0,0]
    v_cvt_pk_bf16_f32 v178, v170, -v171
    v_cvt_pk_bf16_f32 v179, v196, -v197
    ds_write_b64 v200, v[178:179] offset:7920
    v_pk_mul_f32 v[42:43], v[168:169], v[36:37] op_sel:[0,0] op_sel_hi:[1,0]
    v_pk_mul_f32 v[44:45], v[194:195], v[182:183] op_sel:[0,0] op_sel_hi:[1,0]
    v_pk_fma_f32 v[168:169], v[168:169], v[36:37], v[42:43] op_sel:[1,1,0] op_sel_hi:[0,1,1] neg_lo:[1,0,0]
    v_pk_fma_f32 v[194:195], v[194:195], v[182:183], v[44:45] op_sel:[1,1,0] op_sel_hi:[0,1,1] neg_lo:[1,0,0]
    v_cvt_pk_bf16_f32 v180, v168, v169
    v_cvt_pk_bf16_f32 v181, v194, v195
    ds_write_b64 v200, v[180:181] offset:24288
    v_pk_mul_f32 v[42:43], v[168:169], v[36:37] op_sel:[0,0] op_sel_hi:[1,0]
    v_pk_mul_f32 v[44:45], v[194:195], v[182:183] op_sel:[0,0] op_sel_hi:[1,0]
    v_pk_fma_f32 v[168:169], v[168:169], v[36:37], v[42:43] op_sel:[1,1,0] op_sel_hi:[0,1,1] neg_lo:[1,0,0]
    v_pk_fma_f32 v[194:195], v[194:195], v[182:183], v[44:45] op_sel:[1,1,0] op_sel_hi:[0,1,1] neg_lo:[1,0,0]
    v_cvt_pk_bf16_f32 v184, v168, v169
    v_cvt_pk_bf16_f32 v185, v194, v195
    ds_write_b64 v200, v[184:185] offset:24816
    s_mov_b32 s38, 131072
L_chk0:
    s_waitcnt vmcnt(0)
    v_max3_u32 v36, v48, v49, v50
    v_max3_u32 v36, v36, v51, v52
    v_max3_u32 v36, v36, v53, v54
    v_max_u32 v36, v36, v55
    v_cmp_eq_u32 vcc, -1, v36
    s_nop 0
    s_cbranch_vccz L_ok0
    s_sub_u32 s38, s38, 1
    s_cmp_eq_u32 s38, 0
    s_cbranch_scc1 L_ok0
    buffer_load_dwordx4 v[48:51], v150, s[56:59], s72 offen sc1
    buffer_load_dwordx4 v[52:55], v150, s[56:59], s73 offen sc1
    s_branch L_chk0
L_ok0:
    ds_write_b128 v149, v[48:51] offset:8192
    ds_write_b128 v149, v[52:55] offset:12288
    ds_write_b128 v149, v[6:9] offset:32768
    s_cmp_lg_u32 s35, 0
    ds_write_b128 v149, v[10:13] offset:36864
    s_cbranch_scc1 L_no256w
    ds_write_b128 v149, v[32:35] offset:40960
    ds_write_b128 v149, v[38:41] offset:45056
L_no256w:
    s_waitcnt lgkmcnt(0)
    s_barrier
    v_add_u32 v6, 8192, v5
    v_add_u32 v7, 12288, v5
    v_add_u32 v8, 16384, v5
    v_add_u32 v9, 20480, v5
    s_add_u32 s74, s65, 12582912
    s_add_u32 s75, s65, 12587008
    ds_read_b128 v[40:43], v156 offset:8192
    ds_read_b128 v[176:179], v156 offset:8704
    ds_read_b128 v[164:167], v156 offset:10240
    ds_read_b128 v[180:183], v156 offset:10752
    ds_read_b128 v[168:171], v156 offset:12288
    ds_read_b128 v[184:187], v156 offset:12800
    ds_read_b128 v[172:175], v156 offset:14336
    ds_read_b128 v[188:191], v156 offset:14848
    buffer_store_dwordx4 v[144:147], v149, s[56:59], s74 offen sc1
    v_lshrrev_b32 v10, 1, v3
    v_lshlrev_b32 v10, 6, v10
    v_add_u32 v10, v10, v2
    v_add_u32 v10, s43, v10
    buffer_store_dwordx4 v[144:147], v149, s[56:59], s75 offen sc1
    v_lshlrev_b32 v10, 5, v10
    v_and_b32 v4, 1, v3
    v_lshl_add_u32 v10, v4, 4, v10
    ds_read_b128 v[32:35], v10 offset:32768
    global_load_dwordx4 a[44:47], v6, s[50:51] offset:3072
    ds_read_b128 v[36:39], v10 offset:36864
    s_waitcnt lgkmcnt(9)
    v_mfma_f32_16x16x32_bf16 v[192:195], v[40:43], a[100:103], 0
    s_mov_b32 s78, 0x36000000
    s_cmp_lg_u32 s35, 0
    v_mfma_f32_16x16x32_bf16 v[200:203], v[40:43], a[106:109], 0
    s_waitcnt lgkmcnt(8)
    v_mfma_f32_16x16x32_bf16 v[196:199], v[176:179], a[100:103], 0
    global_load_dwordx4 a[48:51], v7, s[50:51] offset:0
    v_mfma_f32_16x16x32_bf16 v[204:207], v[176:179], a[106:109], 0
    s_waitcnt lgkmcnt(7)
    v_mfma_f32_16x16x32_bf16 v[192:195], v[164:167], a[110:113], v[192:195]
    v_mfma_f32_16x16x32_bf16 v[200:203], v[164:167], a[116:119], v[200:203]
    s_waitcnt lgkmcnt(1)
    v_lshlrev_b32 v88, 16, v32
    v_lshlrev_b32 v92, 16, v34
    v_mfma_f32_16x16x32_bf16 v[196:199], v[180:183], a[110:113], v[196:199]
    global_load_dwordx4 a[52:55], v7, s[50:51] offset:1024
    v_mfma_f32_16x16x32_bf16 v[204:207], v[180:183], a[116:119], v[204:207]
    v_and_b32 v89, s49, v32
    v_and_b32 v93, s49, v34
    v_mfma_f32_16x16x32_bf16 v[192:195], v[168:171], a[120:123], v[192:195]
    v_lshlrev_b32 v90, 16, v33
    v_lshlrev_b32 v94, 16, v35
    v_mfma_f32_16x16x32_bf16 v[200:203], v[168:171], a[126:129], v[200:203]
    v_and_b32 v91, s49, v33
    v_and_b32 v95, s49, v35
    v_mfma_f32_16x16x32_bf16 v[196:199], v[184:187], a[120:123], v[196:199]
    global_load_dwordx4 a[56:59], v7, s[50:51] offset:2048
    v_mfma_f32_16x16x32_bf16 v[204:207], v[184:187], a[126:129], v[204:207]
    s_waitcnt lgkmcnt(0)
    v_lshlrev_b32 v96, 16, v36
    v_lshlrev_b32 v100, 16, v38
    v_mfma_f32_16x16x32_bf16 v[192:195], v[172:175], a[130:133], v[192:195]
    v_and_b32 v97, s49, v36
    v_and_b32 v101, s49, v38
    v_mfma_f32_16x16x32_bf16 v[200:203], v[172:175], a[136:139], v[200:203]
    v_lshlrev_b32 v98, 16, v37
    v_lshlrev_b32 v102, 16, v39
    v_mfma_f32_16x16x32_bf16 v[196:199], v[188:191], a[130:133], v[196:199]
    global_load_dwordx4 a[60:63], v7, s[50:51] offset:3072
    v_mfma_f32_16x16x32_bf16 v[204:207], v[188:191], a[136:139], v[204:207]
    v_and_b32 v99, s49, v37
    v_and_b32 v103, s49, v39
    v_mul_f32 v88, s78, v88
    v_mul_f32 v92, s78, v92
    v_mul_f32 v89, s78, v89
    v_pk_mul_f32 v[208:209], v[192:193], v[56:57]
    v_pk_mul_f32 v[216:217], v[200:201], v[56:57]
    v_pk_mul_f32 v[210:211], v[194:195], v[58:59]
    v_pk_mul_f32 v[218:219], v[202:203], v[58:59]
    v_pk_fma_f32 v[208:209], v[200:201], v[64:65], v[208:209]
    global_load_dwordx4 a[64:67], v8, s[50:51] offset:0
    v_pk_fma_f32 v[216:217], v[192:193], v[64:65], v[216:217] neg_lo:[1,0,0] neg_hi:[1,0,0]
    v_pk_fma_f32 v[210:211], v[202:203], v[66:67], v[210:211]
    v_pk_fma_f32 v[218:219], v[194:195], v[66:67], v[218:219] neg_lo:[1,0,0] neg_hi:[1,0,0]
    v_cvt_pk_bf16_f32 v224, v208, v209
    v_cvt_pk_bf16_f32 v225, v210, v211
    v_cvt_pk_bf16_f32 v226, v216, v217
    v_cvt_pk_bf16_f32 v227, v218, v219
    v_pk_mul_f32 v[212:213], v[196:197], v[60:61]
    v_pk_mul_f32 v[220:221], v[204:205], v[60:61]
    v_pk_mul_f32 v[214:215], v[198:199], v[62:63]
    v_pk_mul_f32 v[222:223], v[206:207], v[62:63]
    global_load_dwordx4 a[68:71], v8, s[50:51] offset:1024
    v_pk_fma_f32 v[212:213], v[204:205], v[68:69], v[212:213]
    v_pk_fma_f32 v[220:221], v[196:197], v[68:69], v[220:221] neg_lo:[1,0,0] neg_hi:[1,0,0]
    v_pk_fma_f32 v[214:215], v[206:207], v[70:71], v[214:215]
    v_pk_fma_f32 v[222:223], v[198:199], v[70:71], v[222:223] neg_lo:[1,0,0] neg_hi:[1,0,0]
    v_mfma_f32_16x16x32_bf16 v[192:195], a[4:7], v[224:227], 0
    v_cvt_pk_bf16_f32 v228, v212, v213
    v_cvt_pk_bf16_f32 v229, v214, v215
    v_mfma_f32_16x16x32_bf16 v[200:203], a[10:13], v[224:227], 0
    v_cvt_pk_bf16_f32 v230, v220, v221
    v_cvt_pk_bf16_f32 v231, v222, v223
    global_load_dwordx4 a[72:75], v8, s[50:51] offset:2048
    v_mfma_f32_16x16x32_bf16 v[196:199], a[24:27], v[224:227], 0
    v_mul_f32 v93, s78, v93
    v_mul_f32 v90, s78, v90
    v_mfma_f32_16x16x32_bf16 v[204:207], a[30:33], v[224:227], 0
    v_mul_f32 v94, s78, v94
    v_mul_f32 v91, s78, v91
    v_mfma_f32_16x16x32_bf16 v[192:195], a[14:17], v[228:231], v[192:195]
    v_mul_f32 v95, s78, v95
    v_mul_f32 v96, s78, v96
    v_mfma_f32_16x16x32_bf16 v[200:203], a[20:23], v[228:231], v[200:203]
    global_load_dwordx4 a[76:79], v8, s[50:51] offset:3072
    v_mfma_f32_16x16x32_bf16 v[196:199], a[34:37], v[228:231], v[196:199]
    v_mul_f32 v100, s78, v100
    v_mul_f32 v97, s78, v97
    v_mfma_f32_16x16x32_bf16 v[204:207], a[40:43], v[228:231], v[204:207]
    v_mul_f32 v101, s78, v101
    v_mul_f32 v98, s78, v98
    v_mul_f32 v102, s78, v102
    v_mul_f32 v99, s78, v99
    v_mul_f32 v103, s78, v103
    global_load_dwordx4 a[80:83], v9, s[50:51] offset:0
    s_nop 0
    s_cbranch_scc1 L_q_mid0
    ds_read_b128 v[32:35], v10 offset:40960
    ds_read_b128 v[36:39], v10 offset:45056
    s_waitcnt lgkmcnt(1)
    v_lshlrev_b32 v16, 16, v32
    v_lshlrev_b32 v20, 16, v34
    v_and_b32 v17, s49, v32
    v_and_b32 v21, s49, v34
    v_lshlrev_b32 v18, 16, v33
    v_lshlrev_b32 v22, 16, v35
    v_and_b32 v19, s49, v33
    v_and_b32 v23, s49, v35
    s_waitcnt lgkmcnt(0)
    v_lshlrev_b32 v24, 16, v36
    v_lshlrev_b32 v28, 16, v38
    v_and_b32 v25, s49, v36
    v_and_b32 v29, s49, v38
    v_lshlrev_b32 v26, 16, v37
    v_lshlrev_b32 v30, 16, v39
    v_and_b32 v27, s49, v37
    v_and_b32 v31, s49, v39
    v_mul_f32 v16, s78, v16
    v_mul_f32 v20, s78, v20
    v_mul_f32 v17, s78, v17
    v_mul_f32 v21, s78, v21
    v_mul_f32 v18, s78, v18
    v_mul_f32 v22, s78, v22
    v_mul_f32 v19, s78, v19
    v_mul_f32 v23, s78, v23
    v_mul_f32 v24, s78, v24
    v_mul_f32 v28, s78, v28
    v_mul_f32 v25, s78, v25
    v_mul_f32 v29, s78, v29
    v_mul_f32 v26, s78, v26
    v_mul_f32 v30, s78, v30
    v_mul_f32 v27, s78, v27
    v_mul_f32 v31, s78, v31
    v_accvgpr_write_b32 a236, v16
    v_accvgpr_write_b32 a237, v17
    v_accvgpr_write_b32 a238, v18
    v_accvgpr_write_b32 a239, v19
    v_accvgpr_write_b32 a240, v20
    v_accvgpr_write_b32 a241, v21
    v_accvgpr_write_b32 a242, v22
    v_accvgpr_write_b32 a243, v23
    v_accvgpr_write_b32 a244, v24
    v_accvgpr_write_b32 a245, v25
    v_accvgpr_write_b32 a246, v26
    v_accvgpr_write_b32 a247, v27
    v_accvgpr_write_b32 a248, v28
    v_accvgpr_write_b32 a249, v29
    v_accvgpr_write_b32 a250, v30
    v_accvgpr_write_b32 a251, v31
    s_barrier
    v_lshlrev_b32 v6, 8, v3
    v_add_u32 v6, v6, v2
    v_add_u32 v6, s43, v6
    v_lshlrev_b32 v7, 2, v6
    v_sub_u32 v8, 27904, v7
    v_add_u32 v7, 24576, v7
    ds_write2st64_b32 v7, v192, v200 offset0:0 offset1:33
    ds_write2st64_b32 v7, v193, v201 offset0:1 offset1:34
    ds_write2st64_b32 v7, v194, v202 offset0:2 offset1:35
    ds_write2st64_b32 v7, v195, v203 offset0:3 offset1:36
    ds_write2st64_b32 v7, v196, v204 offset0:16 offset1:49
    ds_write2st64_b32 v7, v197, v205 offset0:17 offset1:50
    ds_write2st64_b32 v7, v198, v206 offset0:18 offset1:51
    ds_write2st64_b32 v7, v199, v207 offset0:19 offset1:52
    v_cmp_eq_u32 vcc, 0, v6
    v_mov_b32 v9, 32772
    v_mov_b32 v4, 32768
    v_cndmask_b32 v9, v9, v4, vcc
    ds_write2st64_b32 v9, v192, v200 offset0:0 offset1:33
    s_nop 0
L_q_mid0:
    v_pk_mul_f32 v[208:209], v[192:193], v[88:89]
    v_pk_mul_f32 v[216:217], v[200:201], v[88:89]
    v_pk_mul_f32 v[210:211], v[194:195], v[90:91]
    v_pk_mul_f32 v[218:219], v[202:203], v[90:91]
    v_pk_mul_f32 v[212:213], v[196:197], v[96:97]
    v_pk_mul_f32 v[220:221], v[204:205], v[96:97]
    v_pk_mul_f32 v[214:215], v[198:199], v[98:99]
    v_pk_mul_f32 v[222:223], v[206:207], v[98:99]
    v_pk_fma_f32 v[208:209], v[200:201], v[92:93], v[208:209] neg_lo:[1,0,0] neg_hi:[1,0,0]
    v_pk_fma_f32 v[216:217], v[192:193], v[92:93], v[216:217]
    v_pk_fma_f32 v[210:211], v[202:203], v[94:95], v[210:211] neg_lo:[1,0,0] neg_hi:[1,0,0]
    v_pk_fma_f32 v[218:219], v[194:195], v[94:95], v[218:219]
    v_pk_fma_f32 v[212:213], v[204:205], v[100:101], v[212:213] neg_lo:[1,0,0] neg_hi:[1,0,0]
    v_pk_fma_f32 v[220:221], v[196:197], v[100:101], v[220:221]
    v_pk_fma_f32 v[214:215], v[206:207], v[102:103], v[214:215] neg_lo:[1,0,0] neg_hi:[1,0,0]
    v_pk_fma_f32 v[222:223], v[198:199], v[102:103], v[222:223]
    s_cmp_lg_u32 s35, 0
    s_cbranch_scc1 L_q_done0
    s_waitcnt lgkmcnt(0)
    s_barrier
    ds_read2st64_b32 v[176:177], v8 offset0:19 offset1:18
    ds_read2st64_b32 v[178:179], v8 offset0:17 offset1:16
    ds_read2st64_b32 v[184:185], v8 offset0:3 offset1:2
    ds_read2st64_b32 v[186:187], v8 offset0:1 offset1:0
    ds_read2st64_b32 v[180:181], v8 offset0:52 offset1:51
    ds_read2st64_b32 v[182:183], v8 offset0:50 offset1:49
    ds_read2st64_b32 v[188:189], v8 offset0:36 offset1:35
    ds_read2st64_b32 v[190:191], v8 offset0:34 offset1:33
    s_waitcnt lgkmcnt(7)
    v_pk_fma_f32 v[208:209], v[176:177], v[16:17], v[208:209]
    v_pk_fma_f32 v[216:217], v[176:177], v[20:21], v[216:217]
    s_waitcnt lgkmcnt(6)
    v_pk_fma_f32 v[210:211], v[178:179], v[18:19], v[210:211]
    v_pk_fma_f32 v[218:219], v[178:179], v[22:23], v[218:219]
    s_waitcnt lgkmcnt(5)
    v_pk_fma_f32 v[212:213], v[184:185], v[24:25], v[212:213]
    v_pk_fma_f32 v[220:221], v[184:185], v[28:29], v[220:221]
    s_waitcnt lgkmcnt(4)
    v_pk_fma_f32 v[214:215], v[186:187], v[26:27], v[214:215]
    v_pk_fma_f32 v[222:223], v[186:187], v[30:31], v[222:223]
    s_waitcnt lgkmcnt(3)
    v_pk_fma_f32 v[208:209], v[180:181], v[20:21], v[208:209]
    v_pk_fma_f32 v[216:217], v[180:181], v[16:17], v[216:217] neg_lo:[1,0,0] neg_hi:[1,0,0]
    s_waitcnt lgkmcnt(2)
    v_pk_fma_f32 v[210:211], v[182:183], v[22:23], v[210:211]
    v_pk_fma_f32 v[218:219], v[182:183], v[18:19], v[218:219] neg_lo:[1,0,0] neg_hi:[1,0,0]
    s_waitcnt lgkmcnt(1)
    v_pk_fma_f32 v[212:213], v[188:189], v[28:29], v[212:213]
    v_pk_fma_f32 v[220:221], v[188:189], v[24:25], v[220:221] neg_lo:[1,0,0] neg_hi:[1,0,0]
    s_waitcnt lgkmcnt(0)
    v_pk_fma_f32 v[214:215], v[190:191], v[30:31], v[214:215]
    v_pk_fma_f32 v[222:223], v[190:191], v[26:27], v[222:223] neg_lo:[1,0,0] neg_hi:[1,0,0]
    s_waitcnt lgkmcnt(0)
    s_nop 0
L_q_done0:
    v_cvt_pk_bf16_f32 v224, v208, v209
    v_cvt_pk_bf16_f32 v225, v210, v211
    v_cvt_pk_bf16_f32 v226, v216, v217
    v_cvt_pk_bf16_f32 v227, v218, v219
    v_cvt_pk_bf16_f32 v228, v212, v213
    v_cvt_pk_bf16_f32 v229, v214, v215
    v_mfma_f32_16x16x32_bf16 v[192:195], v[224:227], a[8:11], 0
    v_cvt_pk_bf16_f32 v230, v220, v221
    v_cvt_pk_bf16_f32 v231, v222, v223
    v_mfma_f32_16x16x32_bf16 v[200:203], v[224:227], a[6:9], 0
    s_nop 0
    v_mfma_f32_16x16x32_bf16 v[192:195], v[228:231], a[18:21], v[192:195]
    v_mfma_f32_16x16x32_bf16 v[200:203], v[228:231], a[16:19], v[200:203]
    v_mfma_f32_16x16x32_bf16 v[196:199], v[224:227], a[28:31], 0
    v_mfma_f32_16x16x32_bf16 v[204:207], v[224:227], a[26:29], 0
    v_mfma_f32_16x16x32_bf16 v[196:199], v[228:231], a[38:41], v[196:199]
    v_mfma_f32_16x16x32_bf16 v[204:207], v[228:231], a[36:39], v[204:207]
    s_nop 2
    v_pk_mul_f32 v[208:209], v[192:193], v[72:73]
    v_pk_mul_f32 v[216:217], v[200:201], v[72:73]
    v_pk_mul_f32 v[210:211], v[194:195], v[74:75]
    v_pk_mul_f32 v[218:219], v[202:203], v[74:75]
    v_pk_fma_f32 v[208:209], v[200:201], v[80:81], v[208:209] neg_lo:[1,0,0] neg_hi:[1,0,0]
    v_pk_fma_f32 v[216:217], v[192:193], v[80:81], v[216:217]
    v_pk_fma_f32 v[210:211], v[202:203], v[82:83], v[210:211] neg_lo:[1,0,0] neg_hi:[1,0,0]
    v_pk_fma_f32 v[218:219], v[194:195], v[82:83], v[218:219]
    v_cvt_pk_bf16_f32 v40, v208, v209
    v_cvt_pk_bf16_f32 v41, v210, v211
    v_cvt_pk_bf16_f32 v42, v216, v217
    v_cvt_pk_bf16_f32 v43, v218, v219
    ds_write_b128 v157, v[40:43] offset:16384
    v_pk_mul_f32 v[212:213], v[196:197], v[76:77]
    v_pk_mul_f32 v[220:221], v[204:205], v[76:77]
    v_pk_mul_f32 v[214:215], v[198:199], v[78:79]
    v_pk_mul_f32 v[222:223], v[206:207], v[78:79]
    v_pk_fma_f32 v[212:213], v[204:205], v[84:85], v[212:213] neg_lo:[1,0,0] neg_hi:[1,0,0]
    v_pk_fma_f32 v[220:221], v[196:197], v[84:85], v[220:221]
    v_pk_fma_f32 v[214:215], v[206:207], v[86:87], v[214:215] neg_lo:[1,0,0] neg_hi:[1,0,0]
    v_pk_fma_f32 v[222:223], v[198:199], v[86:87], v[222:223]
    v_cvt_pk_bf16_f32 v164, v212, v213
    v_cvt_pk_bf16_f32 v165, v214, v215
    v_cvt_pk_bf16_f32 v166, v220, v221
    v_cvt_pk_bf16_f32 v167, v222, v223
    ds_write_b128 v157, v[164:167] offset:17408
    s_waitcnt lgkmcnt(0)
    s_barrier
    ds_read_b128 v[40:43], v5 offset:16384
    ds_read_b128 v[164:167], v5 offset:18432
    ds_read_b128 v[168:171], v5 offset:20480
    ds_read_b128 v[172:175], v5 offset:22528
    ds_read_b128 v[176:179], v5 offset:17408
    ds_read_b128 v[180:183], v5 offset:19456
    ds_read_b128 v[184:187], v5 offset:21504
    ds_read_b128 v[188:191], v5 offset:23552
    v_add_u32 v15, 4096, v5
    v_add_u32 v16, 16384, v5
    v_add_u32 v17, 20480, v5
    v_add_u32 v18, 24576, v5
    v_add_u32 v19, 28672, v5
    v_add_u32 v20, 32768, v5
    s_mul_i32 s36, s41, 50688
    s_mul_i32 s37, s42, 25344
    s_waitcnt lgkmcnt(7)
    v_mfma_f32_16x16x32_bf16 v[192:195], a[104:107], v[40:43], 0
    v_mul_u32_u24 v21, 528, v2
    s_add_u32 s36, s36, s37
    v_mfma_f32_16x16x32_bf16 v[200:203], a[102:105], v[40:43], 0
    v_lshl_add_u32 v21, v3, 4, v21
    s_add_u32 s36, s36, 49152
    s_waitcnt lgkmcnt(6)
    v_mfma_f32_16x16x32_bf16 v[192:195], a[114:117], v[164:167], v[192:195]
    v_add_u32 v21, s36, v21
    ds_read_b128 v[30:33], v21 offset:0
    v_mfma_f32_16x16x32_bf16 v[200:203], a[112:115], v[164:167], v[200:203]
    ds_read_b128 v[34:37], v21 offset:8448
    s_waitcnt lgkmcnt(7)
    v_mfma_f32_16x16x32_bf16 v[192:195], a[124:127], v[168:171], v[192:195]
    ds_read_b128 v[38:41], v21 offset:16896
    v_mfma_f32_16x16x32_bf16 v[200:203], a[122:125], v[168:171], v[200:203]
    ds_read_b128 v[42:45], v21 offset:64
    s_waitcnt lgkmcnt(8)
    v_mfma_f32_16x16x32_bf16 v[192:195], a[134:137], v[172:175], v[192:195]
    ds_read_b128 v[164:167], v21 offset:8512
    v_mfma_f32_16x16x32_bf16 v[200:203], a[132:135], v[172:175], v[200:203]
    ds_read_b128 v[168:171], v21 offset:16960
    s_nop 4
    v_cvt_pk_bf16_f32 v136, v192, v193
    v_cvt_pk_bf16_f32 v138, v194, v195
    s_waitcnt lgkmcnt(9)
    v_mfma_f32_16x16x32_bf16 v[196:199], a[104:107], v[176:179], 0
    ds_read_b128 v[172:175], v21 offset:128
    v_cvt_pk_bf16_f32 v137, v200, v201
    v_cvt_pk_bf16_f32 v139, v202, v203
    buffer_store_dwordx4 v[136:139], v151, s[56:59], s76 offen offset:0 sc1
    v_mfma_f32_16x16x32_bf16 v[204:207], a[102:105], v[176:179], 0
    ds_read_b128 v[176:179], v21 offset:8576
    s_waitcnt lgkmcnt(10)
    v_mfma_f32_16x16x32_bf16 v[196:199], a[114:117], v[180:183], v[196:199]
    ds_read_b128 v[192:195], v21 offset:17088
    v_mfma_f32_16x16x32_bf16 v[204:207], a[112:115], v[180:183], v[204:207]
    ds_read_b128 v[180:183], v21 offset:17024
    s_waitcnt lgkmcnt(11)
    v_mfma_f32_16x16x32_bf16 v[196:199], a[124:127], v[184:187], v[196:199]
    v_lshlrev_b32 v46, 8, v3
    s_lshl_b32 s36, s34, 10
    v_mfma_f32_16x16x32_bf16 v[204:207], a[122:125], v[184:187], v[204:207]
    ds_read_b128 v[184:187], v21 offset:192
    s_waitcnt lgkmcnt(11)
    v_mfma_f32_16x16x32_bf16 v[196:199], a[134:137], v[188:191], v[196:199]
    v_lshl_add_u32 v46, v2, 1, v46
    s_add_u32 s36, s36, 150528
    v_mfma_f32_16x16x32_bf16 v[204:207], a[132:135], v[188:191], v[204:207]
    ds_read_b128 v[188:191], v21 offset:8640
    s_waitcnt lgkmcnt(10)
    v_mfma_f32_16x16x32_bf16 v[22:25], v[30:33], v[34:37], 0
    s_nop 1
    v_cvt_pk_bf16_f32 v140, v196, v197
    v_cvt_pk_bf16_f32 v142, v198, v199
    s_waitcnt lgkmcnt(9)
    v_mfma_f32_16x16x32_bf16 v[26:29], v[30:33], v[38:41], 0
    v_cvt_pk_bf16_f32 v141, v204, v205
    v_cvt_pk_bf16_f32 v143, v206, v207
    buffer_store_dwordx4 v[140:143], v151, s[56:59], s76 offen offset:512 sc1
    ds_read_b128 v[30:33], v21 offset:256
    ds_read_b128 v[34:37], v21 offset:8704
    global_load_dwordx4 v[6:9], v15, s[52:53] offset:0
    s_waitcnt lgkmcnt(9)
    v_mfma_f32_16x16x32_bf16 v[22:25], v[42:45], v[164:167], v[22:25]
    ds_read_b128 v[164:167], v21 offset:8768
    s_waitcnt lgkmcnt(9)
    v_mfma_f32_16x16x32_bf16 v[26:29], v[42:45], v[168:171], v[26:29]
    ds_read_b128 v[42:45], v21 offset:320
    s_waitcnt lgkmcnt(8)
    v_mfma_f32_16x16x32_bf16 v[22:25], v[172:175], v[176:179], v[22:25]
    ds_read_b128 v[176:179], v21 offset:8832
    global_load_dwordx4 v[10:13], v15, s[52:53] offset:1024
    s_waitcnt lgkmcnt(7)
    v_mfma_f32_16x16x32_bf16 v[26:29], v[172:175], v[180:183], v[26:29]
    ds_read_b128 v[172:175], v21 offset:384
    s_waitcnt lgkmcnt(6)
    v_mfma_f32_16x16x32_bf16 v[22:25], v[184:187], v[188:191], v[22:25]
    ds_read_b128 v[188:191], v21 offset:8896
    v_mfma_f32_16x16x32_bf16 v[26:29], v[184:187], v[192:195], v[26:29]
    ds_read_b128 v[184:187], v21 offset:448
    global_load_dwordx4 a[172:175], v16, s[54:55] offset:2048
    ds_read_b128 v[38:41], v21 offset:17152
    ds_read_b128 v[168:171], v21 offset:17216
    ds_read_b128 v[180:183], v21 offset:17280
    ds_read_b128 v[192:195], v21 offset:17344
    s_waitcnt lgkmcnt(10)
    v_mfma_f32_16x16x32_bf16 v[22:25], v[30:33], v[34:37], v[22:25]
    global_load_dwordx4 a[176:179], v16, s[54:55] offset:3072
    s_waitcnt lgkmcnt(8)
    v_mfma_f32_16x16x32_bf16 v[22:25], v[42:45], v[164:167], v[22:25]
    v_add_u32 v46, s36, v46
    s_add_u32 s72, s67, 4194304
    s_waitcnt lgkmcnt(6)
    v_mfma_f32_16x16x32_bf16 v[22:25], v[172:175], v[176:179], v[22:25]
    s_add_u32 s73, s67, 5242880
    s_waitcnt lgkmcnt(4)
    v_mfma_f32_16x16x32_bf16 v[22:25], v[184:187], v[188:191], v[22:25]
    global_load_dwordx4 a[180:183], v17, s[54:55] offset:0
    s_waitcnt lgkmcnt(3)
    v_mfma_f32_16x16x32_bf16 v[26:29], v[30:33], v[38:41], v[26:29]
    s_nop 4
    v_cvt_pk_bf16_f32 v152, v22, v22
    s_waitcnt lgkmcnt(2)
    v_mfma_f32_16x16x32_bf16 v[26:29], v[42:45], v[168:171], v[26:29]
    ds_write_b16 v46, v152 offset:0
    s_waitcnt lgkmcnt(2)
    v_mfma_f32_16x16x32_bf16 v[26:29], v[172:175], v[180:183], v[26:29]
    v_cvt_pk_bf16_f32 v153, v23, v23
    global_load_dwordx4 a[184:187], v17, s[54:55] offset:1024
    ds_write_b16 v46, v153 offset:64
    s_waitcnt lgkmcnt(2)
    v_mfma_f32_16x16x32_bf16 v[26:29], v[184:187], v[192:195], v[26:29]
    v_cvt_pk_bf16_f32 v163, v24, v24
    ds_write_b16 v46, v163 offset:128
    v_cvt_pk_bf16_f32 v196, v25, v25
    ds_write_b16 v46, v196 offset:192
    global_load_dwordx4 a[188:191], v17, s[54:55] offset:2048
    s_nop 2
    v_cvt_pk_bf16_f32 v197, v26, v26
    ds_write_b16 v46, v197 offset:32
    v_cvt_pk_bf16_f32 v198, v27, v27
    ds_write_b16 v46, v198 offset:96
    v_cvt_pk_bf16_f32 v199, v28, v28
    ds_write_b16 v46, v199 offset:160
    global_load_dwordx4 a[192:195], v17, s[54:55] offset:3072
    v_cvt_pk_bf16_f32 v200, v29, v29
    ds_write_b16 v46, v200 offset:224
    global_load_dwordx4 a[196:199], v18, s[54:55] offset:0
    global_load_dwordx4 a[200:203], v18, s[54:55] offset:1024
    global_load_dwordx4 a[204:207], v18, s[54:55] offset:2048
    global_load_dwordx4 a[208:211], v18, s[54:55] offset:3072
    global_load_dwordx4 a[212:215], v19, s[54:55] offset:0
    global_load_dwordx4 a[216:219], v19, s[54:55] offset:1024
    global_load_dwordx4 a[220:223], v19, s[54:55] offset:2048
    global_load_dwordx4 a[224:227], v19, s[54:55] offset:3072
    global_load_dwordx4 a[228:231], v20, s[54:55] offset:0
    global_load_dwordx4 a[232:235], v20, s[54:55] offset:1024
    s_waitcnt vmcnt(0)
    ds_read_b32 v16, v159 offset:0
    ds_read_b32 v17, v159 offset:512
    ds_read_b32 v18, v159 offset:1024
    ds_read_b32 v19, v159 offset:1536
    ds_read_b32 v20, v159 offset:256
    ds_read_b32 v21, v159 offset:768
    ds_read_b32 v22, v159 offset:1280
    ds_read_b32 v23, v159 offset:1792
    v_accvgpr_read_b32 v56, a68
    v_accvgpr_read_b32 v57, a69
    v_accvgpr_read_b32 v58, a70
    v_accvgpr_read_b32 v59, a71
    v_accvgpr_read_b32 v60, a72
    v_accvgpr_read_b32 v61, a73
    v_accvgpr_read_b32 v62, a74
    v_accvgpr_read_b32 v63, a75
    v_accvgpr_read_b32 v64, a76
    v_accvgpr_read_b32 v65, a77
    v_accvgpr_read_b32 v66, a78
    v_accvgpr_read_b32 v67, a79
    v_accvgpr_read_b32 v68, a80
    v_accvgpr_read_b32 v69, a81
    v_accvgpr_read_b32 v70, a82
    v_accvgpr_read_b32 v71, a83
    s_waitcnt lgkmcnt(7)
    v_lshlrev_b32 v24, 16, v16
    v_and_b32 v25, s49, v16
    s_waitcnt lgkmcnt(6)
    v_lshlrev_b32 v26, 16, v17
    v_and_b32 v27, s49, v17
    s_waitcnt lgkmcnt(5)
    v_lshlrev_b32 v28, 16, v18
    v_and_b32 v29, s49, v18
    s_waitcnt lgkmcnt(4)
    v_lshlrev_b32 v30, 16, v19
    v_and_b32 v31, s49, v19
    s_waitcnt lgkmcnt(3)
    v_lshlrev_b32 v32, 16, v20
    v_and_b32 v33, s49, v20
    s_waitcnt lgkmcnt(2)
    v_lshlrev_b32 v34, 16, v21
    v_and_b32 v35, s49, v21
    s_waitcnt lgkmcnt(1)
    v_lshlrev_b32 v36, 16, v22
    v_and_b32 v37, s49, v22
    s_waitcnt lgkmcnt(0)
    v_lshlrev_b32 v38, 16, v23
    v_and_b32 v39, s49, v23
    s_nop 0
    buffer_load_dwordx4 v[48:51], v150, s[56:59], s72 offen sc1
    s_add_u32 s74, s65, 12582912
    s_add_u32 s75, s65, 12587008
    s_add_u32 s76, s65, 8388608
    s_add_u32 s77, s65, 8392704
    buffer_load_dwordx4 v[52:55], v150, s[56:59], s73 offen sc1
    s_barrier
    s_lshl_b32 s78, s41, 11
    s_add_u32 s78, s78, 150528
    s_mov_b32 s79, 0xffff
    v_and_b32 v15, s79, v6
    v_lshrrev_b32 v44, 16, v6
    v_and_b32 v45, s79, v7
    v_lshrrev_b32 v46, 16, v7
    v_and_b32 v152, s79, v8
    v_lshrrev_b32 v153, 16, v8
    v_and_b32 v163, s79, v9
    v_lshrrev_b32 v168, 16, v9
    v_add_u32 v15, s78, v15
    v_add_u32 v44, s78, v44
    v_add_u32 v45, s78, v45
    v_add_u32 v46, s78, v46
    v_add_u32 v152, s78, v152
    v_add_u32 v153, s78, v153
    v_add_u32 v163, s78, v163
    v_add_u32 v168, s78, v168
    ds_read_u16 v15, v15
    ds_read_u16 v44, v44
    ds_read_u16 v45, v45
    ds_read_u16 v46, v46
    ds_read_u16 v152, v152
    ds_read_u16 v153, v153
    ds_read_u16 v163, v163
    ds_read_u16 v168, v168
    v_and_b32 v169, s79, v10
    v_lshrrev_b32 v170, 16, v10
    v_and_b32 v171, s79, v11
    v_lshrrev_b32 v172, 16, v11
    v_and_b32 v173, s79, v12
    v_lshrrev_b32 v174, 16, v12
    v_and_b32 v175, s79, v13
    v_lshrrev_b32 v176, 16, v13
    v_add_u32 v169, s78, v169
    v_add_u32 v170, s78, v170
    v_add_u32 v171, s78, v171
    v_add_u32 v172, s78, v172
    v_add_u32 v173, s78, v173
    v_add_u32 v174, s78, v174
    v_add_u32 v175, s78, v175
    v_add_u32 v176, s78, v176
    ds_read_u16 v169, v169
    ds_read_u16 v170, v170
    ds_read_u16 v171, v171
    ds_read_u16 v172, v172
    ds_read_u16 v173, v173
    ds_read_u16 v174, v174
    ds_read_u16 v175, v175
    ds_read_u16 v176, v176
    s_lshl_b32 s36, s41, 12
    s_lshl_b32 s37, s42, 10
    s_add_u32 s36, s36, s37
    s_add_u32 s36, s36, 49152
    s_waitcnt lgkmcnt(14)
    v_lshl_or_b32 v40, v44, 16, v15
    s_waitcnt lgkmcnt(12)
    v_lshl_or_b32 v41, v46, 16, v45
    s_waitcnt lgkmcnt(10)
    v_lshl_or_b32 v42, v153, 16, v152
    s_waitcnt lgkmcnt(8)
    v_lshl_or_b32 v43, v168, 16, v163
    v_add_u32 v177, s36, v5
    ds_write_b128 v177, v[40:43] offset:0
    s_mov_b32 s38, 131072
    s_waitcnt lgkmcnt(7)
    v_lshl_or_b32 v164, v170, 16, v169
    s_waitcnt lgkmcnt(5)
    v_lshl_or_b32 v165, v172, 16, v171
    s_waitcnt lgkmcnt(3)
    v_lshl_or_b32 v166, v174, 16, v173
    s_waitcnt lgkmcnt(1)
    v_lshl_or_b32 v167, v176, 16, v175
    ds_write_b128 v177, v[164:167] offset:2048
    s_nop 0
L_chk1:
    s_waitcnt vmcnt(0)
    v_max3_u32 v6, v48, v49, v50
    v_max3_u32 v6, v6, v51, v52
    v_max3_u32 v6, v6, v53, v54
    v_max_u32 v6, v6, v55
    v_cmp_eq_u32 vcc, -1, v6
    s_nop 0
    s_cbranch_vccz L_ok1
    s_sub_u32 s38, s38, 1
    s_cmp_eq_u32 s38, 0
    s_cbranch_scc1 L_ok1
    buffer_load_dwordx4 v[48:51], v150, s[56:59], s72 offen sc1
    buffer_load_dwordx4 v[52:55], v150, s[56:59], s73 offen sc1
    s_branch L_chk1
L_ok1:
    ds_write_b128 v149, v[48:51] offset:8192
    ds_write_b128 v149, v[52:55] offset:12288
    s_waitcnt lgkmcnt(0)
    s_barrier
    s_add_u32 s74, s65, 2097152
    s_add_u32 s75, s65, 2101248
    ds_read_b64 v[6:7], v158 offset:8192
    ds_read_b64 v[8:9], v158 offset:8704
    ds_read_b64 v[10:11], v158 offset:9216
    ds_read_b64 v[12:13], v158 offset:9728
    buffer_store_dwordx4 v[144:147], v149, s[56:59], s74 offen sc1
    buffer_store_dwordx4 v[144:147], v149, s[56:59], s75 offen sc1
    s_waitcnt lgkmcnt(2)
    v_perm_b32 v40, v8, v6, s45
    v_perm_b32 v42, v9, v7, s45
    s_waitcnt lgkmcnt(0)
    v_perm_b32 v41, v12, v10, s45
    v_perm_b32 v43, v13, v11, s45
    v_perm_b32 v164, v8, v6, s48
    v_perm_b32 v165, v12, v10, s48
    v_perm_b32 v166, v9, v7, s48
    v_perm_b32 v167, v13, v11, s48
    v_mfma_f32_16x16x32_bf16 v[168:171], v[40:43], a[48:51], 0
    v_readlane_b32 s78, v7, 0
    v_mfma_f32_16x16x32_bf16 v[184:187], v[40:43], a[46:49], 0
    s_nop 2
    s_lshl_b32 s36, s78, 16
    v_mfma_f32_16x16x32_bf16 v[172:175], v[40:43], a[58:61], 0
    s_and_b32 s37, s78, 0xffff0000
    v_xor_b32 v200, s36, v148
    v_mfma_f32_16x16x32_bf16 v[188:191], v[40:43], a[56:59], 0
    v_xor_b32 v204, s37, v148
    v_mov_b32 v201, v200
    v_mfma_f32_16x16x32_bf16 v[176:179], v[164:167], a[48:51], 0
    v_mov_b32 v202, v200
    v_mov_b32 v203, v200
    v_mfma_f32_16x16x32_bf16 v[192:195], v[164:167], a[46:49], 0
    v_mov_b32 v205, v204
    v_mov_b32 v206, v204
    v_mfma_f32_16x16x32_bf16 v[180:183], v[164:167], a[58:61], 0
    v_mov_b32 v207, v204
    v_mfma_f32_16x16x32_bf16 v[196:199], v[164:167], a[56:59], 0
    v_pk_mul_f32 v[208:209], v[168:169], v[56:57]
    v_pk_mul_f32 v[224:225], v[184:185], v[56:57]
    v_pk_mul_f32 v[210:211], v[170:171], v[58:59]
    v_pk_mul_f32 v[226:227], v[186:187], v[58:59]
    v_pk_mul_f32 v[212:213], v[172:173], v[64:65]
    v_pk_mul_f32 v[228:229], v[188:189], v[64:65]
    v_pk_mul_f32 v[214:215], v[174:175], v[66:67]
    v_pk_mul_f32 v[230:231], v[190:191], v[66:67]
    v_pk_mul_f32 v[216:217], v[176:177], v[56:57]
    v_pk_mul_f32 v[232:233], v[192:193], v[56:57]
    v_pk_mul_f32 v[218:219], v[178:179], v[58:59]
    v_pk_mul_f32 v[234:235], v[194:195], v[58:59]
    v_pk_mul_f32 v[220:221], v[180:181], v[64:65]
    v_pk_mul_f32 v[236:237], v[196:197], v[64:65]
    v_pk_mul_f32 v[222:223], v[182:183], v[66:67]
    v_pk_mul_f32 v[238:239], v[198:199], v[66:67]
    v_pk_fma_f32 v[208:209], v[184:185], v[60:61], v[208:209] neg_lo:[1,0,0] neg_hi:[1,0,0]
    v_pk_fma_f32 v[224:225], v[168:169], v[60:61], v[224:225]
    v_pk_fma_f32 v[210:211], v[186:187], v[62:63], v[210:211] neg_lo:[1,0,0] neg_hi:[1,0,0]
    v_pk_fma_f32 v[226:227], v[170:171], v[62:63], v[226:227]
    v_pk_fma_f32 v[212:213], v[188:189], v[68:69], v[212:213] neg_lo:[1,0,0] neg_hi:[1,0,0]
    v_pk_fma_f32 v[228:229], v[172:173], v[68:69], v[228:229]
    v_pk_fma_f32 v[214:215], v[190:191], v[70:71], v[214:215] neg_lo:[1,0,0] neg_hi:[1,0,0]
    v_pk_fma_f32 v[230:231], v[174:175], v[70:71], v[230:231]
    v_pk_fma_f32 v[216:217], v[192:193], v[60:61], v[216:217] neg_lo:[1,0,0] neg_hi:[1,0,0]
    v_pk_fma_f32 v[232:233], v[176:177], v[60:61], v[232:233]
    v_pk_fma_f32 v[218:219], v[194:195], v[62:63], v[218:219] neg_lo:[1,0,0] neg_hi:[1,0,0]
    v_pk_fma_f32 v[234:235], v[178:179], v[62:63], v[234:235]
    v_pk_fma_f32 v[220:221], v[196:197], v[68:69], v[220:221] neg_lo:[1,0,0] neg_hi:[1,0,0]
    v_pk_fma_f32 v[236:237], v[180:181], v[68:69], v[236:237]
    v_pk_fma_f32 v[222:223], v[198:199], v[70:71], v[222:223] neg_lo:[1,0,0] neg_hi:[1,0,0]
    v_pk_fma_f32 v[238:239], v[182:183], v[70:71], v[238:239]
    v_cvt_pk_bf16_f32 v184, v208, v209
    v_cvt_pk_bf16_f32 v185, v210, v211
    v_cvt_pk_bf16_f32 v186, v224, v225
    v_cvt_pk_bf16_f32 v187, v226, v227
    v_cvt_pk_bf16_f32 v188, v212, v213
    v_cvt_pk_bf16_f32 v189, v214, v215
    v_cvt_pk_bf16_f32 v190, v228, v229
    v_cvt_pk_bf16_f32 v191, v230, v231
    v_cvt_pk_bf16_f32 v192, v216, v217
    v_cvt_pk_bf16_f32 v193, v218, v219
    v_cvt_pk_bf16_f32 v194, v232, v233
    v_cvt_pk_bf16_f32 v195, v234, v235
    v_cvt_pk_bf16_f32 v196, v220, v221
    v_cvt_pk_bf16_f32 v197, v222, v223
    v_cvt_pk_bf16_f32 v198, v236, v237
    v_cvt_pk_bf16_f32 v199, v238, v239
    v_mfma_f32_16x16x32_bf16 v[168:171], a[64:67], v[184:187], v[200:203]
    v_mfma_f32_16x16x32_bf16 v[172:175], a[64:67], v[188:191], v[200:203]
    v_mfma_f32_16x16x32_bf16 v[176:179], a[64:67], v[192:195], v[204:207]
    s_nop 5
    v_add_f32 v24, v24, v168
    v_add_f32 v26, v26, v169
    v_mfma_f32_16x16x32_bf16 v[180:183], a[64:67], v[196:199], v[204:207]
    v_add_f32 v32, v32, v172
    v_add_f32 v34, v34, v173
    v_add_f32 v28, v28, v170
    v_add_f32 v36, v36, v174
    v_add_f32 v25, v25, v176
    v_cvt_pk_bf16_f32 v16, v24, v25
    v_add_f32 v27, v27, v177
    v_lshlrev_b32 v24, 16, v16
    v_add_f32 v33, v33, v180
    v_cvt_pk_bf16_f32 v20, v32, v33
    v_add_f32 v35, v35, v181
    v_and_b32 v25, s49, v16
    v_cvt_pk_bf16_f32 v17, v26, v27
    v_lshlrev_b32 v32, 16, v20
    v_and_b32 v33, s49, v20
    v_cvt_pk_bf16_f32 v21, v34, v35
    v_add_f32 v29, v29, v178
    v_add_f32 v37, v37, v182
    v_pk_mul_f32 v[10:11], v[24:25], v[24:25]
    v_pk_mul_f32 v[12:13], v[32:33], v[32:33]
    v_lshlrev_b32 v26, 16, v17
    v_and_b32 v27, s49, v17
    v_cvt_pk_bf16_f32 v18, v28, v29
    v_lshlrev_b32 v34, 16, v21
    v_and_b32 v35, s49, v21
    v_cvt_pk_bf16_f32 v22, v36, v37
    v_add_f32 v30, v30, v171
    v_add_f32 v31, v31, v179
    v_add_f32 v38, v38, v175
    v_add_f32 v39, v39, v183
    v_pk_add_f32 v[6:7], v[24:25], v[26:27]
    v_pk_fma_f32 v[10:11], v[26:27], v[26:27], v[10:11]
    v_pk_add_f32 v[8:9], v[32:33], v[34:35]
    v_pk_fma_f32 v[12:13], v[34:35], v[34:35], v[12:13]
    v_lshlrev_b32 v28, 16, v18
    v_and_b32 v29, s49, v18
    v_cvt_pk_bf16_f32 v19, v30, v31
    v_lshlrev_b32 v36, 16, v22
    v_and_b32 v37, s49, v22
    v_cvt_pk_bf16_f32 v23, v38, v39
    v_pk_add_f32 v[6:7], v[6:7], v[28:29]
    v_pk_fma_f32 v[10:11], v[28:29], v[28:29], v[10:11]
    v_pk_add_f32 v[8:9], v[8:9], v[36:37]
    v_pk_fma_f32 v[12:13], v[36:37], v[36:37], v[12:13]
    v_lshlrev_b32 v30, 16, v19
    v_and_b32 v31, s49, v19
    v_lshlrev_b32 v38, 16, v23
    v_and_b32 v39, s49, v23
    v_pk_add_f32 v[6:7], v[6:7], v[30:31]
    v_pk_fma_f32 v[10:11], v[30:31], v[30:31], v[10:11]
    v_pk_add_f32 v[8:9], v[8:9], v[38:39]
    v_pk_fma_f32 v[12:13], v[38:39], v[38:39], v[12:13]
    v_pk_add_f32 v[6:7], v[6:7], v[8:9]
    v_pk_add_f32 v[10:11], v[10:11], v[12:13]
    s_nop 0
    v_permlane32_swap_b32 v6, v7
    v_permlane32_swap_b32 v10, v11
    v_add_f32 v6, v6, v7
    v_add_f32 v10, v10, v11
    s_nop 1
    v_permlane16_swap_b32 v6, v10
    v_add_f32 v6, v6, v10
    s_nop 1
    v_add_f32_dpp v6, v6, v6 row_ror:8 row_mask:0xf bank_mask:0xf
    s_nop 1
    v_add_f32_dpp v6, v6, v6 row_ror:4 row_mask:0xf bank_mask:0xf
    s_nop 1
    v_add_f32_dpp v6, v6, v6 quad_perm:[2,3,0,1] row_mask:0xf bank_mask:0xf
    s_nop 1
    v_add_f32_dpp v6, v6, v6 quad_perm:[1,0,3,2] row_mask:0xf bank_mask:0xf
    v_mov_b32 v11, v6
    s_nop 1
    v_permlane16_swap_b32 v6, v11
    v_mul_f32 v6, 0x3b000000, v6
    v_mul_f32 v11, 0x3b000000, v11
    v_fma_f32 v11, -v6, v6, v11
    v_cvt_pk_bf16_f32 v4, v6, v6
    v_max_f32 v11, 0, v11
    v_lshlrev_b32 v6, 16, v4
    v_cvt_pk_bf16_f32 v4, v11, v11
    v_lshlrev_b32 v11, 16, v4
    v_add_f32 v11, 0x3727c5ac, v11
    v_cvt_pk_bf16_f32 v4, v11, v11
    v_lshlrev_b32 v11, 16, v4
    v_sqrt_f32 v11, v11
    s_nop 0
    v_cvt_pk_bf16_f32 v4, v11, v11
    v_lshlrev_b32 v11, 16, v4
    v_rcp_f32 v11, v11
    s_nop 0
    v_mul_f32 v6, v6, v11
    v_readlane_b32 s80, v11, 0
    v_readlane_b32 s78, v6, 0
    v_readlane_b32 s79, v6, 32
    v_readlane_b32 s81, v11, 32
    v_mov_b32 v8, s78
    v_mov_b32 v9, s79
    v_pk_fma_f32 v[24:25], v[24:25], s[80:81], v[8:9] neg_lo:[0,0,1] neg_hi:[0,0,1]
    v_cvt_pk_bf16_f32 v40, v24, v25
    ds_write_b32 v159, v40 offset:16384
    v_pk_fma_f32 v[26:27], v[26:27], s[80:81], v[8:9] neg_lo:[0,0,1] neg_hi:[0,0,1]
    v_cvt_pk_bf16_f32 v41, v26, v27
    ds_write_b32 v159, v41 offset:16896
    v_pk_fma_f32 v[28:29], v[28:29], s[80:81], v[8:9] neg_lo:[0,0,1] neg_hi:[0,0,1]
    v_cvt_pk_bf16_f32 v42, v28, v29
    ds_write_b32 v159, v42 offset:17408
    v_pk_fma_f32 v[30:31], v[30:31], s[80:81], v[8:9] neg_lo:[0,0,1] neg_hi:[0,0,1]
    v_cvt_pk_bf16_f32 v43, v30, v31
    ds_write_b32 v159, v43 offset:17920
    v_pk_fma_f32 v[32:33], v[32:33], s[80:81], v[8:9] neg_lo:[0,0,1] neg_hi:[0,0,1]
    v_cvt_pk_bf16_f32 v164, v32, v33
    ds_write_b32 v159, v164 offset:16640
    v_pk_fma_f32 v[34:35], v[34:35], s[80:81], v[8:9] neg_lo:[0,0,1] neg_hi:[0,0,1]
    v_cvt_pk_bf16_f32 v165, v34, v35
    ds_write_b32 v159, v165 offset:17152
    v_pk_fma_f32 v[36:37], v[36:37], s[80:81], v[8:9] neg_lo:[0,0,1] neg_hi:[0,0,1]
    v_cvt_pk_bf16_f32 v166, v36, v37
    ds_write_b32 v159, v166 offset:17664
    v_pk_fma_f32 v[38:39], v[38:39], s[80:81], v[8:9] neg_lo:[0,0,1] neg_hi:[0,0,1]
    v_cvt_pk_bf16_f32 v167, v38, v39
    ds_write_b32 v159, v167 offset:18176
    s_waitcnt lgkmcnt(0)
    s_barrier
    ds_read_b128 v[136:139], v149 offset:16384
    ds_read_b128 v[140:143], v149 offset:20480
    v_add_u32 v6, 49152, v5
    ds_read_b128 v[220:223], v6 offset:0
    ds_read_b128 v[236:239], v6 offset:4096
    ds_read_b128 v[228:231], v6 offset:2048
    ds_read_b128 v[244:247], v6 offset:6144
    ds_read_b128 v[224:227], v6 offset:1024
    ds_read_b128 v[240:243], v6 offset:5120
    ds_read_b128 v[232:235], v6 offset:3072
    ds_read_b128 v[248:251], v6 offset:7168
    v_accvgpr_read_b32 v56, a204
    s_waitcnt lgkmcnt(9)
    buffer_store_dwordx4 v[136:139], v149, s[56:59], s76 offen sc1
    s_waitcnt lgkmcnt(7)
    v_mfma_f32_16x16x32_bf16 v[8:11], v[220:223], a[172:175], 0
    v_accvgpr_read_b32 v57, a205
    v_accvgpr_read_b32 v58, a206
    buffer_store_dwordx4 v[140:143], v149, s[56:59], s77 offen sc1
    v_mfma_f32_16x16x32_bf16 v[28:31], v[220:223], a[176:179], 0
    v_accvgpr_read_b32 v59, a207
    v_accvgpr_read_b32 v64, a212
    s_waitcnt lgkmcnt(6)
    v_mfma_f32_16x16x32_bf16 v[180:183], v[236:239], a[172:175], 0
    v_accvgpr_read_b32 v65, a213
    v_accvgpr_read_b32 v66, a214
    v_mfma_f32_16x16x32_bf16 v[188:191], v[236:239], a[176:179], 0
    v_accvgpr_read_b32 v67, a215
    v_accvgpr_read_b32 v60, a208
    s_waitcnt lgkmcnt(5)
    v_mfma_f32_16x16x32_bf16 v[24:27], v[228:231], a[172:175], 0
    v_accvgpr_read_b32 v61, a209
    v_accvgpr_read_b32 v62, a210
    v_mfma_f32_16x16x32_bf16 v[32:35], v[228:231], a[176:179], 0
    v_accvgpr_read_b32 v63, a211
    v_accvgpr_read_b32 v68, a216
    s_waitcnt lgkmcnt(4)
    v_mfma_f32_16x16x32_bf16 v[184:187], v[244:247], a[172:175], 0
    v_accvgpr_read_b32 v69, a217
    v_accvgpr_read_b32 v70, a218
    v_mfma_f32_16x16x32_bf16 v[192:195], v[244:247], a[176:179], 0
    v_accvgpr_read_b32 v71, a219
    s_add_u32 s72, s67, 8388608
    s_waitcnt lgkmcnt(3)
    v_mfma_f32_16x16x32_bf16 v[8:11], v[224:227], a[180:183], v[8:11]
    v_accvgpr_read_b32 v72, a220
    v_accvgpr_read_b32 v73, a221
    v_mfma_f32_16x16x32_bf16 v[28:31], v[224:227], a[184:187], v[28:31]
    v_accvgpr_read_b32 v74, a222
    v_accvgpr_read_b32 v75, a223
    s_waitcnt lgkmcnt(2)
    v_mfma_f32_16x16x32_bf16 v[180:183], v[240:243], a[180:183], v[180:183]
    s_nop 0
    v_mul_f32 v36, v8, v56
    v_mul_f32 v37, v9, v57
    v_mfma_f32_16x16x32_bf16 v[188:191], v[240:243], a[184:187], v[188:191]
    v_mul_f32 v164, v28, v56
    v_mul_f32 v165, v29, v57
    s_waitcnt lgkmcnt(1)
    v_mfma_f32_16x16x32_bf16 v[24:27], v[232:235], a[180:183], v[24:27]
    v_mul_f32 v38, v10, v58
    v_mul_f32 v166, v30, v58
    v_mfma_f32_16x16x32_bf16 v[32:35], v[232:235], a[184:187], v[32:35]
    v_mul_f32 v39, v11, v59
    v_mul_f32 v167, v31, v59
    s_waitcnt lgkmcnt(0)
    v_mfma_f32_16x16x32_bf16 v[184:187], v[248:251], a[180:183], v[184:187]
    v_mul_f32 v196, v180, v56
    v_mul_f32 v204, v188, v56
    v_mfma_f32_16x16x32_bf16 v[192:195], v[248:251], a[184:187], v[192:195]
    v_mul_f32 v197, v181, v57
    v_mul_f32 v205, v189, v57
    v_mul_f32 v198, v182, v58
    v_mul_f32 v206, v190, v58
    v_mul_f32 v199, v183, v59
    v_mul_f32 v207, v191, v59
    v_fma_f32 v36, v28, v64, v36
    v_fma_f32 v164, -v8, v64, v164
    v_fma_f32 v37, v29, v65, v37
    v_fma_f32 v165, -v9, v65, v165
    v_fma_f32 v38, v30, v66, v38
    v_fma_f32 v166, -v10, v66, v166
    v_fma_f32 v39, v31, v67, v39
    v_fma_f32 v167, -v11, v67, v167
    v_fma_f32 v196, v188, v64, v196
    v_fma_f32 v204, -v180, v64, v204
    v_fma_f32 v197, v189, v65, v197
    v_fma_f32 v205, -v181, v65, v205
    v_fma_f32 v198, v190, v66, v198
    v_fma_f32 v206, -v182, v66, v206
    v_fma_f32 v199, v191, v67, v199
    v_fma_f32 v207, -v183, v67, v207
    v_cvt_pk_bf16_f32 v172, v36, v37
    v_cvt_pk_bf16_f32 v173, v38, v39
    v_cvt_pk_bf16_f32 v174, v164, v165
    v_cvt_pk_bf16_f32 v175, v166, v167
    v_cvt_pk_bf16_f32 v212, v196, v197
    v_cvt_pk_bf16_f32 v213, v198, v199
    v_cvt_pk_bf16_f32 v214, v204, v205
    v_cvt_pk_bf16_f32 v215, v206, v207
    v_mul_f32 v40, v24, v60
    v_mul_f32 v168, v32, v60
    v_mul_f32 v41, v25, v61
    v_mul_f32 v169, v33, v61
    v_mul_f32 v42, v26, v62
    v_mul_f32 v170, v34, v62
    v_mul_f32 v43, v27, v63
    v_mul_f32 v171, v35, v63
    v_mul_f32 v200, v184, v60
    v_mul_f32 v208, v192, v60
    v_mul_f32 v201, v185, v61
    v_mul_f32 v209, v193, v61
    v_mul_f32 v202, v186, v62
    v_mul_f32 v210, v194, v62
    v_mul_f32 v203, v187, v63
    v_mul_f32 v211, v195, v63
    v_fma_f32 v40, v32, v68, v40
    v_fma_f32 v168, -v24, v68, v168
    v_fma_f32 v41, v33, v69, v41
    v_fma_f32 v169, -v25, v69, v169
    v_fma_f32 v42, v34, v70, v42
    v_fma_f32 v170, -v26, v70, v170
    v_fma_f32 v43, v35, v71, v43
    v_fma_f32 v171, -v27, v71, v171
    v_fma_f32 v200, v192, v68, v200
    v_fma_f32 v208, -v184, v68, v208
    v_fma_f32 v201, v193, v69, v201
    v_fma_f32 v209, -v185, v69, v209
    v_fma_f32 v202, v194, v70, v202
    v_fma_f32 v210, -v186, v70, v210
    v_fma_f32 v203, v195, v71, v203
    v_fma_f32 v211, -v187, v71, v211
    v_mfma_f32_16x16x32_bf16 v[8:11], a[4:7], v[172:175], 0
    v_cvt_pk_bf16_f32 v176, v40, v41
    v_cvt_pk_bf16_f32 v177, v42, v43
    v_mfma_f32_16x16x32_bf16 v[28:31], a[10:13], v[172:175], 0
    v_cvt_pk_bf16_f32 v178, v168, v169
    v_cvt_pk_bf16_f32 v179, v170, v171
    v_mfma_f32_16x16x32_bf16 v[24:27], a[24:27], v[172:175], 0
    v_cvt_pk_bf16_f32 v216, v200, v201
    v_cvt_pk_bf16_f32 v217, v202, v203
    v_mfma_f32_16x16x32_bf16 v[32:35], a[30:33], v[172:175], 0
    v_cvt_pk_bf16_f32 v218, v208, v209
    v_cvt_pk_bf16_f32 v219, v210, v211
    v_mfma_f32_16x16x32_bf16 v[180:183], a[4:7], v[212:215], 0
    v_accvgpr_read_b32 v76, a224
    v_accvgpr_read_b32 v77, a225
    v_mfma_f32_16x16x32_bf16 v[188:191], a[10:13], v[212:215], 0
    v_accvgpr_read_b32 v78, a226
    v_accvgpr_read_b32 v79, a227
    v_mfma_f32_16x16x32_bf16 v[184:187], a[24:27], v[212:215], 0
    v_accvgpr_read_b32 v80, a228
    v_accvgpr_read_b32 v81, a229
    v_mfma_f32_16x16x32_bf16 v[192:195], a[30:33], v[212:215], 0
    v_accvgpr_read_b32 v82, a230
    v_accvgpr_read_b32 v83, a231
    v_mfma_f32_16x16x32_bf16 v[8:11], a[14:17], v[176:179], v[8:11]
    v_accvgpr_read_b32 v84, a232
    v_accvgpr_read_b32 v85, a233
    v_mfma_f32_16x16x32_bf16 v[28:31], a[20:23], v[176:179], v[28:31]
    v_accvgpr_read_b32 v86, a234
    v_accvgpr_read_b32 v87, a235
    v_mfma_f32_16x16x32_bf16 v[24:27], a[34:37], v[176:179], v[24:27]
    s_nop 1
    v_mul_f32 v104, 0x3a000000, v8
    v_mul_f32 v105, 0x3a000000, v9
    v_mfma_f32_16x16x32_bf16 v[32:35], a[40:43], v[176:179], v[32:35]
    v_mul_f32 v108, 0x3a000000, v28
    v_mul_f32 v109, 0x3a000000, v29
    v_mfma_f32_16x16x32_bf16 v[180:183], a[14:17], v[216:219], v[180:183]
    v_mul_f32 v106, 0x3a000000, v10
    v_mul_f32 v110, 0x3a000000, v30
    v_mfma_f32_16x16x32_bf16 v[188:191], a[20:23], v[216:219], v[188:191]
    v_mul_f32 v107, 0x3a000000, v11
    v_mul_f32 v111, 0x3a000000, v31
    v_mfma_f32_16x16x32_bf16 v[184:187], a[34:37], v[216:219], v[184:187]
    v_mul_f32 v112, 0x3a000000, v24
    v_mul_f32 v116, 0x3a000000, v32
    v_mfma_f32_16x16x32_bf16 v[192:195], a[40:43], v[216:219], v[192:195]
    v_mul_f32 v113, 0x3a000000, v25
    v_mul_f32 v117, 0x3a000000, v33
    v_mul_f32 v114, 0x3a000000, v26
    v_mul_f32 v118, 0x3a000000, v34
    v_mul_f32 v115, 0x3a000000, v27
    v_mul_f32 v119, 0x3a000000, v35
    v_mul_f32 v120, 0x3a000000, v180
    v_mul_f32 v124, 0x3a000000, v188
    v_mul_f32 v121, 0x3a000000, v181
    v_mul_f32 v125, 0x3a000000, v189
    v_mul_f32 v122, 0x3a000000, v182
    v_mul_f32 v126, 0x3a000000, v190
    v_mul_f32 v123, 0x3a000000, v183
    v_mul_f32 v127, 0x3a000000, v191
    v_mul_f32 v128, 0x3a000000, v184
    v_mul_f32 v132, 0x3a000000, v192
    v_mul_f32 v129, 0x3a000000, v185
    v_mul_f32 v133, 0x3a000000, v193
    v_mul_f32 v130, 0x3a000000, v186
    v_mul_f32 v134, 0x3a000000, v194
    v_mul_f32 v131, 0x3a000000, v187
    v_mul_f32 v135, 0x3a000000, v195
    s_add_u32 s73, s67, 9437184
    s_waitcnt vmcnt(0)
    ds_write_b32 v159, v16 offset:0
    ds_write_b32 v159, v17 offset:512
    ds_write_b32 v159, v18 offset:1024
    ds_write_b32 v159, v19 offset:1536
    ds_write_b32 v159, v20 offset:256
    ds_write_b32 v159, v21 offset:768
    ds_write_b32 v159, v22 offset:1280
    ds_write_b32 v159, v23 offset:1792
    s_nop 0
    buffer_load_dwordx4 v[48:51], v150, s[56:59], s72 offen sc1
    s_add_u32 s74, s65, 2097152
    s_add_u32 s75, s65, 2101248
    s_add_u32 s76, s66, 12582912
    s_mov_b32 s38, 131072
    buffer_load_dwordx4 v[52:55], v150, s[56:59], s73 offen sc1
L_chk2:
    s_waitcnt vmcnt(0)
    v_max3_u32 v6, v48, v49, v50
    v_max3_u32 v6, v6, v51, v52
    v_max3_u32 v6, v6, v53, v54
    v_max_u32 v6, v6, v55
    v_cmp_eq_u32 vcc, -1, v6
    s_nop 0
    s_cbranch_vccz L_ok2
    s_sub_u32 s38, s38, 1
    s_cmp_eq_u32 s38, 0
    s_cbranch_scc1 L_ok2
    buffer_load_dwordx4 v[48:51], v150, s[56:59], s72 offen sc1
    buffer_load_dwordx4 v[52:55], v150, s[56:59], s73 offen sc1
    s_branch L_chk2
L_ok2:
    ds_write_b128 v160, v[48:51] offset:8192
    ds_write_b128 v160, v[52:55] offset:10240
    s_waitcnt lgkmcnt(0)
    s_barrier
    s_add_u32 s74, s65, 6291456
    s_add_u32 s75, s65, 6295552
    ds_read_b128 v[6:9], v161 offset:8192
    ds_read_b128 v[10:13], v161 offset:10240
    ds_read_b128 v[16:19], v161 offset:8448
    ds_read_b128 v[20:23], v161 offset:10496
    ds_read_b128 v[24:27], v161 offset:12288
    ds_read_b128 v[28:31], v161 offset:14336
    ds_read_b128 v[32:35], v161 offset:12544
    ds_read_b128 v[36:39], v161 offset:14592
    ds_read_b64 v[40:41], v162 offset:8192
    ds_read_b64 v[42:43], v162 offset:8448
    ds_read_b64 v[44:45], v162 offset:12288
    ds_read_b64 v[152:153], v162 offset:12544
    buffer_store_dwordx4 v[144:147], v149, s[56:59], s74 offen sc1
    s_waitcnt lgkmcnt(11)
    v_mfma_f32_16x16x32_bf16 v[164:167], v[6:9], a[172:175], 0
    buffer_store_dwordx4 v[144:147], v149, s[56:59], s75 offen sc1
    v_mfma_f32_16x16x32_bf16 v[172:175], v[6:9], a[176:179], 0
    s_waitcnt lgkmcnt(10)
    v_mfma_f32_16x16x32_bf16 v[164:167], v[10:13], a[180:183], v[164:167]
    v_mfma_f32_16x16x32_bf16 v[172:175], v[10:13], a[184:187], v[172:175]
    s_waitcnt lgkmcnt(9)
    v_mfma_f32_16x16x32_bf16 v[168:171], v[16:19], a[172:175], 0
    v_mfma_f32_16x16x32_bf16 v[176:179], v[16:19], a[176:179], 0
    s_waitcnt lgkmcnt(3)
    v_lshlrev_b32 v16, 16, v40
    v_and_b32 v17, s49, v40
    v_mfma_f32_16x16x32_bf16 v[168:171], v[20:23], a[180:183], v[168:171]
    v_lshlrev_b32 v18, 16, v41
    v_and_b32 v19, s49, v41
    v_mfma_f32_16x16x32_bf16 v[176:179], v[20:23], a[184:187], v[176:179]
    s_waitcnt lgkmcnt(2)
    v_lshlrev_b32 v20, 16, v42
    v_and_b32 v21, s49, v42
    v_mfma_f32_16x16x32_bf16 v[204:207], v[24:27], a[172:175], 0
    v_lshlrev_b32 v22, 16, v43
    v_and_b32 v23, s49, v43
    v_mfma_f32_16x16x32_bf16 v[212:215], v[24:27], a[176:179], 0
    v_mfma_f32_16x16x32_bf16 v[204:207], v[28:31], a[180:183], v[204:207]
    v_mfma_f32_16x16x32_bf16 v[212:215], v[28:31], a[184:187], v[212:215]
    v_mfma_f32_16x16x32_bf16 v[208:211], v[32:35], a[172:175], 0
    s_nop 5
    v_mul_f32 v220, v204, v56
    v_mul_f32 v221, v205, v57
    v_mfma_f32_16x16x32_bf16 v[216:219], v[32:35], a[176:179], 0
    v_mul_f32 v228, v212, v56
    v_mul_f32 v229, v213, v57
    v_mfma_f32_16x16x32_bf16 v[208:211], v[36:39], a[180:183], v[208:211]
    v_mul_f32 v222, v206, v58
    v_mul_f32 v230, v214, v58
    v_mfma_f32_16x16x32_bf16 v[216:219], v[36:39], a[184:187], v[216:219]
    v_mul_f32 v223, v207, v59
    v_mul_f32 v231, v215, v59
    v_fma_f32 v220, v212, v64, v220
    v_fma_f32 v228, -v204, v64, v228
    v_pk_mul_f32 v[180:181], v[164:165], v[56:57]
    v_pk_mul_f32 v[188:189], v[172:173], v[56:57]
    v_pk_mul_f32 v[182:183], v[166:167], v[58:59]
    v_pk_mul_f32 v[190:191], v[174:175], v[58:59]
    v_pk_fma_f32 v[180:181], v[172:173], v[64:65], v[180:181]
    v_pk_fma_f32 v[188:189], v[164:165], v[64:65], v[188:189] neg_lo:[1,0,0] neg_hi:[1,0,0]
    v_pk_fma_f32 v[182:183], v[174:175], v[66:67], v[182:183]
    v_pk_fma_f32 v[190:191], v[166:167], v[66:67], v[190:191] neg_lo:[1,0,0] neg_hi:[1,0,0]
    v_cvt_pk_bf16_f32 v196, v180, v181
    v_cvt_pk_bf16_f32 v197, v182, v183
    v_cvt_pk_bf16_f32 v198, v188, v189
    v_cvt_pk_bf16_f32 v199, v190, v191
    v_pk_mul_f32 v[184:185], v[168:169], v[60:61]
    v_pk_mul_f32 v[192:193], v[176:177], v[60:61]
    v_pk_mul_f32 v[186:187], v[170:171], v[62:63]
    v_pk_mul_f32 v[194:195], v[178:179], v[62:63]
    v_pk_fma_f32 v[184:185], v[176:177], v[68:69], v[184:185]
    v_pk_fma_f32 v[192:193], v[168:169], v[68:69], v[192:193] neg_lo:[1,0,0] neg_hi:[1,0,0]
    v_pk_fma_f32 v[186:187], v[178:179], v[70:71], v[186:187]
    v_pk_fma_f32 v[194:195], v[170:171], v[70:71], v[194:195] neg_lo:[1,0,0] neg_hi:[1,0,0]
    v_mfma_f32_16x16x32_bf16 v[164:167], a[4:7], v[196:199], 0
    v_cvt_pk_bf16_f32 v200, v184, v185
    v_cvt_pk_bf16_f32 v201, v186, v187
    v_mfma_f32_16x16x32_bf16 v[172:175], a[10:13], v[196:199], 0
    v_cvt_pk_bf16_f32 v202, v192, v193
    v_cvt_pk_bf16_f32 v203, v194, v195
    v_mfma_f32_16x16x32_bf16 v[168:171], a[24:27], v[196:199], 0
    v_fma_f32 v221, v213, v65, v221
    v_fma_f32 v229, -v205, v65, v229
    v_mfma_f32_16x16x32_bf16 v[176:179], a[30:33], v[196:199], 0
    v_fma_f32 v222, v214, v66, v222
    v_fma_f32 v230, -v206, v66, v230
    v_mfma_f32_16x16x32_bf16 v[164:167], a[14:17], v[200:203], v[164:167]
    v_fma_f32 v223, v215, v67, v223
    v_fma_f32 v231, -v207, v67, v231
    v_mfma_f32_16x16x32_bf16 v[172:175], a[20:23], v[200:203], v[172:175]
    v_cvt_pk_bf16_f32 v236, v220, v221
    v_cvt_pk_bf16_f32 v237, v222, v223
    v_mfma_f32_16x16x32_bf16 v[168:171], a[34:37], v[200:203], v[168:171]
    v_cvt_pk_bf16_f32 v238, v228, v229
    v_cvt_pk_bf16_f32 v239, v230, v231
    v_mfma_f32_16x16x32_bf16 v[176:179], a[40:43], v[200:203], v[176:179]
    v_mul_f32 v224, v208, v60
    v_mul_f32 v232, v216, v60
    v_mul_f32 v225, v209, v61
    v_mul_f32 v233, v217, v61
    v_mul_f32 v226, v210, v62
    v_mul_f32 v234, v218, v62
    v_mul_f32 v227, v211, v63
    v_mul_f32 v235, v219, v63
    v_fma_f32 v224, v216, v68, v224
    v_fma_f32 v232, -v208, v68, v232
    v_fma_f32 v225, v217, v69, v225
    v_fma_f32 v233, -v209, v69, v233
    v_fma_f32 v226, v218, v70, v226
    v_fma_f32 v234, -v210, v70, v234
    v_fma_f32 v227, v219, v71, v227
    v_fma_f32 v235, -v211, v71, v235
    v_pk_mul_f32 v[180:181], v[164:165], v[104:105]
    v_pk_mul_f32 v[188:189], v[172:173], v[104:105]
    v_pk_mul_f32 v[182:183], v[166:167], v[106:107]
    v_pk_mul_f32 v[190:191], v[174:175], v[106:107]
    v_mfma_f32_16x16x32_bf16 v[204:207], a[4:7], v[236:239], 0
    v_cvt_pk_bf16_f32 v240, v224, v225
    v_cvt_pk_bf16_f32 v241, v226, v227
    v_mfma_f32_16x16x32_bf16 v[212:215], a[10:13], v[236:239], 0
    v_cvt_pk_bf16_f32 v242, v232, v233
    v_cvt_pk_bf16_f32 v243, v234, v235
    v_mfma_f32_16x16x32_bf16 v[208:211], a[24:27], v[236:239], 0
    s_waitcnt lgkmcnt(1)
    v_lshlrev_b32 v32, 16, v44
    v_and_b32 v33, s49, v44
    v_mfma_f32_16x16x32_bf16 v[216:219], a[30:33], v[236:239], 0
    v_lshlrev_b32 v34, 16, v45
    v_and_b32 v35, s49, v45
    v_mfma_f32_16x16x32_bf16 v[204:207], a[14:17], v[240:243], v[204:207]
    s_waitcnt lgkmcnt(0)
    v_lshlrev_b32 v36, 16, v152
    v_and_b32 v37, s49, v152
    v_mfma_f32_16x16x32_bf16 v[212:215], a[20:23], v[240:243], v[212:215]
    v_lshlrev_b32 v38, 16, v153
    v_and_b32 v39, s49, v153
    v_mfma_f32_16x16x32_bf16 v[208:211], a[34:37], v[240:243], v[208:211]
    s_nop 0
    v_mul_f32 v220, v204, v120
    v_mul_f32 v221, v205, v121
    v_mfma_f32_16x16x32_bf16 v[216:219], a[40:43], v[240:243], v[216:219]
    s_nop 0
    v_mul_f32 v228, v212, v120
    v_mul_f32 v229, v213, v121
    v_mul_f32 v222, v206, v122
    v_mul_f32 v230, v214, v122
    v_mul_f32 v223, v207, v123
    v_pk_fma_f32 v[180:181], v[172:173], v[108:109], v[180:181] neg_lo:[1,0,0] neg_hi:[1,0,0]
    v_pk_fma_f32 v[188:189], v[164:165], v[108:109], v[188:189]
    v_pk_fma_f32 v[182:183], v[174:175], v[110:111], v[182:183] neg_lo:[1,0,0] neg_hi:[1,0,0]
    v_pk_fma_f32 v[190:191], v[166:167], v[110:111], v[190:191]
    v_cvt_pk_bf16_f32 v196, v180, v181
    v_cvt_pk_bf16_f32 v197, v182, v183
    v_cvt_pk_bf16_f32 v198, v188, v189
    v_cvt_pk_bf16_f32 v199, v190, v191
    v_pk_mul_f32 v[184:185], v[168:169], v[112:113]
    v_pk_mul_f32 v[192:193], v[176:177], v[112:113]
    v_pk_mul_f32 v[186:187], v[170:171], v[114:115]
    v_pk_mul_f32 v[194:195], v[178:179], v[114:115]
    v_pk_fma_f32 v[184:185], v[176:177], v[116:117], v[184:185] neg_lo:[1,0,0] neg_hi:[1,0,0]
    v_pk_fma_f32 v[192:193], v[168:169], v[116:117], v[192:193]
    v_pk_fma_f32 v[186:187], v[178:179], v[118:119], v[186:187] neg_lo:[1,0,0] neg_hi:[1,0,0]
    v_pk_fma_f32 v[194:195], v[170:171], v[118:119], v[194:195]
    v_mfma_f32_16x16x32_bf16 v[164:167], v[196:199], a[8:11], 0
    v_cvt_pk_bf16_f32 v200, v184, v185
    v_cvt_pk_bf16_f32 v201, v186, v187
    v_mfma_f32_16x16x32_bf16 v[172:175], v[196:199], a[6:9], 0
    v_cvt_pk_bf16_f32 v202, v192, v193
    v_cvt_pk_bf16_f32 v203, v194, v195
    v_mfma_f32_16x16x32_bf16 v[168:171], v[196:199], a[28:31], 0
    v_mul_f32 v231, v215, v123
    v_fma_f32 v220, -v212, v124, v220
    v_mfma_f32_16x16x32_bf16 v[164:167], v[200:203], a[18:21], v[164:167]
    v_fma_f32 v228, v204, v124, v228
    v_fma_f32 v221, -v213, v125, v221
    v_mfma_f32_16x16x32_bf16 v[172:175], v[200:203], a[16:19], v[172:175]
    v_fma_f32 v229, v205, v125, v229
    v_fma_f32 v222, -v214, v126, v222
    v_mfma_f32_16x16x32_bf16 v[176:179], v[196:199], a[26:29], 0
    v_fma_f32 v230, v206, v126, v230
    v_fma_f32 v223, -v215, v127, v223
    v_fma_f32 v231, v207, v127, v231
    v_cvt_pk_bf16_f32 v236, v220, v221
    v_cvt_pk_bf16_f32 v237, v222, v223
    v_cvt_pk_bf16_f32 v238, v228, v229
    v_cvt_pk_bf16_f32 v239, v230, v231
    v_mfma_f32_16x16x32_bf16 v[168:171], v[200:203], a[38:41], v[168:171]
    v_mul_f32 v224, v208, v128
    v_mul_f32 v232, v216, v128
    v_mfma_f32_16x16x32_bf16 v[176:179], v[200:203], a[36:39], v[176:179]
    v_mul_f32 v225, v209, v129
    v_mul_f32 v233, v217, v129
    v_mul_f32 v226, v210, v130
    v_mul_f32 v234, v218, v130
    v_mul_f32 v227, v211, v131
    v_mul_f32 v235, v219, v131
    v_fma_f32 v224, -v216, v132, v224
    v_fma_f32 v232, v208, v132, v232
    v_fma_f32 v225, -v217, v133, v225
    v_fma_f32 v233, v209, v133, v233
    v_fma_f32 v226, -v218, v134, v226
    v_fma_f32 v234, v210, v134, v234
    v_fma_f32 v227, -v219, v135, v227
    v_fma_f32 v235, v211, v135, v235
    v_pk_mul_f32 v[180:181], v[164:165], v[72:73]
    v_pk_mul_f32 v[188:189], v[172:173], v[72:73]
    v_pk_mul_f32 v[182:183], v[166:167], v[74:75]
    v_pk_mul_f32 v[190:191], v[174:175], v[74:75]
    v_mfma_f32_16x16x32_bf16 v[204:207], v[236:239], a[8:11], 0
    v_cvt_pk_bf16_f32 v240, v224, v225
    v_cvt_pk_bf16_f32 v241, v226, v227
    v_mfma_f32_16x16x32_bf16 v[212:215], v[236:239], a[6:9], 0
    v_cvt_pk_bf16_f32 v242, v232, v233
    v_cvt_pk_bf16_f32 v243, v234, v235
    v_mfma_f32_16x16x32_bf16 v[208:211], v[236:239], a[28:31], 0
    s_nop 0
    v_mfma_f32_16x16x32_bf16 v[204:207], v[240:243], a[18:21], v[204:207]
    v_mfma_f32_16x16x32_bf16 v[212:215], v[240:243], a[16:19], v[212:215]
    v_mfma_f32_16x16x32_bf16 v[216:219], v[236:239], a[26:29], 0
    v_mfma_f32_16x16x32_bf16 v[208:211], v[240:243], a[38:41], v[208:211]
    v_mfma_f32_16x16x32_bf16 v[216:219], v[240:243], a[36:39], v[216:219]
    v_pk_fma_f32 v[180:181], v[172:173], v[80:81], v[180:181] neg_lo:[1,0,0] neg_hi:[1,0,0]
    v_pk_fma_f32 v[188:189], v[164:165], v[80:81], v[188:189]
    v_pk_fma_f32 v[182:183], v[174:175], v[82:83], v[182:183] neg_lo:[1,0,0] neg_hi:[1,0,0]
    v_pk_fma_f32 v[190:191], v[166:167], v[82:83], v[190:191]
    v_cvt_pk_bf16_f32 v6, v180, v181
    v_cvt_pk_bf16_f32 v7, v182, v183
    v_cvt_pk_bf16_f32 v8, v188, v189
    v_cvt_pk_bf16_f32 v9, v190, v191
    ds_write_b128 v157, v[6:9] offset:16384
    v_pk_mul_f32 v[184:185], v[168:169], v[76:77]
    v_pk_mul_f32 v[192:193], v[176:177], v[76:77]
    v_pk_mul_f32 v[186:187], v[170:171], v[78:79]
    v_pk_mul_f32 v[194:195], v[178:179], v[78:79]
    v_pk_fma_f32 v[184:185], v[176:177], v[84:85], v[184:185] neg_lo:[1,0,0] neg_hi:[1,0,0]
    v_pk_fma_f32 v[192:193], v[168:169], v[84:85], v[192:193]
    v_pk_fma_f32 v[186:187], v[178:179], v[86:87], v[186:187] neg_lo:[1,0,0] neg_hi:[1,0,0]
    v_pk_fma_f32 v[194:195], v[170:171], v[86:87], v[194:195]
    v_cvt_pk_bf16_f32 v10, v184, v185
    v_cvt_pk_bf16_f32 v11, v186, v187
    v_cvt_pk_bf16_f32 v12, v192, v193
    v_cvt_pk_bf16_f32 v13, v194, v195
    ds_write_b128 v157, v[10:13] offset:17408
    v_pk_mul_f32 v[220:221], v[204:205], v[72:73]
    v_pk_mul_f32 v[228:229], v[212:213], v[72:73]
    v_pk_mul_f32 v[222:223], v[206:207], v[74:75]
    v_pk_mul_f32 v[230:231], v[214:215], v[74:75]
    v_pk_fma_f32 v[220:221], v[212:213], v[80:81], v[220:221] neg_lo:[1,0,0] neg_hi:[1,0,0]
    v_pk_fma_f32 v[228:229], v[204:205], v[80:81], v[228:229]
    v_pk_fma_f32 v[222:223], v[214:215], v[82:83], v[222:223] neg_lo:[1,0,0] neg_hi:[1,0,0]
    v_pk_fma_f32 v[230:231], v[206:207], v[82:83], v[230:231]
    v_cvt_pk_bf16_f32 v24, v220, v221
    v_cvt_pk_bf16_f32 v25, v222, v223
    v_cvt_pk_bf16_f32 v26, v228, v229
    v_cvt_pk_bf16_f32 v27, v230, v231
    ds_write_b128 v157, v[24:27] offset:24576
    v_pk_mul_f32 v[224:225], v[208:209], v[76:77]
    v_pk_mul_f32 v[232:233], v[216:217], v[76:77]
    v_pk_mul_f32 v[226:227], v[210:211], v[78:79]
    v_pk_mul_f32 v[234:235], v[218:219], v[78:79]
    v_pk_fma_f32 v[224:225], v[216:217], v[84:85], v[224:225] neg_lo:[1,0,0] neg_hi:[1,0,0]
    v_pk_fma_f32 v[232:233], v[208:209], v[84:85], v[232:233]
    v_pk_fma_f32 v[226:227], v[218:219], v[86:87], v[226:227] neg_lo:[1,0,0] neg_hi:[1,0,0]
    v_pk_fma_f32 v[234:235], v[210:211], v[86:87], v[234:235]
    v_cvt_pk_bf16_f32 v28, v224, v225
    v_cvt_pk_bf16_f32 v29, v226, v227
    v_cvt_pk_bf16_f32 v30, v232, v233
    v_cvt_pk_bf16_f32 v31, v234, v235
    ds_write_b128 v157, v[28:31] offset:25600
    s_waitcnt lgkmcnt(0)
    s_barrier
    ds_read_b128 v[180:183], v5 offset:16384
    ds_read_b128 v[220:223], v5 offset:24576
    ds_read_b128 v[184:187], v5 offset:18432
    ds_read_b128 v[224:227], v5 offset:26624
    ds_read_b128 v[188:191], v5 offset:20480
    ds_read_b128 v[228:231], v5 offset:28672
    ds_read_b128 v[192:195], v5 offset:22528
    ds_read_b128 v[232:235], v5 offset:30720
    ds_read_b128 v[172:175], v5 offset:17408
    ds_read_b128 v[212:215], v5 offset:25600
    ds_read_b128 v[176:179], v5 offset:19456
    s_waitcnt lgkmcnt(10)
    v_mfma_f32_16x16x32_bf16 v[164:167], a[188:191], v[180:183], 0
    ds_read_b128 v[216:219], v5 offset:27648
    s_waitcnt lgkmcnt(10)
    v_mfma_f32_16x16x32_bf16 v[204:207], a[188:191], v[220:223], 0
    ds_read_b128 v[196:199], v5 offset:21504
    s_waitcnt lgkmcnt(10)
    v_mfma_f32_16x16x32_bf16 v[164:167], a[192:195], v[184:187], v[164:167]
    ds_read_b128 v[236:239], v5 offset:29696
    s_waitcnt lgkmcnt(10)
    v_mfma_f32_16x16x32_bf16 v[204:207], a[192:195], v[224:227], v[204:207]
    ds_read_b128 v[200:203], v5 offset:23552
    s_waitcnt lgkmcnt(10)
    v_mfma_f32_16x16x32_bf16 v[164:167], a[196:199], v[188:191], v[164:167]
    ds_read_b128 v[240:243], v5 offset:31744
    s_waitcnt lgkmcnt(10)
    v_mfma_f32_16x16x32_bf16 v[204:207], a[196:199], v[228:231], v[204:207]
    s_add_u32 s72, s67, 12582912
    s_add_u32 s73, s67, 13631488
    s_waitcnt lgkmcnt(9)
    v_mfma_f32_16x16x32_bf16 v[164:167], a[200:203], v[192:195], v[164:167]
    s_waitcnt lgkmcnt(8)
    v_mfma_f32_16x16x32_bf16 v[204:207], a[200:203], v[232:235], v[204:207]
    s_waitcnt lgkmcnt(7)
    v_mfma_f32_16x16x32_bf16 v[168:171], a[188:191], v[172:175], 0
    s_nop 3
    v_fmac_f32 v164, s68, v16
    v_fmac_f32 v165, s68, v17
    v_fmac_f32 v166, s68, v18
    v_fmac_f32 v167, s68, v19
    v_fmac_f32 v204, s70, v32
    v_fmac_f32 v205, s70, v33
    v_fmac_f32 v206, s70, v34
    v_fmac_f32 v207, s70, v35
    v_cvt_pk_bf16_f32 v136, v164, v165
    v_cvt_pk_bf16_f32 v137, v166, v167
    v_cvt_pk_bf16_f32 v138, v204, v205
    v_cvt_pk_bf16_f32 v139, v206, v207
    s_waitcnt lgkmcnt(6)
    v_mfma_f32_16x16x32_bf16 v[208:211], a[188:191], v[212:215], 0
    v_permlane16_swap_b32 v136, v138
    v_permlane16_swap_b32 v137, v139
    buffer_store_dwordx4 v[136:139], v151, s[56:59], s76 offen offset:0 sc1
    s_waitcnt lgkmcnt(5)
    v_mfma_f32_16x16x32_bf16 v[168:171], a[192:195], v[176:179], v[168:171]
    s_waitcnt lgkmcnt(4)
    v_mfma_f32_16x16x32_bf16 v[208:211], a[192:195], v[216:219], v[208:211]
    s_waitcnt lgkmcnt(3)
    v_mfma_f32_16x16x32_bf16 v[168:171], a[196:199], v[196:199], v[168:171]
    s_waitcnt lgkmcnt(2)
    v_mfma_f32_16x16x32_bf16 v[208:211], a[196:199], v[236:239], v[208:211]
    s_waitcnt lgkmcnt(1)
    v_mfma_f32_16x16x32_bf16 v[168:171], a[200:203], v[200:203], v[168:171]
    s_waitcnt lgkmcnt(0)
    v_mfma_f32_16x16x32_bf16 v[208:211], a[200:203], v[240:243], v[208:211]
    s_nop 5
    v_fmac_f32 v168, s68, v20
    v_fmac_f32 v169, s68, v21
    v_fmac_f32 v170, s68, v22
    v_fmac_f32 v171, s68, v23
    v_fmac_f32 v208, s70, v36
    v_fmac_f32 v209, s70, v37
    v_fmac_f32 v210, s70, v38
    v_fmac_f32 v211, s70, v39
    v_cvt_pk_bf16_f32 v140, v168, v169
    v_cvt_pk_bf16_f32 v141, v170, v171
    v_cvt_pk_bf16_f32 v142, v208, v209
    v_cvt_pk_bf16_f32 v143, v210, v211
    s_nop 0
    v_permlane16_swap_b32 v140, v142
    v_permlane16_swap_b32 v141, v143
    buffer_store_dwordx4 v[140:143], v151, s[56:59], s76 offen offset:512 sc1
    s_waitcnt vmcnt(0)
    ds_read_b128 v[6:9], v149 offset:0
    ds_read_b128 v[10:13], v149 offset:4096
    v_accvgpr_read_b32 v56, a92
    v_accvgpr_read_b32 v57, a93
    v_accvgpr_read_b32 v58, a94
    v_accvgpr_read_b32 v59, a95
    v_accvgpr_read_b32 v60, a96
    v_accvgpr_read_b32 v61, a97
    v_accvgpr_read_b32 v62, a98
    v_accvgpr_read_b32 v63, a99
    s_waitcnt lgkmcnt(1)
    v_lshlrev_b32 v16, 16, v6
    v_and_b32 v17, s49, v6
    v_lshlrev_b32 v18, 16, v7
    v_and_b32 v19, s49, v7
    v_lshlrev_b32 v20, 16, v8
    v_and_b32 v21, s49, v8
    v_lshlrev_b32 v22, 16, v9
    v_and_b32 v23, s49, v9
    s_waitcnt lgkmcnt(0)
    v_lshlrev_b32 v24, 16, v10
    v_and_b32 v25, s49, v10
    v_lshlrev_b32 v26, 16, v11
    v_and_b32 v27, s49, v11
    v_lshlrev_b32 v28, 16, v12
    v_and_b32 v29, s49, v12
    v_lshlrev_b32 v30, 16, v13
    v_and_b32 v31, s49, v13
    s_nop 0
    buffer_load_dwordx4 v[48:51], v150, s[56:59], s72 offen sc1
    s_add_u32 s74, s65, 6291456
    s_add_u32 s75, s65, 6295552
    s_add_u32 s76, s65, 2097152
    s_add_u32 s77, s65, 2101248
    s_mov_b32 s38, 131072
    buffer_load_dwordx4 v[52:55], v150, s[56:59], s73 offen sc1
L_chk3:
    s_waitcnt vmcnt(0)
    v_max3_u32 v15, v48, v49, v50
    v_max3_u32 v15, v15, v51, v52
    v_max3_u32 v15, v15, v53, v54
    v_max_u32 v15, v15, v55
    v_cmp_eq_u32 vcc, -1, v15
    s_nop 0
    s_cbranch_vccz L_ok3
    s_sub_u32 s38, s38, 1
    s_cmp_eq_u32 s38, 0
    s_cbranch_scc1 L_ok3
    buffer_load_dwordx4 v[48:51], v150, s[56:59], s72 offen sc1
    buffer_load_dwordx4 v[52:55], v150, s[56:59], s73 offen sc1
    s_branch L_chk3
L_ok3:
    v_lshlrev_b32 v32, 16, v48
    v_and_b32 v33, s49, v48
    v_lshlrev_b32 v34, 16, v49
    v_and_b32 v35, s49, v49
    v_lshlrev_b32 v36, 16, v50
    v_and_b32 v37, s49, v50
    v_lshlrev_b32 v38, 16, v51
    v_and_b32 v39, s49, v51
    v_pk_add_f32 v[32:33], v[32:33], v[16:17]
    v_pk_add_f32 v[34:35], v[34:35], v[18:19]
    v_pk_add_f32 v[36:37], v[36:37], v[20:21]
    v_pk_add_f32 v[38:39], v[38:39], v[22:23]
    v_cvt_pk_bf16_f32 v6, v32, v33
    v_cvt_pk_bf16_f32 v7, v34, v35
    v_cvt_pk_bf16_f32 v8, v36, v37
    v_cvt_pk_bf16_f32 v9, v38, v39
    ds_write_b128 v149, v[6:9] offset:0
    v_lshlrev_b32 v40, 16, v52
    v_and_b32 v41, s49, v52
    v_lshlrev_b32 v42, 16, v53
    v_and_b32 v43, s49, v53
    v_lshlrev_b32 v44, 16, v54
    v_and_b32 v45, s49, v54
    v_lshlrev_b32 v152, 16, v55
    v_and_b32 v153, s49, v55
    v_pk_add_f32 v[40:41], v[40:41], v[24:25]
    v_pk_add_f32 v[42:43], v[42:43], v[26:27]
    v_pk_add_f32 v[44:45], v[44:45], v[28:29]
    v_pk_add_f32 v[152:153], v[152:153], v[30:31]
    v_cvt_pk_bf16_f32 v10, v40, v41
    v_cvt_pk_bf16_f32 v11, v42, v43
    v_cvt_pk_bf16_f32 v12, v44, v45
    v_cvt_pk_bf16_f32 v13, v152, v153
    ds_write_b128 v149, v[10:13] offset:4096
    s_waitcnt lgkmcnt(0)
    s_barrier
    s_add_u32 s74, s65, 10485760
    s_add_u32 s75, s65, 10489856
    ds_read_b64 v[6:7], v154 offset:0
    ds_read_b64 v[8:9], v154 offset:256
    ds_read_b64 v[10:11], v154 offset:512
    ds_read_b64 v[12:13], v154 offset:768
    ds_read_b64 v[16:17], v154 offset:4096
    ds_read_b64 v[18:19], v154 offset:4352
    ds_read_b64 v[20:21], v154 offset:4608
    ds_read_b64 v[22:23], v154 offset:4864
    buffer_store_dwordx4 v[144:147], v149, s[56:59], s74 offen sc1
    buffer_store_dwordx4 v[144:147], v149, s[56:59], s75 offen sc1
    s_waitcnt lgkmcnt(6)
    v_perm_b32 v24, v8, v6, s45
    v_perm_b32 v28, v8, v6, s48
    v_perm_b32 v32, v9, v7, s45
    v_perm_b32 v36, v9, v7, s48
    s_waitcnt lgkmcnt(4)
    v_perm_b32 v25, v12, v10, s45
    v_perm_b32 v29, v12, v10, s48
    v_perm_b32 v33, v13, v11, s45
    v_perm_b32 v37, v13, v11, s48
    v_dot2_f32_bf16 v15, v24, s64, 0
    v_dot2_f32_bf16 v44, v28, s64, 0
    v_dot2_f32_bf16 v45, v32, s64, 0
    v_dot2_f32_bf16 v46, v36, s64, 0
    s_waitcnt lgkmcnt(2)
    v_perm_b32 v26, v18, v16, s45
    v_perm_b32 v30, v18, v16, s48
    v_perm_b32 v34, v19, v17, s45
    v_perm_b32 v38, v19, v17, s48
    v_dot2c_f32_bf16 v15, s64, v25
    v_dot2c_f32_bf16 v44, s64, v29
    v_dot2c_f32_bf16 v45, s64, v33
    v_dot2c_f32_bf16 v46, s64, v37
    s_waitcnt lgkmcnt(0)
    v_perm_b32 v27, v22, v20, s45
    v_perm_b32 v31, v22, v20, s48
    v_perm_b32 v35, v23, v21, s45
    v_perm_b32 v39, v23, v21, s48
    v_dot2_f32_bf16 v152, v24, v24, 0
    v_dot2_f32_bf16 v153, v28, v28, 0
    v_dot2_f32_bf16 v163, v32, v32, 0
    v_dot2_f32_bf16 v176, v36, v36, 0
    v_dot2c_f32_bf16 v15, s64, v26
    v_dot2c_f32_bf16 v44, s64, v30
    v_dot2c_f32_bf16 v45, s64, v34
    v_dot2c_f32_bf16 v46, s64, v38
    v_dot2c_f32_bf16 v152, v25, v25
    v_dot2c_f32_bf16 v153, v29, v29
    v_dot2c_f32_bf16 v163, v33, v33
    v_dot2c_f32_bf16 v176, v37, v37
    v_dot2c_f32_bf16 v15, s64, v27
    v_dot2c_f32_bf16 v44, s64, v31
    v_dot2c_f32_bf16 v45, s64, v35
    v_dot2c_f32_bf16 v46, s64, v39
    v_dot2c_f32_bf16 v152, v26, v26
    v_dot2c_f32_bf16 v153, v30, v30
    v_dot2c_f32_bf16 v163, v34, v34
    v_dot2c_f32_bf16 v176, v38, v38
    v_dot2c_f32_bf16 v152, v27, v27
    v_dot2c_f32_bf16 v153, v31, v31
    v_dot2c_f32_bf16 v163, v35, v35
    v_dot2c_f32_bf16 v176, v39, v39
    v_permlane32_swap_b32 v15, v44
    v_permlane32_swap_b32 v45, v46
    v_add_f32 v15, v15, v44
    v_add_f32 v45, v45, v46
    v_permlane32_swap_b32 v152, v153
    v_permlane32_swap_b32 v163, v176
    v_add_f32 v152, v152, v153
    v_add_f32 v163, v163, v176
    v_permlane16_swap_b32 v15, v45
    v_add_f32 v15, v15, v45
    v_permlane16_swap_b32 v152, v163
    v_add_f32 v152, v152, v163
    v_add_f32_dpp v15, v15, v15 row_ror:8 row_mask:0xf bank_mask:0xf
    v_mfma_f32_16x16x32_bf16 v[6:9], v[24:27], a[84:87], 0
    v_add_f32_dpp v152, v152, v152 row_ror:8 row_mask:0xf bank_mask:0xf
    v_add_f32_dpp v15, v15, v15 row_ror:4 row_mask:0xf bank_mask:0xf
    v_mfma_f32_16x16x32_bf16 v[40:43], v[24:27], a[88:91], 0
    v_add_f32_dpp v152, v152, v152 row_ror:4 row_mask:0xf bank_mask:0xf
    v_add_f32_dpp v15, v15, v15 quad_perm:[2,3,0,1] row_mask:0xf bank_mask:0xf
    v_mfma_f32_16x16x32_bf16 v[10:13], v[28:31], a[84:87], 0
    v_add_f32_dpp v152, v152, v152 quad_perm:[2,3,0,1] row_mask:0xf bank_mask:0xf
    v_mov_b32_dpp v44, v15 quad_perm:[1,0,3,2] row_mask:0xf bank_mask:0xf
    v_mfma_f32_16x16x32_bf16 v[164:167], v[28:31], a[88:91], 0
    v_sub_f32 v45, v15, v44
    v_add_f32_dpp v152, v152, v152 quad_perm:[1,0,3,2] row_mask:0xf bank_mask:0xf
    v_mfma_f32_16x16x32_bf16 v[16:19], v[32:35], a[84:87], 0
    v_add_f32 v15, v15, v44
    v_mul_f32 v15, 0x3b000000, v15
    v_mfma_f32_16x16x32_bf16 v[168:171], v[32:35], a[88:91], 0
    v_mul_f32 v152, 0x3b000000, v152
    v_fma_f32 v152, -v15, v15, v152
    v_mfma_f32_16x16x32_bf16 v[20:23], v[36:39], a[84:87], 0
    v_cvt_pk_bf16_f32 v46, v15, v15
    v_max_f32 v152, 0, v152
    v_mfma_f32_16x16x32_bf16 v[172:175], v[36:39], a[88:91], 0
    v_lshlrev_b32 v15, 16, v46
    v_cvt_pk_bf16_f32 v46, v152, v152
    v_lshlrev_b32 v152, 16, v46
    v_add_f32 v152, 0x3727c5ac, v152
    v_pk_mul_f32 v[178:179], v[6:7], v[56:57]
    v_pk_mul_f32 v[194:195], v[40:41], v[56:57]
    v_pk_mul_f32 v[180:181], v[8:9], v[58:59]
    v_pk_mul_f32 v[196:197], v[42:43], v[58:59]
    v_pk_mul_f32 v[182:183], v[10:11], v[56:57]
    v_pk_mul_f32 v[198:199], v[164:165], v[56:57]
    v_pk_mul_f32 v[184:185], v[12:13], v[58:59]
    v_pk_mul_f32 v[200:201], v[166:167], v[58:59]
    v_pk_mul_f32 v[186:187], v[16:17], v[56:57]
    v_pk_mul_f32 v[202:203], v[168:169], v[56:57]
    v_pk_mul_f32 v[188:189], v[18:19], v[58:59]
    v_pk_mul_f32 v[204:205], v[170:171], v[58:59]
    v_pk_mul_f32 v[190:191], v[20:21], v[56:57]
    v_pk_mul_f32 v[206:207], v[172:173], v[56:57]
    v_pk_mul_f32 v[192:193], v[22:23], v[58:59]
    v_pk_mul_f32 v[208:209], v[174:175], v[58:59]
    v_pk_fma_f32 v[178:179], v[40:41], v[60:61], v[178:179]
    v_pk_fma_f32 v[194:195], v[6:7], v[60:61], v[194:195] neg_lo:[1,0,0] neg_hi:[1,0,0]
    v_pk_fma_f32 v[180:181], v[42:43], v[62:63], v[180:181]
    v_pk_fma_f32 v[196:197], v[8:9], v[62:63], v[196:197] neg_lo:[1,0,0] neg_hi:[1,0,0]
    v_pk_fma_f32 v[182:183], v[164:165], v[60:61], v[182:183]
    v_pk_fma_f32 v[198:199], v[10:11], v[60:61], v[198:199] neg_lo:[1,0,0] neg_hi:[1,0,0]
    v_pk_fma_f32 v[184:185], v[166:167], v[62:63], v[184:185]
    v_pk_fma_f32 v[200:201], v[12:13], v[62:63], v[200:201] neg_lo:[1,0,0] neg_hi:[1,0,0]
    v_pk_fma_f32 v[186:187], v[168:169], v[60:61], v[186:187]
    v_pk_fma_f32 v[202:203], v[16:17], v[60:61], v[202:203] neg_lo:[1,0,0] neg_hi:[1,0,0]
    v_pk_fma_f32 v[188:189], v[170:171], v[62:63], v[188:189]
    v_pk_fma_f32 v[204:205], v[18:19], v[62:63], v[204:205] neg_lo:[1,0,0] neg_hi:[1,0,0]
    v_pk_fma_f32 v[190:191], v[172:173], v[60:61], v[190:191]
    v_pk_fma_f32 v[206:207], v[20:21], v[60:61], v[206:207] neg_lo:[1,0,0] neg_hi:[1,0,0]
    v_pk_fma_f32 v[192:193], v[174:175], v[62:63], v[192:193]
    v_pk_fma_f32 v[208:209], v[22:23], v[62:63], v[208:209] neg_lo:[1,0,0] neg_hi:[1,0,0]
    v_cvt_pk_bf16_f32 v24, v178, v179
    v_cvt_pk_bf16_f32 v25, v180, v181
    v_cvt_pk_bf16_f32 v26, v194, v195
    v_cvt_pk_bf16_f32 v27, v196, v197
    v_cvt_pk_bf16_f32 v28, v182, v183
    v_cvt_pk_bf16_f32 v29, v184, v185
    v_cvt_pk_bf16_f32 v30, v198, v199
    v_cvt_pk_bf16_f32 v31, v200, v201
    v_cvt_pk_bf16_f32 v32, v186, v187
    v_cvt_pk_bf16_f32 v33, v188, v189
    v_cvt_pk_bf16_f32 v34, v202, v203
    v_cvt_pk_bf16_f32 v35, v204, v205
    v_cvt_pk_bf16_f32 v36, v190, v191
    v_cvt_pk_bf16_f32 v37, v192, v193
    v_cvt_pk_bf16_f32 v38, v206, v207
    v_cvt_pk_bf16_f32 v39, v208, v209
    v_cvt_pk_bf16_f32 v46, v152, v152
    v_lshlrev_b32 v152, 16, v46
    v_sqrt_f32 v152, v152
    v_mfma_f32_16x16x32_bf16 v[6:9], a[0:3], v[24:27], 0
    v_cvt_pk_bf16_f32 v46, v152, v152
    v_lshlrev_b32 v152, 16, v46
    v_mfma_f32_16x16x32_bf16 v[10:13], a[0:3], v[28:31], 0
    v_mul_f32 v15, 0x44000000, v15
    v_rcp_f32 v152, v152
    v_mfma_f32_16x16x32_bf16 v[16:19], a[0:3], v[32:35], 0
    v_readlane_b32 s86, v15, 0
    v_readlane_b32 s90, v45, 0
    v_mfma_f32_16x16x32_bf16 v[20:23], a[0:3], v[36:39], 0
    v_readlane_b32 s87, v15, 32
    v_readlane_b32 s91, v45, 32
    v_readlane_b32 s88, v15, 16
    v_readlane_b32 s92, v45, 16
    v_readlane_b32 s89, v15, 48
    v_readlane_b32 s93, v45, 48
    v_readlane_b32 s78, v152, 0
    v_readlane_b32 s80, v152, 32
    v_readlane_b32 s82, v152, 16
    v_readlane_b32 s84, v152, 48
    v_fma_f32 v6, -v47, s86, v6
    v_fma_f32 v7, v47, s90, v7
    v_fma_f32 v10, -v47, s87, v10
    v_fma_f32 v11, v47, s91, v11
    v_fma_f32 v16, -v47, s88, v16
    v_fma_f32 v17, v47, s92, v17
    v_fma_f32 v20, -v47, s89, v20
    v_fma_f32 v21, v47, s93, v21
    v_pk_mul_f32 v[6:7], v[6:7], s[78:79] op_sel_hi:[1,0]
    v_pk_mul_f32 v[10:11], v[10:11], s[80:81] op_sel_hi:[1,0]
    v_pk_mul_f32 v[16:17], v[16:17], s[82:83] op_sel_hi:[1,0]
    v_pk_mul_f32 v[20:21], v[20:21], s[84:85] op_sel_hi:[1,0]
    v_cvt_pk_bf16_f32 v136, v6, v10
    v_cvt_pk_bf16_f32 v137, v16, v20
    v_cvt_pk_bf16_f32 v138, v7, v11
    v_cvt_pk_bf16_f32 v139, v17, v21
    ds_write_b128 v155, v[136:139] offset:16384
    v_pk_mul_f32 v[8:9], v[8:9], s[78:79] op_sel_hi:[1,0]
    v_pk_mul_f32 v[12:13], v[12:13], s[80:81] op_sel_hi:[1,0]
    v_pk_mul_f32 v[18:19], v[18:19], s[82:83] op_sel_hi:[1,0]
    v_pk_mul_f32 v[22:23], v[22:23], s[84:85] op_sel_hi:[1,0]
    v_cvt_pk_bf16_f32 v140, v8, v12
    v_cvt_pk_bf16_f32 v141, v18, v22
    v_cvt_pk_bf16_f32 v142, v9, v13
    v_cvt_pk_bf16_f32 v143, v19, v23
    ds_write_b128 v155, v[140:143] offset:17408
    s_waitcnt lgkmcnt(0)
    s_barrier
    ds_read_b128 v[136:139], v149 offset:16384
    ds_read_b128 v[140:143], v149 offset:20480
    s_add_u32 s72, s67, 2097152
    s_add_u32 s73, s67, 3145728
    s_waitcnt lgkmcnt(1)
    buffer_store_dwordx4 v[136:139], v149, s[56:59], s76 offen sc1
    s_waitcnt lgkmcnt(0)
    buffer_store_dwordx4 v[140:143], v149, s[56:59], s77 offen sc1
    s_waitcnt vmcnt(0)
    v_accvgpr_read_b32 v56, a140
    v_accvgpr_read_b32 v57, a141
    v_accvgpr_read_b32 v58, a142
    v_accvgpr_read_b32 v59, a143
    v_accvgpr_read_b32 v60, a144
    v_accvgpr_read_b32 v61, a145
    v_accvgpr_read_b32 v62, a146
    v_accvgpr_read_b32 v63, a147
    v_accvgpr_read_b32 v64, a148
    v_accvgpr_read_b32 v65, a149
    v_accvgpr_read_b32 v66, a150
    v_accvgpr_read_b32 v67, a151
    v_accvgpr_read_b32 v68, a152
    v_accvgpr_read_b32 v69, a153
    v_accvgpr_read_b32 v70, a154
    v_accvgpr_read_b32 v71, a155
    v_accvgpr_read_b32 v72, a156
    v_accvgpr_read_b32 v73, a157
    v_accvgpr_read_b32 v74, a158
    v_accvgpr_read_b32 v75, a159
    v_accvgpr_read_b32 v76, a160
    v_accvgpr_read_b32 v77, a161
    v_accvgpr_read_b32 v78, a162
    v_accvgpr_read_b32 v79, a163
    v_accvgpr_read_b32 v80, a164
    v_accvgpr_read_b32 v81, a165
    v_accvgpr_read_b32 v82, a166
    v_accvgpr_read_b32 v83, a167
    v_accvgpr_read_b32 v84, a168
    v_accvgpr_read_b32 v85, a169
    v_accvgpr_read_b32 v86, a170
    v_accvgpr_read_b32 v87, a171
    s_nop 0
    buffer_load_dwordx4 v[48:51], v150, s[56:59], s72 offen sc1
    s_add_u32 s74, s65, 10485760
    s_add_u32 s75, s65, 10489856
    s_add_u32 s76, s66, 6291456
    s_cmp_lg_u32 s35, 0
    buffer_load_dwordx4 v[52:55], v150, s[56:59], s73 offen sc1
    s_cbranch_scc1 L_qv_done
    v_accvgpr_read_b32 v16, a236
    v_accvgpr_read_b32 v17, a237
    v_accvgpr_read_b32 v18, a238
    v_accvgpr_read_b32 v19, a239
    v_accvgpr_read_b32 v20, a240
    v_accvgpr_read_b32 v21, a241
    v_accvgpr_read_b32 v22, a242
    v_accvgpr_read_b32 v23, a243
    v_accvgpr_read_b32 v24, a244
    v_accvgpr_read_b32 v25, a245
    v_accvgpr_read_b32 v26, a246
    v_accvgpr_read_b32 v27, a247
    v_accvgpr_read_b32 v28, a248
    v_accvgpr_read_b32 v29, a249
    v_accvgpr_read_b32 v30, a250
    v_accvgpr_read_b32 v31, a251
    s_nop 1
L_qv_done:
    s_mov_b32 s38, 131072
L_chk4:
    s_waitcnt vmcnt(0)
    v_max3_u32 v6, v48, v49, v50
    v_max3_u32 v6, v6, v51, v52
    v_max3_u32 v6, v6, v53, v54
    v_max_u32 v6, v6, v55
    v_cmp_eq_u32 vcc, -1, v6
    s_nop 0
    s_cbranch_vccz L_ok4
    s_sub_u32 s38, s38, 1
    s_cmp_eq_u32 s38, 0
    s_cbranch_scc1 L_ok4
    buffer_load_dwordx4 v[48:51], v150, s[56:59], s72 offen sc1
    buffer_load_dwordx4 v[52:55], v150, s[56:59], s73 offen sc1
    s_branch L_chk4
L_ok4:
    ds_write_b128 v149, v[48:51] offset:8192
    ds_write_b128 v149, v[52:55] offset:12288
    s_waitcnt lgkmcnt(0)
    s_barrier
    s_add_u32 s74, s65, 14680064
    s_add_u32 s75, s65, 14684160
    ds_read_b128 v[6:9], v156 offset:8192
    ds_read_b128 v[40:43], v156 offset:8704
    ds_read_b128 v[10:13], v156 offset:10240
    ds_read_b128 v[164:167], v156 offset:10752
    ds_read_b128 v[32:35], v156 offset:12288
    ds_read_b128 v[168:171], v156 offset:12800
    ds_read_b128 v[36:39], v156 offset:14336
    ds_read_b128 v[172:175], v156 offset:14848
    buffer_store_dwordx4 v[144:147], v149, s[56:59], s74 offen sc1
    s_waitcnt lgkmcnt(7)
    v_mfma_f32_16x16x32_bf16 v[176:179], v[6:9], a[100:103], 0
    s_cmp_lg_u32 s35, 0
    buffer_store_dwordx4 v[144:147], v149, s[56:59], s75 offen sc1
    v_mfma_f32_16x16x32_bf16 v[184:187], v[6:9], a[106:109], 0
    s_waitcnt lgkmcnt(6)
    v_mfma_f32_16x16x32_bf16 v[180:183], v[40:43], a[100:103], 0
    v_mfma_f32_16x16x32_bf16 v[188:191], v[40:43], a[106:109], 0
    s_waitcnt lgkmcnt(5)
    v_mfma_f32_16x16x32_bf16 v[176:179], v[10:13], a[110:113], v[176:179]
    v_mfma_f32_16x16x32_bf16 v[184:187], v[10:13], a[116:119], v[184:187]
    s_waitcnt lgkmcnt(4)
    v_mfma_f32_16x16x32_bf16 v[180:183], v[164:167], a[110:113], v[180:183]
    v_mfma_f32_16x16x32_bf16 v[188:191], v[164:167], a[116:119], v[188:191]
    s_waitcnt lgkmcnt(3)
    v_mfma_f32_16x16x32_bf16 v[176:179], v[32:35], a[120:123], v[176:179]
    v_mfma_f32_16x16x32_bf16 v[184:187], v[32:35], a[126:129], v[184:187]
    s_waitcnt lgkmcnt(2)
    v_mfma_f32_16x16x32_bf16 v[180:183], v[168:171], a[120:123], v[180:183]
    v_mfma_f32_16x16x32_bf16 v[188:191], v[168:171], a[126:129], v[188:191]
    s_waitcnt lgkmcnt(1)
    v_mfma_f32_16x16x32_bf16 v[176:179], v[36:39], a[130:133], v[176:179]
    v_mfma_f32_16x16x32_bf16 v[184:187], v[36:39], a[136:139], v[184:187]
    s_waitcnt lgkmcnt(0)
    v_mfma_f32_16x16x32_bf16 v[180:183], v[172:175], a[130:133], v[180:183]
    v_mfma_f32_16x16x32_bf16 v[188:191], v[172:175], a[136:139], v[188:191]
    s_nop 3
    v_pk_mul_f32 v[192:193], v[176:177], v[56:57]
    v_pk_mul_f32 v[200:201], v[184:185], v[56:57]
    v_pk_mul_f32 v[194:195], v[178:179], v[58:59]
    v_pk_mul_f32 v[202:203], v[186:187], v[58:59]
    v_pk_fma_f32 v[192:193], v[184:185], v[64:65], v[192:193]
    v_pk_fma_f32 v[200:201], v[176:177], v[64:65], v[200:201] neg_lo:[1,0,0] neg_hi:[1,0,0]
    v_pk_fma_f32 v[194:195], v[186:187], v[66:67], v[194:195]
    v_pk_fma_f32 v[202:203], v[178:179], v[66:67], v[202:203] neg_lo:[1,0,0] neg_hi:[1,0,0]
    v_cvt_pk_bf16_f32 v208, v192, v193
    v_cvt_pk_bf16_f32 v209, v194, v195
    v_cvt_pk_bf16_f32 v210, v200, v201
    v_cvt_pk_bf16_f32 v211, v202, v203
    v_pk_mul_f32 v[196:197], v[180:181], v[60:61]
    v_pk_mul_f32 v[204:205], v[188:189], v[60:61]
    v_pk_mul_f32 v[198:199], v[182:183], v[62:63]
    v_pk_mul_f32 v[206:207], v[190:191], v[62:63]
    v_pk_fma_f32 v[196:197], v[188:189], v[68:69], v[196:197]
    v_pk_fma_f32 v[204:205], v[180:181], v[68:69], v[204:205] neg_lo:[1,0,0] neg_hi:[1,0,0]
    v_pk_fma_f32 v[198:199], v[190:191], v[70:71], v[198:199]
    v_pk_fma_f32 v[206:207], v[182:183], v[70:71], v[206:207] neg_lo:[1,0,0] neg_hi:[1,0,0]
    v_mfma_f32_16x16x32_bf16 v[176:179], a[4:7], v[208:211], 0
    v_cvt_pk_bf16_f32 v212, v196, v197
    v_cvt_pk_bf16_f32 v213, v198, v199
    v_mfma_f32_16x16x32_bf16 v[184:187], a[10:13], v[208:211], 0
    v_cvt_pk_bf16_f32 v214, v204, v205
    v_cvt_pk_bf16_f32 v215, v206, v207
    v_mfma_f32_16x16x32_bf16 v[180:183], a[24:27], v[208:211], 0
    v_mfma_f32_16x16x32_bf16 v[188:191], a[30:33], v[208:211], 0
    v_mfma_f32_16x16x32_bf16 v[176:179], a[14:17], v[212:215], v[176:179]
    v_mfma_f32_16x16x32_bf16 v[184:187], a[20:23], v[212:215], v[184:187]
    v_mfma_f32_16x16x32_bf16 v[180:183], a[34:37], v[212:215], v[180:183]
    v_mfma_f32_16x16x32_bf16 v[188:191], a[40:43], v[212:215], v[188:191]
    s_nop 6
    s_cbranch_scc1 L_q_mid1
    v_lshlrev_b32 v15, 8, v3
    v_add_u32 v15, v15, v2
    v_add_u32 v15, s43, v15
    v_lshlrev_b32 v44, 2, v15
    v_sub_u32 v45, 27904, v44
    v_add_u32 v44, 24576, v44
    ds_write2st64_b32 v44, v176, v184 offset0:0 offset1:33
    ds_write2st64_b32 v44, v177, v185 offset0:1 offset1:34
    ds_write2st64_b32 v44, v178, v186 offset0:2 offset1:35
    ds_write2st64_b32 v44, v179, v187 offset0:3 offset1:36
    ds_write2st64_b32 v44, v180, v188 offset0:16 offset1:49
    ds_write2st64_b32 v44, v181, v189 offset0:17 offset1:50
    ds_write2st64_b32 v44, v182, v190 offset0:18 offset1:51
    ds_write2st64_b32 v44, v183, v191 offset0:19 offset1:52
    v_cmp_eq_u32 vcc, 0, v15
    v_mov_b32 v46, 32772
    v_mov_b32 v4, 32768
    v_cndmask_b32 v46, v46, v4, vcc
    ds_write2st64_b32 v46, v176, v184 offset0:0 offset1:33
    s_nop 0
L_q_mid1:
    v_pk_mul_f32 v[192:193], v[176:177], v[88:89]
    v_pk_mul_f32 v[200:201], v[184:185], v[88:89]
    v_pk_mul_f32 v[194:195], v[178:179], v[90:91]
    v_pk_mul_f32 v[202:203], v[186:187], v[90:91]
    v_pk_mul_f32 v[196:197], v[180:181], v[96:97]
    v_pk_mul_f32 v[204:205], v[188:189], v[96:97]
    v_pk_mul_f32 v[198:199], v[182:183], v[98:99]
    v_pk_mul_f32 v[206:207], v[190:191], v[98:99]
    v_pk_fma_f32 v[192:193], v[184:185], v[92:93], v[192:193] neg_lo:[1,0,0] neg_hi:[1,0,0]
    v_pk_fma_f32 v[200:201], v[176:177], v[92:93], v[200:201]
    v_pk_fma_f32 v[194:195], v[186:187], v[94:95], v[194:195] neg_lo:[1,0,0] neg_hi:[1,0,0]
    v_pk_fma_f32 v[202:203], v[178:179], v[94:95], v[202:203]
    v_pk_fma_f32 v[196:197], v[188:189], v[100:101], v[196:197] neg_lo:[1,0,0] neg_hi:[1,0,0]
    v_pk_fma_f32 v[204:205], v[180:181], v[100:101], v[204:205]
    v_pk_fma_f32 v[198:199], v[190:191], v[102:103], v[198:199] neg_lo:[1,0,0] neg_hi:[1,0,0]
    v_pk_fma_f32 v[206:207], v[182:183], v[102:103], v[206:207]
    s_cmp_lg_u32 s35, 0
    s_cbranch_scc1 L_q_done1
    s_waitcnt lgkmcnt(0)
    s_barrier
    ds_read2st64_b32 v[40:41], v45 offset0:19 offset1:18
    ds_read2st64_b32 v[42:43], v45 offset0:17 offset1:16
    ds_read2st64_b32 v[168:169], v45 offset0:3 offset1:2
    ds_read2st64_b32 v[170:171], v45 offset0:1 offset1:0
    ds_read2st64_b32 v[164:165], v45 offset0:52 offset1:51
    ds_read2st64_b32 v[166:167], v45 offset0:50 offset1:49
    ds_read2st64_b32 v[172:173], v45 offset0:36 offset1:35
    ds_read2st64_b32 v[174:175], v45 offset0:34 offset1:33
    s_waitcnt lgkmcnt(7)
    v_pk_fma_f32 v[192:193], v[40:41], v[16:17], v[192:193]
    v_pk_fma_f32 v[200:201], v[40:41], v[20:21], v[200:201]
    s_waitcnt lgkmcnt(6)
    v_pk_fma_f32 v[194:195], v[42:43], v[18:19], v[194:195]
    v_pk_fma_f32 v[202:203], v[42:43], v[22:23], v[202:203]
    s_waitcnt lgkmcnt(5)
    v_pk_fma_f32 v[196:197], v[168:169], v[24:25], v[196:197]
    v_pk_fma_f32 v[204:205], v[168:169], v[28:29], v[204:205]
    s_waitcnt lgkmcnt(4)
    v_pk_fma_f32 v[198:199], v[170:171], v[26:27], v[198:199]
    v_pk_fma_f32 v[206:207], v[170:171], v[30:31], v[206:207]
    s_waitcnt lgkmcnt(3)
    v_pk_fma_f32 v[192:193], v[164:165], v[20:21], v[192:193]
    v_pk_fma_f32 v[200:201], v[164:165], v[16:17], v[200:201] neg_lo:[1,0,0] neg_hi:[1,0,0]
    s_waitcnt lgkmcnt(2)
    v_pk_fma_f32 v[194:195], v[166:167], v[22:23], v[194:195]
    v_pk_fma_f32 v[202:203], v[166:167], v[18:19], v[202:203] neg_lo:[1,0,0] neg_hi:[1,0,0]
    s_waitcnt lgkmcnt(1)
    v_pk_fma_f32 v[196:197], v[172:173], v[28:29], v[196:197]
    v_pk_fma_f32 v[204:205], v[172:173], v[24:25], v[204:205] neg_lo:[1,0,0] neg_hi:[1,0,0]
    s_waitcnt lgkmcnt(0)
    v_pk_fma_f32 v[198:199], v[174:175], v[30:31], v[198:199]
    v_pk_fma_f32 v[206:207], v[174:175], v[26:27], v[206:207] neg_lo:[1,0,0] neg_hi:[1,0,0]
    s_waitcnt lgkmcnt(0)
    s_nop 0
L_q_done1:
    v_cvt_pk_bf16_f32 v208, v192, v193
    v_cvt_pk_bf16_f32 v209, v194, v195
    v_cvt_pk_bf16_f32 v210, v200, v201
    v_cvt_pk_bf16_f32 v211, v202, v203
    v_cvt_pk_bf16_f32 v212, v196, v197
    v_cvt_pk_bf16_f32 v213, v198, v199
    v_mfma_f32_16x16x32_bf16 v[176:179], v[208:211], a[8:11], 0
    v_cvt_pk_bf16_f32 v214, v204, v205
    v_cvt_pk_bf16_f32 v215, v206, v207
    v_mfma_f32_16x16x32_bf16 v[184:187], v[208:211], a[6:9], 0
    s_nop 0
    v_mfma_f32_16x16x32_bf16 v[176:179], v[212:215], a[18:21], v[176:179]
    v_mfma_f32_16x16x32_bf16 v[184:187], v[212:215], a[16:19], v[184:187]
    v_mfma_f32_16x16x32_bf16 v[180:183], v[208:211], a[28:31], 0
    v_mfma_f32_16x16x32_bf16 v[188:191], v[208:211], a[26:29], 0
    v_mfma_f32_16x16x32_bf16 v[180:183], v[212:215], a[38:41], v[180:183]
    v_mfma_f32_16x16x32_bf16 v[188:191], v[212:215], a[36:39], v[188:191]
    s_nop 2
    v_pk_mul_f32 v[192:193], v[176:177], v[72:73]
    v_pk_mul_f32 v[200:201], v[184:185], v[72:73]
    v_pk_mul_f32 v[194:195], v[178:179], v[74:75]
    v_pk_mul_f32 v[202:203], v[186:187], v[74:75]
    v_pk_fma_f32 v[192:193], v[184:185], v[80:81], v[192:193] neg_lo:[1,0,0] neg_hi:[1,0,0]
    v_pk_fma_f32 v[200:201], v[176:177], v[80:81], v[200:201]
    v_pk_fma_f32 v[194:195], v[186:187], v[82:83], v[194:195] neg_lo:[1,0,0] neg_hi:[1,0,0]
    v_pk_fma_f32 v[202:203], v[178:179], v[82:83], v[202:203]
    v_cvt_pk_bf16_f32 v6, v192, v193
    v_cvt_pk_bf16_f32 v7, v194, v195
    v_cvt_pk_bf16_f32 v8, v200, v201
    v_cvt_pk_bf16_f32 v9, v202, v203
    ds_write_b128 v157, v[6:9] offset:16384
    v_pk_mul_f32 v[196:197], v[180:181], v[76:77]
    v_pk_mul_f32 v[204:205], v[188:189], v[76:77]
    v_pk_mul_f32 v[198:199], v[182:183], v[78:79]
    v_pk_mul_f32 v[206:207], v[190:191], v[78:79]
    v_pk_fma_f32 v[196:197], v[188:189], v[84:85], v[196:197] neg_lo:[1,0,0] neg_hi:[1,0,0]
    v_pk_fma_f32 v[204:205], v[180:181], v[84:85], v[204:205]
    v_pk_fma_f32 v[198:199], v[190:191], v[86:87], v[198:199] neg_lo:[1,0,0] neg_hi:[1,0,0]
    v_pk_fma_f32 v[206:207], v[182:183], v[86:87], v[206:207]
    v_cvt_pk_bf16_f32 v10, v196, v197
    v_cvt_pk_bf16_f32 v11, v198, v199
    v_cvt_pk_bf16_f32 v12, v204, v205
    v_cvt_pk_bf16_f32 v13, v206, v207
    ds_write_b128 v157, v[10:13] offset:17408
    s_waitcnt lgkmcnt(0)
    s_barrier
    ds_read_b128 v[6:9], v5 offset:16384
    ds_read_b128 v[10:13], v5 offset:18432
    ds_read_b128 v[32:35], v5 offset:20480
    ds_read_b128 v[36:39], v5 offset:22528
    ds_read_b128 v[40:43], v5 offset:17408
    ds_read_b128 v[164:167], v5 offset:19456
    ds_read_b128 v[168:171], v5 offset:21504
    ds_read_b128 v[172:175], v5 offset:23552
    s_add_u32 s72, s67, 6291456
    s_add_u32 s73, s67, 7340032
    s_waitcnt lgkmcnt(7)
    v_mfma_f32_16x16x32_bf16 v[176:179], a[104:107], v[6:9], 0
    v_mfma_f32_16x16x32_bf16 v[184:187], a[102:105], v[6:9], 0
    s_waitcnt lgkmcnt(6)
    v_mfma_f32_16x16x32_bf16 v[176:179], a[114:117], v[10:13], v[176:179]
    v_mfma_f32_16x16x32_bf16 v[184:187], a[112:115], v[10:13], v[184:187]
    s_waitcnt lgkmcnt(5)
    v_mfma_f32_16x16x32_bf16 v[176:179], a[124:127], v[32:35], v[176:179]
    v_mfma_f32_16x16x32_bf16 v[184:187], a[122:125], v[32:35], v[184:187]
    s_waitcnt lgkmcnt(4)
    v_mfma_f32_16x16x32_bf16 v[176:179], a[134:137], v[36:39], v[176:179]
    v_mfma_f32_16x16x32_bf16 v[184:187], a[132:135], v[36:39], v[184:187]
    s_waitcnt lgkmcnt(3)
    v_mfma_f32_16x16x32_bf16 v[180:183], a[104:107], v[40:43], 0
    s_nop 4
    v_cvt_pk_bf16_f32 v136, v176, v177
    v_cvt_pk_bf16_f32 v138, v178, v179
    v_mfma_f32_16x16x32_bf16 v[188:191], a[102:105], v[40:43], 0
    v_cvt_pk_bf16_f32 v137, v184, v185
    v_cvt_pk_bf16_f32 v139, v186, v187
    buffer_store_dwordx4 v[136:139], v151, s[56:59], s76 offen offset:0 sc1
    s_waitcnt lgkmcnt(2)
    v_mfma_f32_16x16x32_bf16 v[180:183], a[114:117], v[164:167], v[180:183]
    v_mfma_f32_16x16x32_bf16 v[188:191], a[112:115], v[164:167], v[188:191]
    s_waitcnt lgkmcnt(1)
    v_mfma_f32_16x16x32_bf16 v[180:183], a[124:127], v[168:171], v[180:183]
    v_mfma_f32_16x16x32_bf16 v[188:191], a[122:125], v[168:171], v[188:191]
    s_waitcnt lgkmcnt(0)
    v_mfma_f32_16x16x32_bf16 v[180:183], a[134:137], v[172:175], v[180:183]
    v_mfma_f32_16x16x32_bf16 v[188:191], a[132:135], v[172:175], v[188:191]
    s_nop 6
    v_cvt_pk_bf16_f32 v140, v180, v181
    v_cvt_pk_bf16_f32 v142, v182, v183
    v_cvt_pk_bf16_f32 v141, v188, v189
    v_cvt_pk_bf16_f32 v143, v190, v191
    buffer_store_dwordx4 v[140:143], v151, s[56:59], s76 offen offset:512 sc1
    s_waitcnt vmcnt(0)
    ds_read_b32 v6, v159 offset:0
    ds_read_b32 v7, v159 offset:512
    ds_read_b32 v8, v159 offset:1024
    ds_read_b32 v9, v159 offset:1536
    ds_read_b32 v10, v159 offset:256
    ds_read_b32 v11, v159 offset:768
    ds_read_b32 v12, v159 offset:1280
    ds_read_b32 v13, v159 offset:1792
    v_accvgpr_read_b32 v56, a68
    v_accvgpr_read_b32 v57, a69
    v_accvgpr_read_b32 v58, a70
    v_accvgpr_read_b32 v59, a71
    v_accvgpr_read_b32 v60, a72
    v_accvgpr_read_b32 v61, a73
    v_accvgpr_read_b32 v62, a74
    v_accvgpr_read_b32 v63, a75
    v_accvgpr_read_b32 v64, a76
    v_accvgpr_read_b32 v65, a77
    v_accvgpr_read_b32 v66, a78
    v_accvgpr_read_b32 v67, a79
    v_accvgpr_read_b32 v68, a80
    v_accvgpr_read_b32 v69, a81
    v_accvgpr_read_b32 v70, a82
    v_accvgpr_read_b32 v71, a83
    s_waitcnt lgkmcnt(7)
    v_lshlrev_b32 v16, 16, v6
    v_and_b32 v17, s49, v6
    s_waitcnt lgkmcnt(6)
    v_lshlrev_b32 v18, 16, v7
    v_and_b32 v19, s49, v7
    s_waitcnt lgkmcnt(5)
    v_lshlrev_b32 v20, 16, v8
    v_and_b32 v21, s49, v8
    s_waitcnt lgkmcnt(4)
    v_lshlrev_b32 v22, 16, v9
    v_and_b32 v23, s49, v9
    s_waitcnt lgkmcnt(3)
    v_lshlrev_b32 v24, 16, v10
    v_and_b32 v25, s49, v10
    s_waitcnt lgkmcnt(2)
    v_lshlrev_b32 v26, 16, v11
    v_and_b32 v27, s49, v11
    s_waitcnt lgkmcnt(1)
    v_lshlrev_b32 v28, 16, v12
    v_and_b32 v29, s49, v12
    s_waitcnt lgkmcnt(0)
    v_lshlrev_b32 v30, 16, v13
    v_and_b32 v31, s49, v13
    s_nop 0
    buffer_load_dwordx4 v[48:51], v150, s[56:59], s72 offen sc1
    s_add_u32 s74, s65, 14680064
    s_add_u32 s75, s65, 14684160
    s_add_u32 s76, s65, 10485760
    s_add_u32 s77, s65, 10489856
    s_mov_b32 s38, 131072
    buffer_load_dwordx4 v[52:55], v150, s[56:59], s73 offen sc1
L_chk5:
    s_waitcnt vmcnt(0)
    v_max3_u32 v15, v48, v49, v50
    v_max3_u32 v15, v15, v51, v52
    v_max3_u32 v15, v15, v53, v54
    v_max_u32 v15, v15, v55
    v_cmp_eq_u32 vcc, -1, v15
    s_nop 0
    s_cbranch_vccz L_ok5
    s_sub_u32 s38, s38, 1
    s_cmp_eq_u32 s38, 0
    s_cbranch_scc1 L_ok5
    buffer_load_dwordx4 v[48:51], v150, s[56:59], s72 offen sc1
    buffer_load_dwordx4 v[52:55], v150, s[56:59], s73 offen sc1
    s_branch L_chk5
L_ok5:
    ds_write_b128 v149, v[48:51] offset:8192
    ds_write_b128 v149, v[52:55] offset:12288
    s_waitcnt lgkmcnt(0)
    s_barrier
    ds_read_b64 v[32:33], v158 offset:8192
    ds_read_b64 v[34:35], v158 offset:8704
    ds_read_b64 v[36:37], v158 offset:9216
    ds_read_b64 v[38:39], v158 offset:9728
    s_waitcnt lgkmcnt(3)
    v_readlane_b32 s78, v33, 0
    s_waitcnt lgkmcnt(2)
    v_perm_b32 v40, v34, v32, s45
    v_perm_b32 v42, v35, v33, s45
    v_perm_b32 v164, v34, v32, s48
    v_perm_b32 v166, v35, v33, s48
    s_waitcnt lgkmcnt(0)
    v_perm_b32 v41, v38, v36, s45
    v_perm_b32 v43, v39, v37, s45
    v_perm_b32 v165, v38, v36, s48
    v_perm_b32 v167, v39, v37, s48
    v_mfma_f32_16x16x32_bf16 v[168:171], v[40:43], a[48:51], 0
    s_lshl_b32 s36, s78, 16
    s_and_b32 s37, s78, 0xffff0000
    v_mfma_f32_16x16x32_bf16 v[184:187], v[40:43], a[46:49], 0
    v_xor_b32 v200, s36, v148
    v_xor_b32 v204, s37, v148
    v_mfma_f32_16x16x32_bf16 v[172:175], v[40:43], a[58:61], 0
    v_mov_b32 v201, v200
    v_mov_b32 v202, v200
    v_mfma_f32_16x16x32_bf16 v[188:191], v[40:43], a[56:59], 0
    v_mov_b32 v203, v200
    v_mov_b32 v205, v204
    v_mfma_f32_16x16x32_bf16 v[176:179], v[164:167], a[48:51], 0
    v_mov_b32 v206, v204
    v_mov_b32 v207, v204
    v_mfma_f32_16x16x32_bf16 v[192:195], v[164:167], a[46:49], 0
    v_mfma_f32_16x16x32_bf16 v[180:183], v[164:167], a[58:61], 0
    v_mfma_f32_16x16x32_bf16 v[196:199], v[164:167], a[56:59], 0
    v_pk_mul_f32 v[208:209], v[168:169], v[56:57]
    v_pk_mul_f32 v[224:225], v[184:185], v[56:57]
    v_pk_mul_f32 v[210:211], v[170:171], v[58:59]
    v_pk_mul_f32 v[226:227], v[186:187], v[58:59]
    v_pk_mul_f32 v[212:213], v[172:173], v[64:65]
    v_pk_mul_f32 v[228:229], v[188:189], v[64:65]
    v_pk_mul_f32 v[214:215], v[174:175], v[66:67]
    v_pk_mul_f32 v[230:231], v[190:191], v[66:67]
    v_pk_mul_f32 v[216:217], v[176:177], v[56:57]
    v_pk_mul_f32 v[232:233], v[192:193], v[56:57]
    v_pk_mul_f32 v[218:219], v[178:179], v[58:59]
    v_pk_mul_f32 v[234:235], v[194:195], v[58:59]
    v_pk_mul_f32 v[220:221], v[180:181], v[64:65]
    v_pk_mul_f32 v[236:237], v[196:197], v[64:65]
    v_pk_mul_f32 v[222:223], v[182:183], v[66:67]
    v_pk_mul_f32 v[238:239], v[198:199], v[66:67]
    v_pk_fma_f32 v[208:209], v[184:185], v[60:61], v[208:209] neg_lo:[1,0,0] neg_hi:[1,0,0]
    v_pk_fma_f32 v[224:225], v[168:169], v[60:61], v[224:225]
    v_pk_fma_f32 v[210:211], v[186:187], v[62:63], v[210:211] neg_lo:[1,0,0] neg_hi:[1,0,0]
    v_pk_fma_f32 v[226:227], v[170:171], v[62:63], v[226:227]
    v_pk_fma_f32 v[212:213], v[188:189], v[68:69], v[212:213] neg_lo:[1,0,0] neg_hi:[1,0,0]
    v_pk_fma_f32 v[228:229], v[172:173], v[68:69], v[228:229]
    v_pk_fma_f32 v[214:215], v[190:191], v[70:71], v[214:215] neg_lo:[1,0,0] neg_hi:[1,0,0]
    v_pk_fma_f32 v[230:231], v[174:175], v[70:71], v[230:231]
    v_pk_fma_f32 v[216:217], v[192:193], v[60:61], v[216:217] neg_lo:[1,0,0] neg_hi:[1,0,0]
    v_pk_fma_f32 v[232:233], v[176:177], v[60:61], v[232:233]
    v_pk_fma_f32 v[218:219], v[194:195], v[62:63], v[218:219] neg_lo:[1,0,0] neg_hi:[1,0,0]
    v_pk_fma_f32 v[234:235], v[178:179], v[62:63], v[234:235]
    v_pk_fma_f32 v[220:221], v[196:197], v[68:69], v[220:221] neg_lo:[1,0,0] neg_hi:[1,0,0]
    v_pk_fma_f32 v[236:237], v[180:181], v[68:69], v[236:237]
    v_pk_fma_f32 v[222:223], v[198:199], v[70:71], v[222:223] neg_lo:[1,0,0] neg_hi:[1,0,0]
    v_pk_fma_f32 v[238:239], v[182:183], v[70:71], v[238:239]
    v_cvt_pk_bf16_f32 v184, v208, v209
    v_cvt_pk_bf16_f32 v185, v210, v211
    v_cvt_pk_bf16_f32 v186, v224, v225
    v_cvt_pk_bf16_f32 v187, v226, v227
    v_cvt_pk_bf16_f32 v188, v212, v213
    v_cvt_pk_bf16_f32 v189, v214, v215
    v_cvt_pk_bf16_f32 v190, v228, v229
    v_cvt_pk_bf16_f32 v191, v230, v231
    v_cvt_pk_bf16_f32 v192, v216, v217
    v_cvt_pk_bf16_f32 v193, v218, v219
    v_cvt_pk_bf16_f32 v194, v232, v233
    v_cvt_pk_bf16_f32 v195, v234, v235
    v_cvt_pk_bf16_f32 v196, v220, v221
    v_cvt_pk_bf16_f32 v197, v222, v223
    v_cvt_pk_bf16_f32 v198, v236, v237
    v_cvt_pk_bf16_f32 v199, v238, v239
    v_mfma_f32_16x16x32_bf16 v[168:171], a[64:67], v[184:187], v[200:203]
    v_mfma_f32_16x16x32_bf16 v[172:175], a[64:67], v[188:191], v[200:203]
    v_mfma_f32_16x16x32_bf16 v[176:179], a[64:67], v[192:195], v[204:207]
    s_nop 5
    v_add_f32 v16, v16, v168
    v_add_f32 v18, v18, v169
    v_mfma_f32_16x16x32_bf16 v[180:183], a[64:67], v[196:199], v[204:207]
    v_add_f32 v24, v24, v172
    v_add_f32 v26, v26, v173
    v_add_f32 v20, v20, v170
    v_add_f32 v28, v28, v174
    v_add_f32 v17, v17, v176
    v_cvt_pk_bf16_f32 v6, v16, v17
    v_add_f32 v19, v19, v177
    v_lshlrev_b32 v16, 16, v6
    v_add_f32 v25, v25, v180
    v_cvt_pk_bf16_f32 v10, v24, v25
    v_add_f32 v27, v27, v181
    v_and_b32 v17, s49, v6
    v_cvt_pk_bf16_f32 v7, v18, v19
    v_lshlrev_b32 v24, 16, v10
    v_and_b32 v25, s49, v10
    v_cvt_pk_bf16_f32 v11, v26, v27
    v_add_f32 v21, v21, v178
    v_add_f32 v29, v29, v182
    v_pk_mul_f32 v[36:37], v[16:17], v[16:17]
    v_pk_mul_f32 v[38:39], v[24:25], v[24:25]
    v_lshlrev_b32 v18, 16, v7
    v_and_b32 v19, s49, v7
    v_cvt_pk_bf16_f32 v8, v20, v21
    v_lshlrev_b32 v26, 16, v11
    v_and_b32 v27, s49, v11
    v_cvt_pk_bf16_f32 v12, v28, v29
    v_add_f32 v22, v22, v171
    v_add_f32 v23, v23, v179
    v_add_f32 v30, v30, v175
    v_add_f32 v31, v31, v183
    v_pk_add_f32 v[32:33], v[16:17], v[18:19]
    v_pk_fma_f32 v[36:37], v[18:19], v[18:19], v[36:37]
    v_pk_add_f32 v[34:35], v[24:25], v[26:27]
    v_pk_fma_f32 v[38:39], v[26:27], v[26:27], v[38:39]
    v_lshlrev_b32 v20, 16, v8
    v_and_b32 v21, s49, v8
    v_cvt_pk_bf16_f32 v9, v22, v23
    v_lshlrev_b32 v28, 16, v12
    v_and_b32 v29, s49, v12
    v_cvt_pk_bf16_f32 v13, v30, v31
    v_pk_add_f32 v[32:33], v[32:33], v[20:21]
    v_pk_fma_f32 v[36:37], v[20:21], v[20:21], v[36:37]
    v_pk_add_f32 v[34:35], v[34:35], v[28:29]
    v_pk_fma_f32 v[38:39], v[28:29], v[28:29], v[38:39]
    v_lshlrev_b32 v22, 16, v9
    v_and_b32 v23, s49, v9
    v_lshlrev_b32 v30, 16, v13
    v_and_b32 v31, s49, v13
    v_pk_add_f32 v[32:33], v[32:33], v[22:23]
    v_pk_fma_f32 v[36:37], v[22:23], v[22:23], v[36:37]
    v_pk_add_f32 v[34:35], v[34:35], v[30:31]
    v_pk_fma_f32 v[38:39], v[30:31], v[30:31], v[38:39]
    v_pk_add_f32 v[32:33], v[32:33], v[34:35]
    v_pk_add_f32 v[36:37], v[36:37], v[38:39]
    s_nop 0
    v_permlane32_swap_b32 v32, v33
    v_permlane32_swap_b32 v36, v37
    v_add_f32 v32, v32, v33
    v_add_f32 v36, v36, v37
    s_nop 1
    v_permlane16_swap_b32 v32, v36
    v_add_f32 v32, v32, v36
    s_nop 1
    v_add_f32_dpp v32, v32, v32 row_ror:8 row_mask:0xf bank_mask:0xf
    s_nop 1
    v_add_f32_dpp v32, v32, v32 row_ror:4 row_mask:0xf bank_mask:0xf
    s_nop 1
    v_add_f32_dpp v32, v32, v32 quad_perm:[2,3,0,1] row_mask:0xf bank_mask:0xf
    s_nop 1
    v_add_f32_dpp v32, v32, v32 quad_perm:[1,0,3,2] row_mask:0xf bank_mask:0xf
    v_mov_b32 v37, v32
    s_nop 1
    v_permlane16_swap_b32 v32, v37
    v_mul_f32 v32, 0x3b000000, v32
    v_mul_f32 v37, 0x3b000000, v37
    v_fma_f32 v37, -v32, v32, v37
    v_cvt_pk_bf16_f32 v4, v32, v32
    v_max_f32 v37, 0, v37
    v_lshlrev_b32 v32, 16, v4
    v_cvt_pk_bf16_f32 v4, v37, v37
    v_lshlrev_b32 v37, 16, v4
    v_add_f32 v37, 0x3727c5ac, v37
    v_cvt_pk_bf16_f32 v4, v37, v37
    v_lshlrev_b32 v37, 16, v4
    v_sqrt_f32 v37, v37
    s_nop 0
    v_cvt_pk_bf16_f32 v4, v37, v37
    v_lshlrev_b32 v37, 16, v4
    v_rcp_f32 v37, v37
    s_nop 0
    v_mul_f32 v32, v32, v37
    v_readlane_b32 s80, v37, 0
    v_readlane_b32 s78, v32, 0
    v_readlane_b32 s79, v32, 32
    v_readlane_b32 s81, v37, 32
    v_mov_b32 v34, s78
    v_mov_b32 v35, s79
    v_pk_fma_f32 v[16:17], v[16:17], s[80:81], v[34:35] neg_lo:[0,0,1] neg_hi:[0,0,1]
    v_cvt_pk_bf16_f32 v40, v16, v17
    ds_write_b32 v159, v40 offset:16384
    v_pk_fma_f32 v[18:19], v[18:19], s[80:81], v[34:35] neg_lo:[0,0,1] neg_hi:[0,0,1]
    v_cvt_pk_bf16_f32 v41, v18, v19
    ds_write_b32 v159, v41 offset:16896
    v_pk_fma_f32 v[20:21], v[20:21], s[80:81], v[34:35] neg_lo:[0,0,1] neg_hi:[0,0,1]
    v_cvt_pk_bf16_f32 v42, v20, v21
    ds_write_b32 v159, v42 offset:17408
    v_pk_fma_f32 v[22:23], v[22:23], s[80:81], v[34:35] neg_lo:[0,0,1] neg_hi:[0,0,1]
    v_cvt_pk_bf16_f32 v43, v22, v23
    ds_write_b32 v159, v43 offset:17920
    v_pk_fma_f32 v[24:25], v[24:25], s[80:81], v[34:35] neg_lo:[0,0,1] neg_hi:[0,0,1]
    v_cvt_pk_bf16_f32 v164, v24, v25
    ds_write_b32 v159, v164 offset:16640
    v_pk_fma_f32 v[26:27], v[26:27], s[80:81], v[34:35] neg_lo:[0,0,1] neg_hi:[0,0,1]
    v_cvt_pk_bf16_f32 v165, v26, v27
    ds_write_b32 v159, v165 offset:17152
    v_pk_fma_f32 v[28:29], v[28:29], s[80:81], v[34:35] neg_lo:[0,0,1] neg_hi:[0,0,1]
    v_cvt_pk_bf16_f32 v166, v28, v29
    ds_write_b32 v159, v166 offset:17664
    v_pk_fma_f32 v[30:31], v[30:31], s[80:81], v[34:35] neg_lo:[0,0,1] neg_hi:[0,0,1]
    v_cvt_pk_bf16_f32 v167, v30, v31
    ds_write_b32 v159, v167 offset:18176
    s_waitcnt lgkmcnt(0)
    s_barrier
    ds_read_b128 v[136:139], v149 offset:16384
    ds_read_b128 v[140:143], v149 offset:20480
    s_add_u32 s72, s67, 10485760
    s_add_u32 s73, s67, 11534336
    s_waitcnt lgkmcnt(1)
    buffer_store_dwordx4 v[136:139], v149, s[56:59], s76 offen sc1
    s_waitcnt lgkmcnt(0)
    buffer_store_dwordx4 v[140:143], v149, s[56:59], s77 offen sc1
    s_waitcnt vmcnt(0)
    ds_write_b32 v159, v6 offset:0
    ds_write_b32 v159, v7 offset:512
    ds_write_b32 v159, v8 offset:1024
    ds_write_b32 v159, v9 offset:1536
    ds_write_b32 v159, v10 offset:256
    ds_write_b32 v159, v11 offset:768
    ds_write_b32 v159, v12 offset:1280
    ds_write_b32 v159, v13 offset:1792
    v_accvgpr_read_b32 v56, a204
    v_accvgpr_read_b32 v57, a205
    v_accvgpr_read_b32 v58, a206
    v_accvgpr_read_b32 v59, a207
    v_accvgpr_read_b32 v60, a208
    v_accvgpr_read_b32 v61, a209
    v_accvgpr_read_b32 v62, a210
    v_accvgpr_read_b32 v63, a211
    v_accvgpr_read_b32 v64, a212
    v_accvgpr_read_b32 v65, a213
    v_accvgpr_read_b32 v66, a214
    v_accvgpr_read_b32 v67, a215
    v_accvgpr_read_b32 v68, a216
    v_accvgpr_read_b32 v69, a217
    v_accvgpr_read_b32 v70, a218
    v_accvgpr_read_b32 v71, a219
    v_accvgpr_read_b32 v72, a220
    v_accvgpr_read_b32 v73, a221
    v_accvgpr_read_b32 v74, a222
    v_accvgpr_read_b32 v75, a223
    v_accvgpr_read_b32 v76, a224
    v_accvgpr_read_b32 v77, a225
    v_accvgpr_read_b32 v78, a226
    v_accvgpr_read_b32 v79, a227
    v_accvgpr_read_b32 v80, a228
    v_accvgpr_read_b32 v81, a229
    v_accvgpr_read_b32 v82, a230
    v_accvgpr_read_b32 v83, a231
    v_accvgpr_read_b32 v84, a232
    v_accvgpr_read_b32 v85, a233
    v_accvgpr_read_b32 v86, a234
    v_accvgpr_read_b32 v87, a235
    s_nop 0
    buffer_load_dwordx4 v[48:51], v150, s[56:59], s72 offen sc1
    s_add_u32 s76, s66, 14680064
    s_mov_b32 s38, 131072
    buffer_load_dwordx4 v[52:55], v150, s[56:59], s73 offen sc1
L_chk6:
    s_waitcnt vmcnt(0)
    v_max3_u32 v6, v48, v49, v50
    v_max3_u32 v6, v6, v51, v52
    v_max3_u32 v6, v6, v53, v54
    v_max_u32 v6, v6, v55
    v_cmp_eq_u32 vcc, -1, v6
    s_nop 0
    s_cbranch_vccz L_ok6
    s_sub_u32 s38, s38, 1
    s_cmp_eq_u32 s38, 0
    s_cbranch_scc1 L_ok6
    buffer_load_dwordx4 v[48:51], v150, s[56:59], s72 offen sc1
    buffer_load_dwordx4 v[52:55], v150, s[56:59], s73 offen sc1
    s_branch L_chk6
L_ok6:
    ds_write_b128 v160, v[48:51] offset:8192
    ds_write_b128 v160, v[52:55] offset:10240
    s_waitcnt lgkmcnt(0)
    s_barrier
    ds_read_b128 v[6:9], v161 offset:8192
    ds_read_b128 v[10:13], v161 offset:10240
    ds_read_b128 v[16:19], v161 offset:8448
    ds_read_b128 v[20:23], v161 offset:10496
    ds_read_b128 v[24:27], v161 offset:12288
    ds_read_b128 v[28:31], v161 offset:14336
    ds_read_b128 v[32:35], v161 offset:12544
    ds_read_b128 v[36:39], v161 offset:14592
    ds_read_b64 v[40:41], v162 offset:8192
    ds_read_b64 v[42:43], v162 offset:8448
    ds_read_b64 v[44:45], v162 offset:12288
    ds_read_b64 v[152:153], v162 offset:12544
    s_waitcnt lgkmcnt(11)
    v_mfma_f32_16x16x32_bf16 v[164:167], v[6:9], a[172:175], 0
    v_mfma_f32_16x16x32_bf16 v[172:175], v[6:9], a[176:179], 0
    s_waitcnt lgkmcnt(10)
    v_mfma_f32_16x16x32_bf16 v[164:167], v[10:13], a[180:183], v[164:167]
    v_mfma_f32_16x16x32_bf16 v[172:175], v[10:13], a[184:187], v[172:175]
    s_waitcnt lgkmcnt(9)
    v_mfma_f32_16x16x32_bf16 v[168:171], v[16:19], a[172:175], 0
    v_mfma_f32_16x16x32_bf16 v[176:179], v[16:19], a[176:179], 0
    s_waitcnt lgkmcnt(8)
    v_mfma_f32_16x16x32_bf16 v[168:171], v[20:23], a[180:183], v[168:171]
    s_waitcnt lgkmcnt(3)
    v_lshlrev_b32 v16, 16, v40
    v_and_b32 v17, s49, v40
    v_mfma_f32_16x16x32_bf16 v[176:179], v[20:23], a[184:187], v[176:179]
    v_lshlrev_b32 v18, 16, v41
    v_and_b32 v19, s49, v41
    v_mfma_f32_16x16x32_bf16 v[204:207], v[24:27], a[172:175], 0
    s_waitcnt lgkmcnt(2)
    v_lshlrev_b32 v20, 16, v42
    v_and_b32 v21, s49, v42
    v_mfma_f32_16x16x32_bf16 v[212:215], v[24:27], a[176:179], 0
    v_lshlrev_b32 v22, 16, v43
    v_and_b32 v23, s49, v43
    v_mfma_f32_16x16x32_bf16 v[204:207], v[28:31], a[180:183], v[204:207]
    v_mfma_f32_16x16x32_bf16 v[212:215], v[28:31], a[184:187], v[212:215]
    v_mfma_f32_16x16x32_bf16 v[208:211], v[32:35], a[172:175], 0
    s_nop 5
    v_mul_f32 v220, v204, v56
    v_mul_f32 v221, v205, v57
    v_mfma_f32_16x16x32_bf16 v[216:219], v[32:35], a[176:179], 0
    v_mul_f32 v228, v212, v56
    v_mul_f32 v229, v213, v57
    v_mfma_f32_16x16x32_bf16 v[208:211], v[36:39], a[180:183], v[208:211]
    v_mul_f32 v222, v206, v58
    v_mul_f32 v230, v214, v58
    v_mfma_f32_16x16x32_bf16 v[216:219], v[36:39], a[184:187], v[216:219]
    v_mul_f32 v223, v207, v59
    v_mul_f32 v231, v215, v59
    v_fma_f32 v220, v212, v64, v220
    v_fma_f32 v228, -v204, v64, v228
    v_pk_mul_f32 v[180:181], v[164:165], v[56:57]
    v_pk_mul_f32 v[188:189], v[172:173], v[56:57]
    v_pk_mul_f32 v[182:183], v[166:167], v[58:59]
    v_pk_mul_f32 v[190:191], v[174:175], v[58:59]
    v_pk_fma_f32 v[180:181], v[172:173], v[64:65], v[180:181]
    v_pk_fma_f32 v[188:189], v[164:165], v[64:65], v[188:189] neg_lo:[1,0,0] neg_hi:[1,0,0]
    v_pk_fma_f32 v[182:183], v[174:175], v[66:67], v[182:183]
    v_pk_fma_f32 v[190:191], v[166:167], v[66:67], v[190:191] neg_lo:[1,0,0] neg_hi:[1,0,0]
    v_cvt_pk_bf16_f32 v196, v180, v181
    v_cvt_pk_bf16_f32 v197, v182, v183
    v_cvt_pk_bf16_f32 v198, v188, v189
    v_cvt_pk_bf16_f32 v199, v190, v191
    v_pk_mul_f32 v[184:185], v[168:169], v[60:61]
    v_pk_mul_f32 v[192:193], v[176:177], v[60:61]
    v_pk_mul_f32 v[186:187], v[170:171], v[62:63]
    v_pk_mul_f32 v[194:195], v[178:179], v[62:63]
    v_pk_fma_f32 v[184:185], v[176:177], v[68:69], v[184:185]
    v_pk_fma_f32 v[192:193], v[168:169], v[68:69], v[192:193] neg_lo:[1,0,0] neg_hi:[1,0,0]
    v_pk_fma_f32 v[186:187], v[178:179], v[70:71], v[186:187]
    v_pk_fma_f32 v[194:195], v[170:171], v[70:71], v[194:195] neg_lo:[1,0,0] neg_hi:[1,0,0]
    v_mfma_f32_16x16x32_bf16 v[164:167], a[4:7], v[196:199], 0
    v_cvt_pk_bf16_f32 v200, v184, v185
    v_cvt_pk_bf16_f32 v201, v186, v187
    v_mfma_f32_16x16x32_bf16 v[172:175], a[10:13], v[196:199], 0
    v_cvt_pk_bf16_f32 v202, v192, v193
    v_cvt_pk_bf16_f32 v203, v194, v195
    v_mfma_f32_16x16x32_bf16 v[168:171], a[24:27], v[196:199], 0
    v_fma_f32 v221, v213, v65, v221
    v_fma_f32 v229, -v205, v65, v229
    v_mfma_f32_16x16x32_bf16 v[176:179], a[30:33], v[196:199], 0
    v_fma_f32 v222, v214, v66, v222
    v_fma_f32 v230, -v206, v66, v230
    v_mfma_f32_16x16x32_bf16 v[164:167], a[14:17], v[200:203], v[164:167]
    v_fma_f32 v223, v215, v67, v223
    v_fma_f32 v231, -v207, v67, v231
    v_mfma_f32_16x16x32_bf16 v[172:175], a[20:23], v[200:203], v[172:175]
    v_cvt_pk_bf16_f32 v236, v220, v221
    v_cvt_pk_bf16_f32 v237, v222, v223
    v_mfma_f32_16x16x32_bf16 v[168:171], a[34:37], v[200:203], v[168:171]
    v_cvt_pk_bf16_f32 v238, v228, v229
    v_cvt_pk_bf16_f32 v239, v230, v231
    v_mfma_f32_16x16x32_bf16 v[176:179], a[40:43], v[200:203], v[176:179]
    v_mul_f32 v224, v208, v60
    v_mul_f32 v232, v216, v60
    v_mul_f32 v225, v209, v61
    v_mul_f32 v233, v217, v61
    v_mul_f32 v226, v210, v62
    v_mul_f32 v234, v218, v62
    v_mul_f32 v227, v211, v63
    v_mul_f32 v235, v219, v63
    v_fma_f32 v224, v216, v68, v224
    v_fma_f32 v232, -v208, v68, v232
    v_fma_f32 v225, v217, v69, v225
    v_fma_f32 v233, -v209, v69, v233
    v_fma_f32 v226, v218, v70, v226
    v_fma_f32 v234, -v210, v70, v234
    v_fma_f32 v227, v219, v71, v227
    v_fma_f32 v235, -v211, v71, v235
    v_pk_mul_f32 v[180:181], v[164:165], v[104:105]
    v_pk_mul_f32 v[188:189], v[172:173], v[104:105]
    v_pk_mul_f32 v[182:183], v[166:167], v[106:107]
    v_pk_mul_f32 v[190:191], v[174:175], v[106:107]
    v_mfma_f32_16x16x32_bf16 v[204:207], a[4:7], v[236:239], 0
    v_cvt_pk_bf16_f32 v240, v224, v225
    v_cvt_pk_bf16_f32 v241, v226, v227
    v_mfma_f32_16x16x32_bf16 v[212:215], a[10:13], v[236:239], 0
    v_cvt_pk_bf16_f32 v242, v232, v233
    v_cvt_pk_bf16_f32 v243, v234, v235
    v_mfma_f32_16x16x32_bf16 v[208:211], a[24:27], v[236:239], 0
    s_waitcnt lgkmcnt(1)
    v_lshlrev_b32 v32, 16, v44
    v_and_b32 v33, s49, v44
    v_mfma_f32_16x16x32_bf16 v[216:219], a[30:33], v[236:239], 0
    v_lshlrev_b32 v34, 16, v45
    v_and_b32 v35, s49, v45
    v_mfma_f32_16x16x32_bf16 v[204:207], a[14:17], v[240:243], v[204:207]
    s_waitcnt lgkmcnt(0)
    v_lshlrev_b32 v36, 16, v152
    v_and_b32 v37, s49, v152
    v_mfma_f32_16x16x32_bf16 v[212:215], a[20:23], v[240:243], v[212:215]
    v_lshlrev_b32 v38, 16, v153
    v_and_b32 v39, s49, v153
    v_mfma_f32_16x16x32_bf16 v[208:211], a[34:37], v[240:243], v[208:211]
    s_nop 0
    v_mul_f32 v220, v204, v120
    v_mul_f32 v221, v205, v121
    v_mfma_f32_16x16x32_bf16 v[216:219], a[40:43], v[240:243], v[216:219]
    s_nop 0
    v_mul_f32 v228, v212, v120
    v_mul_f32 v229, v213, v121
    v_mul_f32 v222, v206, v122
    v_mul_f32 v230, v214, v122
    v_mul_f32 v223, v207, v123
    v_pk_fma_f32 v[180:181], v[172:173], v[108:109], v[180:181] neg_lo:[1,0,0] neg_hi:[1,0,0]
    v_pk_fma_f32 v[188:189], v[164:165], v[108:109], v[188:189]
    v_pk_fma_f32 v[182:183], v[174:175], v[110:111], v[182:183] neg_lo:[1,0,0] neg_hi:[1,0,0]
    v_pk_fma_f32 v[190:191], v[166:167], v[110:111], v[190:191]
    v_cvt_pk_bf16_f32 v196, v180, v181
    v_cvt_pk_bf16_f32 v197, v182, v183
    v_cvt_pk_bf16_f32 v198, v188, v189
    v_cvt_pk_bf16_f32 v199, v190, v191
    v_pk_mul_f32 v[184:185], v[168:169], v[112:113]
    v_pk_mul_f32 v[192:193], v[176:177], v[112:113]
    v_pk_mul_f32 v[186:187], v[170:171], v[114:115]
    v_pk_mul_f32 v[194:195], v[178:179], v[114:115]
    v_pk_fma_f32 v[184:185], v[176:177], v[116:117], v[184:185] neg_lo:[1,0,0] neg_hi:[1,0,0]
    v_pk_fma_f32 v[192:193], v[168:169], v[116:117], v[192:193]
    v_pk_fma_f32 v[186:187], v[178:179], v[118:119], v[186:187] neg_lo:[1,0,0] neg_hi:[1,0,0]
    v_pk_fma_f32 v[194:195], v[170:171], v[118:119], v[194:195]
    v_mfma_f32_16x16x32_bf16 v[164:167], v[196:199], a[8:11], 0
    v_cvt_pk_bf16_f32 v200, v184, v185
    v_cvt_pk_bf16_f32 v201, v186, v187
    v_mfma_f32_16x16x32_bf16 v[172:175], v[196:199], a[6:9], 0
    v_cvt_pk_bf16_f32 v202, v192, v193
    v_cvt_pk_bf16_f32 v203, v194, v195
    v_mfma_f32_16x16x32_bf16 v[168:171], v[196:199], a[28:31], 0
    v_mul_f32 v231, v215, v123
    v_fma_f32 v220, -v212, v124, v220
    v_mfma_f32_16x16x32_bf16 v[164:167], v[200:203], a[18:21], v[164:167]
    v_fma_f32 v228, v204, v124, v228
    v_fma_f32 v221, -v213, v125, v221
    v_mfma_f32_16x16x32_bf16 v[172:175], v[200:203], a[16:19], v[172:175]
    v_fma_f32 v229, v205, v125, v229
    v_fma_f32 v222, -v214, v126, v222
    v_mfma_f32_16x16x32_bf16 v[176:179], v[196:199], a[26:29], 0
    v_fma_f32 v230, v206, v126, v230
    v_fma_f32 v223, -v215, v127, v223
    v_fma_f32 v231, v207, v127, v231
    v_cvt_pk_bf16_f32 v236, v220, v221
    v_cvt_pk_bf16_f32 v237, v222, v223
    v_cvt_pk_bf16_f32 v238, v228, v229
    v_cvt_pk_bf16_f32 v239, v230, v231
    v_mfma_f32_16x16x32_bf16 v[168:171], v[200:203], a[38:41], v[168:171]
    v_mul_f32 v224, v208, v128
    v_mul_f32 v232, v216, v128
    v_mfma_f32_16x16x32_bf16 v[176:179], v[200:203], a[36:39], v[176:179]
    v_mul_f32 v225, v209, v129
    v_mul_f32 v233, v217, v129
    v_mul_f32 v226, v210, v130
    v_mul_f32 v234, v218, v130
    v_mul_f32 v227, v211, v131
    v_mul_f32 v235, v219, v131
    v_fma_f32 v224, -v216, v132, v224
    v_fma_f32 v232, v208, v132, v232
    v_fma_f32 v225, -v217, v133, v225
    v_fma_f32 v233, v209, v133, v233
    v_fma_f32 v226, -v218, v134, v226
    v_fma_f32 v234, v210, v134, v234
    v_fma_f32 v227, -v219, v135, v227
    v_fma_f32 v235, v211, v135, v235
    v_pk_mul_f32 v[180:181], v[164:165], v[72:73]
    v_pk_mul_f32 v[188:189], v[172:173], v[72:73]
    v_pk_mul_f32 v[182:183], v[166:167], v[74:75]
    v_pk_mul_f32 v[190:191], v[174:175], v[74:75]
    v_mfma_f32_16x16x32_bf16 v[204:207], v[236:239], a[8:11], 0
    v_cvt_pk_bf16_f32 v240, v224, v225
    v_cvt_pk_bf16_f32 v241, v226, v227
    v_mfma_f32_16x16x32_bf16 v[212:215], v[236:239], a[6:9], 0
    v_cvt_pk_bf16_f32 v242, v232, v233
    v_cvt_pk_bf16_f32 v243, v234, v235
    v_mfma_f32_16x16x32_bf16 v[208:211], v[236:239], a[28:31], 0
    s_nop 0
    v_mfma_f32_16x16x32_bf16 v[204:207], v[240:243], a[18:21], v[204:207]
    v_mfma_f32_16x16x32_bf16 v[212:215], v[240:243], a[16:19], v[212:215]
    v_mfma_f32_16x16x32_bf16 v[216:219], v[236:239], a[26:29], 0
    v_mfma_f32_16x16x32_bf16 v[208:211], v[240:243], a[38:41], v[208:211]
    v_mfma_f32_16x16x32_bf16 v[216:219], v[240:243], a[36:39], v[216:219]
    v_pk_fma_f32 v[180:181], v[172:173], v[80:81], v[180:181] neg_lo:[1,0,0] neg_hi:[1,0,0]
    v_pk_fma_f32 v[188:189], v[164:165], v[80:81], v[188:189]
    v_pk_fma_f32 v[182:183], v[174:175], v[82:83], v[182:183] neg_lo:[1,0,0] neg_hi:[1,0,0]
    v_pk_fma_f32 v[190:191], v[166:167], v[82:83], v[190:191]
    v_cvt_pk_bf16_f32 v6, v180, v181
    v_cvt_pk_bf16_f32 v7, v182, v183
    v_cvt_pk_bf16_f32 v8, v188, v189
    v_cvt_pk_bf16_f32 v9, v190, v191
    ds_write_b128 v157, v[6:9] offset:16384
    v_pk_mul_f32 v[184:185], v[168:169], v[76:77]
    v_pk_mul_f32 v[192:193], v[176:177], v[76:77]
    v_pk_mul_f32 v[186:187], v[170:171], v[78:79]
    v_pk_mul_f32 v[194:195], v[178:179], v[78:79]
    v_pk_fma_f32 v[184:185], v[176:177], v[84:85], v[184:185] neg_lo:[1,0,0] neg_hi:[1,0,0]
    v_pk_fma_f32 v[192:193], v[168:169], v[84:85], v[192:193]
    v_pk_fma_f32 v[186:187], v[178:179], v[86:87], v[186:187] neg_lo:[1,0,0] neg_hi:[1,0,0]
    v_pk_fma_f32 v[194:195], v[170:171], v[86:87], v[194:195]
    v_cvt_pk_bf16_f32 v10, v184, v185
    v_cvt_pk_bf16_f32 v11, v186, v187
    v_cvt_pk_bf16_f32 v12, v192, v193
    v_cvt_pk_bf16_f32 v13, v194, v195
    ds_write_b128 v157, v[10:13] offset:17408
    v_pk_mul_f32 v[220:221], v[204:205], v[72:73]
    v_pk_mul_f32 v[228:229], v[212:213], v[72:73]
    v_pk_mul_f32 v[222:223], v[206:207], v[74:75]
    v_pk_mul_f32 v[230:231], v[214:215], v[74:75]
    v_pk_fma_f32 v[220:221], v[212:213], v[80:81], v[220:221] neg_lo:[1,0,0] neg_hi:[1,0,0]
    v_pk_fma_f32 v[228:229], v[204:205], v[80:81], v[228:229]
    v_pk_fma_f32 v[222:223], v[214:215], v[82:83], v[222:223] neg_lo:[1,0,0] neg_hi:[1,0,0]
    v_pk_fma_f32 v[230:231], v[206:207], v[82:83], v[230:231]
    v_cvt_pk_bf16_f32 v24, v220, v221
    v_cvt_pk_bf16_f32 v25, v222, v223
    v_cvt_pk_bf16_f32 v26, v228, v229
    v_cvt_pk_bf16_f32 v27, v230, v231
    ds_write_b128 v157, v[24:27] offset:24576
    v_pk_mul_f32 v[224:225], v[208:209], v[76:77]
    v_pk_mul_f32 v[232:233], v[216:217], v[76:77]
    v_pk_mul_f32 v[226:227], v[210:211], v[78:79]
    v_pk_mul_f32 v[234:235], v[218:219], v[78:79]
    v_pk_fma_f32 v[224:225], v[216:217], v[84:85], v[224:225] neg_lo:[1,0,0] neg_hi:[1,0,0]
    v_pk_fma_f32 v[232:233], v[208:209], v[84:85], v[232:233]
    v_pk_fma_f32 v[226:227], v[218:219], v[86:87], v[226:227] neg_lo:[1,0,0] neg_hi:[1,0,0]
    v_pk_fma_f32 v[234:235], v[210:211], v[86:87], v[234:235]
    v_cvt_pk_bf16_f32 v28, v224, v225
    v_cvt_pk_bf16_f32 v29, v226, v227
    v_cvt_pk_bf16_f32 v30, v232, v233
    v_cvt_pk_bf16_f32 v31, v234, v235
    ds_write_b128 v157, v[28:31] offset:25600
    s_waitcnt lgkmcnt(0)
    s_barrier
    ds_read_b128 v[180:183], v5 offset:16384
    ds_read_b128 v[220:223], v5 offset:24576
    ds_read_b128 v[184:187], v5 offset:18432
    ds_read_b128 v[224:227], v5 offset:26624
    ds_read_b128 v[188:191], v5 offset:20480
    ds_read_b128 v[228:231], v5 offset:28672
    ds_read_b128 v[192:195], v5 offset:22528
    ds_read_b128 v[232:235], v5 offset:30720
    ds_read_b128 v[172:175], v5 offset:17408
    ds_read_b128 v[212:215], v5 offset:25600
    ds_read_b128 v[176:179], v5 offset:19456
    s_waitcnt lgkmcnt(10)
    v_mfma_f32_16x16x32_bf16 v[164:167], a[188:191], v[180:183], 0
    ds_read_b128 v[216:219], v5 offset:27648
    s_waitcnt lgkmcnt(10)
    v_mfma_f32_16x16x32_bf16 v[204:207], a[188:191], v[220:223], 0
    ds_read_b128 v[196:199], v5 offset:21504
    s_waitcnt lgkmcnt(10)
    v_mfma_f32_16x16x32_bf16 v[164:167], a[192:195], v[184:187], v[164:167]
    ds_read_b128 v[236:239], v5 offset:29696
    s_waitcnt lgkmcnt(10)
    v_mfma_f32_16x16x32_bf16 v[204:207], a[192:195], v[224:227], v[204:207]
    ds_read_b128 v[200:203], v5 offset:23552
    s_waitcnt lgkmcnt(10)
    v_mfma_f32_16x16x32_bf16 v[164:167], a[196:199], v[188:191], v[164:167]
    ds_read_b128 v[240:243], v5 offset:31744
    s_waitcnt lgkmcnt(10)
    v_mfma_f32_16x16x32_bf16 v[204:207], a[196:199], v[228:231], v[204:207]
    s_add_u32 s72, s67, 14680064
    s_add_u32 s73, s67, 15728640
    s_waitcnt lgkmcnt(9)
    v_mfma_f32_16x16x32_bf16 v[164:167], a[200:203], v[192:195], v[164:167]
    s_waitcnt lgkmcnt(8)
    v_mfma_f32_16x16x32_bf16 v[204:207], a[200:203], v[232:235], v[204:207]
    s_waitcnt lgkmcnt(7)
    v_mfma_f32_16x16x32_bf16 v[168:171], a[188:191], v[172:175], 0
    s_nop 3
    v_fmac_f32 v164, s68, v16
    v_fmac_f32 v165, s68, v17
    v_fmac_f32 v166, s68, v18
    v_fmac_f32 v167, s68, v19
    v_fmac_f32 v204, s70, v32
    v_fmac_f32 v205, s70, v33
    v_fmac_f32 v206, s70, v34
    v_fmac_f32 v207, s70, v35
    v_cvt_pk_bf16_f32 v136, v164, v165
    v_cvt_pk_bf16_f32 v137, v166, v167
    v_cvt_pk_bf16_f32 v138, v204, v205
    v_cvt_pk_bf16_f32 v139, v206, v207
    s_waitcnt lgkmcnt(6)
    v_mfma_f32_16x16x32_bf16 v[208:211], a[188:191], v[212:215], 0
    v_permlane16_swap_b32 v136, v138
    v_permlane16_swap_b32 v137, v139
    buffer_store_dwordx4 v[136:139], v151, s[56:59], s76 offen offset:0 sc1
    s_waitcnt lgkmcnt(5)
    v_mfma_f32_16x16x32_bf16 v[168:171], a[192:195], v[176:179], v[168:171]
    s_waitcnt lgkmcnt(4)
    v_mfma_f32_16x16x32_bf16 v[208:211], a[192:195], v[216:219], v[208:211]
    s_waitcnt lgkmcnt(3)
    v_mfma_f32_16x16x32_bf16 v[168:171], a[196:199], v[196:199], v[168:171]
    s_waitcnt lgkmcnt(2)
    v_mfma_f32_16x16x32_bf16 v[208:211], a[196:199], v[236:239], v[208:211]
    s_waitcnt lgkmcnt(1)
    v_mfma_f32_16x16x32_bf16 v[168:171], a[200:203], v[200:203], v[168:171]
    s_waitcnt lgkmcnt(0)
    v_mfma_f32_16x16x32_bf16 v[208:211], a[200:203], v[240:243], v[208:211]
    s_nop 5
    v_fmac_f32 v168, s68, v20
    v_fmac_f32 v169, s68, v21
    v_fmac_f32 v170, s68, v22
    v_fmac_f32 v171, s68, v23
    v_fmac_f32 v208, s70, v36
    v_fmac_f32 v209, s70, v37
    v_fmac_f32 v210, s70, v38
    v_fmac_f32 v211, s70, v39
    v_cvt_pk_bf16_f32 v140, v168, v169
    v_cvt_pk_bf16_f32 v141, v170, v171
    v_cvt_pk_bf16_f32 v142, v208, v209
    v_cvt_pk_bf16_f32 v143, v210, v211
    s_nop 0
    v_permlane16_swap_b32 v140, v142
    v_permlane16_swap_b32 v141, v143
    buffer_store_dwordx4 v[140:143], v151, s[56:59], s76 offen offset:512 sc1
    s_waitcnt vmcnt(0)
    ds_read_b128 v[6:9], v149 offset:0
    ds_read_b128 v[10:13], v149 offset:4096
    s_waitcnt lgkmcnt(1)
    v_lshlrev_b32 v16, 16, v6
    v_and_b32 v17, s49, v6
    v_lshlrev_b32 v18, 16, v7
    v_and_b32 v19, s49, v7
    v_lshlrev_b32 v20, 16, v8
    v_and_b32 v21, s49, v8
    v_lshlrev_b32 v22, 16, v9
    v_and_b32 v23, s49, v9
    s_waitcnt lgkmcnt(0)
    v_lshlrev_b32 v24, 16, v10
    v_and_b32 v25, s49, v10
    v_lshlrev_b32 v26, 16, v11
    v_and_b32 v27, s49, v11
    v_lshlrev_b32 v28, 16, v12
    v_and_b32 v29, s49, v12
    v_lshlrev_b32 v30, 16, v13
    v_and_b32 v31, s49, v13
    s_nop 0
    buffer_load_dwordx4 v[48:51], v150, s[56:59], s72 offen sc1
    s_mov_b32 s38, 131072
    buffer_load_dwordx4 v[52:55], v150, s[56:59], s73 offen sc1
L_chk7:
    s_waitcnt vmcnt(0)
    v_max3_u32 v15, v48, v49, v50
    v_max3_u32 v15, v15, v51, v52
    v_max3_u32 v15, v15, v53, v54
    v_max_u32 v15, v15, v55
    v_cmp_eq_u32 vcc, -1, v15
    s_nop 0
    s_cbranch_vccz L_ok7
    s_sub_u32 s38, s38, 1
    s_cmp_eq_u32 s38, 0
    s_cbranch_scc1 L_ok7
    buffer_load_dwordx4 v[48:51], v150, s[56:59], s72 offen sc1
    buffer_load_dwordx4 v[52:55], v150, s[56:59], s73 offen sc1
    s_branch L_chk7
L_ok7:
    v_lshlrev_b32 v32, 16, v48
    v_and_b32 v33, s49, v48
    v_lshlrev_b32 v34, 16, v49
    v_and_b32 v35, s49, v49
    v_lshlrev_b32 v36, 16, v50
    v_and_b32 v37, s49, v50
    v_lshlrev_b32 v38, 16, v51
    v_and_b32 v39, s49, v51
    v_pk_add_f32 v[32:33], v[32:33], v[16:17]
    v_pk_add_f32 v[34:35], v[34:35], v[18:19]
    v_pk_add_f32 v[36:37], v[36:37], v[20:21]
    v_pk_add_f32 v[38:39], v[38:39], v[22:23]
    v_cvt_pk_bf16_f32 v6, v32, v33
    v_cvt_pk_bf16_f32 v7, v34, v35
    v_cvt_pk_bf16_f32 v8, v36, v37
    v_cvt_pk_bf16_f32 v9, v38, v39
    ds_write_b128 v149, v[6:9] offset:0
    v_lshlrev_b32 v40, 16, v52
    v_and_b32 v41, s49, v52
    v_lshlrev_b32 v42, 16, v53
    v_and_b32 v43, s49, v53
    v_lshlrev_b32 v44, 16, v54
    v_and_b32 v45, s49, v54
    v_lshlrev_b32 v152, 16, v55
    v_and_b32 v153, s49, v55
    v_pk_add_f32 v[40:41], v[40:41], v[24:25]
    v_pk_add_f32 v[42:43], v[42:43], v[26:27]
    v_pk_add_f32 v[44:45], v[44:45], v[28:29]
    v_pk_add_f32 v[152:153], v[152:153], v[30:31]
    v_cvt_pk_bf16_f32 v10, v40, v41
    v_cvt_pk_bf16_f32 v11, v42, v43
    v_cvt_pk_bf16_f32 v12, v44, v45
    v_cvt_pk_bf16_f32 v13, v152, v153
    ds_write_b128 v149, v[10:13] offset:4096
    s_waitcnt lgkmcnt(0)
    s_barrier
    v_lshrrev_b32 v4, 2, v2
    v_lshlrev_b32 v6, 4, v4
    v_and_b32 v4, 1, v2
    v_lshl_add_u32 v6, v4, 3, v6
    v_bfe_u32 v4, v2, 1, 1
    v_lshl_add_u32 v6, v4, 7, v6
    v_lshl_add_u32 v6, v3, 8, v6
    s_lshl_b32 s36, s34, 11
    v_add_u32 v6, s36, v6
    ds_read_b64_tr_b16 v[8:9], v6 offset:0
    ds_read_b64_tr_b16 v[10:11], v6 offset:64
    s_mov_b32 s60, s28
    s_mov_b32 s61, s29
    s_mov_b32 s62, 0x200000
    s_mov_b32 s63, 0x20000
    s_lshl_b32 s36, s40, 8
    v_and_b32 v7, 7, v2
    s_add_u32 s36, s36, s39
    v_lshlrev_b32 v7, 15, v7
    v_lshrrev_b32 v4, 3, v2
    s_lshl_b32 s36, s36, 10
    v_lshl_add_u32 v7, v4, 4, v7
    s_lshl_b32 s37, s34, 8
    v_lshl_add_u32 v7, v3, 5, v7
    s_add_u32 s36, s36, s37
    ds_read_b64_tr_b16 v[16:17], v6 offset:1024
    ds_read_b64_tr_b16 v[18:19], v6 offset:1088
    s_waitcnt lgkmcnt(2)
    buffer_store_dwordx4 v[8:11], v7, s[60:63], s36 offen offset:0 sc1
    s_waitcnt lgkmcnt(0)
    buffer_store_dwordx4 v[16:19], v7, s[60:63], s36 offen offset:128 sc1
    s_nop 1
L_end:
    s_endpgm
L_code_end:
.p2align 8
.type L_tables,@object
L_tables:
.quad 0x3f803f803f803f80,0,0,0x3f803f803f803f80,0x3ec43f353f6d3f80,0x3f6d3f353ec40000,0xbf6dbf35bec40000,0x3ec43f353f6d3f80,0xbf3500003f353f80,0x3f353f803f350000,0xbf35bf80bf350000,0xbf3500003f353f80,0xbf6dbf353ec43f80,0xbec43f353f6d0000,0x3ec4bf35bf6d0000,0xbf6dbf353ec43f80
.quad 0xbf8000003f80,0xbf8000003f800000,0x3f800000bf800000,0xbf8000003f80,0x3f6dbf35bec43f80,0xbec4bf353f6d0000,0x3ec43f35bf6d0000,0x3f6dbf35bec43f80,0x3f350000bf353f80,0x3f35bf803f350000,0xbf353f80bf350000,0x3f350000bf353f80,0xbec43f35bf6d3f80,0x3f6dbf353ec40000,0xbf6d3f35bec40000,0xbec43f35bf6d3f80
.quad 0x3f803f803f803f80,0,0,0x3f803f803f803f80,0xbf6dbf35bec40000,0x3ec43f353f6d3f80,0xbec4bf35bf6dbf80,0xbf6dbf35bec40000,0x3f350000bf35bf80,0xbf35bf80bf350000,0x3f353f803f350000,0x3f350000bf35bf80,0xbec43f353f6d0000,0x3f6d3f35bec4bf80,0xbf6dbf353ec43f80,0xbec43f353f6d0000
.quad 0xbf8000003f80,0xbf8000003f800000,0x3f800000bf800000,0xbf8000003f80,0x3ec43f35bf6d0000,0x3f6dbf35bec43f80,0xbf6d3f353ec4bf80,0x3ec43f35bf6d0000,0xbf3500003f35bf80,0xbf353f80bf350000,0x3f35bf803f350000,0xbf3500003f35bf80,0x3f6dbf353ec40000,0x3ec4bf353f6dbf80,0xbec43f35bf6d3f80,0x3f6dbf353ec40000
.quad 0x3f803f803f803f80,0,0,0x3f803f803f803f80,0xbec4bf35bf6dbf80,0xbf6dbf35bec40000,0x3f6d3f353ec40000,0xbec4bf35bf6dbf80,0xbf3500003f353f80,0x3f353f803f350000,0xbf35bf80bf350000,0xbf3500003f353f80,0x3f6d3f35bec4bf80,0x3ec4bf35bf6d0000,0xbec43f353f6d0000,0x3f6d3f35bec4bf80
.quad 0xbf8000003f80,0xbf8000003f800000,0x3f800000bf800000,0xbf8000003f80,0xbf6d3f353ec4bf80,0x3ec43f35bf6d0000,0xbec4bf353f6d0000,0xbf6d3f353ec4bf80,0x3f350000bf353f80,0x3f35bf803f350000,0xbf353f80bf350000,0x3f350000bf353f80,0x3ec4bf353f6dbf80,0xbf6d3f35bec40000,0x3f6dbf353ec40000,0x3ec4bf353f6dbf80
.quad 0x3f803f803f803f80,0,0,0x3f803f803f803f80,0x3f6d3f353ec40000,0xbec4bf35bf6dbf80,0x3ec43f353f6d3f80,0x3f6d3f353ec40000,0x3f350000bf35bf80,0xbf35bf80bf350000,0x3f353f803f350000,0x3f350000bf35bf80,0x3ec4bf35bf6d0000,0xbf6dbf353ec43f80,0x3f6d3f35bec4bf80,0x3ec4bf35bf6d0000
.quad 0xbf8000003f80,0xbf8000003f800000,0x3f800000bf800000,0xbf8000003f80,0xbec4bf353f6d0000,0xbf6d3f353ec4bf80,0x3f6dbf35bec43f80,0xbec4bf353f6d0000,0xbf3500003f35bf80,0xbf353f80bf350000,0x3f35bf803f350000,0xbf3500003f35bf80,0xbf6d3f35bec40000,0xbec43f35bf6d3f80,0x3ec4bf353f6dbf80,0xbf6d3f35bec40000
.quad 0x3f803f803f803f80,0,0x3f553f6d3f7b3f80,0x3f0e3ec43e480000,0x3ec43f353f6d3f80,0x3f6d3f353ec40000,0xbe483ec43f553f80,0x3f7b3f6d3f0e0000,0xbf3500003f353f80,0x3f353f803f350000,0xbf7bbec43f0e3f80,0x3e483f6d3f550000,0xbf6dbf353ec43f80,0xbec43f353f6d0000,0xbf0ebf6d3e483f80,0xbf553ec43f7b0000
.quad 0xbf8000003f80,0xbf8000003f800000,0x3f0ebf6dbe483f80,0xbf55bec43f7b0000,0x3f6dbf35bec43f80,0xbec4bf353f6d0000,0x3f7bbec4bf0e3f80,0x3e48bf6d3f550000,0x3f350000bf353f80,0x3f35bf803f350000,0x3e483ec4bf553f80,0x3f7bbf6d3f0e0000,0xbec43f35bf6d3f80,0x3f6dbf353ec40000,0xbf553f6dbf7b3f80,0x3f0ebec43e480000
.quad 0x3f803f803f803f80,0,0x3e483ec43f0e3f35,0x3f7b3f6d3f553f35,0xbf6dbf35bec40000,0x3ec43f353f6d3f80,0xbf0ebf6dbf7bbf35,0xbf55bec43e483f35,0x3f350000bf35bf80,0xbf35bf80bf350000,0x3f553f6d3e48bf35,0x3f0ebec4bf7bbf35,0xbec43f353f6d0000,0x3f6d3f35bec4bf80,0xbf7bbec43f553f35,0xbe483f6d3f0ebf35
.quad 0xbf8000003f80,0xbf8000003f800000,0x3f7bbec4bf553f35,0xbe48bf6d3f0e3f35,0x3ec43f35bf6d0000,0x3f6dbf35bec43f80,0xbf553f6dbe48bf35,0x3f0e3ec4bf7b3f35,0xbf3500003f35bf80,0xbf353f80bf350000,0x3f0ebf6d3f7bbf35,0xbf553ec43e48bf35,0x3f6dbf353ec40000,0x3ec4bf353f6dbf80,0xbe483ec4bf0e3f35,0x3f7bbf6d3f55bf35
.quad 0x3f803f803f803f80,0,0xbf0ebec4be480000,0x3f553f6d3f7b3f80,0xbec4bf35bf6dbf80,0xbf6dbf35bec40000,0x3f7b3f6d3f0e0000,0x3e48bec4bf55bf80,0xbf3500003f353f80,0x3f353f803f350000,0xbe48bf6dbf550000,0xbf7bbec43f0e3f80,0x3f6d3f35bec4bf80,0x3ec4bf35bf6d0000,0xbf553ec43f7b0000,0x3f0e3f6dbe48bf80
.quad 0xbf8000003f80,0xbf8000003f800000,0x3f553ec4bf7b0000,0x3f0ebf6dbe483f80,0xbf6d3f353ec4bf80,0x3ec43f35bf6d0000,0x3e48bf6d3f550000,0xbf7b3ec43f0ebf80,0x3f350000bf353f80,0x3f35bf803f350000,0xbf7b3f6dbf0e0000,0x3e483ec4bf553f80,0x3ec4bf353f6dbf80,0xbf6d3f35bec40000,0x3f0ebec43e480000,0x3f55bf6d3f7bbf80
.quad 0x3f803f803f803f80,0,0xbf7bbf6dbf55bf35,0x3e483ec43f0e3f35,0x3f6d3f353ec40000,0xbec4bf35bf6dbf80,0xbf55bec43e483f35,0x3f0e3f6d3f7b3f35,0x3f350000bf35bf80,0xbf35bf80bf350000,0xbf0e3ec43f7b3f35,0x3f553f6d3e48bf35,0x3ec4bf35bf6d0000,0xbf6dbf353ec43f80,0xbe483f6d3f0ebf35,0x3f7b3ec4bf55bf35
.quad 0xbf8000003f80,0xbf8000003f800000,0x3e483f6dbf0ebf35,0x3f7bbec4bf553f35,0xbec4bf353f6d0000,0xbf6d3f353ec4bf80,0x3f0e3ec4bf7b3f35,0x3f55bf6d3e483f35,0xbf3500003f35bf80,0xbf353f80bf350000,0x3f55bec4be483f35,0x3f0ebf6d3f7bbf35,0xbf6d3f35bec40000,0xbec43f35bf6d3f80,0x3f7bbf6d3f55bf35,0x3e48bec43f0ebf35
.quad 0x3f803f803f803f80,0x8000800080008000,0x3f553f6d3f7b3f80,0xbf0ebec4be488000,0x3ec43f353f6d3f80,0xbf6dbf35bec48000,0xbe483ec43f553f80,0xbf7bbf6dbf0e8000,0xbf3500003f353f80,0xbf35bf80bf358000,0xbf7bbec43f0e3f80,0xbe48bf6dbf558000,0xbf6dbf353ec43f80,0x3ec4bf35bf6d8000,0xbf0ebf6d3e483f80,0x3f55bec4bf7b8000
.quad 0xbf8000003f80,0x3f808000bf808000,0x3f0ebf6dbe483f80,0x3f553ec4bf7b8000,0x3f6dbf35bec43f80,0x3ec43f35bf6d8000,0x3f7bbec4bf0e3f80,0xbe483f6dbf558000,0x3f350000bf353f80,0xbf353f80bf358000,0x3e483ec4bf553f80,0xbf7b3f6dbf0e8000,0xbec43f35bf6d3f80,0xbf6d3f35bec48000,0xbf553f6dbf7b3f80,0xbf0e3ec4be488000
.quad 0x3f803f803f803f80,0x8000800080008000,0x3e483ec43f0e3f35,0xbf7bbf6dbf55bf35,0xbf6dbf35bec40000,0xbec4bf35bf6dbf80,0xbf0ebf6dbf7bbf35,0x3f553ec4be48bf35,0x3f350000bf35bf80,0x3f353f803f358000,0x3f553f6d3e48bf35,0xbf0e3ec43f7b3f35,0xbec43f353f6d0000,0xbf6dbf353ec43f80,0xbf7bbec43f553f35,0x3e48bf6dbf0e3f35
.quad 0xbf8000003f80,0x3f808000bf808000,0x3f7bbec4bf553f35,0x3e483f6dbf0ebf35,0x3ec43f35bf6d0000,0xbf6d3f353ec4bf80,0xbf553f6dbe48bf35,0xbf0ebec43f7bbf35,0xbf3500003f35bf80,0x3f35bf803f358000,0x3f0ebf6d3f7bbf35,0x3f55bec4be483f35,0x3f6dbf353ec40000,0xbec43f35bf6d3f80,0xbe483ec4bf0e3f35,0xbf7b3f6dbf553f35
.quad 0x3f803f803f803f80,0x8000800080008000,0xbf0ebec4be480000,0xbf55bf6dbf7bbf80,0xbec4bf35bf6dbf80,0x3f6d3f353ec48000,0x3f7b3f6d3f0e0000,0xbe483ec43f553f80,0xbf3500003f353f80,0xbf35bf80bf358000,0xbe48bf6dbf550000,0x3f7b3ec4bf0ebf80,0x3f6d3f35bec4bf80,0xbec43f353f6d8000,0xbf553ec43f7b0000,0xbf0ebf6d3e483f80
.quad 0xbf8000003f80,0x3f808000bf808000,0x3f553ec4bf7b0000,0xbf0e3f6d3e48bf80,0xbf6d3f353ec4bf80,0xbec4bf353f6d8000,0x3e48bf6d3f550000,0x3f7bbec4bf0e3f80,0x3f350000bf353f80,0xbf353f80bf358000,0xbf7b3f6dbf0e0000,0xbe48bec43f55bf80,0x3ec4bf353f6dbf80,0x3f6dbf353ec48000,0x3f0ebec43e480000,0xbf553f6dbf7b3f80
.quad 0x3f803f803f803f80,0x8000800080008000,0xbf7bbf6dbf55bf35,0xbe48bec4bf0ebf35,0x3f6d3f353ec40000,0x3ec43f353f6d3f80,0xbf55bec43e483f35,0xbf0ebf6dbf7bbf35,0x3f350000bf35bf80,0x3f353f803f358000,0xbf0e3ec43f7b3f35,0xbf55bf6dbe483f35,0x3ec4bf35bf6d0000,0x3f6d3f35bec4bf80,0xbe483f6d3f0ebf35,0xbf7bbec43f553f35
.quad 0xbf8000003f80,0x3f808000bf808000,0x3e483f6dbf0ebf35,0xbf7b3ec43f55bf35,0xbec4bf353f6d0000,0x3f6dbf35bec43f80,0x3f0e3ec4bf7b3f35,0xbf553f6dbe48bf35,0xbf3500003f35bf80,0x3f35bf803f358000,0x3f55bec4be483f35,0xbf0e3f6dbf7b3f35,0xbf6d3f35bec40000,0x3ec4bf353f6dbf80,0x3f7bbf6d3f55bf35,0xbe483ec4bf0e3f35
.quad 0x3f803f803f803f80,0x3f803f803f803f80,0x3f553f6d3f7b3f80,0xbf55bf6dbf7bbf80,0x3ec43f353f6d3f80,0x3ec43f353f6d3f80,0xbe483ec43f553f80,0x3e48bec4bf55bf80,0xbf3500003f353f80,0xbf3500003f353f80,0xbf7bbec43f0e3f80,0x3f7b3ec4bf0ebf80,0xbf6dbf353ec43f80,0xbf6dbf353ec43f80,0xbf0ebf6d3e483f80,0x3f0e3f6dbe48bf80
.quad 0xbf8000003f80,0xbf8000003f80,0x3f0ebf6dbe483f80,0xbf0e3f6d3e48bf80,0x3f6dbf35bec43f80,0x3f6dbf35bec43f80,0x3f7bbec4bf0e3f80,0xbf7b3ec43f0ebf80,0x3f350000bf353f80,0x3f350000bf353f80,0x3e483ec4bf553f80,0xbe48bec43f55bf80,0xbec43f35bf6d3f80,0xbec43f35bf6d3f80,0xbf553f6dbf7b3f80,0x3f55bf6d3f7bbf80
.quad 0x3f803f803f803f80,0x3f803f803f803f80,0x3e483ec43f0e3f35,0xbe48bec4bf0ebf35,0xbf6dbf35bec40000,0xbf6dbf35bec40000,0xbf0ebf6dbf7bbf35,0x3f0e3f6d3f7b3f35,0x3f350000bf35bf80,0x3f350000bf35bf80,0x3f553f6d3e48bf35,0xbf55bf6dbe483f35,0xbec43f353f6d0000,0xbec43f353f6d0000,0xbf7bbec43f553f35,0x3f7b3ec4bf55bf35
.quad 0xbf8000003f80,0xbf8000003f80,0x3f7bbec4bf553f35,0xbf7b3ec43f55bf35,0x3ec43f35bf6d0000,0x3ec43f35bf6d0000,0xbf553f6dbe48bf35,0x3f55bf6d3e483f35,0xbf3500003f35bf80,0xbf3500003f35bf80,0x3f0ebf6d3f7bbf35,0xbf0e3f6dbf7b3f35,0x3f6dbf353ec40000,0x3f6dbf353ec40000,0xbe483ec4bf0e3f35,0x3e48bec43f0ebf35
.quad 0x3f803f803f803f80,0x3f803f803f803f80,0xbf0ebec4be480000,0x3f0e3ec43e480000,0xbec4bf35bf6dbf80,0xbec4bf35bf6dbf80,0x3f7b3f6d3f0e0000,0xbf7bbf6dbf0e0000,0xbf3500003f353f80,0xbf3500003f353f80,0xbe48bf6dbf550000,0x3e483f6d3f550000,0x3f6d3f35bec4bf80,0x3f6d3f35bec4bf80,0xbf553ec43f7b0000,0x3f55bec4bf7b0000
.quad 0xbf8000003f80,0xbf8000003f80,0x3f553ec4bf7b0000,0xbf55bec43f7b0000,0xbf6d3f353ec4bf80,0xbf6d3f353ec4bf80,0x3e48bf6d3f550000,0xbe483f6dbf550000,0x3f350000bf353f80,0x3f350000bf353f80,0xbf7b3f6dbf0e0000,0x3f7bbf6d3f0e0000,0x3ec4bf353f6dbf80,0x3ec4bf353f6dbf80,0x3f0ebec43e480000,0xbf0e3ec4be480000
.quad 0x3f803f803f803f80,0x3f803f803f803f80,0xbf7bbf6dbf55bf35,0x3f7b3f6d3f553f35,0x3f6d3f353ec40000,0x3f6d3f353ec40000,0xbf55bec43e483f35,0x3f553ec4be48bf35,0x3f350000bf35bf80,0x3f350000bf35bf80,0xbf0e3ec43f7b3f35,0x3f0ebec4bf7bbf35,0x3ec4bf35bf6d0000,0x3ec4bf35bf6d0000,0xbe483f6d3f0ebf35,0x3e48bf6dbf0e3f35
.quad 0xbf8000003f80,0xbf8000003f80,0x3e483f6dbf0ebf35,0xbe48bf6d3f0e3f35,0xbec4bf353f6d0000,0xbec4bf353f6d0000,0x3f0e3ec4bf7b3f35,0xbf0ebec43f7bbf35,0xbf3500003f35bf80,0xbf3500003f35bf80,0x3f55bec4be483f35,0xbf553ec43e48bf35,0xbf6d3f35bec40000,0xbf6d3f35bec40000,0x3f7bbf6d3f55bf35,0xbf7b3f6dbf553f35
.quad 0,0x3f803f803f803f80,0xbf0ebec4be480000,0xbf55bf6dbf7bbf80,0x3f6d3f353ec40000,0x3ec43f353f6d3f80,0xbf7bbf6dbf0e0000,0x3e48bec4bf55bf80,0x3f353f803f350000,0xbf3500003f353f80,0xbe48bf6dbf550000,0x3f7b3ec4bf0ebf80,0xbec43f353f6d0000,0xbf6dbf353ec43f80,0x3f55bec4bf7b0000,0x3f0e3f6dbe48bf80
.quad 0xbf8000003f800000,0xbf8000003f80,0x3f553ec4bf7b0000,0xbf0e3f6d3e48bf80,0xbec4bf353f6d0000,0x3f6dbf35bec43f80,0xbe483f6dbf550000,0xbf7b3ec43f0ebf80,0x3f35bf803f350000,0x3f350000bf353f80,0xbf7b3f6dbf0e0000,0xbe48bec43f55bf80,0x3f6dbf353ec40000,0xbec43f35bf6d3f80,0xbf0e3ec4be480000,0x3f55bf6d3f7bbf80
.quad 0,0x3f803f803f803f80,0xbf7bbf6dbf55bf35,0xbe48bec4bf0ebf35,0x3ec43f353f6d3f80,0xbf6dbf35bec40000,0x3f553ec4be48bf35,0x3f0e3f6d3f7b3f35,0xbf35bf80bf350000,0x3f350000bf35bf80,0xbf0e3ec43f7b3f35,0xbf55bf6dbe483f35,0x3f6d3f35bec4bf80,0xbec43f353f6d0000,0x3e48bf6dbf0e3f35,0x3f7b3ec4bf55bf35
.quad 0xbf8000003f800000,0xbf8000003f80,0x3e483f6dbf0ebf35,0xbf7b3ec43f55bf35,0x3f6dbf35bec43f80,0x3ec43f35bf6d0000,0xbf0ebec43f7bbf35,0x3f55bf6d3e483f35,0xbf353f80bf350000,0xbf3500003f35bf80,0x3f55bec4be483f35,0xbf0e3f6dbf7b3f35,0x3ec4bf353f6dbf80,0x3f6dbf353ec40000,0xbf7b3f6dbf553f35,0x3e48bec43f0ebf35
.quad 0,0x3f803f803f803f80,0xbf55bf6dbf7bbf80,0x3f0e3ec43e480000,0xbf6dbf35bec40000,0xbec4bf35bf6dbf80,0xbe483ec43f553f80,0xbf7bbf6dbf0e0000,0x3f353f803f350000,0xbf3500003f353f80,0x3f7b3ec4bf0ebf80,0x3e483f6d3f550000,0x3ec4bf35bf6d0000,0x3f6d3f35bec4bf80,0xbf0ebf6d3e483f80,0x3f55bec4bf7b0000
.quad 0xbf8000003f800000,0xbf8000003f80,0xbf0e3f6d3e48bf80,0xbf55bec43f7b0000,0x3ec43f35bf6d0000,0xbf6d3f353ec4bf80,0x3f7bbec4bf0e3f80,0xbe483f6dbf550000,0x3f35bf803f350000,0x3f350000bf353f80,0xbe48bec43f55bf80,0x3f7bbf6d3f0e0000,0xbf6d3f35bec40000,0x3ec4bf353f6dbf80,0xbf553f6dbf7b3f80,0xbf0e3ec4be480000
.quad 0,0x3f803f803f803f80,0xbe48bec4bf0ebf35,0x3f7b3f6d3f553f35,0xbec4bf35bf6dbf80,0x3f6d3f353ec40000,0xbf0ebf6dbf7bbf35,0x3f553ec4be48bf35,0xbf35bf80bf350000,0x3f350000bf35bf80,0xbf55bf6dbe483f35,0x3f0ebec4bf7bbf35,0xbf6dbf353ec43f80,0x3ec4bf35bf6d0000,0xbf7bbec43f553f35,0x3e48bf6dbf0e3f35
.quad 0xbf8000003f800000,0xbf8000003f80,0xbf7b3ec43f55bf35,0xbe48bf6d3f0e3f35,0xbf6d3f353ec4bf80,0xbec4bf353f6d0000,0xbf553f6dbe48bf35,0xbf0ebec43f7bbf35,0xbf353f80bf350000,0xbf3500003f35bf80,0xbf0e3f6dbf7b3f35,0xbf553ec43e48bf35,0xbec43f35bf6d3f80,0xbf6d3f35bec40000,0xbe483ec4bf0e3f35,0xbf7b3f6dbf553f35
.quad 0x8000800080008000,0x3f803f803f803f80,0x3f0e3ec43e488000,0xbf55bf6dbf7bbf80,0xbf6dbf35bec48000,0x3ec43f353f6d3f80,0x3f7b3f6d3f0e8000,0x3e48bec4bf55bf80,0xbf35bf80bf358000,0xbf3500003f353f80,0x3e483f6d3f558000,0x3f7b3ec4bf0ebf80,0x3ec4bf35bf6d8000,0xbf6dbf353ec43f80,0xbf553ec43f7b8000,0x3f0e3f6dbe48bf80
.quad 0x3f808000bf808000,0xbf8000003f80,0xbf55bec43f7b8000,0xbf0e3f6d3e48bf80,0x3ec43f35bf6d8000,0x3f6dbf35bec43f80,0x3e48bf6d3f558000,0xbf7b3ec43f0ebf80,0xbf353f80bf358000,0x3f350000bf353f80,0x3f7bbf6d3f0e8000,0xbe48bec43f55bf80,0xbf6d3f35bec48000,0xbec43f35bf6d3f80,0x3f0ebec43e488000,0x3f55bf6d3f7bbf80
.quad 0x8000800080008000,0x3f803f803f803f80,0x3f7b3f6d3f553f35,0xbe48bec4bf0ebf35,0xbec4bf35bf6dbf80,0xbf6dbf35bec40000,0xbf55bec43e483f35,0x3f0e3f6d3f7b3f35,0x3f353f803f358000,0x3f350000bf35bf80,0x3f0ebec4bf7bbf35,0xbf55bf6dbe483f35,0xbf6dbf353ec43f80,0xbec43f353f6d0000,0xbe483f6d3f0ebf35,0x3f7b3ec4bf55bf35
.quad 0x3f808000bf808000,0xbf8000003f80,0xbe48bf6d3f0e3f35,0xbf7b3ec43f55bf35,0xbf6d3f353ec4bf80,0x3ec43f35bf6d0000,0x3f0e3ec4bf7b3f35,0x3f55bf6d3e483f35,0x3f35bf803f358000,0xbf3500003f35bf80,0xbf553ec43e48bf35,0xbf0e3f6dbf7b3f35,0xbec43f35bf6d3f80,0x3f6dbf353ec40000,0x3f7bbf6d3f55bf35,0x3e48bec43f0ebf35
.quad 0x8000800080008000,0x3f803f803f803f80,0x3f553f6d3f7b3f80,0x3f0e3ec43e480000,0x3f6d3f353ec48000,0xbec4bf35bf6dbf80,0x3e48bec4bf55bf80,0xbf7bbf6dbf0e0000,0xbf35bf80bf358000,0xbf3500003f353f80,0xbf7bbec43f0e3f80,0x3e483f6d3f550000,0xbec43f353f6d8000,0x3f6d3f35bec4bf80,0x3f0e3f6dbe48bf80,0x3f55bec4bf7b0000
.quad 0x3f808000bf808000,0xbf8000003f80,0x3f0ebf6dbe483f80,0xbf55bec43f7b0000,0xbec4bf353f6d8000,0xbf6d3f353ec4bf80,0xbf7b3ec43f0ebf80,0xbe483f6dbf550000,0xbf353f80bf358000,0x3f350000bf353f80,0x3e483ec4bf553f80,0x3f7bbf6d3f0e0000,0x3f6dbf353ec48000,0x3ec4bf353f6dbf80,0x3f55bf6d3f7bbf80,0xbf0e3ec4be480000
.quad 0x8000800080008000,0x3f803f803f803f80,0x3e483ec43f0e3f35,0x3f7b3f6d3f553f35,0x3ec43f353f6d3f80,0x3f6d3f353ec40000,0x3f0e3f6d3f7b3f35,0x3f553ec4be48bf35,0x3f353f803f358000,0x3f350000bf35bf80,0x3f553f6d3e48bf35,0x3f0ebec4bf7bbf35,0x3f6d3f35bec4bf80,0x3ec4bf35bf6d0000,0x3f7b3ec4bf55bf35,0x3e48bf6dbf0e3f35
.quad 0x3f808000bf808000,0xbf8000003f80,0x3f7bbec4bf553f35,0xbe48bf6d3f0e3f35,0x3f6dbf35bec43f80,0xbec4bf353f6d0000,0x3f55bf6d3e483f35,0xbf0ebec43f7bbf35,0x3f35bf803f358000,0xbf3500003f35bf80,0x3f0ebf6d3f7bbf35,0xbf553ec43e48bf35,0x3ec4bf353f6dbf80,0xbf6d3f35bec40000,0x3e48bec43f0ebf35,0xbf7b3f6dbf553f35
.quad 0xbf803f80bf803f80,0,0xbf553f6dbf7b3f80,0xbf0e3ec4be480000,0xbec43f35bf6d3f80,0xbf6d3f35bec40000,0x3e483ec4bf553f80,0xbf7b3f6dbf0e0000,0x3f350000bf353f80,0xbf353f80bf350000,0x3f7bbec4bf0e3f80,0xbe483f6dbf550000,0x3f6dbf35bec43f80,0x3ec43f35bf6d0000,0x3f0ebf6dbe483f80,0x3f553ec4bf7b0000
.quad 0xbf8000003f80,0x3f800000bf800000,0xbf0ebf6d3e483f80,0x3f55bec4bf7b0000,0xbf6dbf353ec43f80,0x3ec4bf35bf6d0000,0xbf7bbec43f0e3f80,0xbe48bf6dbf550000,0xbf3500003f353f80,0xbf35bf80bf350000,0xbe483ec43f553f80,0xbf7bbf6dbf0e0000,0x3ec43f353f6d3f80,0xbf6dbf35bec40000,0x3f553f6d3f7b3f80,0xbf0ebec4be480000
.quad 0xbf803f80bf803f80,0,0xbe483ec4bf0e3f35,0xbf7b3f6dbf553f35,0x3f6dbf353ec40000,0xbec43f35bf6d3f80,0x3f0ebf6d3f7bbf35,0x3f55bec4be483f35,0xbf3500003f35bf80,0x3f35bf803f350000,0xbf553f6dbe48bf35,0xbf0ebec43f7bbf35,0x3ec43f35bf6d0000,0xbf6d3f353ec4bf80,0x3f7bbec4bf553f35,0x3e483f6dbf0ebf35
.quad 0xbf8000003f80,0x3f800000bf800000,0xbf7bbec43f553f35,0x3e48bf6dbf0e3f35,0xbec43f353f6d0000,0xbf6dbf353ec43f80,0x3f553f6d3e48bf35,0xbf0e3ec43f7b3f35,0x3f350000bf35bf80,0x3f353f803f350000,0xbf0ebf6dbf7bbf35,0x3f553ec4be48bf35,0xbf6dbf35bec40000,0xbec4bf35bf6dbf80,0x3e483ec43f0e3f35,0xbf7bbf6dbf55bf35
.quad 0xbf803f80bf803f80,0,0x3f0ebec43e480000,0xbf553f6dbf7b3f80,0x3ec4bf353f6dbf80,0x3f6dbf353ec40000,0xbf7b3f6dbf0e0000,0xbe48bec43f55bf80,0x3f350000bf353f80,0xbf353f80bf350000,0x3e48bf6d3f550000,0x3f7bbec4bf0e3f80,0xbf6d3f353ec4bf80,0xbec4bf353f6d0000,0x3f553ec4bf7b0000,0xbf0e3f6d3e48bf80
.quad 0xbf8000003f80,0x3f800000bf800000,0xbf553ec43f7b0000,0xbf0ebf6d3e483f80,0x3f6d3f35bec4bf80,0xbec43f353f6d0000,0xbe48bf6dbf550000,0x3f7b3ec4bf0ebf80,0xbf3500003f353f80,0xbf35bf80bf350000,0x3f7b3f6d3f0e0000,0xbe483ec43f553f80,0xbec4bf35bf6dbf80,0x3f6d3f353ec40000,0xbf0ebec4be480000,0xbf55bf6dbf7bbf80
.quad 0xbf803f80bf803f80,0,0x3f7bbf6d3f55bf35,0xbe483ec4bf0e3f35,0xbf6d3f35bec40000,0x3ec4bf353f6dbf80,0x3f55bec4be483f35,0xbf0e3f6dbf7b3f35,0xbf3500003f35bf80,0x3f35bf803f350000,0x3f0e3ec4bf7b3f35,0xbf553f6dbe48bf35,0xbec4bf353f6d0000,0x3f6dbf35bec43f80,0x3e483f6dbf0ebf35,0xbf7b3ec43f55bf35
.quad 0xbf8000003f80,0x3f800000bf800000,0xbe483f6d3f0ebf35,0xbf7bbec43f553f35,0x3ec4bf35bf6d0000,0x3f6d3f35bec4bf80,0xbf0e3ec43f7b3f35,0xbf55bf6dbe483f35,0x3f350000bf35bf80,0x3f353f803f350000,0xbf55bec43e483f35,0xbf0ebf6dbf7bbf35,0x3f6d3f353ec40000,0x3ec43f353f6d3f80,0xbf7bbf6dbf55bf35,0xbe48bec4bf0ebf35
.quad 0xbf803f80bf803f80,0x8000800080008000,0xbf553f6dbf7b3f80,0x3f0ebec43e488000,0xbec43f35bf6d3f80,0x3f6dbf353ec48000,0x3e483ec4bf553f80,0x3f7bbf6d3f0e8000,0x3f350000bf353f80,0x3f35bf803f358000,0x3f7bbec4bf0e3f80,0x3e48bf6d3f558000,0x3f6dbf35bec43f80,0xbec4bf353f6d8000,0x3f0ebf6dbe483f80,0xbf55bec43f7b8000
.quad 0xbf8000003f80,0xbf8080003f808000,0xbf0ebf6d3e483f80,0xbf553ec43f7b8000,0xbf6dbf353ec43f80,0xbec43f353f6d8000,0xbf7bbec43f0e3f80,0x3e483f6d3f558000,0xbf3500003f353f80,0x3f353f803f358000,0xbe483ec43f553f80,0x3f7b3f6d3f0e8000,0x3ec43f353f6d3f80,0x3f6d3f353ec48000,0x3f553f6d3f7b3f80,0x3f0e3ec43e488000
.quad 0xbf803f80bf803f80,0x8000800080008000,0xbe483ec4bf0e3f35,0x3f7bbf6d3f55bf35,0x3f6dbf353ec40000,0x3ec4bf353f6dbf80,0x3f0ebf6d3f7bbf35,0xbf553ec43e48bf35,0xbf3500003f35bf80,0xbf353f80bf358000,0xbf553f6dbe48bf35,0x3f0e3ec4bf7b3f35,0x3ec43f35bf6d0000,0x3f6dbf35bec43f80,0x3f7bbec4bf553f35,0xbe48bf6d3f0e3f35
.quad 0xbf8000003f80,0xbf8080003f808000,0xbf7bbec43f553f35,0xbe483f6d3f0ebf35,0xbec43f353f6d0000,0x3f6d3f35bec4bf80,0x3f553f6d3e48bf35,0x3f0ebec4bf7bbf35,0x3f350000bf35bf80,0xbf35bf80bf358000,0xbf0ebf6dbf7bbf35,0xbf55bec43e483f35,0xbf6dbf35bec40000,0x3ec43f353f6d3f80,0x3e483ec43f0e3f35,0x3f7b3f6d3f553f35
.quad 0xbf803f80bf803f80,0x8000800080008000,0x3f0ebec43e480000,0x3f55bf6d3f7bbf80,0x3ec4bf353f6dbf80,0xbf6d3f35bec48000,0xbf7b3f6dbf0e0000,0x3e483ec4bf553f80,0x3f350000bf353f80,0x3f35bf803f358000,0x3e48bf6d3f550000,0xbf7b3ec43f0ebf80,0xbf6d3f353ec4bf80,0x3ec43f35bf6d8000,0x3f553ec4bf7b0000,0x3f0ebf6dbe483f80
.quad 0xbf8000003f80,0xbf8080003f808000,0xbf553ec43f7b0000,0x3f0e3f6dbe48bf80,0x3f6d3f35bec4bf80,0x3ec4bf35bf6d8000,0xbe48bf6dbf550000,0xbf7bbec43f0e3f80,0xbf3500003f353f80,0x3f353f803f358000,0x3f7b3f6d3f0e0000,0x3e48bec4bf55bf80,0xbec4bf35bf6dbf80,0xbf6dbf35bec48000,0xbf0ebec4be480000,0x3f553f6d3f7b3f80
.quad 0xbf803f80bf803f80,0x8000800080008000,0x3f7bbf6d3f55bf35,0x3e48bec43f0ebf35,0xbf6d3f35bec40000,0xbec43f35bf6d3f80,0x3f55bec4be483f35,0x3f0ebf6d3f7bbf35,0xbf3500003f35bf80,0xbf353f80bf358000,0x3f0e3ec4bf7b3f35,0x3f55bf6d3e483f35,0xbec4bf353f6d0000,0xbf6d3f353ec4bf80,0x3e483f6dbf0ebf35,0x3f7bbec4bf553f35
.quad 0xbf8000003f80,0xbf8080003f808000,0xbe483f6d3f0ebf35,0x3f7b3ec4bf55bf35,0x3ec4bf35bf6d0000,0xbf6dbf353ec43f80,0xbf0e3ec43f7b3f35,0x3f553f6d3e48bf35,0x3f350000bf35bf80,0xbf35bf80bf358000,0xbf55bec43e483f35,0x3f0e3f6d3f7b3f35,0x3f6d3f353ec40000,0xbec4bf35bf6dbf80,0xbf7bbf6dbf55bf35,0x3e483ec43f0e3f35
.quad 0xbf803f80bf803f80,0xbf803f80bf803f80,0xbf553f6dbf7b3f80,0x3f55bf6d3f7bbf80,0xbec43f35bf6d3f80,0xbec43f35bf6d3f80,0x3e483ec4bf553f80,0xbe48bec43f55bf80,0x3f350000bf353f80,0x3f350000bf353f80,0x3f7bbec4bf0e3f80,0xbf7b3ec43f0ebf80,0x3f6dbf35bec43f80,0x3f6dbf35bec43f80,0x3f0ebf6dbe483f80,0xbf0e3f6d3e48bf80
.quad 0xbf8000003f80,0xbf8000003f80,0xbf0ebf6d3e483f80,0x3f0e3f6dbe48bf80,0xbf6dbf353ec43f80,0xbf6dbf353ec43f80,0xbf7bbec43f0e3f80,0x3f7b3ec4bf0ebf80,0xbf3500003f353f80,0xbf3500003f353f80,0xbe483ec43f553f80,0x3e48bec4bf55bf80,0x3ec43f353f6d3f80,0x3ec43f353f6d3f80,0x3f553f6d3f7b3f80,0xbf55bf6dbf7bbf80
.quad 0xbf803f80bf803f80,0xbf803f80bf803f80,0xbe483ec4bf0e3f35,0x3e48bec43f0ebf35,0x3f6dbf353ec40000,0x3f6dbf353ec40000,0x3f0ebf6d3f7bbf35,0xbf0e3f6dbf7b3f35,0xbf3500003f35bf80,0xbf3500003f35bf80,0xbf553f6dbe48bf35,0x3f55bf6d3e483f35,0x3ec43f35bf6d0000,0x3ec43f35bf6d0000,0x3f7bbec4bf553f35,0xbf7b3ec43f55bf35
.quad 0xbf8000003f80,0xbf8000003f80,0xbf7bbec43f553f35,0x3f7b3ec4bf55bf35,0xbec43f353f6d0000,0xbec43f353f6d0000,0x3f553f6d3e48bf35,0xbf55bf6dbe483f35,0x3f350000bf35bf80,0x3f350000bf35bf80,0xbf0ebf6dbf7bbf35,0x3f0e3f6d3f7b3f35,0xbf6dbf35bec40000,0xbf6dbf35bec40000,0x3e483ec43f0e3f35,0xbe48bec4bf0ebf35
.quad 0xbf803f80bf803f80,0xbf803f80bf803f80,0x3f0ebec43e480000,0xbf0e3ec4be480000,0x3ec4bf353f6dbf80,0x3ec4bf353f6dbf80,0xbf7b3f6dbf0e0000,0x3f7bbf6d3f0e0000,0x3f350000bf353f80,0x3f350000bf353f80,0x3e48bf6d3f550000,0xbe483f6dbf550000,0xbf6d3f353ec4bf80,0xbf6d3f353ec4bf80,0x3f553ec4bf7b0000,0xbf55bec43f7b0000
.quad 0xbf8000003f80,0xbf8000003f80,0xbf553ec43f7b0000,0x3f55bec4bf7b0000,0x3f6d3f35bec4bf80,0x3f6d3f35bec4bf80,0xbe48bf6dbf550000,0x3e483f6d3f550000,0xbf3500003f353f80,0xbf3500003f353f80,0x3f7b3f6d3f0e0000,0xbf7bbf6dbf0e0000,0xbec4bf35bf6dbf80,0xbec4bf35bf6dbf80,0xbf0ebec4be480000,0x3f0e3ec43e480000
.quad 0xbf803f80bf803f80,0xbf803f80bf803f80,0x3f7bbf6d3f55bf35,0xbf7b3f6dbf553f35,0xbf6d3f35bec40000,0xbf6d3f35bec40000,0x3f55bec4be483f35,0xbf553ec43e48bf35,0xbf3500003f35bf80,0xbf3500003f35bf80,0x3f0e3ec4bf7b3f35,0xbf0ebec43f7bbf35,0xbec4bf353f6d0000,0xbec4bf353f6d0000,0x3e483f6dbf0ebf35,0xbe48bf6d3f0e3f35
.quad 0xbf8000003f80,0xbf8000003f80,0xbe483f6d3f0ebf35,0x3e48bf6dbf0e3f35,0x3ec4bf35bf6d0000,0x3ec4bf35bf6d0000,0xbf0e3ec43f7b3f35,0x3f0ebec4bf7bbf35,0x3f350000bf35bf80,0x3f350000bf35bf80,0xbf55bec43e483f35,0x3f553ec4be48bf35,0x3f6d3f353ec40000,0x3f6d3f353ec40000,0xbf7bbf6dbf55bf35,0x3f7b3f6d3f553f35
.quad 0,0xbf803f80bf803f80,0x3f0ebec43e480000,0x3f55bf6d3f7bbf80,0xbf6d3f35bec40000,0xbec43f35bf6d3f80,0x3f7bbf6d3f0e0000,0xbe48bec43f55bf80,0xbf353f80bf350000,0x3f350000bf353f80,0x3e48bf6d3f550000,0xbf7b3ec43f0ebf80,0x3ec43f35bf6d0000,0x3f6dbf35bec43f80,0xbf55bec43f7b0000,0xbf0e3f6d3e48bf80
.quad 0x3f800000bf800000,0xbf8000003f80,0xbf553ec43f7b0000,0x3f0e3f6dbe48bf80,0x3ec4bf35bf6d0000,0xbf6dbf353ec43f80,0x3e483f6d3f550000,0x3f7b3ec4bf0ebf80,0xbf35bf80bf350000,0xbf3500003f353f80,0x3f7b3f6d3f0e0000,0x3e48bec4bf55bf80,0xbf6dbf35bec40000,0x3ec43f353f6d3f80,0x3f0e3ec43e480000,0xbf55bf6dbf7bbf80
.quad 0,0xbf803f80bf803f80,0x3f7bbf6d3f55bf35,0x3e48bec43f0ebf35,0xbec43f35bf6d3f80,0x3f6dbf353ec40000,0xbf553ec43e48bf35,0xbf0e3f6dbf7b3f35,0x3f35bf803f350000,0xbf3500003f35bf80,0x3f0e3ec4bf7b3f35,0x3f55bf6d3e483f35,0xbf6d3f353ec4bf80,0x3ec43f35bf6d0000,0xbe48bf6d3f0e3f35,0xbf7b3ec43f55bf35
.quad 0x3f800000bf800000,0xbf8000003f80,0xbe483f6d3f0ebf35,0x3f7b3ec4bf55bf35,0xbf6dbf353ec43f80,0xbec43f353f6d0000,0x3f0ebec4bf7bbf35,0xbf55bf6dbe483f35,0x3f353f803f350000,0x3f350000bf35bf80,0xbf55bec43e483f35,0x3f0e3f6d3f7b3f35,0xbec4bf35bf6dbf80,0xbf6dbf35bec40000,0x3f7b3f6d3f553f35,0xbe48bec4bf0ebf35
.quad 0,0xbf803f80bf803f80,0x3f55bf6d3f7bbf80,0xbf0e3ec4be480000,0x3f6dbf353ec40000,0x3ec4bf353f6dbf80,0x3e483ec4bf553f80,0x3f7bbf6d3f0e0000,0xbf353f80bf350000,0x3f350000bf353f80,0xbf7b3ec43f0ebf80,0xbe483f6dbf550000,0xbec4bf353f6d0000,0xbf6d3f353ec4bf80,0x3f0ebf6dbe483f80,0xbf55bec43f7b0000
.quad 0x3f800000bf800000,0xbf8000003f80,0x3f0e3f6dbe48bf80,0x3f55bec4bf7b0000,0xbec43f353f6d0000,0x3f6d3f35bec4bf80,0xbf7bbec43f0e3f80,0x3e483f6d3f550000,0xbf35bf80bf350000,0xbf3500003f353f80,0x3e48bec4bf55bf80,0xbf7bbf6dbf0e0000,0x3f6d3f353ec40000,0xbec4bf35bf6dbf80,0x3f553f6d3f7b3f80,0x3f0e3ec43e480000
.quad 0,0xbf803f80bf803f80,0x3e48bec43f0ebf35,0xbf7b3f6dbf553f35,0x3ec4bf353f6dbf80,0xbf6d3f35bec40000,0x3f0ebf6d3f7bbf35,0xbf553ec43e48bf35,0x3f35bf803f350000,0xbf3500003f35bf80,0x3f55bf6d3e483f35,0xbf0ebec43f7bbf35,0x3f6dbf35bec43f80,0xbec4bf353f6d0000,0x3f7bbec4bf553f35,0xbe48bf6d3f0e3f35
.quad 0x3f800000bf800000,0xbf8000003f80,0x3f7b3ec4bf55bf35,0x3e48bf6dbf0e3f35,0x3f6d3f35bec4bf80,0x3ec4bf35bf6d0000,0x3f553f6d3e48bf35,0x3f0ebec4bf7bbf35,0x3f353f803f350000,0x3f350000bf35bf80,0x3f0e3f6d3f7b3f35,0x3f553ec4be48bf35,0x3ec43f353f6d3f80,0x3f6d3f353ec40000,0x3e483ec43f0e3f35,0x3f7b3f6d3f553f35
.quad 0x8000800080008000,0xbf803f80bf803f80,0xbf0e3ec4be488000,0x3f55bf6d3f7bbf80,0x3f6dbf353ec48000,0xbec43f35bf6d3f80,0xbf7b3f6dbf0e8000,0xbe48bec43f55bf80,0x3f35bf803f358000,0x3f350000bf353f80,0xbe483f6dbf558000,0xbf7b3ec43f0ebf80,0xbec4bf353f6d8000,0x3f6dbf35bec43f80,0x3f553ec4bf7b8000,0xbf0e3f6d3e48bf80
.quad 0xbf8080003f808000,0xbf8000003f80,0x3f55bec4bf7b8000,0x3f0e3f6dbe48bf80,0xbec43f353f6d8000,0xbf6dbf353ec43f80,0xbe48bf6dbf558000,0x3f7b3ec4bf0ebf80,0x3f353f803f358000,0xbf3500003f353f80,0xbf7bbf6dbf0e8000,0x3e48bec4bf55bf80,0x3f6d3f353ec48000,0x3ec43f353f6d3f80,0xbf0ebec4be488000,0xbf55bf6dbf7bbf80
.quad 0x8000800080008000,0xbf803f80bf803f80,0xbf7b3f6dbf553f35,0x3e48bec43f0ebf35,0x3ec4bf353f6dbf80,0x3f6dbf353ec40000,0x3f55bec4be483f35,0xbf0e3f6dbf7b3f35,0xbf353f80bf358000,0xbf3500003f35bf80,0xbf0ebec43f7bbf35,0x3f55bf6d3e483f35,0x3f6dbf35bec43f80,0x3ec43f35bf6d0000,0x3e483f6dbf0ebf35,0xbf7b3ec43f55bf35
.quad 0xbf8080003f808000,0xbf8000003f80,0x3e48bf6dbf0e3f35,0x3f7b3ec4bf55bf35,0x3f6d3f35bec4bf80,0xbec43f353f6d0000,0xbf0e3ec43f7b3f35,0xbf55bf6dbe483f35,0xbf35bf80bf358000,0x3f350000bf35bf80,0x3f553ec4be48bf35,0x3f0e3f6d3f7b3f35,0x3ec43f353f6d3f80,0xbf6dbf35bec40000,0xbf7bbf6dbf55bf35,0xbe48bec4bf0ebf35
.quad 0x8000800080008000,0xbf803f80bf803f80,0xbf553f6dbf7b3f80,0xbf0e3ec4be480000,0xbf6d3f35bec48000,0x3ec4bf353f6dbf80,0xbe48bec43f55bf80,0x3f7bbf6d3f0e0000,0x3f35bf803f358000,0x3f350000bf353f80,0x3f7bbec4bf0e3f80,0xbe483f6dbf550000,0x3ec43f35bf6d8000,0xbf6d3f353ec4bf80,0xbf0e3f6d3e48bf80,0xbf55bec43f7b0000
.quad 0xbf8080003f808000,0xbf8000003f80,0xbf0ebf6d3e483f80,0x3f55bec4bf7b0000,0x3ec4bf35bf6d8000,0x3f6d3f35bec4bf80,0x3f7b3ec4bf0ebf80,0x3e483f6d3f550000,0x3f353f803f358000,0xbf3500003f353f80,0xbe483ec43f553f80,0xbf7bbf6dbf0e0000,0xbf6dbf35bec48000,0xbec4bf35bf6dbf80,0xbf55bf6dbf7bbf80,0x3f0e3ec43e480000
.quad 0x8000800080008000,0xbf803f80bf803f80,0xbe483ec4bf0e3f35,0xbf7b3f6dbf553f35,0xbec43f35bf6d3f80,0xbf6d3f35bec40000,0xbf0e3f6dbf7b3f35,0xbf553ec43e48bf35,0xbf353f80bf358000,0xbf3500003f35bf80,0xbf553f6dbe48bf35,0xbf0ebec43f7bbf35,0xbf6d3f353ec4bf80,0xbec4bf353f6d0000,0xbf7b3ec43f55bf35,0xbe48bf6d3f0e3f35
.quad 0xbf8080003f808000,0xbf8000003f80,0xbf7bbec43f553f35,0x3e48bf6dbf0e3f35,0xbf6dbf353ec43f80,0x3ec4bf35bf6d0000,0xbf55bf6dbe483f35,0x3f0ebec4bf7bbf35,0xbf35bf80bf358000,0x3f350000bf35bf80,0xbf0ebf6dbf7bbf35,0x3f553ec4be48bf35,0xbec4bf35bf6dbf80,0x3f6d3f353ec40000,0xbe48bec4bf0ebf35,0x3f7b3f6d3f553f35
.quad 0x3f803f803f803f80,0,0x3f553f6d3f7b3f80,0x3f0e3ec43e480000,0x3ec43f353f6d3f80,0x3f6d3f353ec40000,0xbe483ec43f553f80,0x3f7b3f6d3f0e0000,0xbf3500003f353f80,0x3f353f803f350000,0xbf7bbec43f0e3f80,0x3e483f6d3f550000,0xbf6dbf353ec43f80,0xbec43f353f6d0000,0xbf0ebf6d3e483f80,0xbf553ec43f7b0000
.quad 0xbf8000003f80,0xbf8000003f800000,0x3f0ebf6dbe483f80,0xbf55bec43f7b0000,0x3f6dbf35bec43f80,0xbec4bf353f6d0000,0x3f7bbec4bf0e3f80,0x3e48bf6d3f550000,0x3f350000bf353f80,0x3f35bf803f350000,0x3e483ec4bf553f80,0x3f7bbf6d3f0e0000,0xbec43f35bf6d3f80,0x3f6dbf353ec40000,0xbf553f6dbf7b3f80,0x3f0ebec43e480000
.quad 0x3f803f803f803f80,0,0x3e483ec43f0e3f35,0x3f7b3f6d3f553f35,0xbf6dbf35bec40000,0x3ec43f353f6d3f80,0xbf0ebf6dbf7bbf35,0xbf55bec43e483f35,0x3f350000bf35bf80,0xbf35bf80bf350000,0x3f553f6d3e48bf35,0x3f0ebec4bf7bbf35,0xbec43f353f6d0000,0x3f6d3f35bec4bf80,0xbf7bbec43f553f35,0xbe483f6d3f0ebf35
.quad 0xbf8000003f80,0xbf8000003f800000,0x3f7bbec4bf553f35,0xbe48bf6d3f0e3f35,0x3ec43f35bf6d0000,0x3f6dbf35bec43f80,0xbf553f6dbe48bf35,0x3f0e3ec4bf7b3f35,0xbf3500003f35bf80,0xbf353f80bf350000,0x3f0ebf6d3f7bbf35,0xbf553ec43e48bf35,0x3f6dbf353ec40000,0x3ec4bf353f6dbf80,0xbe483ec4bf0e3f35,0x3f7bbf6d3f55bf35
.quad 0x3f803f803f803f80,0,0xbf0ebec4be480000,0x3f553f6d3f7b3f80,0xbec4bf35bf6dbf80,0xbf6dbf35bec40000,0x3f7b3f6d3f0e0000,0x3e48bec4bf55bf80,0xbf3500003f353f80,0x3f353f803f350000,0xbe48bf6dbf550000,0xbf7bbec43f0e3f80,0x3f6d3f35bec4bf80,0x3ec4bf35bf6d0000,0xbf553ec43f7b0000,0x3f0e3f6dbe48bf80
.quad 0xbf8000003f80,0xbf8000003f800000,0x3f553ec4bf7b0000,0x3f0ebf6dbe483f80,0xbf6d3f353ec4bf80,0x3ec43f35bf6d0000,0x3e48bf6d3f550000,0xbf7b3ec43f0ebf80,0x3f350000bf353f80,0x3f35bf803f350000,0xbf7b3f6dbf0e0000,0x3e483ec4bf553f80,0x3ec4bf353f6dbf80,0xbf6d3f35bec40000,0x3f0ebec43e480000,0x3f55bf6d3f7bbf80
.quad 0x3f803f803f803f80,0,0xbf7bbf6dbf55bf35,0x3e483ec43f0e3f35,0x3f6d3f353ec40000,0xbec4bf35bf6dbf80,0xbf55bec43e483f35,0x3f0e3f6d3f7b3f35,0x3f350000bf35bf80,0xbf35bf80bf350000,0xbf0e3ec43f7b3f35,0x3f553f6d3e48bf35,0x3ec4bf35bf6d0000,0xbf6dbf353ec43f80,0xbe483f6d3f0ebf35,0x3f7b3ec4bf55bf35
.quad 0xbf8000003f80,0xbf8000003f800000,0x3e483f6dbf0ebf35,0x3f7bbec4bf553f35,0xbec4bf353f6d0000,0xbf6d3f353ec4bf80,0x3f0e3ec4bf7b3f35,0x3f55bf6d3e483f35,0xbf3500003f35bf80,0xbf353f80bf350000,0x3f55bec4be483f35,0x3f0ebf6d3f7bbf35,0xbf6d3f35bec40000,0xbec43f35bf6d3f80,0x3f7bbf6d3f55bf35,0x3e48bec43f0ebf35
.quad 0x3f803f803f803f80,0x8000800080008000,0x3f553f6d3f7b3f80,0xbf0ebec4be488000,0x3ec43f353f6d3f80,0xbf6dbf35bec48000,0xbe483ec43f553f80,0xbf7bbf6dbf0e8000,0xbf3500003f353f80,0xbf35bf80bf358000,0xbf7bbec43f0e3f80,0xbe48bf6dbf558000,0xbf6dbf353ec43f80,0x3ec4bf35bf6d8000,0xbf0ebf6d3e483f80,0x3f55bec4bf7b8000
.quad 0xbf8000003f80,0x3f808000bf808000,0x3f0ebf6dbe483f80,0x3f553ec4bf7b8000,0x3f6dbf35bec43f80,0x3ec43f35bf6d8000,0x3f7bbec4bf0e3f80,0xbe483f6dbf558000,0x3f350000bf353f80,0xbf353f80bf358000,0x3e483ec4bf553f80,0xbf7b3f6dbf0e8000,0xbec43f35bf6d3f80,0xbf6d3f35bec48000,0xbf553f6dbf7b3f80,0xbf0e3ec4be488000
.quad 0x3f803f803f803f80,0x8000800080008000,0x3e483ec43f0e3f35,0xbf7bbf6dbf55bf35,0xbf6dbf35bec40000,0xbec4bf35bf6dbf80,0xbf0ebf6dbf7bbf35,0x3f553ec4be48bf35,0x3f350000bf35bf80,0x3f353f803f358000,0x3f553f6d3e48bf35,0xbf0e3ec43f7b3f35,0xbec43f353f6d0000,0xbf6dbf353ec43f80,0xbf7bbec43f553f35,0x3e48bf6dbf0e3f35
.quad 0xbf8000003f80,0x3f808000bf808000,0x3f7bbec4bf553f35,0x3e483f6dbf0ebf35,0x3ec43f35bf6d0000,0xbf6d3f353ec4bf80,0xbf553f6dbe48bf35,0xbf0ebec43f7bbf35,0xbf3500003f35bf80,0x3f35bf803f358000,0x3f0ebf6d3f7bbf35,0x3f55bec4be483f35,0x3f6dbf353ec40000,0xbec43f35bf6d3f80,0xbe483ec4bf0e3f35,0xbf7b3f6dbf553f35
.quad 0x3f803f803f803f80,0x8000800080008000,0xbf0ebec4be480000,0xbf55bf6dbf7bbf80,0xbec4bf35bf6dbf80,0x3f6d3f353ec48000,0x3f7b3f6d3f0e0000,0xbe483ec43f553f80,0xbf3500003f353f80,0xbf35bf80bf358000,0xbe48bf6dbf550000,0x3f7b3ec4bf0ebf80,0x3f6d3f35bec4bf80,0xbec43f353f6d8000,0xbf553ec43f7b0000,0xbf0ebf6d3e483f80
.quad 0xbf8000003f80,0x3f808000bf808000,0x3f553ec4bf7b0000,0xbf0e3f6d3e48bf80,0xbf6d3f353ec4bf80,0xbec4bf353f6d8000,0x3e48bf6d3f550000,0x3f7bbec4bf0e3f80,0x3f350000bf353f80,0xbf353f80bf358000,0xbf7b3f6dbf0e0000,0xbe48bec43f55bf80,0x3ec4bf353f6dbf80,0x3f6dbf353ec48000,0x3f0ebec43e480000,0xbf553f6dbf7b3f80
.quad 0x3f803f803f803f80,0x8000800080008000,0xbf7bbf6dbf55bf35,0xbe48bec4bf0ebf35,0x3f6d3f353ec40000,0x3ec43f353f6d3f80,0xbf55bec43e483f35,0xbf0ebf6dbf7bbf35,0x3f350000bf35bf80,0x3f353f803f358000,0xbf0e3ec43f7b3f35,0xbf55bf6dbe483f35,0x3ec4bf35bf6d0000,0x3f6d3f35bec4bf80,0xbe483f6d3f0ebf35,0xbf7bbec43f553f35
.quad 0xbf8000003f80,0x3f808000bf808000,0x3e483f6dbf0ebf35,0xbf7b3ec43f55bf35,0xbec4bf353f6d0000,0x3f6dbf35bec43f80,0x3f0e3ec4bf7b3f35,0xbf553f6dbe48bf35,0xbf3500003f35bf80,0x3f35bf803f358000,0x3f55bec4be483f35,0xbf0e3f6dbf7b3f35,0xbf6d3f35bec40000,0x3ec4bf353f6dbf80,0x3f7bbf6d3f55bf35,0xbe483ec4bf0e3f35
.quad 0x3f803f803f803f80,0xbf803f80bf803f80,0x3f553f6d3f7b3f80,0xbf553f6dbf7b3f80,0x3ec43f353f6d3f80,0xbec43f35bf6d3f80,0xbe483ec43f553f80,0x3e483ec4bf553f80,0xbf3500003f353f80,0x3f350000bf353f80,0xbf7bbec43f0e3f80,0x3f7bbec4bf0e3f80,0xbf6dbf353ec43f80,0x3f6dbf35bec43f80,0xbf0ebf6d3e483f80,0x3f0ebf6dbe483f80
.quad 0xbf8000003f80,0xbf8000003f80,0x3f0ebf6dbe483f80,0xbf0ebf6d3e483f80,0x3f6dbf35bec43f80,0xbf6dbf353ec43f80,0x3f7bbec4bf0e3f80,0xbf7bbec43f0e3f80,0x3f350000bf353f80,0xbf3500003f353f80,0x3e483ec4bf553f80,0xbe483ec43f553f80,0xbec43f35bf6d3f80,0x3ec43f353f6d3f80,0xbf553f6dbf7b3f80,0x3f553f6d3f7b3f80
.quad 0x3f803f803f803f80,0xbf803f80bf803f80,0x3e483ec43f0e3f35,0xbe483ec4bf0e3f35,0xbf6dbf35bec40000,0x3f6dbf353ec40000,0xbf0ebf6dbf7bbf35,0x3f0ebf6d3f7bbf35,0x3f350000bf35bf80,0xbf3500003f35bf80,0x3f553f6d3e48bf35,0xbf553f6dbe48bf35,0xbec43f353f6d0000,0x3ec43f35bf6d0000,0xbf7bbec43f553f35,0x3f7bbec4bf553f35
.quad 0xbf8000003f80,0xbf8000003f80,0x3f7bbec4bf553f35,0xbf7bbec43f553f35,0x3ec43f35bf6d0000,0xbec43f353f6d0000,0xbf553f6dbe48bf35,0x3f553f6d3e48bf35,0xbf3500003f35bf80,0x3f350000bf35bf80,0x3f0ebf6d3f7bbf35,0xbf0ebf6dbf7bbf35,0x3f6dbf353ec40000,0xbf6dbf35bec40000,0xbe483ec4bf0e3f35,0x3e483ec43f0e3f35
.quad 0x3f803f803f803f80,0xbf803f80bf803f80,0xbf0ebec4be480000,0x3f0ebec43e480000,0xbec4bf35bf6dbf80,0x3ec4bf353f6dbf80,0x3f7b3f6d3f0e0000,0xbf7b3f6dbf0e0000,0xbf3500003f353f80,0x3f350000bf353f80,0xbe48bf6dbf550000,0x3e48bf6d3f550000,0x3f6d3f35bec4bf80,0xbf6d3f353ec4bf80,0xbf553ec43f7b0000,0x3f553ec4bf7b0000
.quad 0xbf8000003f80,0xbf8000003f80,0x3f553ec4bf7b0000,0xbf553ec43f7b0000,0xbf6d3f353ec4bf80,0x3f6d3f35bec4bf80,0x3e48bf6d3f550000,0xbe48bf6dbf550000,0x3f350000bf353f80,0xbf3500003f353f80,0xbf7b3f6dbf0e0000,0x3f7b3f6d3f0e0000,0x3ec4bf353f6dbf80,0xbec4bf35bf6dbf80,0x3f0ebec43e480000,0xbf0ebec4be480000
.quad 0x3f803f803f803f80,0xbf803f80bf803f80,0xbf7bbf6dbf55bf35,0x3f7bbf6d3f55bf35,0x3f6d3f353ec40000,0xbf6d3f35bec40000,0xbf55bec43e483f35,0x3f55bec4be483f35,0x3f350000bf35bf80,0xbf3500003f35bf80,0xbf0e3ec43f7b3f35,0x3f0e3ec4bf7b3f35,0x3ec4bf35bf6d0000,0xbec4bf353f6d0000,0xbe483f6d3f0ebf35,0x3e483f6dbf0ebf35
.quad 0xbf8000003f80,0xbf8000003f80,0x3e483f6dbf0ebf35,0xbe483f6d3f0ebf35,0xbec4bf353f6d0000,0x3ec4bf35bf6d0000,0x3f0e3ec4bf7b3f35,0xbf0e3ec43f7b3f35,0xbf3500003f35bf80,0x3f350000bf35bf80,0x3f55bec4be483f35,0xbf55bec43e483f35,0xbf6d3f35bec40000,0x3f6d3f353ec40000,0x3f7bbf6d3f55bf35,0xbf7bbf6dbf55bf35
.quad 0,0xbf803f80bf803f80,0xbf0e3ec4be480000,0xbf553f6dbf7b3f80,0xbf6d3f35bec40000,0xbec43f35bf6d3f80,0xbf7b3f6dbf0e0000,0x3e483ec4bf553f80,0xbf353f80bf350000,0x3f350000bf353f80,0xbe483f6dbf550000,0x3f7bbec4bf0e3f80,0x3ec43f35bf6d0000,0x3f6dbf35bec43f80,0x3f553ec4bf7b0000,0x3f0ebf6dbe483f80
.quad 0x3f800000bf800000,0xbf8000003f80,0x3f55bec4bf7b0000,0xbf0ebf6d3e483f80,0x3ec4bf35bf6d0000,0xbf6dbf353ec43f80,0xbe48bf6dbf550000,0xbf7bbec43f0e3f80,0xbf35bf80bf350000,0xbf3500003f353f80,0xbf7bbf6dbf0e0000,0xbe483ec43f553f80,0xbf6dbf35bec40000,0x3ec43f353f6d3f80,0xbf0ebec4be480000,0x3f553f6d3f7b3f80
.quad 0,0xbf803f80bf803f80,0xbf7b3f6dbf553f35,0xbe483ec4bf0e3f35,0xbec43f35bf6d3f80,0x3f6dbf353ec40000,0x3f55bec4be483f35,0x3f0ebf6d3f7bbf35,0x3f35bf803f350000,0xbf3500003f35bf80,0xbf0ebec43f7bbf35,0xbf553f6dbe48bf35,0xbf6d3f353ec4bf80,0x3ec43f35bf6d0000,0x3e483f6dbf0ebf35,0x3f7bbec4bf553f35
.quad 0x3f800000bf800000,0xbf8000003f80,0x3e48bf6dbf0e3f35,0xbf7bbec43f553f35,0xbf6dbf353ec43f80,0xbec43f353f6d0000,0xbf0e3ec43f7b3f35,0x3f553f6d3e48bf35,0x3f353f803f350000,0x3f350000bf35bf80,0x3f553ec4be48bf35,0xbf0ebf6dbf7bbf35,0xbec4bf35bf6dbf80,0xbf6dbf35bec40000,0xbf7bbf6dbf55bf35,0x3e483ec43f0e3f35
.quad 0,0xbf803f80bf803f80,0xbf553f6dbf7b3f80,0x3f0ebec43e480000,0x3f6dbf353ec40000,0x3ec4bf353f6dbf80,0xbe48bec43f55bf80,0xbf7b3f6dbf0e0000,0xbf353f80bf350000,0x3f350000bf353f80,0x3f7bbec4bf0e3f80,0x3e48bf6d3f550000,0xbec4bf353f6d0000,0xbf6d3f353ec4bf80,0xbf0e3f6d3e48bf80,0x3f553ec4bf7b0000
.quad 0x3f800000bf800000,0xbf8000003f80,0xbf0ebf6d3e483f80,0xbf553ec43f7b0000,0xbec43f353f6d0000,0x3f6d3f35bec4bf80,0x3f7b3ec4bf0ebf80,0xbe48bf6dbf550000,0xbf35bf80bf350000,0xbf3500003f353f80,0xbe483ec43f553f80,0x3f7b3f6d3f0e0000,0x3f6d3f353ec40000,0xbec4bf35bf6dbf80,0xbf55bf6dbf7bbf80,0xbf0ebec4be480000
.quad 0,0xbf803f80bf803f80,0xbe483ec4bf0e3f35,0x3f7bbf6d3f55bf35,0x3ec4bf353f6dbf80,0xbf6d3f35bec40000,0xbf0e3f6dbf7b3f35,0x3f55bec4be483f35,0x3f35bf803f350000,0xbf3500003f35bf80,0xbf553f6dbe48bf35,0x3f0e3ec4bf7b3f35,0x3f6dbf35bec43f80,0xbec4bf353f6d0000,0xbf7b3ec43f55bf35,0x3e483f6dbf0ebf35
.quad 0x3f800000bf800000,0xbf8000003f80,0xbf7bbec43f553f35,0xbe483f6d3f0ebf35,0x3f6d3f35bec4bf80,0x3ec4bf35bf6d0000,0xbf55bf6dbe483f35,0xbf0e3ec43f7b3f35,0x3f353f803f350000,0x3f350000bf35bf80,0xbf0ebf6dbf7bbf35,0xbf55bec43e483f35,0x3ec43f353f6d3f80,0x3f6d3f353ec40000,0xbe48bec4bf0ebf35,0xbf7bbf6dbf55bf35
.quad 0x8000800080008000,0xbf803f80bf803f80,0x3f0ebec43e488000,0xbf553f6dbf7b3f80,0x3f6dbf353ec48000,0xbec43f35bf6d3f80,0x3f7bbf6d3f0e8000,0x3e483ec4bf553f80,0x3f35bf803f358000,0x3f350000bf353f80,0x3e48bf6d3f558000,0x3f7bbec4bf0e3f80,0xbec4bf353f6d8000,0x3f6dbf35bec43f80,0xbf55bec43f7b8000,0x3f0ebf6dbe483f80
.quad 0xbf8080003f808000,0xbf8000003f80,0xbf553ec43f7b8000,0xbf0ebf6d3e483f80,0xbec43f353f6d8000,0xbf6dbf353ec43f80,0x3e483f6d3f558000,0xbf7bbec43f0e3f80,0x3f353f803f358000,0xbf3500003f353f80,0x3f7b3f6d3f0e8000,0xbe483ec43f553f80,0x3f6d3f353ec48000,0x3ec43f353f6d3f80,0x3f0e3ec43e488000,0x3f553f6d3f7b3f80
.quad 0x8000800080008000,0xbf803f80bf803f80,0x3f7bbf6d3f55bf35,0xbe483ec4bf0e3f35,0x3ec4bf353f6dbf80,0x3f6dbf353ec40000,0xbf553ec43e48bf35,0x3f0ebf6d3f7bbf35,0xbf353f80bf358000,0xbf3500003f35bf80,0x3f0e3ec4bf7b3f35,0xbf553f6dbe48bf35,0x3f6dbf35bec43f80,0x3ec43f35bf6d0000,0xbe48bf6d3f0e3f35,0x3f7bbec4bf553f35
.quad 0xbf8080003f808000,0xbf8000003f80,0xbe483f6d3f0ebf35,0xbf7bbec43f553f35,0x3f6d3f35bec4bf80,0xbec43f353f6d0000,0x3f0ebec4bf7bbf35,0x3f553f6d3e48bf35,0xbf35bf80bf358000,0x3f350000bf35bf80,0xbf55bec43e483f35,0xbf0ebf6dbf7bbf35,0x3ec43f353f6d3f80,0xbf6dbf35bec40000,0x3f7b3f6d3f553f35,0x3e483ec43f0e3f35
.quad 0x8000800080008000,0xbf803f80bf803f80,0x3f55bf6d3f7bbf80,0x3f0ebec43e480000,0xbf6d3f35bec48000,0x3ec4bf353f6dbf80,0x3e483ec4bf553f80,0xbf7b3f6dbf0e0000,0x3f35bf803f358000,0x3f350000bf353f80,0xbf7b3ec43f0ebf80,0x3e48bf6d3f550000,0x3ec43f35bf6d8000,0xbf6d3f353ec4bf80,0x3f0ebf6dbe483f80,0x3f553ec4bf7b0000
.quad 0xbf8080003f808000,0xbf8000003f80,0x3f0e3f6dbe48bf80,0xbf553ec43f7b0000,0x3ec4bf35bf6d8000,0x3f6d3f35bec4bf80,0xbf7bbec43f0e3f80,0xbe48bf6dbf550000,0x3f353f803f358000,0xbf3500003f353f80,0x3e48bec4bf55bf80,0x3f7b3f6d3f0e0000,0xbf6dbf35bec48000,0xbec4bf35bf6dbf80,0x3f553f6d3f7b3f80,0xbf0ebec4be480000
.quad 0x8000800080008000,0xbf803f80bf803f80,0x3e48bec43f0ebf35,0x3f7bbf6d3f55bf35,0xbec43f35bf6d3f80,0xbf6d3f35bec40000,0x3f0ebf6d3f7bbf35,0x3f55bec4be483f35,0xbf353f80bf358000,0xbf3500003f35bf80,0x3f55bf6d3e483f35,0x3f0e3ec4bf7b3f35,0xbf6d3f353ec4bf80,0xbec4bf353f6d0000,0x3f7bbec4bf553f35,0x3e483f6dbf0ebf35
.quad 0xbf8080003f808000,0xbf8000003f80,0x3f7b3ec4bf55bf35,0xbe483f6d3f0ebf35,0xbf6dbf353ec43f80,0x3ec4bf35bf6d0000,0x3f553f6d3e48bf35,0xbf0e3ec43f7b3f35,0xbf35bf80bf358000,0x3f350000bf35bf80,0x3f0e3f6d3f7b3f35,0xbf55bec43e483f35,0xbec4bf35bf6dbf80,0x3f6d3f353ec40000,0x3e483ec43f0e3f35,0xbf7bbf6dbf55bf35
.quad 0x3f803f803f803f80,0x8000800080008000,0x3ec43f353f6d3f80,0xbf6dbf35bec48000,0xbf3500003f353f80,0xbf35bf80bf358000,0xbf6dbf353ec43f80,0x3ec4bf35bf6d8000,0xbf8000003f80,0x3f808000bf808000,0x3f6dbf35bec43f80,0x3ec43f35bf6d8000,0x3f350000bf353f80,0xbf353f80bf358000,0xbec43f35bf6d3f80,0xbf6d3f35bec48000
.quad 0xbf803f80bf803f80,0x8000800080008000,0xbec43f35bf6d3f80,0x3f6dbf353ec48000,0x3f350000bf353f80,0x3f35bf803f358000,0x3f6dbf35bec43f80,0xbec4bf353f6d8000,0xbf8000003f80,0xbf8080003f808000,0xbf6dbf353ec43f80,0xbec43f353f6d8000,0xbf3500003f353f80,0x3f353f803f358000,0x3ec43f353f6d3f80,0x3f6d3f353ec48000
.quad 0x3f803f803f803f80,0x8000800080008000,0xbf6dbf35bec40000,0xbec4bf35bf6dbf80,0x3f350000bf35bf80,0x3f353f803f358000,0xbec43f353f6d0000,0xbf6dbf353ec43f80,0xbf8000003f80,0x3f808000bf808000,0x3ec43f35bf6d0000,0xbf6d3f353ec4bf80,0xbf3500003f35bf80,0x3f35bf803f358000,0x3f6dbf353ec40000,0xbec43f35bf6d3f80
.quad 0xbf803f80bf803f80,0x8000800080008000,0x3f6dbf353ec40000,0x3ec4bf353f6dbf80,0xbf3500003f35bf80,0xbf353f80bf358000,0x3ec43f35bf6d0000,0x3f6dbf35bec43f80,0xbf8000003f80,0xbf8080003f808000,0xbec43f353f6d0000,0x3f6d3f35bec4bf80,0x3f350000bf35bf80,0xbf35bf80bf358000,0xbf6dbf35bec40000,0x3ec43f353f6d3f80
.quad 0x3f803f803f803f80,0x8000800080008000,0xbec4bf35bf6dbf80,0x3f6d3f353ec48000,0xbf3500003f353f80,0xbf35bf80bf358000,0x3f6d3f35bec4bf80,0xbec43f353f6d8000,0xbf8000003f80,0x3f808000bf808000,0xbf6d3f353ec4bf80,0xbec4bf353f6d8000,0x3f350000bf353f80,0xbf353f80bf358000,0x3ec4bf353f6dbf80,0x3f6dbf353ec48000
.quad 0xbf803f80bf803f80,0x8000800080008000,0x3ec4bf353f6dbf80,0xbf6d3f35bec48000,0x3f350000bf353f80,0x3f35bf803f358000,0xbf6d3f353ec4bf80,0x3ec43f35bf6d8000,0xbf8000003f80,0xbf8080003f808000,0x3f6d3f35bec4bf80,0x3ec4bf35bf6d8000,0xbf3500003f353f80,0x3f353f803f358000,0xbec4bf35bf6dbf80,0xbf6dbf35bec48000
.quad 0x3f803f803f803f80,0x8000800080008000,0x3f6d3f353ec40000,0x3ec43f353f6d3f80,0x3f350000bf35bf80,0x3f353f803f358000,0x3ec4bf35bf6d0000,0x3f6d3f35bec4bf80,0xbf8000003f80,0x3f808000bf808000,0xbec4bf353f6d0000,0x3f6dbf35bec43f80,0xbf3500003f35bf80,0x3f35bf803f358000,0xbf6d3f35bec40000,0x3ec4bf353f6dbf80
.quad 0xbf803f80bf803f80,0x8000800080008000,0xbf6d3f35bec40000,0xbec43f35bf6d3f80,0xbf3500003f35bf80,0xbf353f80bf358000,0xbec4bf353f6d0000,0xbf6d3f353ec4bf80,0xbf8000003f80,0xbf8080003f808000,0x3ec4bf35bf6d0000,0xbf6dbf353ec43f80,0x3f350000bf35bf80,0xbf35bf80bf358000,0x3f6d3f353ec40000,0xbec4bf35bf6dbf80
.quad 0x3f8000003f800000,0x3f8000003f800000,0x3f7ffb113f800000,0x3f7fd3973f7fec43,0x3f7fec433f800000,0x3f7f4e6d3f7fb10f,0x3f7fd3973f800000,0x3f7e70b03f7f4e6d,0x3f7fb10f3f800000,0x3f7d3aac3f7ec46d,0x3f7f84ab3f800000,0x3f7baccd3f7e1324,0x3f7f4e6d3f800000,0x3f79c79d3f7d3aac,0x3f7f0e583f800000,0x3f778bc53f7c3b28
.quad 0x3f7ec46d3f800000,0x3f74fa0b3f7b14be,0x3f7e70b03f800000,0x3f7213523f79c79d,0x3f7e13243f800000,0x3f6ed89e3f7853f8,0x3f7dabcc3f800000,0x3f6b4b0c3f76ba07,0x3f7d3aac3f800000,0x3f676bd83f74fa0b,0x3f7cbfc93f800000,0x3f633c5a3f731447,0x3f7c3b283f800000,0x3f5ebe053f710908,0x3f7baccd3f800000,0x3f59f26a3f6ed89e
.quad 0x3f8000003f800000,0x3f8000003f800000,0x3f7f84ab3f7fb10f,0x3f7f0e583f7f4e6d,0x3f7e13243f7ec46d,0x3f7c3b283f7d3aac,0x3f7baccd3f7d3aac,0x3f778bc53f79c79d,0x3f7853f83f7b14be,0x3f7109083f74fa0b,0x3f740bdd3f7853f8,0x3f68bf3c3f6ed89e,0x3f6ed89e3f74fa0b,0x3f5ebe053f676bd8,0x3f68bf3c3f710908,0x3f5318493f5ebe05
.quad 0x3f61c5983f6c835e,0x3f45e4033f54db31,0x3f59f26a3f676bd8,0x3f373a233f49d112,0x3f514d3d3f61c598,0x3f2736563f3daef9,0x3f47de653f5b941a,0x3f15f6d93f3085bb,0x3f3daef93f54db31,0x3f039c3d3f226799,0x3f32c8c93f4d9f02,0x3ee0924f3f13682a,0x3f2736563f45e403,0x3eb8442a3f039c3d,0x3f1b02c63f3daef9,0x3e8e9a223ee63375
.quad 0x3f8000003f800000,0x3f8000003f800000,0x3f7e70b03f7ec46d,0x3f7dabcc3f7e1324,0x3f79c79d3f7b14be,0x3f76ba073f7853f8,0x3f7213523f74fa0b,0x3f6b4b0c3f6ed89e,0x3f676bd83f6c835e,0x3f5b941a3f61c598,0x3f59f26a3f61c598,0x3f47de653f514d3d,0x3f49d1123f54db31,0x3f3085bb3f3daef9,0x3f373a233f45e403,0x3f15f6d93f273656
.quad 0x3f2267993f3504f3,0x3ef15aea3f0e39da,0x3f0b9a6b3f226799,0x3eb263ef3ee63375,0x3ee633753f0e39da,0x3e605c133eac7cd4,0x3eb263ef3ef15aea,0x3dafb6803e605c13,0x3e78cfcc3ec3ef15,0xbd48fb303dc8bd36,0x3e09cf863e94a031,0xbe3b6ecfbcc90ab0,0x3cc90ab03e47c5c2,0xbea09ae5be164083,0xbdafb6803dc8bd36,0xbee0924fbe888e93
.quad 0x3f8000003f800000,0x3f8000003f800000,0x3f7cbfc93f7d3aac,0x3f7baccd3f7c3b28,0x3f7314473f74fa0b,0x3f6ed89e3f710908,0x3f633c5a3f676bd8,0x3f59f26a3f5ebe05,0x3f4d9f023f54db31,0x3f3daef93f45e403,0x3f32c8c93f3daef9,0x3f1b02c63f273656,0x3f13682a3f226799,0x3ee633753f039c3d,0x3ee0924f3f039c3d,0x3e8e9a223eb8442a
.quad 0x3e94a0313ec3ef15,0x3dc8bd363e47c5c2,0x3e09cf863e78cfcc,0xbdafb6803cc90ab0,0xbcc90ab03dc8bd36,0xbe888e93be164083,0xbe3b6ecfbd48fb30,0xbee0924fbea09ae5,0xbeac7cd4be47c5c2,0xbf187fc0bef15aea,0xbef6e0cbbeac7cd4,0xbf3b8f3bbf1d7fd1,0xbf1d7fd1bef15aea,0xbf584853bf3daef9,0xbf3b8f3bbf187fc0,0xbf6db293bf584853
.quad 0,0,0x3c490e9000000000,0x3d16c32c3cc90ab0,0x3cc90ab000000000,0x3d96a9053d48fb30,0x3d16c32c00000000,0x3de1bc2e3d96a905,0x3d48fb3000000000,0x3e1640833dc8bd36,0x3d7b2b7400000000,0x3e3b6ecf3dfab273,0x3d96a90500000000,0x3e605c133e164083,0x3dafb68000000000,0x3e827dc03e2f10a2
.quad 0x3dc8bd3600000000,0x3e94a0313e47c5c2,0x3de1bc2e00000000,0x3ea68f123e605c13,0x3dfab27300000000,0x3eb8442a3e78cfcc,0x3e09cf8600000000,0x3ec9b9533e888e93,0x3e16408300000000,0x3edae8803e94a031,0x3e22abb600000000,0x3eebcbbb3ea09ae5,0x3e2f10a200000000,0x3efc5d273eac7cd4,0x3e3b6ecf00000000,0x3f064b823eb8442a
.quad 0,0,0x3d7b2b743d48fb30,0x3dafb6803d96a905,0x3dfab2733dc8bd36,0x3e2f10a23e164083,0x3e3b6ecf3e164083,0x3e827dc03e605c13,0x3e78cfcc3e47c5c2,0x3eac7cd43e94a031,0x3e9aa0863e78cfcc,0x3ed536413eb8442a,0x3eb8442a3e94a031,0x3efc5d273edae880,0x3ed536413eac7cd4,0x3f10d3cd3efc5d27
.quad 0x3ef15aea3ec3ef15,0x3f2267993f0e39da,0x3f064b823edae880,0x3f32c8c93f1d7fd1,0x3f13682a3ef15aea,0x3f41d8703f2beb4a,0x3f1ff6cb3f039c3d,0x3f4f7a1f3f396842,0x3f2beb4a3f0e39da,0x3f5b941a3f45e403,0x3f373a233f187fc0,0x3f660f883f514d3d,0x3f41d8703f226799,0x3f6ed89e3f5b941a,0x3f4bbbf83f2beb4a,0x3f75dec63f64aa59
.quad 0,0,0x3de1bc2e3dc8bd36,0x3e09cf863dfab273,0x3e605c133e47c5c2,0x3e888e933e78cfcc,0x3ea68f123e94a031,0x3ec9b9533eb8442a,0x3edae8803ec3ef15,0x3f039c3d3ef15aea,0x3f064b823ef15aea,0x3f1ff6cb3f13682a,0x3f1d7fd13f0e39da,0x3f3968423f2beb4a,0x3f32c8c93f226799,0x3f4f7a1f3f41d870
.quad 0x3f45e4033f3504f3,0x3f61c5983f54db31,0x3f5695e53f45e403,0x3f6ff5733f64aa59,0x3f64aa593f54db31,0x3f79c79d3f710908,0x3f6ff5733f61c598,0x3f7f0e583f79c79d,0x3f7853f83f6c835e,0x3f7fb10f3f7ec46d,0x3f7dabcc3f74fa0b,0x3f7baccd3f7fec43,0x3f7fec433f7b14be,0x3f7314473f7d3aac,0x3f7f0e583f7ec46d,0x3f660f883f76ba07
.quad 0,0,0x3e22abb63e164083,0x3e3b6ecf3e2f10a2,0x3ea09ae53e94a031,0x3eb8442a3eac7cd4,0x3eebcbbb3edae880,0x3f064b823efc5d27,0x3f187fc03f0e39da,0x3f2beb4a3f226799,0x3f373a233f2beb4a,0x3f4bbbf83f41d870,0x3f514d3d3f45e403,0x3f64aa593f5b941a,0x3f660f883f5b941a,0x3f75dec63f6ed89e
.quad 0x3f74fa0b3f6c835e,0x3f7ec46d3f7b14be,0x3f7dabcc3f7853f8,0x3f7f0e583f7fec43,0x3f7fec433f7ec46d,0x3f76ba073f7d3aac,0x3f7baccd3f7fb10f,0x3f660f883f731447,0x3f7109083f7b14be,0x3f4d9f023f61c598,0x3f6046213f710908,0x3f2e3bde3f49d112,0x3f49d1123f61c598,0x3f08f59b3f2beb4a,0x3f2e3bde3f4d9f02,0x3ebe1d4a3f08f59b
.quad 0x3f7b14be3f800000,0x3f54db313f6c835e,0x3f7a73023f800000,0x3f4f7a1f3f6a09a7,0x3f79c79d3f800000,0x3f49d1123f676bd8,0x3f7912983f800000,0x3f43e2003f64aa59,0x3f7853f83f800000,0x3f3daef93f61c598,0x3f778bc53f800000,0x3f373a233f5ebe05,0x3f76ba073f800000,0x3f3085bb3f5b941a,0x3f75dec63f800000,0x3f2994153f584853
.quad 0x3f74fa0b3f800000,0x3f2267993f54db31,0x3f740bdd3f800000,0x3f1b02c63f514d3d,0x3f7314473f800000,0x3f13682a3f4d9f02,0x3f7213523f800000,0x3f0b9a6b3f49d112,0x3f7109083f800000,0x3f039c3d3f45e403,0x3f6ff5733f800000,0x3ef6e0cb3f41d870,0x3f6ed89e3f800000,0x3ee633753f3daef9,0x3f6db2933f800000,0x3ed536413f396842
.quad 0x3f0e39da3f3504f3,0x3e47c5c23ec3ef15,0x3f00e7e43f2beb4a,0x3de1bc2e3ea09ae5,0x3ee633753f226799,0x3cc90ab03e78cfcc,0x3ec9b9533f187fc0,0xbd7b2b743e2f10a2,0x3eac7cd43f0e39da,0xbe1640833dc8bd36,0x3e8e9a223f039c3d,0xbe6c9a7f3cc90ab0,0x3e605c133ef15aea,0xbea09ae5bd48fb30,0x3e22abb63edae880,0xbec9b953bdfab273
.quad 0x3dc8bd363ec3ef15,0xbef15aeabe47c5c2,0x3d16c32c3eac7cd4,0xbf0b9a6bbe888e93,0xbcc90ab03e94a031,0xbf1d7fd1beac7cd4,0xbdafb6803e78cfcc,0xbf2e3bdebecf7bca,0xbe1640833e47c5c2,0xbf3daef9bef15aea,0xbe5415013e164083,0xbf4bbbf8bf08f59b,0xbe888e933dc8bd36,0xbf584853bf187fc0,0xbea68f123d48fb30,0xbf633c5abf273656
.quad 0xbe47c5c200000000,0xbf0e39dabec3ef15,0xbe9aa086bdc8bd36,0xbf299415befc5d27,0xbecf7bcabe47c5c2,0xbf41d870bf187fc0,0xbf00e7e4be94a031,0xbf5695e5bf3085bb,0xbf187fc0bec3ef15,0xbf676bd8bf45e403,0xbf2e3bdebef15aea,0xbf740bddbf584853,0xbf41d870bf0e39da,0xbf7c3b28bf676bd8,0xbf531849bf226799,0xbf7fd397bf731447
.quad 0xbf61c598bf3504f3,0xbf7ec46dbf7b14be,0xbf6db293bf45e403,0xbf791298bf7f4e6d,0xbf76ba07bf54db31,0xbf6ed89ebf7fb10f,0xbf7cbfc9bf61c598,0xbf604621bf7c3b28,0xbf7fb10fbf6c835e,0xbf4d9f02bf74fa0b,0xbf7f84abbf74fa0b,0xbf373a23bf6a09a7,0xbf7c3b28bf7b14be,0xbf1d7fd1bf5b941a,0xbf75dec6bf7ec46d,0xbf00e7e4bf49d112
.quad 0xbf54db31bf3504f3,0xbf7b14bebf6c835e,0xbf68bf3cbf4d9f02,0xbf7ffb11bf79c79d,0xbf76ba07bf61c598,0xbf7c3b28bf7fb10f,0xbf7e70b0bf710908,0xbf6ff573bf7e1324,0xbf7fb10fbf7b14be,0xbf5b941abf74fa0b,0xbf7a7302bf7fb10f,0xbf3fc767bf64aa59,0xbf6ed89ebf7ec46d,0xbf1d7fd1bf4d9f02,0xbf5d2d53bf7853f8,0xbeebcbbbbf3085bb
.quad 0xbf45e403bf6c835e,0xbe94a031bf0e39da,0xbf299415bf5b941a,0xbde1bc2ebecf7bca,0xbf08f59bbf45e403,0x3d96a905be78cfcc,0xbec9b953bf2beb4a,0x3e827dc0bd96a905,0xbe78cfccbf0e39da,0x3edae8803dc8bd36,0xbdafb680bedae880,0x3f15f6d93e888e93,0x3d96a905be94a031,0x3f3968423edae880,0x3e6c9a7fbe164083,0x3f5695e53f13682a
.quad 0x3e47c5c200000000,0x3f0e39da3ec3ef15,0x3e54150100000000,0x3f15f6d93ecf7bca,0x3e605c1300000000,0x3f1d7fd13edae880,0x3e6c9a7f00000000,0x3f24d2253ee63375,0x3e78cfcc00000000,0x3f2beb4a3ef15aea,0x3e827dc000000000,0x3f32c8c93efc5d27,0x3e888e9300000000,0x3f3968423f039c3d,0x3e8e9a2200000000,0x3f3fc7673f08f59b
.quad 0x3e94a03100000000,0x3f45e4033f0e39da,0x3e9aa08600000000,0x3f4bbbf83f13682a,0x3ea09ae500000000,0x3f514d3d3f187fc0,0x3ea68f1200000000,0x3f5695e53f1d7fd1,0x3eac7cd400000000,0x3f5b941a3f226799,0x3eb263ef00000000,0x3f6046213f273656,0x3eb8442a00000000,0x3f64aa593f2beb4a,0x3ebe1d4a00000000,0x3f68bf3c3f3085bb
.quad 0x3f54db313f3504f3,0x3f7b14be3f6c835e,0x3f5d2d533f3daef9,0x3f7e70b03f731447,0x3f64aa593f45e403,0x3f7fec433f7853f8,0x3f6b4b0c3f4d9f02,0x3f7f84ab3f7c3b28,0x3f7109083f54db31,0x3f7d3aac3f7ec46d,0x3f75dec63f5b941a,0x3f7912983f7fec43,0x3f79c79d3f61c598,0x3f7314473f7fb10f,0x3f7cbfc93f676bd8,0x3f6b4b0c3f7e1324
.quad 0x3f7ec46d3f6c835e,0x3f61c5983f7b14be,0x3f7fd3973f710908,0x3f5695e53f76ba07,0x3f7fec433f74fa0b,0x3f49d1123f710908,0x3f7f0e583f7853f8,0x3f3b8f3b3f6a09a7,0x3f7d3aac3f7b14be,0x3f2beb4a3f61c598,0x3f7a73023f7d3aac,0x3f1b02c63f584853,0x3f76ba073f7ec46d,0x3f08f59b3f4d9f02,0x3f7213523f7fb10f,0x3eebcbbb3f41d870
.quad 0x3f7b14be3f800000,0x3f54db313f6c835e,0x3f740bdd3f7ec46d,0x3f3fc7673f5ebe05,0x3f6a09a73f7b14be,0x3f2736563f4d9f02,0x3f5d2d533f74fa0b,0x3f0b9a6b3f396842,0x3f4d9f023f6c835e,0x3edae8803f226799,0x3f3b8f3b3f61c598,0x3e9aa0863f08f59b,0x3f2736563f54db31,0x3e2f10a23edae880,0x3f10d3cd3f45e403,0x3d16c32c3ea09ae5
.quad 0x3ef15aea3f3504f3,0xbdc8bd363e47c5c2,0x3ebe1d4a3f226799,0xbe6c9a7f3d96a905,0x3e888e933f0e39da,0xbeb8442abd48fb30,0x3e22abb63ef15aea,0xbef6e0cbbe2f10a2,0x3d48fb303ec3ef15,0xbf187fc0be94a031,0xbd7b2b743e94a031,0xbf32c8c9becf7bca,0xbe2f10a23e47c5c2,0xbf49d112bf039c3d,0xbe8e9a223dc8bd36,0xbf5d2d53bf1d7fd1
.quad 0x3f0e39da3f3504f3,0x3e47c5c23ec3ef15,0x3ed536413f187fc0,0x3c490e903e605c13,0x3e888e933ef15aea,0xbe2f10a23d48fb30,0x3de1bc2e3eac7cd4,0xbeb263efbdfab273,0xbd48fb303e47c5c2,0xbf039c3dbe94a031,0xbe5415013d48fb30,0xbf299415bee63375,0xbeb8442abdc8bd36,0xbf49d112bf187fc0,0xbf00e7e4be78cfcc,0xbf633c5abf396842
.quad 0xbf226799bec3ef15,0xbf74fa0bbf54db31,0xbf3fc767bf039c3d,0xbf7e70b0bf6a09a7,0xbf584853bf226799,0xbf7f4e6dbf7853f8,0xbf6b4b0cbf3daef9,0xbf778bc5bf7f4e6d,0xbf7853f8bf54db31,0xbf676bd8bf7ec46d,0xbf7f0e58bf676bd8,0xbf4f7a1fbf76ba07,0xbf7f4e6dbf74fa0b,0xbf3085bbbf676bd8,0xbf791298bf7d3aac,0xbf0b9a6bbf514d3d
.quad 0x3f803f803f803f80,0x3f803f803f803f80,0x3f553f6d3f7b3f80,0xbf55bf6dbf7bbf80,0x3ec43f353f6d3f80,0x3ec43f353f6d3f80,0xbe483ec43f553f80,0x3e48bec4bf55bf80,0xbf3500003f353f80,0xbf3500003f353f80,0xbf7bbec43f0e3f80,0x3f7b3ec4bf0ebf80,0xbf6dbf353ec43f80,0xbf6dbf353ec43f80,0xbf0ebf6d3e483f80,0x3f0e3f6dbe48bf80
.quad 0xbf8000003f80,0xbf8000003f80,0x3f0ebf6dbe483f80,0xbf0e3f6d3e48bf80,0x3f6dbf35bec43f80,0x3f6dbf35bec43f80,0x3f7bbec4bf0e3f80,0xbf7b3ec43f0ebf80,0x3f350000bf353f80,0x3f350000bf353f80,0x3e483ec4bf553f80,0xbe48bec43f55bf80,0xbec43f35bf6d3f80,0xbec43f35bf6d3f80,0xbf553f6dbf7b3f80,0x3f55bf6d3f7bbf80
.quad 0x3f803f803f803f80,0x3f803f803f803f80,0x3e483ec43f0e3f35,0xbe48bec4bf0ebf35,0xbf6dbf35bec40000,0xbf6dbf35bec40000,0xbf0ebf6dbf7bbf35,0x3f0e3f6d3f7b3f35,0x3f350000bf35bf80,0x3f350000bf35bf80,0x3f553f6d3e48bf35,0xbf55bf6dbe483f35,0xbec43f353f6d0000,0xbec43f353f6d0000,0xbf7bbec43f553f35,0x3f7b3ec4bf55bf35
.quad 0xbf8000003f80,0xbf8000003f80,0x3f7bbec4bf553f35,0xbf7b3ec43f55bf35,0x3ec43f35bf6d0000,0x3ec43f35bf6d0000,0xbf553f6dbe48bf35,0x3f55bf6d3e483f35,0xbf3500003f35bf80,0xbf3500003f35bf80,0x3f0ebf6d3f7bbf35,0xbf0e3f6dbf7b3f35,0x3f6dbf353ec40000,0x3f6dbf353ec40000,0xbe483ec4bf0e3f35,0x3e48bec43f0ebf35
.quad 0x3f803f803f803f80,0x3f803f803f803f80,0xbf0ebec4be480000,0x3f0e3ec43e480000,0xbec4bf35bf6dbf80,0xbec4bf35bf6dbf80,0x3f7b3f6d3f0e0000,0xbf7bbf6dbf0e0000,0xbf3500003f353f80,0xbf3500003f353f80,0xbe48bf6dbf550000,0x3e483f6d3f550000,0x3f6d3f35bec4bf80,0x3f6d3f35bec4bf80,0xbf553ec43f7b0000,0x3f55bec4bf7b0000
.quad 0xbf8000003f80,0xbf8000003f80,0x3f553ec4bf7b0000,0xbf55bec43f7b0000,0xbf6d3f353ec4bf80,0xbf6d3f353ec4bf80,0x3e48bf6d3f550000,0xbe483f6dbf550000,0x3f350000bf353f80,0x3f350000bf353f80,0xbf7b3f6dbf0e0000,0x3f7bbf6d3f0e0000,0x3ec4bf353f6dbf80,0x3ec4bf353f6dbf80,0x3f0ebec43e480000,0xbf0e3ec4be480000
.quad 0x3f803f803f803f80,0x3f803f803f803f80,0xbf7bbf6dbf55bf35,0x3f7b3f6d3f553f35,0x3f6d3f353ec40000,0x3f6d3f353ec40000,0xbf55bec43e483f35,0x3f553ec4be48bf35,0x3f350000bf35bf80,0x3f350000bf35bf80,0xbf0e3ec43f7b3f35,0x3f0ebec4bf7bbf35,0x3ec4bf35bf6d0000,0x3ec4bf35bf6d0000,0xbe483f6d3f0ebf35,0x3e48bf6dbf0e3f35
.quad 0xbf8000003f80,0xbf8000003f80,0x3e483f6dbf0ebf35,0xbe48bf6d3f0e3f35,0xbec4bf353f6d0000,0xbec4bf353f6d0000,0x3f0e3ec4bf7b3f35,0xbf0ebec43f7bbf35,0xbf3500003f35bf80,0xbf3500003f35bf80,0x3f55bec4be483f35,0xbf553ec43e48bf35,0xbf6d3f35bec40000,0xbf6d3f35bec40000,0x3f7bbf6d3f55bf35,0xbf7b3f6dbf553f35
.quad 0x8000800080008000,0x8000800080008000,0xbf0ebec4be488000,0x3f0e3ec43e488000,0xbf6dbf35bec48000,0xbf6dbf35bec48000,0xbf7bbf6dbf0e8000,0x3f7b3f6d3f0e8000,0xbf35bf80bf358000,0xbf35bf80bf358000,0xbe48bf6dbf558000,0x3e483f6d3f558000,0x3ec4bf35bf6d8000,0x3ec4bf35bf6d8000,0x3f55bec4bf7b8000,0xbf553ec43f7b8000
.quad 0x3f808000bf808000,0x3f808000bf808000,0x3f553ec4bf7b8000,0xbf55bec43f7b8000,0x3ec43f35bf6d8000,0x3ec43f35bf6d8000,0xbe483f6dbf558000,0x3e48bf6d3f558000,0xbf353f80bf358000,0xbf353f80bf358000,0xbf7b3f6dbf0e8000,0x3f7bbf6d3f0e8000,0xbf6d3f35bec48000,0xbf6d3f35bec48000,0xbf0e3ec4be488000,0x3f0ebec43e488000
.quad 0x8000800080008000,0x8000800080008000,0xbf7bbf6dbf55bf35,0x3f7b3f6d3f553f35,0xbec4bf35bf6dbf80,0xbec4bf35bf6dbf80,0x3f553ec4be48bf35,0xbf55bec43e483f35,0x3f353f803f358000,0x3f353f803f358000,0xbf0e3ec43f7b3f35,0x3f0ebec4bf7bbf35,0xbf6dbf353ec43f80,0xbf6dbf353ec43f80,0x3e48bf6dbf0e3f35,0xbe483f6d3f0ebf35
.quad 0x3f808000bf808000,0x3f808000bf808000,0x3e483f6dbf0ebf35,0xbe48bf6d3f0e3f35,0xbf6d3f353ec4bf80,0xbf6d3f353ec4bf80,0xbf0ebec43f7bbf35,0x3f0e3ec4bf7b3f35,0x3f35bf803f358000,0x3f35bf803f358000,0x3f55bec4be483f35,0xbf553ec43e48bf35,0xbec43f35bf6d3f80,0xbec43f35bf6d3f80,0xbf7b3f6dbf553f35,0x3f7bbf6d3f55bf35
.quad 0x8000800080008000,0x8000800080008000,0xbf55bf6dbf7bbf80,0x3f553f6d3f7b3f80,0x3f6d3f353ec48000,0x3f6d3f353ec48000,0xbe483ec43f553f80,0x3e48bec4bf55bf80,0xbf35bf80bf358000,0xbf35bf80bf358000,0x3f7b3ec4bf0ebf80,0xbf7bbec43f0e3f80,0xbec43f353f6d8000,0xbec43f353f6d8000,0xbf0ebf6d3e483f80,0x3f0e3f6dbe48bf80
.quad 0x3f808000bf808000,0x3f808000bf808000,0xbf0e3f6d3e48bf80,0x3f0ebf6dbe483f80,0xbec4bf353f6d8000,0xbec4bf353f6d8000,0x3f7bbec4bf0e3f80,0xbf7b3ec43f0ebf80,0xbf353f80bf358000,0xbf353f80bf358000,0xbe48bec43f55bf80,0x3e483ec4bf553f80,0x3f6dbf353ec48000,0x3f6dbf353ec48000,0xbf553f6dbf7b3f80,0x3f55bf6d3f7bbf80
.quad 0x8000800080008000,0x8000800080008000,0xbe48bec4bf0ebf35,0x3e483ec43f0e3f35,0x3ec43f353f6d3f80,0x3ec43f353f6d3f80,0xbf0ebf6dbf7bbf35,0x3f0e3f6d3f7b3f35,0x3f353f803f358000,0x3f353f803f358000,0xbf55bf6dbe483f35,0x3f553f6d3e48bf35,0x3f6d3f35bec4bf80,0x3f6d3f35bec4bf80,0xbf7bbec43f553f35,0x3f7b3ec4bf55bf35
.quad 0x3f808000bf808000,0x3f808000bf808000,0xbf7b3ec43f55bf35,0x3f7bbec4bf553f35,0x3f6dbf35bec43f80,0x3f6dbf35bec43f80,0xbf553f6dbe48bf35,0x3f55bf6d3e483f35,0x3f35bf803f358000,0x3f35bf803f358000,0xbf0e3f6dbf7b3f35,0x3f0ebf6d3f7bbf35,0x3ec4bf353f6dbf80,0x3ec4bf353f6dbf80,0xbe483ec4bf0e3f35,0x3e48bec43f0ebf35
.quad 0x3f8000003f800000,0x3f8000003f800000,0x3f7ffb113f800000,0x3f7fd3973f7fec43,0x3f7fec433f800000,0x3f7f4e6d3f7fb10f,0x3f7fd3973f800000,0x3f7e70b03f7f4e6d,0x3f7fb10f3f800000,0x3f7d3aac3f7ec46d,0x3f7f84ab3f800000,0x3f7baccd3f7e1324,0x3f7f4e6d3f800000,0x3f79c79d3f7d3aac,0x3f7f0e583f800000,0x3f778bc53f7c3b28
.quad 0x3f7ec46d3f800000,0x3f74fa0b3f7b14be,0x3f7e70b03f800000,0x3f7213523f79c79d,0x3f7e13243f800000,0x3f6ed89e3f7853f8,0x3f7dabcc3f800000,0x3f6b4b0c3f76ba07,0x3f7d3aac3f800000,0x3f676bd83f74fa0b,0x3f7cbfc93f800000,0x3f633c5a3f731447,0x3f7c3b283f800000,0x3f5ebe053f710908,0x3f7baccd3f800000,0x3f59f26a3f6ed89e
.quad 0x3f8000003f800000,0x3f8000003f800000,0x3f7f84ab3f7fb10f,0x3f7f0e583f7f4e6d,0x3f7e13243f7ec46d,0x3f7c3b283f7d3aac,0x3f7baccd3f7d3aac,0x3f778bc53f79c79d,0x3f7853f83f7b14be,0x3f7109083f74fa0b,0x3f740bdd3f7853f8,0x3f68bf3c3f6ed89e,0x3f6ed89e3f74fa0b,0x3f5ebe053f676bd8,0x3f68bf3c3f710908,0x3f5318493f5ebe05
.quad 0x3f61c5983f6c835e,0x3f45e4033f54db31,0x3f59f26a3f676bd8,0x3f373a233f49d112,0x3f514d3d3f61c598,0x3f2736563f3daef9,0x3f47de653f5b941a,0x3f15f6d93f3085bb,0x3f3daef93f54db31,0x3f039c3d3f226799,0x3f32c8c93f4d9f02,0x3ee0924f3f13682a,0x3f2736563f45e403,0x3eb8442a3f039c3d,0x3f1b02c63f3daef9,0x3e8e9a223ee63375
.quad 0x3f8000003f800000,0x3f8000003f800000,0x3f7e70b03f7ec46d,0x3f7dabcc3f7e1324,0x3f79c79d3f7b14be,0x3f76ba073f7853f8,0x3f7213523f74fa0b,0x3f6b4b0c3f6ed89e,0x3f676bd83f6c835e,0x3f5b941a3f61c598,0x3f59f26a3f61c598,0x3f47de653f514d3d,0x3f49d1123f54db31,0x3f3085bb3f3daef9,0x3f373a233f45e403,0x3f15f6d93f273656
.quad 0x3f2267993f3504f3,0x3ef15aea3f0e39da,0x3f0b9a6b3f226799,0x3eb263ef3ee63375,0x3ee633753f0e39da,0x3e605c133eac7cd4,0x3eb263ef3ef15aea,0x3dafb6803e605c13,0x3e78cfcc3ec3ef15,0xbd48fb303dc8bd36,0x3e09cf863e94a031,0xbe3b6ecfbcc90ab0,0x3cc90ab03e47c5c2,0xbea09ae5be164083,0xbdafb6803dc8bd36,0xbee0924fbe888e93
.quad 0x3f8000003f800000,0x3f8000003f800000,0x3f7cbfc93f7d3aac,0x3f7baccd3f7c3b28,0x3f7314473f74fa0b,0x3f6ed89e3f710908,0x3f633c5a3f676bd8,0x3f59f26a3f5ebe05,0x3f4d9f023f54db31,0x3f3daef93f45e403,0x3f32c8c93f3daef9,0x3f1b02c63f273656,0x3f13682a3f226799,0x3ee633753f039c3d,0x3ee0924f3f039c3d,0x3e8e9a223eb8442a
.quad 0x3e94a0313ec3ef15,0x3dc8bd363e47c5c2,0x3e09cf863e78cfcc,0xbdafb6803cc90ab0,0xbcc90ab03dc8bd36,0xbe888e93be164083,0xbe3b6ecfbd48fb30,0xbee0924fbea09ae5,0xbeac7cd4be47c5c2,0xbf187fc0bef15aea,0xbef6e0cbbeac7cd4,0xbf3b8f3bbf1d7fd1,0xbf1d7fd1bef15aea,0xbf584853bf3daef9,0xbf3b8f3bbf187fc0,0xbf6db293bf584853
.quad 0,0,0x3c490e9000000000,0x3d16c32c3cc90ab0,0x3cc90ab000000000,0x3d96a9053d48fb30,0x3d16c32c00000000,0x3de1bc2e3d96a905,0x3d48fb3000000000,0x3e1640833dc8bd36,0x3d7b2b7400000000,0x3e3b6ecf3dfab273,0x3d96a90500000000,0x3e605c133e164083,0x3dafb68000000000,0x3e827dc03e2f10a2
.quad 0x3dc8bd3600000000,0x3e94a0313e47c5c2,0x3de1bc2e00000000,0x3ea68f123e605c13,0x3dfab27300000000,0x3eb8442a3e78cfcc,0x3e09cf8600000000,0x3ec9b9533e888e93,0x3e16408300000000,0x3edae8803e94a031,0x3e22abb600000000,0x3eebcbbb3ea09ae5,0x3e2f10a200000000,0x3efc5d273eac7cd4,0x3e3b6ecf00000000,0x3f064b823eb8442a
.quad 0,0,0x3d7b2b743d48fb30,0x3dafb6803d96a905,0x3dfab2733dc8bd36,0x3e2f10a23e164083,0x3e3b6ecf3e164083,0x3e827dc03e605c13,0x3e78cfcc3e47c5c2,0x3eac7cd43e94a031,0x3e9aa0863e78cfcc,0x3ed536413eb8442a,0x3eb8442a3e94a031,0x3efc5d273edae880,0x3ed536413eac7cd4,0x3f10d3cd3efc5d27
.quad 0x3ef15aea3ec3ef15,0x3f2267993f0e39da,0x3f064b823edae880,0x3f32c8c93f1d7fd1,0x3f13682a3ef15aea,0x3f41d8703f2beb4a,0x3f1ff6cb3f039c3d,0x3f4f7a1f3f396842,0x3f2beb4a3f0e39da,0x3f5b941a3f45e403,0x3f373a233f187fc0,0x3f660f883f514d3d,0x3f41d8703f226799,0x3f6ed89e3f5b941a,0x3f4bbbf83f2beb4a,0x3f75dec63f64aa59
.quad 0,0,0x3de1bc2e3dc8bd36,0x3e09cf863dfab273,0x3e605c133e47c5c2,0x3e888e933e78cfcc,0x3ea68f123e94a031,0x3ec9b9533eb8442a,0x3edae8803ec3ef15,0x3f039c3d3ef15aea,0x3f064b823ef15aea,0x3f1ff6cb3f13682a,0x3f1d7fd13f0e39da,0x3f3968423f2beb4a,0x3f32c8c93f226799,0x3f4f7a1f3f41d870
.quad 0x3f45e4033f3504f3,0x3f61c5983f54db31,0x3f5695e53f45e403,0x3f6ff5733f64aa59,0x3f64aa593f54db31,0x3f79c79d3f710908,0x3f6ff5733f61c598,0x3f7f0e583f79c79d,0x3f7853f83f6c835e,0x3f7fb10f3f7ec46d,0x3f7dabcc3f74fa0b,0x3f7baccd3f7fec43,0x3f7fec433f7b14be,0x3f7314473f7d3aac,0x3f7f0e583f7ec46d,0x3f660f883f76ba07
.quad 0,0,0x3e22abb63e164083,0x3e3b6ecf3e2f10a2,0x3ea09ae53e94a031,0x3eb8442a3eac7cd4,0x3eebcbbb3edae880,0x3f064b823efc5d27,0x3f187fc03f0e39da,0x3f2beb4a3f226799,0x3f373a233f2beb4a,0x3f4bbbf83f41d870,0x3f514d3d3f45e403,0x3f64aa593f5b941a,0x3f660f883f5b941a,0x3f75dec63f6ed89e
.quad 0x3f74fa0b3f6c835e,0x3f7ec46d3f7b14be,0x3f7dabcc3f7853f8,0x3f7f0e583f7fec43,0x3f7fec433f7ec46d,0x3f76ba073f7d3aac,0x3f7baccd3f7fb10f,0x3f660f883f731447,0x3f7109083f7b14be,0x3f4d9f023f61c598,0x3f6046213f710908,0x3f2e3bde3f49d112,0x3f49d1123f61c598,0x3f08f59b3f2beb4a,0x3f2e3bde3f4d9f02,0x3ebe1d4a3f08f59b
.quad 0xc0008000400000,0x1c0018001400100,0xc2008200420002,0x1c2018201420102,0xc4008400440004,0x1c4018401440104,0xc6008600460006,0x1c6018601460106,0xc8008800480008,0x1c8018801480108,0xca008a004a000a,0x1ca018a014a010a,0xcc008c004c000c,0x1cc018c014c010c,0xce008e004e000e,0x1ce018e014e010e
.quad 0xd0009000500010,0x1d0019001500110,0xd2009200520012,0x1d2019201520112,0xd4009400540014,0x1d4019401540114,0xd6009600560016,0x1d6019601560116,0xd8009800580018,0x1d8019801580118,0xda009a005a001a,0x1da019a015a011a,0xdc009c005c001c,0x1dc019c015c011c,0xde009e005e001e,0x1de019e015e011e
.quad 0x2c0028002400200,0x3c0038003400300,0x2c0028002400200,0x3c0038003400300,0x2c4028402440204,0x3c4038403440304,0x2c8028802480208,0x3c8038803480308,0x2c8028802480208,0x3c8038803480308,0x2c8028802480208,0x3c8038803480308,0x2cc028c024c020c,0x3cc038c034c030c,0x2d0029002500210,0x3d0039003500310
.quad 0x2d0029002500210,0x3d0039003500310,0x2d0029002500210,0x3d0039003500310,0x2d4029402540214,0x3d4039403540314,0x2d8029802580218,0x3d8039803580318,0x2d8029802580218,0x3d8039803580318,0x2d8029802580218,0x3d8039803580318,0x2dc029c025c021c,0x3dc039c035c031c,0x2e002a002600220,0x3e003a003600320
.quad 0x430042004100400,0x470046004500440,0x430042004100400,0x470046004500440,0x430042004100400,0x470046004500440,0x432042204120402,0x472046204520442,0x432042204120402,0x472046204520442,0x432042204120402,0x472046204520442,0x434042404140404,0x474046404540444,0x434042404140404,0x474046404540444
.quad 0x434042404140404,0x474046404540444,0x434042404140404,0x474046404540444,0x434042404140404,0x474046404540444,0x436042604160406,0x476046604560446,0x436042604160406,0x476046604560446,0x436042604160406,0x476046604560446,0x438042804180408,0x478046804580448,0x438042804180408,0x478046804580448
.quad 0x4b004a004900480,0x4f004e004d004c0,0x4b004a004900480,0x4f004e004d004c0,0x4b004a004900480,0x4f004e004d004c0,0x4b204a204920482,0x4f204e204d204c2,0x4b204a204920482,0x4f204e204d204c2,0x4b204a204920482,0x4f204e204d204c2,0x4b404a404940484,0x4f404e404d404c4,0x4b404a404940484,0x4f404e404d404c4
.quad 0x4b404a404940484,0x4f404e404d404c4,0x4b404a404940484,0x4f404e404d404c4,0x4b404a404940484,0x4f404e404d404c4,0x4b604a604960486,0x4f604e604d604c6,0x4b604a604960486,0x4f604e604d604c6,0x4b604a604960486,0x4f604e604d604c6,0x4b804a804980488,0x4f804e804d804c8,0x4b804a804980488,0x4f804e804d804c8
.quad 0xe000a000600020,0x1e001a001600120,0xe200a200620022,0x1e201a201620122,0xe400a400640024,0x1e401a401640124,0xe600a600660026,0x1e601a601660126,0xe800a800680028,0x1e801a801680128,0xea00aa006a002a,0x1ea01aa016a012a,0xec00ac006c002c,0x1ec01ac016c012c,0xee00ae006e002e,0x1ee01ae016e012e
.quad 0xf000b000700030,0x1f001b001700130,0xf200b200720032,0x1f201b201720132,0xf400b400740034,0x1f401b401740134,0xf600b600760036,0x1f601b601760136,0xf800b800780038,0x1f801b801780138,0xfa00ba007a003a,0x1fa01ba017a013a,0xfc00bc007c003c,0x1fc01bc017c013c,0xfe00be007e003e,0x1fe01be017e013e
.quad 0x2e002a002600220,0x3e003a003600320,0x2e002a002600220,0x3e003a003600320,0x2e402a402640224,0x3e403a403640324,0x2e802a802680228,0x3e803a803680328,0x2e802a802680228,0x3e803a803680328,0x2e802a802680228,0x3e803a803680328,0x2ec02ac026c022c,0x3ec03ac036c032c,0x2f002b002700230,0x3f003b003700330
.quad 0x2f002b002700230,0x3f003b003700330,0x2f002b002700230,0x3f003b003700330,0x2f402b402740234,0x3f403b403740334,0x2f802b802780238,0x3f803b803780338,0x2f802b802780238,0x3f803b803780338,0x2f802b802780238,0x3f803b803780338,0x2fc02bc027c023c,0x3fc03bc037c033c,0x30002c002800240,0x40003c003800340
.quad 0x438042804180408,0x478046804580448,0x438042804180408,0x478046804580448,0x438042804180408,0x478046804580448,0x43a042a041a040a,0x47a046a045a044a,0x43a042a041a040a,0x47a046a045a044a,0x43a042a041a040a,0x47a046a045a044a,0x43c042c041c040c,0x47c046c045c044c,0x43c042c041c040c,0x47c046c045c044c
.quad 0x43c042c041c040c,0x47c046c045c044c,0x43c042c041c040c,0x47c046c045c044c,0x43c042c041c040c,0x47c046c045c044c,0x43e042e041e040e,0x47e046e045e044e,0x43e042e041e040e,0x47e046e045e044e,0x43e042e041e040e,0x47e046e045e044e,0x440043004200410,0x480047004600450,0x440043004200410,0x480047004600450
.quad 0x4b804a804980488,0x4f804e804d804c8,0x4b804a804980488,0x4f804e804d804c8,0x4b804a804980488,0x4f804e804d804c8,0x4ba04aa049a048a,0x4fa04ea04da04ca,0x4ba04aa049a048a,0x4fa04ea04da04ca,0x4ba04aa049a048a,0x4fa04ea04da04ca,0x4bc04ac049c048c,0x4fc04ec04dc04cc,0x4bc04ac049c048c,0x4fc04ec04dc04cc
.quad 0x4bc04ac049c048c,0x4fc04ec04dc04cc,0x4bc04ac049c048c,0x4fc04ec04dc04cc,0x4bc04ac049c048c,0x4fc04ec04dc04cc,0x4be04ae049e048e,0x4fe04ee04de04ce,0x4be04ae049e048e,0x4fe04ee04de04ce,0x4be04ae049e048e,0x4fe04ee04de04ce,0x4c004b004a00490,0x50004f004e004d0,0x4c004b004a00490,0x50004f004e004d0
.quad 0xbf803f80bf803f80,0xbf803f80bf803f80,0xbf553f6dbf7b3f80,0x3f55bf6d3f7bbf80,0xbec43f35bf6d3f80,0xbec43f35bf6d3f80,0x3e483ec4bf553f80,0xbe48bec43f55bf80,0x3f350000bf353f80,0x3f350000bf353f80,0x3f7bbec4bf0e3f80,0xbf7b3ec43f0ebf80,0x3f6dbf35bec43f80,0x3f6dbf35bec43f80,0x3f0ebf6dbe483f80,0xbf0e3f6d3e48bf80
.quad 0xbf8000003f80,0xbf8000003f80,0xbf0ebf6d3e483f80,0x3f0e3f6dbe48bf80,0xbf6dbf353ec43f80,0xbf6dbf353ec43f80,0xbf7bbec43f0e3f80,0x3f7b3ec4bf0ebf80,0xbf3500003f353f80,0xbf3500003f353f80,0xbe483ec43f553f80,0x3e48bec4bf55bf80,0x3ec43f353f6d3f80,0x3ec43f353f6d3f80,0x3f553f6d3f7b3f80,0xbf55bf6dbf7bbf80
.quad 0xbf803f80bf803f80,0xbf803f80bf803f80,0xbe483ec4bf0e3f35,0x3e48bec43f0ebf35,0x3f6dbf353ec40000,0x3f6dbf353ec40000,0x3f0ebf6d3f7bbf35,0xbf0e3f6dbf7b3f35,0xbf3500003f35bf80,0xbf3500003f35bf80,0xbf553f6dbe48bf35,0x3f55bf6d3e483f35,0x3ec43f35bf6d0000,0x3ec43f35bf6d0000,0x3f7bbec4bf553f35,0xbf7b3ec43f55bf35
.quad 0xbf8000003f80,0xbf8000003f80,0xbf7bbec43f553f35,0x3f7b3ec4bf55bf35,0xbec43f353f6d0000,0xbec43f353f6d0000,0x3f553f6d3e48bf35,0xbf55bf6dbe483f35,0x3f350000bf35bf80,0x3f350000bf35bf80,0xbf0ebf6dbf7bbf35,0x3f0e3f6d3f7b3f35,0xbf6dbf35bec40000,0xbf6dbf35bec40000,0x3e483ec43f0e3f35,0xbe48bec4bf0ebf35
.quad 0xbf803f80bf803f80,0xbf803f80bf803f80,0x3f0ebec43e480000,0xbf0e3ec4be480000,0x3ec4bf353f6dbf80,0x3ec4bf353f6dbf80,0xbf7b3f6dbf0e0000,0x3f7bbf6d3f0e0000,0x3f350000bf353f80,0x3f350000bf353f80,0x3e48bf6d3f550000,0xbe483f6dbf550000,0xbf6d3f353ec4bf80,0xbf6d3f353ec4bf80,0x3f553ec4bf7b0000,0xbf55bec43f7b0000
.quad 0xbf8000003f80,0xbf8000003f80,0xbf553ec43f7b0000,0x3f55bec4bf7b0000,0x3f6d3f35bec4bf80,0x3f6d3f35bec4bf80,0xbe48bf6dbf550000,0x3e483f6d3f550000,0xbf3500003f353f80,0xbf3500003f353f80,0x3f7b3f6d3f0e0000,0xbf7bbf6dbf0e0000,0xbec4bf35bf6dbf80,0xbec4bf35bf6dbf80,0xbf0ebec4be480000,0x3f0e3ec43e480000
.quad 0xbf803f80bf803f80,0xbf803f80bf803f80,0x3f7bbf6d3f55bf35,0xbf7b3f6dbf553f35,0xbf6d3f35bec40000,0xbf6d3f35bec40000,0x3f55bec4be483f35,0xbf553ec43e48bf35,0xbf3500003f35bf80,0xbf3500003f35bf80,0x3f0e3ec4bf7b3f35,0xbf0ebec43f7bbf35,0xbec4bf353f6d0000,0xbec4bf353f6d0000,0x3e483f6dbf0ebf35,0xbe48bf6d3f0e3f35
.quad 0xbf8000003f80,0xbf8000003f80,0xbe483f6d3f0ebf35,0x3e48bf6dbf0e3f35,0x3ec4bf35bf6d0000,0x3ec4bf35bf6d0000,0xbf0e3ec43f7b3f35,0x3f0ebec4bf7bbf35,0x3f350000bf35bf80,0x3f350000bf35bf80,0xbf55bec43e483f35,0x3f553ec4be48bf35,0x3f6d3f353ec40000,0x3f6d3f353ec40000,0xbf7bbf6dbf55bf35,0x3f7b3f6d3f553f35
.quad 0x8000800080008000,0x8000800080008000,0x3f0ebec43e488000,0xbf0e3ec4be488000,0x3f6dbf353ec48000,0x3f6dbf353ec48000,0x3f7bbf6d3f0e8000,0xbf7b3f6dbf0e8000,0x3f35bf803f358000,0x3f35bf803f358000,0x3e48bf6d3f558000,0xbe483f6dbf558000,0xbec4bf353f6d8000,0xbec4bf353f6d8000,0xbf55bec43f7b8000,0x3f553ec4bf7b8000
.quad 0xbf8080003f808000,0xbf8080003f808000,0xbf553ec43f7b8000,0x3f55bec4bf7b8000,0xbec43f353f6d8000,0xbec43f353f6d8000,0x3e483f6d3f558000,0xbe48bf6dbf558000,0x3f353f803f358000,0x3f353f803f358000,0x3f7b3f6d3f0e8000,0xbf7bbf6dbf0e8000,0x3f6d3f353ec48000,0x3f6d3f353ec48000,0x3f0e3ec43e488000,0xbf0ebec4be488000
.quad 0x8000800080008000,0x8000800080008000,0x3f7bbf6d3f55bf35,0xbf7b3f6dbf553f35,0x3ec4bf353f6dbf80,0x3ec4bf353f6dbf80,0xbf553ec43e48bf35,0x3f55bec4be483f35,0xbf353f80bf358000,0xbf353f80bf358000,0x3f0e3ec4bf7b3f35,0xbf0ebec43f7bbf35,0x3f6dbf35bec43f80,0x3f6dbf35bec43f80,0xbe48bf6d3f0e3f35,0x3e483f6dbf0ebf35
.quad 0xbf8080003f808000,0xbf8080003f808000,0xbe483f6d3f0ebf35,0x3e48bf6dbf0e3f35,0x3f6d3f35bec4bf80,0x3f6d3f35bec4bf80,0x3f0ebec4bf7bbf35,0xbf0e3ec43f7b3f35,0xbf35bf80bf358000,0xbf35bf80bf358000,0xbf55bec43e483f35,0x3f553ec4be48bf35,0x3ec43f353f6d3f80,0x3ec43f353f6d3f80,0x3f7b3f6d3f553f35,0xbf7bbf6dbf55bf35
.quad 0x8000800080008000,0x8000800080008000,0x3f55bf6d3f7bbf80,0xbf553f6dbf7b3f80,0xbf6d3f35bec48000,0xbf6d3f35bec48000,0x3e483ec4bf553f80,0xbe48bec43f55bf80,0x3f35bf803f358000,0x3f35bf803f358000,0xbf7b3ec43f0ebf80,0x3f7bbec4bf0e3f80,0x3ec43f35bf6d8000,0x3ec43f35bf6d8000,0x3f0ebf6dbe483f80,0xbf0e3f6d3e48bf80
.quad 0xbf8080003f808000,0xbf8080003f808000,0x3f0e3f6dbe48bf80,0xbf0ebf6d3e483f80,0x3ec4bf35bf6d8000,0x3ec4bf35bf6d8000,0xbf7bbec43f0e3f80,0x3f7b3ec4bf0ebf80,0x3f353f803f358000,0x3f353f803f358000,0x3e48bec4bf55bf80,0xbe483ec43f553f80,0xbf6dbf35bec48000,0xbf6dbf35bec48000,0x3f553f6d3f7b3f80,0xbf55bf6dbf7bbf80
.quad 0x8000800080008000,0x8000800080008000,0x3e48bec43f0ebf35,0xbe483ec4bf0e3f35,0xbec43f35bf6d3f80,0xbec43f35bf6d3f80,0x3f0ebf6d3f7bbf35,0xbf0e3f6dbf7b3f35,0xbf353f80bf358000,0xbf353f80bf358000,0x3f55bf6d3e483f35,0xbf553f6dbe48bf35,0xbf6d3f353ec4bf80,0xbf6d3f353ec4bf80,0x3f7bbec4bf553f35,0xbf7b3ec43f55bf35
.quad 0xbf8080003f808000,0xbf8080003f808000,0x3f7b3ec4bf55bf35,0xbf7bbec43f553f35,0xbf6dbf353ec43f80,0xbf6dbf353ec43f80,0x3f553f6d3e48bf35,0xbf55bf6dbe483f35,0xbf35bf80bf358000,0xbf35bf80bf358000,0x3f0e3f6d3f7b3f35,0xbf0ebf6dbf7bbf35,0xbec4bf35bf6dbf80,0xbec4bf35bf6dbf80,0x3e483ec43f0e3f35,0xbe48bec4bf0ebf35
.quad 0x3f7b14be3f800000,0x3f54db313f6c835e,0x3f7a73023f800000,0x3f4f7a1f3f6a09a7,0x3f79c79d3f800000,0x3f49d1123f676bd8,0x3f7912983f800000,0x3f43e2003f64aa59,0x3f7853f83f800000,0x3f3daef93f61c598,0x3f778bc53f800000,0x3f373a233f5ebe05,0x3f76ba073f800000,0x3f3085bb3f5b941a,0x3f75dec63f800000,0x3f2994153f584853
.quad 0x3f74fa0b3f800000,0x3f2267993f54db31,0x3f740bdd3f800000,0x3f1b02c63f514d3d,0x3f7314473f800000,0x3f13682a3f4d9f02,0x3f7213523f800000,0x3f0b9a6b3f49d112,0x3f7109083f800000,0x3f039c3d3f45e403,0x3f6ff5733f800000,0x3ef6e0cb3f41d870,0x3f6ed89e3f800000,0x3ee633753f3daef9,0x3f6db2933f800000,0x3ed536413f396842
.quad 0x3f0e39da3f3504f3,0x3e47c5c23ec3ef15,0x3f00e7e43f2beb4a,0x3de1bc2e3ea09ae5,0x3ee633753f226799,0x3cc90ab03e78cfcc,0x3ec9b9533f187fc0,0xbd7b2b743e2f10a2,0x3eac7cd43f0e39da,0xbe1640833dc8bd36,0x3e8e9a223f039c3d,0xbe6c9a7f3cc90ab0,0x3e605c133ef15aea,0xbea09ae5bd48fb30,0x3e22abb63edae880,0xbec9b953bdfab273
.quad 0x3dc8bd363ec3ef15,0xbef15aeabe47c5c2,0x3d16c32c3eac7cd4,0xbf0b9a6bbe888e93,0xbcc90ab03e94a031,0xbf1d7fd1beac7cd4,0xbdafb6803e78cfcc,0xbf2e3bdebecf7bca,0xbe1640833e47c5c2,0xbf3daef9bef15aea,0xbe5415013e164083,0xbf4bbbf8bf08f59b,0xbe888e933dc8bd36,0xbf584853bf187fc0,0xbea68f123d48fb30,0xbf633c5abf273656
.quad 0xbe47c5c200000000,0xbf0e39dabec3ef15,0xbe9aa086bdc8bd36,0xbf299415befc5d27,0xbecf7bcabe47c5c2,0xbf41d870bf187fc0,0xbf00e7e4be94a031,0xbf5695e5bf3085bb,0xbf187fc0bec3ef15,0xbf676bd8bf45e403,0xbf2e3bdebef15aea,0xbf740bddbf584853,0xbf41d870bf0e39da,0xbf7c3b28bf676bd8,0xbf531849bf226799,0xbf7fd397bf731447
.quad 0xbf61c598bf3504f3,0xbf7ec46dbf7b14be,0xbf6db293bf45e403,0xbf791298bf7f4e6d,0xbf76ba07bf54db31,0xbf6ed89ebf7fb10f,0xbf7cbfc9bf61c598,0xbf604621bf7c3b28,0xbf7fb10fbf6c835e,0xbf4d9f02bf74fa0b,0xbf7f84abbf74fa0b,0xbf373a23bf6a09a7,0xbf7c3b28bf7b14be,0xbf1d7fd1bf5b941a,0xbf75dec6bf7ec46d,0xbf00e7e4bf49d112
.quad 0xbf54db31bf3504f3,0xbf7b14bebf6c835e,0xbf68bf3cbf4d9f02,0xbf7ffb11bf79c79d,0xbf76ba07bf61c598,0xbf7c3b28bf7fb10f,0xbf7e70b0bf710908,0xbf6ff573bf7e1324,0xbf7fb10fbf7b14be,0xbf5b941abf74fa0b,0xbf7a7302bf7fb10f,0xbf3fc767bf64aa59,0xbf6ed89ebf7ec46d,0xbf1d7fd1bf4d9f02,0xbf5d2d53bf7853f8,0xbeebcbbbbf3085bb
.quad 0xbf45e403bf6c835e,0xbe94a031bf0e39da,0xbf299415bf5b941a,0xbde1bc2ebecf7bca,0xbf08f59bbf45e403,0x3d96a905be78cfcc,0xbec9b953bf2beb4a,0x3e827dc0bd96a905,0xbe78cfccbf0e39da,0x3edae8803dc8bd36,0xbdafb680bedae880,0x3f15f6d93e888e93,0x3d96a905be94a031,0x3f3968423edae880,0x3e6c9a7fbe164083,0x3f5695e53f13682a
.quad 0x3e47c5c200000000,0x3f0e39da3ec3ef15,0x3e54150100000000,0x3f15f6d93ecf7bca,0x3e605c1300000000,0x3f1d7fd13edae880,0x3e6c9a7f00000000,0x3f24d2253ee63375,0x3e78cfcc00000000,0x3f2beb4a3ef15aea,0x3e827dc000000000,0x3f32c8c93efc5d27,0x3e888e9300000000,0x3f3968423f039c3d,0x3e8e9a2200000000,0x3f3fc7673f08f59b
.quad 0x3e94a03100000000,0x3f45e4033f0e39da,0x3e9aa08600000000,0x3f4bbbf83f13682a,0x3ea09ae500000000,0x3f514d3d3f187fc0,0x3ea68f1200000000,0x3f5695e53f1d7fd1,0x3eac7cd400000000,0x3f5b941a3f226799,0x3eb263ef00000000,0x3f6046213f273656,0x3eb8442a00000000,0x3f64aa593f2beb4a,0x3ebe1d4a00000000,0x3f68bf3c3f3085bb
.quad 0x3f54db313f3504f3,0x3f7b14be3f6c835e,0x3f5d2d533f3daef9,0x3f7e70b03f731447,0x3f64aa593f45e403,0x3f7fec433f7853f8,0x3f6b4b0c3f4d9f02,0x3f7f84ab3f7c3b28,0x3f7109083f54db31,0x3f7d3aac3f7ec46d,0x3f75dec63f5b941a,0x3f7912983f7fec43,0x3f79c79d3f61c598,0x3f7314473f7fb10f,0x3f7cbfc93f676bd8,0x3f6b4b0c3f7e1324
.quad 0x3f7ec46d3f6c835e,0x3f61c5983f7b14be,0x3f7fd3973f710908,0x3f5695e53f76ba07,0x3f7fec433f74fa0b,0x3f49d1123f710908,0x3f7f0e583f7853f8,0x3f3b8f3b3f6a09a7,0x3f7d3aac3f7b14be,0x3f2beb4a3f61c598,0x3f7a73023f7d3aac,0x3f1b02c63f584853,0x3f76ba073f7ec46d,0x3f08f59b3f4d9f02,0x3f7213523f7fb10f,0x3eebcbbb3f41d870
.quad 0x3f7b14be3f800000,0x3f54db313f6c835e,0x3f740bdd3f7ec46d,0x3f3fc7673f5ebe05,0x3f6a09a73f7b14be,0x3f2736563f4d9f02,0x3f5d2d533f74fa0b,0x3f0b9a6b3f396842,0x3f4d9f023f6c835e,0x3edae8803f226799,0x3f3b8f3b3f61c598,0x3e9aa0863f08f59b,0x3f2736563f54db31,0x3e2f10a23edae880,0x3f10d3cd3f45e403,0x3d16c32c3ea09ae5
.quad 0x3ef15aea3f3504f3,0xbdc8bd363e47c5c2,0x3ebe1d4a3f226799,0xbe6c9a7f3d96a905,0x3e888e933f0e39da,0xbeb8442abd48fb30,0x3e22abb63ef15aea,0xbef6e0cbbe2f10a2,0x3d48fb303ec3ef15,0xbf187fc0be94a031,0xbd7b2b743e94a031,0xbf32c8c9becf7bca,0xbe2f10a23e47c5c2,0xbf49d112bf039c3d,0xbe8e9a223dc8bd36,0xbf5d2d53bf1d7fd1
.quad 0x3f0e39da3f3504f3,0x3e47c5c23ec3ef15,0x3ed536413f187fc0,0x3c490e903e605c13,0x3e888e933ef15aea,0xbe2f10a23d48fb30,0x3de1bc2e3eac7cd4,0xbeb263efbdfab273,0xbd48fb303e47c5c2,0xbf039c3dbe94a031,0xbe5415013d48fb30,0xbf299415bee63375,0xbeb8442abdc8bd36,0xbf49d112bf187fc0,0xbf00e7e4be78cfcc,0xbf633c5abf396842
.quad 0xbf226799bec3ef15,0xbf74fa0bbf54db31,0xbf3fc767bf039c3d,0xbf7e70b0bf6a09a7,0xbf584853bf226799,0xbf7f4e6dbf7853f8,0xbf6b4b0cbf3daef9,0xbf778bc5bf7f4e6d,0xbf7853f8bf54db31,0xbf676bd8bf7ec46d,0xbf7f0e58bf676bd8,0xbf4f7a1fbf76ba07,0xbf7f4e6dbf74fa0b,0xbf3085bbbf676bd8,0xbf791298bf7d3aac,0xbf0b9a6bbf514d3d
.quad 0x530052005100500,0x570056005500540,0x530052005100500,0x570056005500540,0x530052005100500,0x570056005500540,0x530052005100500,0x570056005500540,0x530052005100500,0x570056005500540,0x534052405140504,0x574056405540544,0x534052405140504,0x574056405540544,0x534052405140504,0x574056405540544
.quad 0x534052405140504,0x574056405540544,0x534052405140504,0x574056405540544,0x534052405140504,0x574056405540544,0x534052405140504,0x574056405540544,0x538052805180508,0x578056805580548,0x538052805180508,0x578056805580548,0x538052805180508,0x578056805580548,0x538052805180508,0x578056805580548
.quad 0x5b005a005900580,0x5f005e005d005c0,0x5b005a005900580,0x5f005e005d005c0,0x5b005a005900580,0x5f005e005d005c0,0x5b005a005900580,0x5f005e005d005c0,0x5b005a005900580,0x5f005e005d005c0,0x5b405a405940584,0x5f405e405d405c4,0x5b405a405940584,0x5f405e405d405c4,0x5b405a405940584,0x5f405e405d405c4
.quad 0x5b405a405940584,0x5f405e405d405c4,0x5b405a405940584,0x5f405e405d405c4,0x5b405a405940584,0x5f405e405d405c4,0x5b405a405940584,0x5f405e405d405c4,0x5b805a805980588,0x5f805e805d805c8,0x5b805a805980588,0x5f805e805d805c8,0x5b805a805980588,0x5f805e805d805c8,0x5b805a805980588,0x5f805e805d805c8
.quad 0x630062006100600,0x670066006500640,0x630062006100600,0x670066006500640,0x630062006100600,0x670066006500640,0x630062006100600,0x670066006500640,0x630062006100600,0x670066006500640,0x634062406140604,0x674066406540644,0x634062406140604,0x674066406540644,0x634062406140604,0x674066406540644
.quad 0x634062406140604,0x674066406540644,0x634062406140604,0x674066406540644,0x634062406140604,0x674066406540644,0x634062406140604,0x674066406540644,0x638062806180608,0x678066806580648,0x638062806180608,0x678066806580648,0x638062806180608,0x678066806580648,0x638062806180608,0x678066806580648
.quad 0x6b006a006900680,0x6f006e006d006c0,0x6b006a006900680,0x6f006e006d006c0,0x6b006a006900680,0x6f006e006d006c0,0x6b006a006900680,0x6f006e006d006c0,0x6b006a006900680,0x6f006e006d006c0,0x6b406a406940684,0x6f406e406d406c4,0x6b406a406940684,0x6f406e406d406c4,0x6b406a406940684,0x6f406e406d406c4
.quad 0x6b406a406940684,0x6f406e406d406c4,0x6b406a406940684,0x6f406e406d406c4,0x6b406a406940684,0x6f406e406d406c4,0x6b406a406940684,0x6f406e406d406c4,0x6b806a806980688,0x6f806e806d806c8,0x6b806a806980688,0x6f806e806d806c8,0x6b806a806980688,0x6f806e806d806c8,0x6b806a806980688,0x6f806e806d806c8
.quad 0x538052805180508,0x578056805580548,0x538052805180508,0x578056805580548,0x538052805180508,0x578056805580548,0x538052805180508,0x578056805580548,0x538052805180508,0x578056805580548,0x53c052c051c050c,0x57c056c055c054c,0x53c052c051c050c,0x57c056c055c054c,0x53c052c051c050c,0x57c056c055c054c
.quad 0x53c052c051c050c,0x57c056c055c054c,0x53c052c051c050c,0x57c056c055c054c,0x53c052c051c050c,0x57c056c055c054c,0x53c052c051c050c,0x57c056c055c054c,0x540053005200510,0x580057005600550,0x540053005200510,0x580057005600550,0x540053005200510,0x580057005600550,0x540053005200510,0x580057005600550
.quad 0x5b805a805980588,0x5f805e805d805c8,0x5b805a805980588,0x5f805e805d805c8,0x5b805a805980588,0x5f805e805d805c8,0x5b805a805980588,0x5f805e805d805c8,0x5b805a805980588,0x5f805e805d805c8,0x5bc05ac059c058c,0x5fc05ec05dc05cc,0x5bc05ac059c058c,0x5fc05ec05dc05cc,0x5bc05ac059c058c,0x5fc05ec05dc05cc
.quad 0x5bc05ac059c058c,0x5fc05ec05dc05cc,0x5bc05ac059c058c,0x5fc05ec05dc05cc,0x5bc05ac059c058c,0x5fc05ec05dc05cc,0x5bc05ac059c058c,0x5fc05ec05dc05cc,0x5c005b005a00590,0x60005f005e005d0,0x5c005b005a00590,0x60005f005e005d0,0x5c005b005a00590,0x60005f005e005d0,0x5c005b005a00590,0x60005f005e005d0
.quad 0x638062806180608,0x678066806580648,0x638062806180608,0x678066806580648,0x638062806180608,0x678066806580648,0x638062806180608,0x678066806580648,0x638062806180608,0x678066806580648,0x63c062c061c060c,0x67c066c065c064c,0x63c062c061c060c,0x67c066c065c064c,0x63c062c061c060c,0x67c066c065c064c
.quad 0x63c062c061c060c,0x67c066c065c064c,0x63c062c061c060c,0x67c066c065c064c,0x63c062c061c060c,0x67c066c065c064c,0x63c062c061c060c,0x67c066c065c064c,0x640063006200610,0x680067006600650,0x640063006200610,0x680067006600650,0x640063006200610,0x680067006600650,0x640063006200610,0x680067006600650
.quad 0x6b806a806980688,0x6f806e806d806c8,0x6b806a806980688,0x6f806e806d806c8,0x6b806a806980688,0x6f806e806d806c8,0x6b806a806980688,0x6f806e806d806c8,0x6b806a806980688,0x6f806e806d806c8,0x6bc06ac069c068c,0x6fc06ec06dc06cc,0x6bc06ac069c068c,0x6fc06ec06dc06cc,0x6bc06ac069c068c,0x6fc06ec06dc06cc
.quad 0x6bc06ac069c068c,0x6fc06ec06dc06cc,0x6bc06ac069c068c,0x6fc06ec06dc06cc,0x6bc06ac069c068c,0x6fc06ec06dc06cc,0x6bc06ac069c068c,0x6fc06ec06dc06cc,0x6c006b006a00690,0x70006f006e006d0,0x6c006b006a00690,0x70006f006e006d0,0x6c006b006a00690,0x70006f006e006d0,0x6c006b006a00690,0x70006f006e006d0
.quad 0x3f803f803f803f80,0,0x3f753f7b3f7f3f80,0x3e953e483dc90000,0x3f553f6d3f7b3f80,0x3f0e3ec43e480000,0x3f223f553f753f80,0x3f463f0e3e950000,0x3ec43f353f6d3f80,0x3f6d3f353ec40000,0x3dc93f0e3f623f80,0x3f7f3f553ef10000,0xbe483ec43f553f80,0x3f7b3f6d3f0e0000,0xbef13e483f463f80,0x3f623f7b3f220000
.quad 0xbf3500003f353f80,0x3f353f803f350000,0xbf62be483f223f80,0x3ef13f7b3f460000,0xbf7bbec43f0e3f80,0x3e483f6d3f550000,0xbf7fbf0e3ef13f80,0xbdc93f553f620000,0xbf6dbf353ec43f80,0xbec43f353f6d0000,0xbf46bf553e953f80,0xbf223f0e3f750000,0xbf0ebf6d3e483f80,0xbf553ec43f7b0000,0xbe95bf7b3dc93f80,0xbf753e483f7f0000
.quad 0x3f803f803f803f80,0,0x3f463f553f623f6d,0x3f223f0e3ef13ec4,0x3e483ec43f0e3f35,0x3f7b3f6d3f553f35,0xbef1be483dc93ec4,0x3f623f7b3f7f3f6d,0xbf6dbf35bec40000,0x3ec43f353f6d3f80,0xbf75bf7bbf46bec4,0xbe953e483f223f6d,0xbf0ebf6dbf7bbf35,0xbf55bec43e483f35,0x3dc9bf0ebf75bf6d,0xbf7fbf55be953ec4
.quad 0x3f350000bf35bf80,0xbf35bf80bf350000,0x3f7f3f0ebe95bf6d,0xbdc9bf55bf75bec4,0x3f553f6d3e48bf35,0x3f0ebec4bf7bbf35,0x3e953f7b3f22bec4,0x3f753e48bf46bf6d,0xbec43f353f6d0000,0x3f6d3f35bec4bf80,0xbf623e483f7f3ec4,0x3ef13f7b3dc9bf6d,0xbf7bbec43f553f35,0xbe483f6d3f0ebf35,0xbf22bf553ef13f6d,0xbf463f0e3f62bec4
.quad 0x3f803f803f803f80,0,0x3ef13f0e3f223f35,0x3f623f553f463f35,0xbf0ebec4be480000,0x3f553f6d3f7b3f80,0xbf7fbf7bbf62bf35,0xbdc93e483ef13f35,0xbec4bf35bf6dbf80,0xbf6dbf35bec40000,0x3f223e48be95bf35,0xbf46bf7bbf75bf35,0x3f7b3f6d3f0e0000,0x3e48bec4bf55bf80,0x3e953f553f7f3f35,0x3f753f0ebdc9bf35
.quad 0xbf3500003f353f80,0x3f353f803f350000,0xbf75bf55bdc93f35,0xbe953f0e3f7f3f35,0xbe48bf6dbf550000,0xbf7bbec43f0e3f80,0x3f46be48bf75bf35,0xbf22bf7bbe953f35,0x3f6d3f35bec4bf80,0x3ec4bf35bf6d0000,0x3dc93f7b3ef1bf35,0x3f7f3e48bf62bf35,0xbf553ec43f7b0000,0x3f0e3f6dbe48bf80,0xbf62bf0e3f463f35,0xbef13f553f22bf35
.quad 0x3f803f803f803f80,0,0x3dc93e483e953ec4,0x3f7f3f7b3f753f6d,0xbf7bbf6dbf55bf35,0x3e483ec43f0e3f35,0xbe95bf0ebf46bf6d,0xbf75bf55bf22bec4,0x3f6d3f353ec40000,0xbec4bf35bf6dbf80,0x3ef13f553f7f3f6d,0x3f623f0e3dc9bec4,0xbf55bec43e483f35,0x3f0e3f6d3f7b3f35,0xbf22bf7bbf62bec4,0xbf46be483ef13f6d
.quad 0x3f350000bf35bf80,0xbf35bf80bf350000,0x3f463f7b3ef1bec4,0x3f22be48bf62bf6d,0xbf0e3ec43f7b3f35,0x3f553f6d3e48bf35,0xbf62bf553dc93f6d,0xbef13f0e3f7f3ec4,0x3ec4bf35bf6d0000,0xbf6dbf353ec43f80,0x3f753f0ebf22bf6d,0x3e95bf55bf463ec4,0xbe483f6d3f0ebf35,0x3f7b3ec4bf55bf35,0xbf7fbe483f753ec4,0xbdc93f7b3e95bf6d
.quad 0x3f803f803f803f80,0x8000800080008000,0x3f753f7b3f7f3f80,0xbe95be48bdc98000,0x3f553f6d3f7b3f80,0xbf0ebec4be488000,0x3f223f553f753f80,0xbf46bf0ebe958000,0x3ec43f353f6d3f80,0xbf6dbf35bec48000,0x3dc93f0e3f623f80,0xbf7fbf55bef18000,0xbe483ec43f553f80,0xbf7bbf6dbf0e8000,0xbef13e483f463f80,0xbf62bf7bbf228000
.quad 0xbf3500003f353f80,0xbf35bf80bf358000,0xbf62be483f223f80,0xbef1bf7bbf468000,0xbf7bbec43f0e3f80,0xbe48bf6dbf558000,0xbf7fbf0e3ef13f80,0x3dc9bf55bf628000,0xbf6dbf353ec43f80,0x3ec4bf35bf6d8000,0xbf46bf553e953f80,0x3f22bf0ebf758000,0xbf0ebf6d3e483f80,0x3f55bec4bf7b8000,0xbe95bf7b3dc93f80,0x3f75be48bf7f8000
.quad 0x3f803f803f803f80,0x8000800080008000,0x3f463f553f623f6d,0xbf22bf0ebef1bec4,0x3e483ec43f0e3f35,0xbf7bbf6dbf55bf35,0xbef1be483dc93ec4,0xbf62bf7bbf7fbf6d,0xbf6dbf35bec40000,0xbec4bf35bf6dbf80,0xbf75bf7bbf46bec4,0x3e95be48bf22bf6d,0xbf0ebf6dbf7bbf35,0x3f553ec4be48bf35,0x3dc9bf0ebf75bf6d,0x3f7f3f553e95bec4
.quad 0x3f350000bf35bf80,0x3f353f803f358000,0x3f7f3f0ebe95bf6d,0x3dc93f553f753ec4,0x3f553f6d3e48bf35,0xbf0e3ec43f7b3f35,0x3e953f7b3f22bec4,0xbf75be483f463f6d,0xbec43f353f6d0000,0xbf6dbf353ec43f80,0xbf623e483f7f3ec4,0xbef1bf7bbdc93f6d,0xbf7bbec43f553f35,0x3e48bf6dbf0e3f35,0xbf22bf553ef13f6d,0x3f46bf0ebf623ec4
.quad 0x3f803f803f803f80,0x8000800080008000,0x3ef13f0e3f223f35,0xbf62bf55bf46bf35,0xbf0ebec4be480000,0xbf55bf6dbf7bbf80,0xbf7fbf7bbf62bf35,0x3dc9be48bef1bf35,0xbec4bf35bf6dbf80,0x3f6d3f353ec48000,0x3f223e48be95bf35,0x3f463f7b3f753f35,0x3f7b3f6d3f0e0000,0xbe483ec43f553f80,0x3e953f553f7f3f35,0xbf75bf0e3dc93f35
.quad 0xbf3500003f353f80,0xbf35bf80bf358000,0xbf75bf55bdc93f35,0x3e95bf0ebf7fbf35,0xbe48bf6dbf550000,0x3f7b3ec4bf0ebf80,0x3f46be48bf75bf35,0x3f223f7b3e95bf35,0x3f6d3f35bec4bf80,0xbec43f353f6d8000,0x3dc93f7b3ef1bf35,0xbf7fbe483f623f35,0xbf553ec43f7b0000,0xbf0ebf6d3e483f80,0xbf62bf0e3f463f35,0x3ef1bf55bf223f35
.quad 0x3f803f803f803f80,0x8000800080008000,0x3dc93e483e953ec4,0xbf7fbf7bbf75bf6d,0xbf7bbf6dbf55bf35,0xbe48bec4bf0ebf35,0xbe95bf0ebf46bf6d,0x3f753f553f223ec4,0x3f6d3f353ec40000,0x3ec43f353f6d3f80,0x3ef13f553f7f3f6d,0xbf62bf0ebdc93ec4,0xbf55bec43e483f35,0xbf0ebf6dbf7bbf35,0xbf22bf7bbf62bec4,0x3f463e48bef1bf6d
.quad 0x3f350000bf35bf80,0x3f353f803f358000,0x3f463f7b3ef1bec4,0xbf223e483f623f6d,0xbf0e3ec43f7b3f35,0xbf55bf6dbe483f35,0xbf62bf553dc93f6d,0x3ef1bf0ebf7fbec4,0x3ec4bf35bf6d0000,0x3f6d3f35bec4bf80,0x3f753f0ebf22bf6d,0xbe953f553f46bec4,0xbe483f6d3f0ebf35,0xbf7bbec43f553f35,0xbf7fbe483f753ec4,0x3dc9bf7bbe953f6d
.quad 0x3f803f803f803f80,0x3f803f803f803f80,0x3f753f7b3f7f3f80,0xbe95be48bdc90000,0x3f553f6d3f7b3f80,0xbf55bf6dbf7bbf80,0x3f223f553f753f80,0x3f463f0e3e950000,0x3ec43f353f6d3f80,0x3ec43f353f6d3f80,0x3dc93f0e3f623f80,0xbf7fbf55bef10000,0xbe483ec43f553f80,0x3e48bec4bf55bf80,0xbef13e483f463f80,0x3f623f7b3f220000
.quad 0xbf3500003f353f80,0xbf3500003f353f80,0xbf62be483f223f80,0xbef1bf7bbf460000,0xbf7bbec43f0e3f80,0x3f7b3ec4bf0ebf80,0xbf7fbf0e3ef13f80,0xbdc93f553f620000,0xbf6dbf353ec43f80,0xbf6dbf353ec43f80,0xbf46bf553e953f80,0x3f22bf0ebf750000,0xbf0ebf6d3e483f80,0x3f0e3f6dbe48bf80,0xbe95bf7b3dc93f80,0xbf753e483f7f0000
.quad 0x3f803f803f803f80,0x3f803f803f803f80,0x3f463f553f623f6d,0xbf22bf0ebef1bec4,0x3e483ec43f0e3f35,0xbe48bec4bf0ebf35,0xbef1be483dc93ec4,0x3f623f7b3f7f3f6d,0xbf6dbf35bec40000,0xbf6dbf35bec40000,0xbf75bf7bbf46bec4,0x3e95be48bf22bf6d,0xbf0ebf6dbf7bbf35,0x3f0e3f6d3f7b3f35,0x3dc9bf0ebf75bf6d,0xbf7fbf55be953ec4
.quad 0x3f350000bf35bf80,0x3f350000bf35bf80,0x3f7f3f0ebe95bf6d,0x3dc93f553f753ec4,0x3f553f6d3e48bf35,0xbf55bf6dbe483f35,0x3e953f7b3f22bec4,0x3f753e48bf46bf6d,0xbec43f353f6d0000,0xbec43f353f6d0000,0xbf623e483f7f3ec4,0xbef1bf7bbdc93f6d,0xbf7bbec43f553f35,0x3f7b3ec4bf55bf35,0xbf22bf553ef13f6d,0xbf463f0e3f62bec4
.quad 0x3f803f803f803f80,0x3f803f803f803f80,0x3ef13f0e3f223f35,0xbf62bf55bf46bf35,0xbf0ebec4be480000,0x3f0e3ec43e480000,0xbf7fbf7bbf62bf35,0xbdc93e483ef13f35,0xbec4bf35bf6dbf80,0xbec4bf35bf6dbf80,0x3f223e48be95bf35,0x3f463f7b3f753f35,0x3f7b3f6d3f0e0000,0xbf7bbf6dbf0e0000,0x3e953f553f7f3f35,0x3f753f0ebdc9bf35
.quad 0xbf3500003f353f80,0xbf3500003f353f80,0xbf75bf55bdc93f35,0x3e95bf0ebf7fbf35,0xbe48bf6dbf550000,0x3e483f6d3f550000,0x3f46be48bf75bf35,0xbf22bf7bbe953f35,0x3f6d3f35bec4bf80,0x3f6d3f35bec4bf80,0x3dc93f7b3ef1bf35,0xbf7fbe483f623f35,0xbf553ec43f7b0000,0x3f55bec4bf7b0000,0xbf62bf0e3f463f35,0xbef13f553f22bf35
.quad 0x3f803f803f803f80,0x3f803f803f803f80,0x3dc93e483e953ec4,0xbf7fbf7bbf75bf6d,0xbf7bbf6dbf55bf35,0x3f7b3f6d3f553f35,0xbe95bf0ebf46bf6d,0xbf75bf55bf22bec4,0x3f6d3f353ec40000,0x3f6d3f353ec40000,0x3ef13f553f7f3f6d,0xbf62bf0ebdc93ec4,0xbf55bec43e483f35,0x3f553ec4be48bf35,0xbf22bf7bbf62bec4,0xbf46be483ef13f6d
.quad 0x3f350000bf35bf80,0x3f350000bf35bf80,0x3f463f7b3ef1bec4,0xbf223e483f623f6d,0xbf0e3ec43f7b3f35,0x3f0ebec4bf7bbf35,0xbf62bf553dc93f6d,0xbef13f0e3f7f3ec4,0x3ec4bf35bf6d0000,0x3ec4bf35bf6d0000,0x3f753f0ebf22bf6d,0xbe953f553f46bec4,0xbe483f6d3f0ebf35,0x3e48bf6dbf0e3f35,0xbf7fbe483f753ec4,0xbdc93f7b3e95bf6d
.quad 0,0x3f803f803f803f80,0x3f753f7b3f7f3f80,0xbe95be48bdc90000,0xbf0ebec4be480000,0xbf55bf6dbf7bbf80,0xbf22bf55bf75bf80,0x3f463f0e3e950000,0x3f6d3f353ec40000,0x3ec43f353f6d3f80,0x3dc93f0e3f623f80,0xbf7fbf55bef10000,0xbf7bbf6dbf0e0000,0x3e48bec4bf55bf80,0x3ef1be48bf46bf80,0x3f623f7b3f220000
.quad 0x3f353f803f350000,0xbf3500003f353f80,0xbf62be483f223f80,0xbef1bf7bbf460000,0xbe48bf6dbf550000,0x3f7b3ec4bf0ebf80,0x3f7f3f0ebef1bf80,0xbdc93f553f620000,0xbec43f353f6d0000,0xbf6dbf353ec43f80,0xbf46bf553e953f80,0x3f22bf0ebf750000,0x3f55bec4bf7b0000,0x3f0e3f6dbe48bf80,0x3e953f7bbdc9bf80,0xbf753e483f7f0000
.quad 0,0x3f803f803f803f80,0x3f463f553f623f6d,0xbf22bf0ebef1bec4,0xbf7bbf6dbf55bf35,0xbe48bec4bf0ebf35,0x3ef13e48bdc9bec4,0x3f623f7b3f7f3f6d,0x3ec43f353f6d3f80,0xbf6dbf35bec40000,0xbf75bf7bbf46bec4,0x3e95be48bf22bf6d,0x3f553ec4be48bf35,0x3f0e3f6d3f7b3f35,0xbdc93f0e3f753f6d,0xbf7fbf55be953ec4
.quad 0xbf35bf80bf350000,0x3f350000bf35bf80,0x3f7f3f0ebe95bf6d,0x3dc93f553f753ec4,0xbf0e3ec43f7b3f35,0xbf55bf6dbe483f35,0xbe95bf7bbf223ec4,0x3f753e48bf46bf6d,0x3f6d3f35bec4bf80,0xbec43f353f6d0000,0xbf623e483f7f3ec4,0xbef1bf7bbdc93f6d,0x3e48bf6dbf0e3f35,0x3f7b3ec4bf55bf35,0x3f223f55bef1bf6d,0xbf463f0e3f62bec4
.quad 0,0x3f803f803f803f80,0x3ef13f0e3f223f35,0xbf62bf55bf46bf35,0xbf55bf6dbf7bbf80,0x3f0e3ec43e480000,0x3f7f3f7b3f623f35,0xbdc93e483ef13f35,0xbf6dbf35bec40000,0xbec4bf35bf6dbf80,0x3f223e48be95bf35,0x3f463f7b3f753f35,0xbe483ec43f553f80,0xbf7bbf6dbf0e0000,0xbe95bf55bf7fbf35,0x3f753f0ebdc9bf35
.quad 0x3f353f803f350000,0xbf3500003f353f80,0xbf75bf55bdc93f35,0x3e95bf0ebf7fbf35,0x3f7b3ec4bf0ebf80,0x3e483f6d3f550000,0xbf463e483f753f35,0xbf22bf7bbe953f35,0x3ec4bf35bf6d0000,0x3f6d3f35bec4bf80,0x3dc93f7b3ef1bf35,0xbf7fbe483f623f35,0xbf0ebf6d3e483f80,0x3f55bec4bf7b0000,0x3f623f0ebf46bf35,0xbef13f553f22bf35
.quad 0,0x3f803f803f803f80,0x3dc93e483e953ec4,0xbf7fbf7bbf75bf6d,0xbe48bec4bf0ebf35,0x3f7b3f6d3f553f35,0x3e953f0e3f463f6d,0xbf75bf55bf22bec4,0xbec4bf35bf6dbf80,0x3f6d3f353ec40000,0x3ef13f553f7f3f6d,0xbf62bf0ebdc93ec4,0xbf0ebf6dbf7bbf35,0x3f553ec4be48bf35,0x3f223f7b3f623ec4,0xbf46be483ef13f6d
.quad 0xbf35bf80bf350000,0x3f350000bf35bf80,0x3f463f7b3ef1bec4,0xbf223e483f623f6d,0xbf55bf6dbe483f35,0x3f0ebec4bf7bbf35,0x3f623f55bdc9bf6d,0xbef13f0e3f7f3ec4,0xbf6dbf353ec43f80,0x3ec4bf35bf6d0000,0x3f753f0ebf22bf6d,0xbe953f553f46bec4,0xbf7bbec43f553f35,0x3e48bf6dbf0e3f35,0x3f7f3e48bf75bec4,0xbdc93f7b3e95bf6d
.quad 0x8000800080008000,0x3f803f803f803f80,0xbf75bf7bbf7fbf80,0xbe95be48bdc90000,0x3f0e3ec43e488000,0xbf55bf6dbf7bbf80,0x3f223f553f753f80,0x3f463f0e3e950000,0xbf6dbf35bec48000,0x3ec43f353f6d3f80,0xbdc9bf0ebf62bf80,0xbf7fbf55bef10000,0x3f7b3f6d3f0e8000,0x3e48bec4bf55bf80,0xbef13e483f463f80,0x3f623f7b3f220000
.quad 0xbf35bf80bf358000,0xbf3500003f353f80,0x3f623e48bf22bf80,0xbef1bf7bbf460000,0x3e483f6d3f558000,0x3f7b3ec4bf0ebf80,0xbf7fbf0e3ef13f80,0xbdc93f553f620000,0x3ec4bf35bf6d8000,0xbf6dbf353ec43f80,0x3f463f55be95bf80,0x3f22bf0ebf750000,0xbf553ec43f7b8000,0x3f0e3f6dbe48bf80,0xbe95bf7b3dc93f80,0xbf753e483f7f0000
.quad 0x8000800080008000,0x3f803f803f803f80,0xbf46bf55bf62bf6d,0xbf22bf0ebef1bec4,0x3f7b3f6d3f553f35,0xbe48bec4bf0ebf35,0xbef1be483dc93ec4,0x3f623f7b3f7f3f6d,0xbec4bf35bf6dbf80,0xbf6dbf35bec40000,0x3f753f7b3f463ec4,0x3e95be48bf22bf6d,0xbf55bec43e483f35,0x3f0e3f6d3f7b3f35,0x3dc9bf0ebf75bf6d,0xbf7fbf55be953ec4
.quad 0x3f353f803f358000,0x3f350000bf35bf80,0xbf7fbf0e3e953f6d,0x3dc93f553f753ec4,0x3f0ebec4bf7bbf35,0xbf55bf6dbe483f35,0x3e953f7b3f22bec4,0x3f753e48bf46bf6d,0xbf6dbf353ec43f80,0xbec43f353f6d0000,0x3f62be48bf7fbec4,0xbef1bf7bbdc93f6d,0xbe483f6d3f0ebf35,0x3f7b3ec4bf55bf35,0xbf22bf553ef13f6d,0xbf463f0e3f62bec4
.quad 0x8000800080008000,0x3f803f803f803f80,0xbef1bf0ebf22bf35,0xbf62bf55bf46bf35,0x3f553f6d3f7b3f80,0x3f0e3ec43e480000,0xbf7fbf7bbf62bf35,0xbdc93e483ef13f35,0x3f6d3f353ec48000,0xbec4bf35bf6dbf80,0xbf22be483e953f35,0x3f463f7b3f753f35,0x3e48bec4bf55bf80,0xbf7bbf6dbf0e0000,0x3e953f553f7f3f35,0x3f753f0ebdc9bf35
.quad 0xbf35bf80bf358000,0xbf3500003f353f80,0x3f753f553dc9bf35,0x3e95bf0ebf7fbf35,0xbf7bbec43f0e3f80,0x3e483f6d3f550000,0x3f46be48bf75bf35,0xbf22bf7bbe953f35,0xbec43f353f6d8000,0x3f6d3f35bec4bf80,0xbdc9bf7bbef13f35,0xbf7fbe483f623f35,0x3f0e3f6dbe48bf80,0x3f55bec4bf7b0000,0xbf62bf0e3f463f35,0xbef13f553f22bf35
.quad 0x8000800080008000,0x3f803f803f803f80,0xbdc9be48be95bec4,0xbf7fbf7bbf75bf6d,0x3e483ec43f0e3f35,0x3f7b3f6d3f553f35,0xbe95bf0ebf46bf6d,0xbf75bf55bf22bec4,0x3ec43f353f6d3f80,0x3f6d3f353ec40000,0xbef1bf55bf7fbf6d,0xbf62bf0ebdc93ec4,0x3f0e3f6d3f7b3f35,0x3f553ec4be48bf35,0xbf22bf7bbf62bec4,0xbf46be483ef13f6d
.quad 0x3f353f803f358000,0x3f350000bf35bf80,0xbf46bf7bbef13ec4,0xbf223e483f623f6d,0x3f553f6d3e48bf35,0x3f0ebec4bf7bbf35,0xbf62bf553dc93f6d,0xbef13f0e3f7f3ec4,0x3f6d3f35bec4bf80,0x3ec4bf35bf6d0000,0xbf75bf0e3f223f6d,0xbe953f553f46bec4,0x3f7b3ec4bf55bf35,0x3e48bf6dbf0e3f35,0xbf7fbe483f753ec4,0xbdc93f7b3e95bf6d
.quad 0x3f803f803f803f80,0,0xbf75bf7bbf7fbf80,0xbe95be48bdc90000,0x3f553f6d3f7b3f80,0x3f0e3ec43e480000,0xbf22bf55bf75bf80,0xbf46bf0ebe950000,0x3ec43f353f6d3f80,0x3f6d3f353ec40000,0xbdc9bf0ebf62bf80,0xbf7fbf55bef10000,0xbe483ec43f553f80,0x3f7b3f6d3f0e0000,0x3ef1be48bf46bf80,0xbf62bf7bbf220000
.quad 0xbf3500003f353f80,0x3f353f803f350000,0x3f623e48bf22bf80,0xbef1bf7bbf460000,0xbf7bbec43f0e3f80,0x3e483f6d3f550000,0x3f7f3f0ebef1bf80,0x3dc9bf55bf620000,0xbf6dbf353ec43f80,0xbec43f353f6d0000,0x3f463f55be95bf80,0x3f22bf0ebf750000,0xbf0ebf6d3e483f80,0xbf553ec43f7b0000,0x3e953f7bbdc9bf80,0x3f75be48bf7f0000
.quad 0x3f803f803f803f80,0,0xbf46bf55bf62bf6d,0xbf22bf0ebef1bec4,0x3e483ec43f0e3f35,0x3f7b3f6d3f553f35,0x3ef13e48bdc9bec4,0xbf62bf7bbf7fbf6d,0xbf6dbf35bec40000,0x3ec43f353f6d3f80,0x3f753f7b3f463ec4,0x3e95be48bf22bf6d,0xbf0ebf6dbf7bbf35,0xbf55bec43e483f35,0xbdc93f0e3f753f6d,0x3f7f3f553e95bec4
.quad 0x3f350000bf35bf80,0xbf35bf80bf350000,0xbf7fbf0e3e953f6d,0x3dc93f553f753ec4,0x3f553f6d3e48bf35,0x3f0ebec4bf7bbf35,0xbe95bf7bbf223ec4,0xbf75be483f463f6d,0xbec43f353f6d0000,0x3f6d3f35bec4bf80,0x3f62be48bf7fbec4,0xbef1bf7bbdc93f6d,0xbf7bbec43f553f35,0xbe483f6d3f0ebf35,0x3f223f55bef1bf6d,0x3f46bf0ebf623ec4
.quad 0x3f803f803f803f80,0,0xbef1bf0ebf22bf35,0xbf62bf55bf46bf35,0xbf0ebec4be480000,0x3f553f6d3f7b3f80,0x3f7f3f7b3f623f35,0x3dc9be48bef1bf35,0xbec4bf35bf6dbf80,0xbf6dbf35bec40000,0xbf22be483e953f35,0x3f463f7b3f753f35,0x3f7b3f6d3f0e0000,0x3e48bec4bf55bf80,0xbe95bf55bf7fbf35,0xbf75bf0e3dc93f35
.quad 0xbf3500003f353f80,0x3f353f803f350000,0x3f753f553dc9bf35,0x3e95bf0ebf7fbf35,0xbe48bf6dbf550000,0xbf7bbec43f0e3f80,0xbf463e483f753f35,0x3f223f7b3e95bf35,0x3f6d3f35bec4bf80,0x3ec4bf35bf6d0000,0xbdc9bf7bbef13f35,0xbf7fbe483f623f35,0xbf553ec43f7b0000,0x3f0e3f6dbe48bf80,0x3f623f0ebf46bf35,0x3ef1bf55bf223f35
.quad 0x3f803f803f803f80,0,0xbdc9be48be95bec4,0xbf7fbf7bbf75bf6d,0xbf7bbf6dbf55bf35,0x3e483ec43f0e3f35,0x3e953f0e3f463f6d,0x3f753f553f223ec4,0x3f6d3f353ec40000,0xbec4bf35bf6dbf80,0xbef1bf55bf7fbf6d,0xbf62bf0ebdc93ec4,0xbf55bec43e483f35,0x3f0e3f6d3f7b3f35,0x3f223f7b3f623ec4,0x3f463e48bef1bf6d
.quad 0x3f350000bf35bf80,0xbf35bf80bf350000,0xbf46bf7bbef13ec4,0xbf223e483f623f6d,0xbf0e3ec43f7b3f35,0x3f553f6d3e48bf35,0x3f623f55bdc9bf6d,0x3ef1bf0ebf7fbec4,0x3ec4bf35bf6d0000,0xbf6dbf353ec43f80,0xbf75bf0e3f223f6d,0xbe953f553f46bec4,0xbe483f6d3f0ebf35,0x3f7b3ec4bf55bf35,0x3f7f3e48bf75bec4,0x3dc9bf7bbe953f6d
.quad 0x3f803f803f803f80,0x8000800080008000,0xbf75bf7bbf7fbf80,0x3e953e483dc98000,0x3f553f6d3f7b3f80,0xbf0ebec4be488000,0xbf22bf55bf75bf80,0x3f463f0e3e958000,0x3ec43f353f6d3f80,0xbf6dbf35bec48000,0xbdc9bf0ebf62bf80,0x3f7f3f553ef18000,0xbe483ec43f553f80,0xbf7bbf6dbf0e8000,0x3ef1be48bf46bf80,0x3f623f7b3f228000
.quad 0xbf3500003f353f80,0xbf35bf80bf358000,0x3f623e48bf22bf80,0x3ef13f7b3f468000,0xbf7bbec43f0e3f80,0xbe48bf6dbf558000,0x3f7f3f0ebef1bf80,0xbdc93f553f628000,0xbf6dbf353ec43f80,0x3ec4bf35bf6d8000,0x3f463f55be95bf80,0xbf223f0e3f758000,0xbf0ebf6d3e483f80,0x3f55bec4bf7b8000,0x3e953f7bbdc9bf80,0xbf753e483f7f8000
.quad 0x3f803f803f803f80,0x8000800080008000,0xbf46bf55bf62bf6d,0x3f223f0e3ef13ec4,0x3e483ec43f0e3f35,0xbf7bbf6dbf55bf35,0x3ef13e48bdc9bec4,0x3f623f7b3f7f3f6d,0xbf6dbf35bec40000,0xbec4bf35bf6dbf80,0x3f753f7b3f463ec4,0xbe953e483f223f6d,0xbf0ebf6dbf7bbf35,0x3f553ec4be48bf35,0xbdc93f0e3f753f6d,0xbf7fbf55be953ec4
.quad 0x3f350000bf35bf80,0x3f353f803f358000,0xbf7fbf0e3e953f6d,0xbdc9bf55bf75bec4,0x3f553f6d3e48bf35,0xbf0e3ec43f7b3f35,0xbe95bf7bbf223ec4,0x3f753e48bf46bf6d,0xbec43f353f6d0000,0xbf6dbf353ec43f80,0x3f62be48bf7fbec4,0x3ef13f7b3dc9bf6d,0xbf7bbec43f553f35,0x3e48bf6dbf0e3f35,0x3f223f55bef1bf6d,0xbf463f0e3f62bec4
.quad 0x3f803f803f803f80,0x8000800080008000,0xbef1bf0ebf22bf35,0x3f623f553f463f35,0xbf0ebec4be480000,0xbf55bf6dbf7bbf80,0x3f7f3f7b3f623f35,0xbdc93e483ef13f35,0xbec4bf35bf6dbf80,0x3f6d3f353ec48000,0xbf22be483e953f35,0xbf46bf7bbf75bf35,0x3f7b3f6d3f0e0000,0xbe483ec43f553f80,0xbe95bf55bf7fbf35,0x3f753f0ebdc9bf35
.quad 0xbf3500003f353f80,0xbf35bf80bf358000,0x3f753f553dc9bf35,0xbe953f0e3f7f3f35,0xbe48bf6dbf550000,0x3f7b3ec4bf0ebf80,0xbf463e483f753f35,0xbf22bf7bbe953f35,0x3f6d3f35bec4bf80,0xbec43f353f6d8000,0xbdc9bf7bbef13f35,0x3f7f3e48bf62bf35,0xbf553ec43f7b0000,0xbf0ebf6d3e483f80,0x3f623f0ebf46bf35,0xbef13f553f22bf35
.quad 0x3f803f803f803f80,0x8000800080008000,0xbdc9be48be95bec4,0x3f7f3f7b3f753f6d,0xbf7bbf6dbf55bf35,0xbe48bec4bf0ebf35,0x3e953f0e3f463f6d,0xbf75bf55bf22bec4,0x3f6d3f353ec40000,0x3ec43f353f6d3f80,0xbef1bf55bf7fbf6d,0x3f623f0e3dc9bec4,0xbf55bec43e483f35,0xbf0ebf6dbf7bbf35,0x3f223f7b3f623ec4,0xbf46be483ef13f6d
.quad 0x3f350000bf35bf80,0x3f353f803f358000,0xbf46bf7bbef13ec4,0x3f22be48bf62bf6d,0xbf0e3ec43f7b3f35,0xbf55bf6dbe483f35,0x3f623f55bdc9bf6d,0xbef13f0e3f7f3ec4,0x3ec4bf35bf6d0000,0x3f6d3f35bec4bf80,0xbf75bf0e3f223f6d,0x3e95bf55bf463ec4,0xbe483f6d3f0ebf35,0xbf7bbec43f553f35,0x3f7f3e48bf75bec4,0xbdc93f7b3e95bf6d
.quad 0x3f803f803f803f80,0x3f803f803f803f80,0xbf75bf7bbf7fbf80,0x3e953e483dc90000,0x3f553f6d3f7b3f80,0xbf55bf6dbf7bbf80,0xbf22bf55bf75bf80,0xbf46bf0ebe950000,0x3ec43f353f6d3f80,0x3ec43f353f6d3f80,0xbdc9bf0ebf62bf80,0x3f7f3f553ef10000,0xbe483ec43f553f80,0x3e48bec4bf55bf80,0x3ef1be48bf46bf80,0xbf62bf7bbf220000
.quad 0xbf3500003f353f80,0xbf3500003f353f80,0x3f623e48bf22bf80,0x3ef13f7b3f460000,0xbf7bbec43f0e3f80,0x3f7b3ec4bf0ebf80,0x3f7f3f0ebef1bf80,0x3dc9bf55bf620000,0xbf6dbf353ec43f80,0xbf6dbf353ec43f80,0x3f463f55be95bf80,0xbf223f0e3f750000,0xbf0ebf6d3e483f80,0x3f0e3f6dbe48bf80,0x3e953f7bbdc9bf80,0x3f75be48bf7f0000
.quad 0x3f803f803f803f80,0x3f803f803f803f80,0xbf46bf55bf62bf6d,0x3f223f0e3ef13ec4,0x3e483ec43f0e3f35,0xbe48bec4bf0ebf35,0x3ef13e48bdc9bec4,0xbf62bf7bbf7fbf6d,0xbf6dbf35bec40000,0xbf6dbf35bec40000,0x3f753f7b3f463ec4,0xbe953e483f223f6d,0xbf0ebf6dbf7bbf35,0x3f0e3f6d3f7b3f35,0xbdc93f0e3f753f6d,0x3f7f3f553e95bec4
.quad 0x3f350000bf35bf80,0x3f350000bf35bf80,0xbf7fbf0e3e953f6d,0xbdc9bf55bf75bec4,0x3f553f6d3e48bf35,0xbf55bf6dbe483f35,0xbe95bf7bbf223ec4,0xbf75be483f463f6d,0xbec43f353f6d0000,0xbec43f353f6d0000,0x3f62be48bf7fbec4,0x3ef13f7b3dc9bf6d,0xbf7bbec43f553f35,0x3f7b3ec4bf55bf35,0x3f223f55bef1bf6d,0x3f46bf0ebf623ec4
.quad 0x3f803f803f803f80,0x3f803f803f803f80,0xbef1bf0ebf22bf35,0x3f623f553f463f35,0xbf0ebec4be480000,0x3f0e3ec43e480000,0x3f7f3f7b3f623f35,0x3dc9be48bef1bf35,0xbec4bf35bf6dbf80,0xbec4bf35bf6dbf80,0xbf22be483e953f35,0xbf46bf7bbf75bf35,0x3f7b3f6d3f0e0000,0xbf7bbf6dbf0e0000,0xbe95bf55bf7fbf35,0xbf75bf0e3dc93f35
.quad 0xbf3500003f353f80,0xbf3500003f353f80,0x3f753f553dc9bf35,0xbe953f0e3f7f3f35,0xbe48bf6dbf550000,0x3e483f6d3f550000,0xbf463e483f753f35,0x3f223f7b3e95bf35,0x3f6d3f35bec4bf80,0x3f6d3f35bec4bf80,0xbdc9bf7bbef13f35,0x3f7f3e48bf62bf35,0xbf553ec43f7b0000,0x3f55bec4bf7b0000,0x3f623f0ebf46bf35,0x3ef1bf55bf223f35
.quad 0x3f803f803f803f80,0x3f803f803f803f80,0xbdc9be48be95bec4,0x3f7f3f7b3f753f6d,0xbf7bbf6dbf55bf35,0x3f7b3f6d3f553f35,0x3e953f0e3f463f6d,0x3f753f553f223ec4,0x3f6d3f353ec40000,0x3f6d3f353ec40000,0xbef1bf55bf7fbf6d,0x3f623f0e3dc9bec4,0xbf55bec43e483f35,0x3f553ec4be48bf35,0x3f223f7b3f623ec4,0x3f463e48bef1bf6d
.quad 0x3f350000bf35bf80,0x3f350000bf35bf80,0xbf46bf7bbef13ec4,0x3f22be48bf62bf6d,0xbf0e3ec43f7b3f35,0x3f0ebec4bf7bbf35,0x3f623f55bdc9bf6d,0x3ef1bf0ebf7fbec4,0x3ec4bf35bf6d0000,0x3ec4bf35bf6d0000,0xbf75bf0e3f223f6d,0x3e95bf55bf463ec4,0xbe483f6d3f0ebf35,0x3e48bf6dbf0e3f35,0x3f7f3e48bf75bec4,0x3dc9bf7bbe953f6d
.quad 0,0x3f803f803f803f80,0xbf75bf7bbf7fbf80,0x3e953e483dc90000,0xbf0ebec4be480000,0xbf55bf6dbf7bbf80,0x3f223f553f753f80,0xbf46bf0ebe950000,0x3f6d3f353ec40000,0x3ec43f353f6d3f80,0xbdc9bf0ebf62bf80,0x3f7f3f553ef10000,0xbf7bbf6dbf0e0000,0x3e48bec4bf55bf80,0xbef13e483f463f80,0xbf62bf7bbf220000
.quad 0x3f353f803f350000,0xbf3500003f353f80,0x3f623e48bf22bf80,0x3ef13f7b3f460000,0xbe48bf6dbf550000,0x3f7b3ec4bf0ebf80,0xbf7fbf0e3ef13f80,0x3dc9bf55bf620000,0xbec43f353f6d0000,0xbf6dbf353ec43f80,0x3f463f55be95bf80,0xbf223f0e3f750000,0x3f55bec4bf7b0000,0x3f0e3f6dbe48bf80,0xbe95bf7b3dc93f80,0x3f75be48bf7f0000
.quad 0,0x3f803f803f803f80,0xbf46bf55bf62bf6d,0x3f223f0e3ef13ec4,0xbf7bbf6dbf55bf35,0xbe48bec4bf0ebf35,0xbef1be483dc93ec4,0xbf62bf7bbf7fbf6d,0x3ec43f353f6d3f80,0xbf6dbf35bec40000,0x3f753f7b3f463ec4,0xbe953e483f223f6d,0x3f553ec4be48bf35,0x3f0e3f6d3f7b3f35,0x3dc9bf0ebf75bf6d,0x3f7f3f553e95bec4
.quad 0xbf35bf80bf350000,0x3f350000bf35bf80,0xbf7fbf0e3e953f6d,0xbdc9bf55bf75bec4,0xbf0e3ec43f7b3f35,0xbf55bf6dbe483f35,0x3e953f7b3f22bec4,0xbf75be483f463f6d,0x3f6d3f35bec4bf80,0xbec43f353f6d0000,0x3f62be48bf7fbec4,0x3ef13f7b3dc9bf6d,0x3e48bf6dbf0e3f35,0x3f7b3ec4bf55bf35,0xbf22bf553ef13f6d,0x3f46bf0ebf623ec4
.quad 0,0x3f803f803f803f80,0xbef1bf0ebf22bf35,0x3f623f553f463f35,0xbf55bf6dbf7bbf80,0x3f0e3ec43e480000,0xbf7fbf7bbf62bf35,0x3dc9be48bef1bf35,0xbf6dbf35bec40000,0xbec4bf35bf6dbf80,0xbf22be483e953f35,0xbf46bf7bbf75bf35,0xbe483ec43f553f80,0xbf7bbf6dbf0e0000,0x3e953f553f7f3f35,0xbf75bf0e3dc93f35
.quad 0x3f353f803f350000,0xbf3500003f353f80,0x3f753f553dc9bf35,0xbe953f0e3f7f3f35,0x3f7b3ec4bf0ebf80,0x3e483f6d3f550000,0x3f46be48bf75bf35,0x3f223f7b3e95bf35,0x3ec4bf35bf6d0000,0x3f6d3f35bec4bf80,0xbdc9bf7bbef13f35,0x3f7f3e48bf62bf35,0xbf0ebf6d3e483f80,0x3f55bec4bf7b0000,0xbf62bf0e3f463f35,0x3ef1bf55bf223f35
.quad 0,0x3f803f803f803f80,0xbdc9be48be95bec4,0x3f7f3f7b3f753f6d,0xbe48bec4bf0ebf35,0x3f7b3f6d3f553f35,0xbe95bf0ebf46bf6d,0x3f753f553f223ec4,0xbec4bf35bf6dbf80,0x3f6d3f353ec40000,0xbef1bf55bf7fbf6d,0x3f623f0e3dc9bec4,0xbf0ebf6dbf7bbf35,0x3f553ec4be48bf35,0xbf22bf7bbf62bec4,0x3f463e48bef1bf6d
.quad 0xbf35bf80bf350000,0x3f350000bf35bf80,0xbf46bf7bbef13ec4,0x3f22be48bf62bf6d,0xbf55bf6dbe483f35,0x3f0ebec4bf7bbf35,0xbf62bf553dc93f6d,0x3ef1bf0ebf7fbec4,0xbf6dbf353ec43f80,0x3ec4bf35bf6d0000,0xbf75bf0e3f223f6d,0x3e95bf55bf463ec4,0xbf7bbec43f553f35,0x3e48bf6dbf0e3f35,0xbf7fbe483f753ec4,0x3dc9bf7bbe953f6d
.quad 0x8000800080008000,0x3f803f803f803f80,0x3f753f7b3f7f3f80,0x3e953e483dc90000,0x3f0e3ec43e488000,0xbf55bf6dbf7bbf80,0xbf22bf55bf75bf80,0xbf46bf0ebe950000,0xbf6dbf35bec48000,0x3ec43f353f6d3f80,0x3dc93f0e3f623f80,0x3f7f3f553ef10000,0x3f7b3f6d3f0e8000,0x3e48bec4bf55bf80,0x3ef1be48bf46bf80,0xbf62bf7bbf220000
.quad 0xbf35bf80bf358000,0xbf3500003f353f80,0xbf62be483f223f80,0x3ef13f7b3f460000,0x3e483f6d3f558000,0x3f7b3ec4bf0ebf80,0x3f7f3f0ebef1bf80,0x3dc9bf55bf620000,0x3ec4bf35bf6d8000,0xbf6dbf353ec43f80,0xbf46bf553e953f80,0xbf223f0e3f750000,0xbf553ec43f7b8000,0x3f0e3f6dbe48bf80,0x3e953f7bbdc9bf80,0x3f75be48bf7f0000
.quad 0x8000800080008000,0x3f803f803f803f80,0x3f463f553f623f6d,0x3f223f0e3ef13ec4,0x3f7b3f6d3f553f35,0xbe48bec4bf0ebf35,0x3ef13e48bdc9bec4,0xbf62bf7bbf7fbf6d,0xbec4bf35bf6dbf80,0xbf6dbf35bec40000,0xbf75bf7bbf46bec4,0xbe953e483f223f6d,0xbf55bec43e483f35,0x3f0e3f6d3f7b3f35,0xbdc93f0e3f753f6d,0x3f7f3f553e95bec4
.quad 0x3f353f803f358000,0x3f350000bf35bf80,0x3f7f3f0ebe95bf6d,0xbdc9bf55bf75bec4,0x3f0ebec4bf7bbf35,0xbf55bf6dbe483f35,0xbe95bf7bbf223ec4,0xbf75be483f463f6d,0xbf6dbf353ec43f80,0xbec43f353f6d0000,0xbf623e483f7f3ec4,0x3ef13f7b3dc9bf6d,0xbe483f6d3f0ebf35,0x3f7b3ec4bf55bf35,0x3f223f55bef1bf6d,0x3f46bf0ebf623ec4
.quad 0x8000800080008000,0x3f803f803f803f80,0x3ef13f0e3f223f35,0x3f623f553f463f35,0x3f553f6d3f7b3f80,0x3f0e3ec43e480000,0x3f7f3f7b3f623f35,0x3dc9be48bef1bf35,0x3f6d3f353ec48000,0xbec4bf35bf6dbf80,0x3f223e48be95bf35,0xbf46bf7bbf75bf35,0x3e48bec4bf55bf80,0xbf7bbf6dbf0e0000,0xbe95bf55bf7fbf35,0xbf75bf0e3dc93f35
.quad 0xbf35bf80bf358000,0xbf3500003f353f80,0xbf75bf55bdc93f35,0xbe953f0e3f7f3f35,0xbf7bbec43f0e3f80,0x3e483f6d3f550000,0xbf463e483f753f35,0x3f223f7b3e95bf35,0xbec43f353f6d8000,0x3f6d3f35bec4bf80,0x3dc93f7b3ef1bf35,0x3f7f3e48bf62bf35,0x3f0e3f6dbe48bf80,0x3f55bec4bf7b0000,0x3f623f0ebf46bf35,0x3ef1bf55bf223f35
.quad 0x8000800080008000,0x3f803f803f803f80,0x3dc93e483e953ec4,0x3f7f3f7b3f753f6d,0x3e483ec43f0e3f35,0x3f7b3f6d3f553f35,0x3e953f0e3f463f6d,0x3f753f553f223ec4,0x3ec43f353f6d3f80,0x3f6d3f353ec40000,0x3ef13f553f7f3f6d,0x3f623f0e3dc9bec4,0x3f0e3f6d3f7b3f35,0x3f553ec4be48bf35,0x3f223f7b3f623ec4,0x3f463e48bef1bf6d
.quad 0x3f353f803f358000,0x3f350000bf35bf80,0x3f463f7b3ef1bec4,0x3f22be48bf62bf6d,0x3f553f6d3e48bf35,0x3f0ebec4bf7bbf35,0x3f623f55bdc9bf6d,0x3ef1bf0ebf7fbec4,0x3f6d3f35bec4bf80,0x3ec4bf35bf6d0000,0x3f753f0ebf22bf6d,0x3e95bf55bf463ec4,0x3f7b3ec4bf55bf35,0x3e48bf6dbf0e3f35,0x3f7f3e48bf75bec4,0x3dc9bf7bbe953f6d
.quad 0x3f8000003f800000,0x3f8000003f800000,0x3f7fffb13f800000,0x3f7ffd393f7ffec4,0x3f7ffec43f800000,0x3f7ff4e63f7ffb11,0x3f7ffd393f800000,0x3f7fe7053f7ff4e6,0x3f7ffb113f800000,0x3f7fd3973f7fec43,0x3f7ff84a3f800000,0x3f7fba9e3f7fe129,0x3f7ff4e63f800000,0x3f7f9c183f7fd397,0x3f7ff0e33f800000,0x3f7f78083f7fc38f
.quad 0x3f7fec433f800000,0x3f7f4e6d3f7fb10f,0x3f7fe7053f800000,0x3f7f1f493f7f9c18,0x3f7fe1293f800000,0x3f7eea9d3f7f84ab,0x3f7fdaaf3f800000,0x3f7eb0693f7f6ac7,0x3f7fd3973f800000,0x3f7e70b03f7f4e6d,0x3f7fcbe23f800000,0x3f7e2b723f7f2f9d,0x3f7fc38f3f800000,0x3f7de0b13f7f0e58,0x3f7fba9e3f800000,0x3f7d906e3f7eea9d
.quad 0x3f8000003f800000,0x3f8000003f800000,0x3f7ff84a3f7ffb11,0x3f7ff0e33f7ff4e6,0x3f7fe1293f7fec43,0x3f7fc38f3f7fd397,0x3f7fba9e3f7fd397,0x3f7f78083f7f9c18,0x3f7f84ab3f7fb10f,0x3f7f0e583f7f4e6d,0x3f7f3f543f7f84ab,0x3f7e868b3f7eea9d,0x3f7eea9d3f7f4e6d,0x3f7de0b13f7e70b0,0x3f7e868b3f7f0e58,0x3f7d1cdd3f7de0b1
.quad 0x3f7e13243f7ec46d,0x3f7c3b283f7d3aac,0x3f7d906e3f7e70b0,0x3f7b3bab3f7c7eb0,0x3f7cfe733f7e1324,0x3f7a1e843f7baccd,0x3f7c5d3a3f7dabcc,0x3f78e3d63f7ac516,0x3f7baccd3f7d3aac,0x3f778bc53f79c79d,0x3f7aed373f7cbfc9,0x3f76167a3f78b47b,0x3f7a1e843f7c3b28,0x3f7484223f778bc5,0x3f7940c03f7baccd,0x3f72d4eb3f764d97
.quad 0x3f8000003f800000,0x3f8000003f800000,0x3f7fe7053f7fec43,0x3f7fdaaf3f7fe129,0x3f7f9c183f7fb10f,0x3f7f6ac73f7f84ab,0x3f7f1f493f7f4e6d,0x3f7eb0693f7eea9d,0x3f7e70b03f7ec46d,0x3f7dabcc3f7e1324,0x3f7d906e3f7e1324,0x3f7c5d3a3f7cfe73,0x3f7c7eb03f7d3aac,0x3f7ac5163f7baccd,0x3f7b3bab3f7c3b28,0x3f78e3d63f7a1e84
.quad 0x3f79c79d3f7b14be,0x3f76ba073f7853f8,0x3f7822d13f79c79d,0x3f74484b3f764d97,0x3f764d973f7853f8,0x3f718f573f740bdd,0x3f74484b3f76ba07,0x3f6e8ff83f718f57,0x3f7213523f74fa0b,0x3f6b4b0c3f6ed89e,0x3f6faf1b3f731447,0x3f67c1873f6be858,0x3f6d1c1d3f710908,0x3f63f4733f68bf3c,0x3f6a5ad93f6ed89e,0x3f5fe4e93f655e0b
.quad 0x3f8000003f800000,0x3f8000003f800000,0x3f7fcbe23f7fd397,0x3f7fba9e3f7fc38f,0x3f7f2f9d3f7f4e6d,0x3f7eea9d3f7f0e58,0x3f7e2b723f7e70b0,0x3f7d906e3f7de0b1,0x3f7cbfc93f7d3aac,0x3f7baccd3f7c3b28,0x3f7aed373f7baccd,0x3f7940c03f7a1e84,0x3f78b47b3f79c79d,0x3f764d973f778bc5,0x3f76167a3f778bc5,0x3f72d4eb3f748422
.quad 0x3f7314473f74fa0b,0x3f6ed89e3f710908,0x3f6faf1b3f721352,0x3f6a5ad93f6d1c1d,0x3f6be8583f6ed89e,0x3f655e0b3f68bf3c,0x3f67c1873f6b4b0c,0x3f5fe4e93f63f473,0x3f633c5a3f676bd8,0x3f59f26a3f5ebe05,0x3f5e5aa63f633c5a,0x3f5389c73f591e6a,0x3f591e6a3f5ebe05,0x3f4cae793f531849,0x3f5389c73f59f26a,0x3f4564393f4cae79
.quad 0x3f8000003f800000,0x3f8000003f800000,0x3f7fa6e33f7fb10f,0x3f7f90b13f7f9c18,0x3f7e9bc93f7ec46d,0x3f7e43233f7e70b0,0x3f7cdf6c3f7d3aac,0x3f7c187a3f7c7eb0,0x3f7a73023f7b14be,0x3f7912983f79c79d,0x3f77583a3f7853f8,0x3f75341d3f764d97,0x3f73913f3f74fa0b,0x3f7080663f721352,0x3f6f20b03f710908,0x3f6afb8c3f6d1c1d
.quad 0x3f6a09a73f6c835e,0x3f64aa593f676bd8,0x3f644fac3f676bd8,0x3f5d924d3f6106f2,0x3f5df6be3f61c598,0x3f55b9933f59f26a,0x3f5703483f5b941a,0x3f4d26fd3f5233c6,0x3f4f7a1f3f54db31,0x3f43e2003f49d112,0x3f4760853f4d9f02,0x3f39f2ac3f40d0da,0x3f3ebc1b3f45e403,0x3f2f61a53f373a23,0x3f3592e73f3daef9,0x3f24381a3f2d1469
.quad 0x3f8000003f800000,0x3f8000003f800000,0x3f7f78083f7f84ab,0x3f7f5ce93f7f6ac7,0x3f7de0b13f7e1324,0x3f7d74743f7dabcc,0x3f7b3bab3f7baccd,0x3f7a49103f7ac516,0x3f778bc53f7853f8,0x3f75dec63f76ba07,0x3f72d4eb3f740bdd,0x3f703b373f718f57,0x3f6d1c1d3f6ed89e,0x3f6965913f6b4b0c,0x3f6667713f68bf3c,0x3f61668a3f63f473
.quad 0x3f5ebe053f61c598,0x3f5848533f5b941a,0x3f5627fe3f59f26a,0x3f4e16893f5233c6,0x3f4cae793f514d3d,0x3f42de293f47de65,0x3f425b893f47de65,0x3f36ad7f3f3ca003,0x3f373a233f3daef9,0x3f2994153f3085bb,0x3f2b561b3f32c8c9,0x3f1ba2993f239da9,0x3f1ebc123f273656,0x3f0cead03f15f6d9,0x3f11796b3f1b02c6,0x3efafef73f07a136
.quad 0x3f8000003f800000,0x3f8000003f800000,0x3f7f3f543f7f4e6d,0x3f7f1f493f7f2f9d,0x3f7cfe733f7d3aac,0x3f7c7eb03f7cbfc9,0x3f7940c03f79c79d,0x3f7822d13f78b47b,0x3f740bdd3f74fa0b,0x3f7213523f731447,0x3f6d67a13f6ed89e,0x3f6a5ad93f6be858,0x3f655e0b3f676bd8,0x3f6106f23f633c5a,0x3f5bfb343f5ebe05,0x3f5627fe3f591e6a
.quad 0x3f514d3d3f54db31,0x3f49d1123f4d9f02,0x3f4564393f49d112,0x3f3c17d93f40d0da,0x3f3852163f3daef9,0x3f2d14693f32c8c9,0x3f2a2a803f3085bb,0x3f1ce11f3f239da9,0x3f1b02c63f226799,0x3f0b9a6b3f13682a,0x3f0af1b73f13682a,0x3ef2bd433f0242b1,0x3ef41f073f039c3d,0x3ecc9b8b3ee0924f,0x3ed0eb2a3ee63375,0x3ea5129f3ebb31a0
.quad 0x3f8000003f800000,0x3f8000003f800000,0x3f7efcc93f7f0e58,0x3f7ed7d43f7eea9d,0x3f7bf5313f7c3b28,0x3f7b61fc3f7baccd,0x3f76ef5b3f778bc5,0x3f75a67b3f764d97,0x3f6ff5733f710908,0x3f6db2933f6ed89e,0x3f6715993f68bf3c,0x3f6398ac3f655e0b,0x3f5c61c73f5ebe05,0x3f5770263f59f26a,0x3f4fefa83f531849,0x3f4955213f4cae79
.quad 0x3f41d8703f45e403,0x3f3968423f3daef9,0x3f3238aa3f373a23,0x3f27ce613f2d1469,0x3f212ff93f273656,0x3f14b0393f1b02c6,0x3f0ee0db3f15f6d9,0x3f003a063f07a136,0x3ef6e0cb3f039c3d,0x3ed536413ee63375,0x3ece0bea3ee0924f,0x3ea80b1f3ebb31a0,0x3ea395c53eb8442a,0x3e72b6513e8e9a22,0x3e6fa8b23e8e9a22,0x3e1324ca3e419b37
.quad 0,0,0x3b490fc600000000,0x3c16cb583bc90f88,0x3bc90f8800000000,0x3c96c9b63c490e90,0x3c16cb5800000000,0x3ce22a7a3c96c9b6,0x3c490e9000000000,0x3d16c32c3cc90ab0,0x3c7b514b00000000,0x3d3c6dd53cfb49ba,0x3c96c9b600000000,0x3d6214693d16c32c,0x3cafea6900000000,0x3d83db0a3d2fe007
.quad 0x3cc90ab000000000,0x3d96a9053d48fb30,0x3ce22a7a00000000,0x3da973ba3d621469,0x3cfb49ba00000000,0x3dbc3ac33d7b2b74,0x3d0a342f00000000,0x3dcefdb73d8a200a,0x3d16c32c00000000,0x3de1bc2e3d96a905,0x3d2351cb00000000,0x3df475c03da3308c,0x3d2fe00700000000,0x3e0395023dafb680,0x3d3c6dd500000000,0x3e0cec4a3dbc3ac3
.quad 0,0,0x3c7b514b3c490e90,0x3cafea693c96c9b6,0x3cfb49ba3cc90ab0,0x3d2fe0073d16c32c,0x3d3c6dd53d16c32c,0x3d83db0a3d621469,0x3d7b2b743d48fb30,0x3dafb6803d96a905,0x3d9cecf93d7b2b74,0x3ddb7d373dbc3ac3,0x3dbc3ac33d96a905,0x3e0395023de1bc2e,0x3ddb7d373dafb680,0x3e195be03e039502
.quad 0x3dfab2733dc8bd36,0x3e2f10a23e164083,0x3e0cec4a3de1bc2e,0x3e44b0b93e28defc,0x3e1c76de3dfab273,0x3e5a39973e3b6ecf,0x3e2bf8043e09cf86,0x3e6fa8b23e4dee60,0x3e3b6ecf3e164083,0x3e827dc03e605c13,0x3e4ada4f3e22abb6,0x3e8d17c03e72b651,0x3e5a39973e2f10a2,0x3e97a1173e827dc0,0x3e698bba3e3b6ecf,0x3ea218873e8b9507
.quad 0,0,0x3ce22a7a3cc90ab0,0x3d0a342f3cfb49ba,0x3d6214693d48fb30,0x3d8a200a3d7b2b74,0x3da973ba3d96a905,0x3dcefdb73dbc3ac3,0x3de1bc2e3dc8bd36,0x3e09cf863dfab273,0x3e0cec4a3dfab273,0x3e2bf8043e1c76de,0x3e28defc3e164083,0x3e4dee603e3b6ecf,0x3e44b0b93e2f10a2,0x3e6fa8b23e5a3997
.quad 0x3e605c133e47c5c2,0x3e888e933e78cfcc,0x3e7bdba43e605c13,0x3e9920fe3e8b9507,0x3e8b95073e78cfcc,0x3ea986c43e9aa086,0x3e9920fe3e888e93,0x3eb9bb1e3ea986c4,0x3ea68f123e94a031,0x3ec9b9533eb8442a,0x3eb3dca53ea09ae5,0x3ed97cb93ec6d529,0x3ec1071e3eac7cd4,0x3ee900b73ed53641,0x3ece0bea3eb8442a,0x3ef840c83ee363fa
.quad 0,0,0x3d2351cb3d16c32c,0x3d3c6dd53d2fe007,0x3da3308c3d96a905,0x3dbc3ac33dafb680,0x3df475c03de1bc2e,0x3e0cec4a3e039502,0x3e22abb63e164083,0x3e3b6ecf3e2f10a2,0x3e4ada4f3e3b6ecf,0x3e698bba3e5a3997,0x3e72b6513e605c13,0x3e8b95073e827dc0,0x3e8d17c03e827dc0,0x3ea218873e97a117
.quad 0x3ea09ae53e94a031,0x3eb8442a3eac7cd4,0x3eb3dca53ea68f12,0x3ece0bea3ec1071e,0x3ec6d5293eb8442a,0x3ee363fa3ed53641,0x3ed97cb93ec9b953,0x3ef840c83ee900b7,0x3eebcbbb3edae880,0x3f064b823efc5d27,0x3efdbabb3eebcbbb,0x3f102dd53f07a136,0x3f07a1363efc5d27,0x3f19c2003f10d3cd,0x3f102dd53f064b82,0x3f2302d33f19c200
.quad 0,0,0x3d55880e3d48fb30,0x3d6ea0383d621469,0x3dd53db93dc8bd36,0x3dee38763de1bc2e,0x3e1f917b3e164083,0x3e3228d43e28defc,0x3e5415013e47c5c2,0x3e6c9a7f3e605c13,0x3e8402703e78cfcc,0x3e931f353e8b9507,0x3e9d9e783e94a031,0x3eaf713a3ea68f12,0x3eb6ccc33eac7cd4,0x3ecb2aae3ec1071e
.quad 0x3ecf7bca3ec3ef15,0x3ee633753edae880,0x3ee79a5d3edae880,0x3f003a063ef41f07,0x3eff17b23ef15aea,0x3f0cead03f064b82,0x3f0af1b73f039c3d,0x3f19210f3f121eb0,0x3f15f6d93f0e39da,0x3f24d2253f1d7fd1,0x3f2093933f187fc0,0x3f2ff3e63f286605,0x3f2ac0823f226799,0x3f3a7ca43f32c8c9,0x3f34768f3f2beb4a,0x3f4463373f3ca003
.quad 0,0,0x3d83db0a3d7b2b74,0x3d9064b43d8a200a,0x3e0395023dfab273,0x3e1008b73e09cf86,0x3e44b0b93e3b6ecf,0x3e57278f3e4dee60,0x3e827dc03e78cfcc,0x3e8e9a223e888e93,0x3ea218873e9aa086,0x3eb0eacb3ea986c4,0x3ec1071e3eb8442a,0x3ed25a093ec9b953,0x3edf28a93ed53641,0x3ef2bd433ee900b7
.quad 0x3efc5d273ef15aea,0x3f08f59b3f039c3d,0x3f0c42c93f064b82,0x3f17de123f121eb0,0x3f19c2003f13682a,0x3f26050a3f1ff6cb,0x3f269de33f1ff6cb,0x3f33587a3f2d1469,0x3f32c8c93f2beb4a,0x3f3fc7673f396842,0x3f3e35c53f373a23,0x3f4b41fa3f44e3f5,0x3f48d8b33f41d870,0x3f55b9933f4f7a1f,0x3f52a6493f4bbbf8,0x3f5f20db3f591e6a
.quad 0,0,0x3d9cecf93d96a905,0x3da973ba3da3308c,0x3e1c76de3e164083,0x3e28defc3e22abb6,0x3e698bba3e605c13,0x3e7bdba43e72b651,0x3e9aa0863e94a031,0x3ea68f123ea09ae5,0x3ebf926f3eb8442a,0x3ece0bea3ec6d529,0x3ee363fa3edae880,0x3ef41f073eebcbbb,0x3f02ef9f3efc5d27,0x3f0c42c93f07a136
.quad 0x3f13682a3f0e39da,0x3f1d7fd13f187fc0,0x3f2302d33f1d7fd1,0x3f2da8593f286605,0x3f31a81d3f2beb4a,0x3f3ca0033f373a23,0x3f3f41fc3f396842,0x3f4a4c873f44e3f5,0x3f4bbbf83f45e403,0x3f5695e53f514d3d,0x3f5703483f514d3d,0x3f61668a3f5c61c7,0x3f6106f23f5b941a,0x3f6aab7b3f660f88,0x3f69b7e43f64aa59,0x3f7254703f6e46be
.quad 0,0,0x3db5f8da3dafb680,0x3dc27c393dbc3ac3,0x3e3540983e2f10a2,0x3e419b373e3b6ecf,0x3e870ada3e827dc0,0x3e901c2c3e8b9507,0x3eb263ef3eac7cd4,0x3ebe1d4a3eb8442a,0x3edc53c13ed53641,0x3eea66813ee363fa,0x3f0242b13efc5d27,0x3f0a48ad3f064b82,0x3f1553b73f10d3cd,0x3f1e1e223f19c200
.quad 0x3f2736563f226799,0x3f3085bb3f2beb4a,0x3f37c6553f32c8c9,0x3f4154e13f3ca003,0x3f46e22a3f41d870,0x3f5064af3f4bbbf8,0x3f546b3b3f4f7a1f,0x3f5d924d3f591e6a,0x3f6046213f5b941a,0x3f68bf3c3f64aa59,0x3f6a5ad93f660f88,0x3f71d19f3f6e46be,0x3f7294f83f6ed89e,0x3f78b47b3f75dec6,0x3f78e3d63f75dec6,0x3f7d57de3f7b61fc
.quad 0x3f8000003f800000,0x3f8000003f800000,0x3f7fffb13f800000,0x3f7ffd393f7ffec4,0x3f7ffec43f800000,0x3f7ff4e63f7ffb11,0x3f7ffd393f800000,0x3f7fe7053f7ff4e6,0x3f7ffb113f800000,0x3f7fd3973f7fec43,0x3f7ff84a3f800000,0x3f7fba9e3f7fe129,0x3f7ff4e63f800000,0x3f7f9c183f7fd397,0x3f7ff0e33f800000,0x3f7f78083f7fc38f
.quad 0x3f7fec433f800000,0x3f7f4e6d3f7fb10f,0x3f7fe7053f800000,0x3f7f1f493f7f9c18,0x3f7fe1293f800000,0x3f7eea9d3f7f84ab,0x3f7fdaaf3f800000,0x3f7eb0693f7f6ac7,0x3f7fd3973f800000,0x3f7e70b03f7f4e6d,0x3f7fcbe23f800000,0x3f7e2b723f7f2f9d,0x3f7fc38f3f800000,0x3f7de0b13f7f0e58,0x3f7fba9e3f800000,0x3f7d906e3f7eea9d
.quad 0x3f8000003f800000,0x3f8000003f800000,0x3f7ff84a3f7ffb11,0x3f7ff0e33f7ff4e6,0x3f7fe1293f7fec43,0x3f7fc38f3f7fd397,0x3f7fba9e3f7fd397,0x3f7f78083f7f9c18,0x3f7f84ab3f7fb10f,0x3f7f0e583f7f4e6d,0x3f7f3f543f7f84ab,0x3f7e868b3f7eea9d,0x3f7eea9d3f7f4e6d,0x3f7de0b13f7e70b0,0x3f7e868b3f7f0e58,0x3f7d1cdd3f7de0b1
.quad 0x3f7e13243f7ec46d,0x3f7c3b283f7d3aac,0x3f7d906e3f7e70b0,0x3f7b3bab3f7c7eb0,0x3f7cfe733f7e1324,0x3f7a1e843f7baccd,0x3f7c5d3a3f7dabcc,0x3f78e3d63f7ac516,0x3f7baccd3f7d3aac,0x3f778bc53f79c79d,0x3f7aed373f7cbfc9,0x3f76167a3f78b47b,0x3f7a1e843f7c3b28,0x3f7484223f778bc5,0x3f7940c03f7baccd,0x3f72d4eb3f764d97
.quad 0x3f8000003f800000,0x3f8000003f800000,0x3f7fe7053f7fec43,0x3f7fdaaf3f7fe129,0x3f7f9c183f7fb10f,0x3f7f6ac73f7f84ab,0x3f7f1f493f7f4e6d,0x3f7eb0693f7eea9d,0x3f7e70b03f7ec46d,0x3f7dabcc3f7e1324,0x3f7d906e3f7e1324,0x3f7c5d3a3f7cfe73,0x3f7c7eb03f7d3aac,0x3f7ac5163f7baccd,0x3f7b3bab3f7c3b28,0x3f78e3d63f7a1e84
.quad 0x3f79c79d3f7b14be,0x3f76ba073f7853f8,0x3f7822d13f79c79d,0x3f74484b3f764d97,0x3f764d973f7853f8,0x3f718f573f740bdd,0x3f74484b3f76ba07,0x3f6e8ff83f718f57,0x3f7213523f74fa0b,0x3f6b4b0c3f6ed89e,0x3f6faf1b3f731447,0x3f67c1873f6be858,0x3f6d1c1d3f710908,0x3f63f4733f68bf3c,0x3f6a5ad93f6ed89e,0x3f5fe4e93f655e0b
.quad 0x3f8000003f800000,0x3f8000003f800000,0x3f7fcbe23f7fd397,0x3f7fba9e3f7fc38f,0x3f7f2f9d3f7f4e6d,0x3f7eea9d3f7f0e58,0x3f7e2b723f7e70b0,0x3f7d906e3f7de0b1,0x3f7cbfc93f7d3aac,0x3f7baccd3f7c3b28,0x3f7aed373f7baccd,0x3f7940c03f7a1e84,0x3f78b47b3f79c79d,0x3f764d973f778bc5,0x3f76167a3f778bc5,0x3f72d4eb3f748422
.quad 0x3f7314473f74fa0b,0x3f6ed89e3f710908,0x3f6faf1b3f721352,0x3f6a5ad93f6d1c1d,0x3f6be8583f6ed89e,0x3f655e0b3f68bf3c,0x3f67c1873f6b4b0c,0x3f5fe4e93f63f473,0x3f633c5a3f676bd8,0x3f59f26a3f5ebe05,0x3f5e5aa63f633c5a,0x3f5389c73f591e6a,0x3f591e6a3f5ebe05,0x3f4cae793f531849,0x3f5389c73f59f26a,0x3f4564393f4cae79
.quad 0x3f7fb10f3f800000,0x3f7d3aac3f7ec46d,0x3f7fa6e33f800000,0x3f7cdf6c3f7e9bc9,0x3f7f9c183f800000,0x3f7c7eb03f7e70b0,0x3f7f90b13f800000,0x3f7c187a3f7e4323,0x3f7f84ab3f800000,0x3f7baccd3f7e1324,0x3f7f78083f800000,0x3f7b3bab3f7de0b1,0x3f7f6ac73f800000,0x3f7ac5163f7dabcc,0x3f7f5ce93f800000,0x3f7a49103f7d7474
.quad 0x3f7f4e6d3f800000,0x3f79c79d3f7d3aac,0x3f7f3f543f800000,0x3f7940c03f7cfe73,0x3f7f2f9d3f800000,0x3f78b47b3f7cbfc9,0x3f7f1f493f800000,0x3f7822d13f7c7eb0,0x3f7f0e583f800000,0x3f778bc53f7c3b28,0x3f7efcc93f800000,0x3f76ef5b3f7bf531,0x3f7eea9d3f800000,0x3f764d973f7baccd,0x3f7ed7d43f800000,0x3f75a67b3f7b61fc
.quad 0x3f7853f83f7b14be,0x3f7109083f74fa0b,0x3f77583a3f7a7302,0x3f6f20b03f73913f,0x3f764d973f79c79d,0x3f6d1c1d3f721352,0x3f75341d3f791298,0x3f6afb8c3f708066,0x3f740bdd3f7853f8,0x3f68bf3c3f6ed89e,0x3f72d4eb3f778bc5,0x3f6667713f6d1c1d,0x3f718f573f76ba07,0x3f63f4733f6b4b0c,0x3f703b373f75dec6,0x3f61668a3f696591
.quad 0x3f6ed89e3f74fa0b,0x3f5ebe053f676bd8,0x3f6d67a13f740bdd,0x3f5bfb343f655e0b,0x3f6be8583f731447,0x3f591e6a3f633c5a,0x3f6a5ad93f721352,0x3f5627fe3f6106f2,0x3f68bf3c3f710908,0x3f5318493f5ebe05,0x3f6715993f6ff573,0x3f4fefa83f5c61c7,0x3f655e0b3f6ed89e,0x3f4cae793f59f26a,0x3f6398ac3f6db293,0x3f4955213f577026
.quad 0x3f676bd83f6c835e,0x3f5b941a3f61c598,0x3f644fac3f6a09a7,0x3f5703483f5df6be,0x3f6106f23f676bd8,0x3f5233c63f59f26a,0x3f5d924d3f64aa59,0x3f4d26fd3f55b993,0x3f59f26a3f61c598,0x3f47de653f514d3d,0x3f5627fe3f5ebe05,0x3f425b893f4cae79,0x3f5233c63f5b941a,0x3f3ca0033f47de65,0x3f4e16893f584853,0x3f36ad7f3f42de29
.quad 0x3f49d1123f54db31,0x3f3085bb3f3daef9,0x3f4564393f514d3d,0x3f2a2a803f385216,0x3f40d0da3f4d9f02,0x3f239da93f32c8c9,0x3f3c17d93f49d112,0x3f1ce11f3f2d1469,0x3f373a233f45e403,0x3f15f6d93f273656,0x3f3238aa3f41d870,0x3f0ee0db3f212ff9,0x3f2d14693f3daef9,0x3f07a1363f1b02c6,0x3f27ce613f396842,0x3f003a063f14b039
.quad 0x3f4d9f023f54db31,0x3f3daef93f45e403,0x3f4760853f4f7a1f,0x3f3592e73f3ebc1b,0x3f40d0da3f49d112,0x3f2d14693f373a23,0x3f39f2ac3f43e200,0x3f24381a3f2f61a5,0x3f32c8c93f3daef9,0x3f1b02c63f273656,0x3f2b561b3f373a23,0x3f11796b3f1ebc12,0x3f239da93f3085bb,0x3f07a1363f15f6d9,0x3f1ba2993f299415,0x3efafef73f0cead0
.quad 0x3f13682a3f226799,0x3ee633753f039c3d,0x3f0af1b73f1b02c6,0x3ed0eb2a3ef41f07,0x3f0242b13f13682a,0x3ebb31a03ee0924f,0x3ef2bd433f0b9a6b,0x3ea5129f3ecc9b8b,0x3ee0924f3f039c3d,0x3e8e9a223eb8442a,0x3ece0bea3ef6e0cb,0x3e6fa8b23ea395c5,0x3ebb31a03ee63375,0x3e419b373e8e9a22,0x3ea80b1f3ed53641,0x3e1324ca3e72b651
.quad 0,0,0x3b490fc600000000,0x3c16cb583bc90f88,0x3bc90f8800000000,0x3c96c9b63c490e90,0x3c16cb5800000000,0x3ce22a7a3c96c9b6,0x3c490e9000000000,0x3d16c32c3cc90ab0,0x3c7b514b00000000,0x3d3c6dd53cfb49ba,0x3c96c9b600000000,0x3d6214693d16c32c,0x3cafea6900000000,0x3d83db0a3d2fe007
.quad 0x3cc90ab000000000,0x3d96a9053d48fb30,0x3ce22a7a00000000,0x3da973ba3d621469,0x3cfb49ba00000000,0x3dbc3ac33d7b2b74,0x3d0a342f00000000,0x3dcefdb73d8a200a,0x3d16c32c00000000,0x3de1bc2e3d96a905,0x3d2351cb00000000,0x3df475c03da3308c,0x3d2fe00700000000,0x3e0395023dafb680,0x3d3c6dd500000000,0x3e0cec4a3dbc3ac3
.quad 0,0,0x3c7b514b3c490e90,0x3cafea693c96c9b6,0x3cfb49ba3cc90ab0,0x3d2fe0073d16c32c,0x3d3c6dd53d16c32c,0x3d83db0a3d621469,0x3d7b2b743d48fb30,0x3dafb6803d96a905,0x3d9cecf93d7b2b74,0x3ddb7d373dbc3ac3,0x3dbc3ac33d96a905,0x3e0395023de1bc2e,0x3ddb7d373dafb680,0x3e195be03e039502
.quad 0x3dfab2733dc8bd36,0x3e2f10a23e164083,0x3e0cec4a3de1bc2e,0x3e44b0b93e28defc,0x3e1c76de3dfab273,0x3e5a39973e3b6ecf,0x3e2bf8043e09cf86,0x3e6fa8b23e4dee60,0x3e3b6ecf3e164083,0x3e827dc03e605c13,0x3e4ada4f3e22abb6,0x3e8d17c03e72b651,0x3e5a39973e2f10a2,0x3e97a1173e827dc0,0x3e698bba3e3b6ecf,0x3ea218873e8b9507
.quad 0,0,0x3ce22a7a3cc90ab0,0x3d0a342f3cfb49ba,0x3d6214693d48fb30,0x3d8a200a3d7b2b74,0x3da973ba3d96a905,0x3dcefdb73dbc3ac3,0x3de1bc2e3dc8bd36,0x3e09cf863dfab273,0x3e0cec4a3dfab273,0x3e2bf8043e1c76de,0x3e28defc3e164083,0x3e4dee603e3b6ecf,0x3e44b0b93e2f10a2,0x3e6fa8b23e5a3997
.quad 0x3e605c133e47c5c2,0x3e888e933e78cfcc,0x3e7bdba43e605c13,0x3e9920fe3e8b9507,0x3e8b95073e78cfcc,0x3ea986c43e9aa086,0x3e9920fe3e888e93,0x3eb9bb1e3ea986c4,0x3ea68f123e94a031,0x3ec9b9533eb8442a,0x3eb3dca53ea09ae5,0x3ed97cb93ec6d529,0x3ec1071e3eac7cd4,0x3ee900b73ed53641,0x3ece0bea3eb8442a,0x3ef840c83ee363fa
.quad 0,0,0x3d2351cb3d16c32c,0x3d3c6dd53d2fe007,0x3da3308c3d96a905,0x3dbc3ac33dafb680,0x3df475c03de1bc2e,0x3e0cec4a3e039502,0x3e22abb63e164083,0x3e3b6ecf3e2f10a2,0x3e4ada4f3e3b6ecf,0x3e698bba3e5a3997,0x3e72b6513e605c13,0x3e8b95073e827dc0,0x3e8d17c03e827dc0,0x3ea218873e97a117
.quad 0x3ea09ae53e94a031,0x3eb8442a3eac7cd4,0x3eb3dca53ea68f12,0x3ece0bea3ec1071e,0x3ec6d5293eb8442a,0x3ee363fa3ed53641,0x3ed97cb93ec9b953,0x3ef840c83ee900b7,0x3eebcbbb3edae880,0x3f064b823efc5d27,0x3efdbabb3eebcbbb,0x3f102dd53f07a136,0x3f07a1363efc5d27,0x3f19c2003f10d3cd,0x3f102dd53f064b82,0x3f2302d33f19c200
.quad 0x3d48fb3000000000,0x3e1640833dc8bd36,0x3d55880e00000000,0x3e1f917b3dd53db9,0x3d62146900000000,0x3e28defc3de1bc2e,0x3d6ea03800000000,0x3e3228d43dee3876,0x3d7b2b7400000000,0x3e3b6ecf3dfab273,0x3d83db0a00000000,0x3e44b0b93e039502,0x3d8a200a00000000,0x3e4dee603e09cf86,0x3d9064b400000000,0x3e57278f3e1008b7
.quad 0x3d96a90500000000,0x3e605c133e164083,0x3d9cecf900000000,0x3e698bba3e1c76de,0x3da3308c00000000,0x3e72b6513e22abb6,0x3da973ba00000000,0x3e7bdba43e28defc,0x3dafb68000000000,0x3e827dc03e2f10a2,0x3db5f8da00000000,0x3e870ada3e354098,0x3dbc3ac300000000,0x3e8b95073e3b6ecf,0x3dc27c3900000000,0x3e901c2c3e419b37
.quad 0x3e78cfcc3e47c5c2,0x3eac7cd43e94a031,0x3e8402703e541501,0x3eb6ccc33e9d9e78,0x3e8b95073e605c13,0x3ec1071e3ea68f12,0x3e931f353e6c9a7f,0x3ecb2aae3eaf713a,0x3e9aa0863e78cfcc,0x3ed536413eb8442a,0x3ea218873e827dc0,0x3edf28a93ec1071e,0x3ea986c43e888e93,0x3ee900b73ec9b953,0x3eb0eacb3e8e9a22,0x3ef2bd433ed25a09
.quad 0x3eb8442a3e94a031,0x3efc5d273edae880,0x3ebf926f3e9aa086,0x3f02ef9f3ee363fa,0x3ec6d5293ea09ae5,0x3f07a1363eebcbbb,0x3ece0bea3ea68f12,0x3f0c42c93ef41f07,0x3ed536413eac7cd4,0x3f10d3cd3efc5d27,0x3edc53c13eb263ef,0x3f1553b73f0242b1,0x3ee363fa3eb8442a,0x3f19c2003f064b82,0x3eea66813ebe1d4a,0x3f1e1e223f0a48ad
.quad 0x3edae8803ec3ef15,0x3f039c3d3ef15aea,0x3ee79a5d3ecf7bca,0x3f0af1b73eff17b2,0x3ef41f073edae880,0x3f121eb03f064b82,0x3f003a063ee63375,0x3f19210f3f0cead0,0x3f064b823ef15aea,0x3f1ff6cb3f13682a,0x3f0c42c93efc5d27,0x3f269de33f19c200,0x3f121eb03f039c3d,0x3f2d14693f1ff6cb,0x3f17de123f08f59b,0x3f33587a3f26050a
.quad 0x3f1d7fd13f0e39da,0x3f3968423f2beb4a,0x3f2302d33f13682a,0x3f3f41fc3f31a81d,0x3f2866053f187fc0,0x3f44e3f53f373a23,0x3f2da8593f1d7fd1,0x3f4a4c873f3ca003,0x3f32c8c93f226799,0x3f4f7a1f3f41d870,0x3f37c6553f273656,0x3f546b3b3f46e22a,0x3f3ca0033f2beb4a,0x3f591e6a3f4bbbf8,0x3f4154e13f3085bb,0x3f5d924d3f5064af
.quad 0x3f187fc03f0e39da,0x3f2beb4a3f226799,0x3f2093933f15f6d9,0x3f34768f3f2ac082,0x3f2866053f1d7fd1,0x3f3ca0033f32c8c9,0x3f2ff3e63f24d225,0x3f4463373f3a7ca4,0x3f373a233f2beb4a,0x3f4bbbf83f41d870,0x3f3e35c53f32c8c9,0x3f52a6493f48d8b3,0x3f44e3f53f396842,0x3f591e6a3f4f7a1f,0x3f4b41fa3f3fc767,0x3f5f20db3f55b993
.quad 0x3f514d3d3f45e403,0x3f64aa593f5b941a,0x3f5703483f4bbbf8,0x3f69b7e43f6106f2,0x3f5c61c73f514d3d,0x3f6e46be3f660f88,0x3f61668a3f5695e5,0x3f7254703f6aab7b,0x3f660f883f5b941a,0x3f75dec63f6ed89e,0x3f6a5ad93f604621,0x3f78e3d63f7294f8,0x3f6e46be3f64aa59,0x3f7b61fc3f75dec6,0x3f71d19f3f68bf3c,0x3f7d57de3f78b47b
.quad 0x3f7f3f803f803f80,0x3f7c3f7d3f7e3f7f,0x3f7a3f7d3f7f3f80,0x3f5f3f673f6f3f75,0x3f5f3f713f7c3f80,0x3eb83f043f273f46,0x3f313f5c3f773f80,0xbea1bd493e603ef1,0x3ee63f3e3f6f3f80,0xbf58bf18be893dc9,0x3e2f3f183f653f80,0xbf7ebf71bf31be95,0xbdfb3edb3f583f80,0xbf31bf78bf73bf22,0xbecf3e793f4a3f80,0xbd97bf2cbf7cbf62
.quad 0xbf273d493f393f80,0x3f13be16bf4abf7f,0xbf58be163f273f80,0x3f773edbbecfbf75,0xbf77beac3f133f80,0x3f6a3f5c3d97bf46,0xbf80bf043efc3f80,0x3ee63f803f09bef1,0xbf73bf2c3ecf3f80,0xbe603f4e3f5fbdc9,0xbf51bf4e3ea13f80,0xbf4a3eac3f803e95,0xbf1dbf673e603f80,0xbf80be793f653f22,0xbeb8bf783dfb3f80,0xbf42bf3e3f133f62
.quad 0x3f773f783f7a3f7b,0x3f6f3f713f733f75,0x3f313f3e3f4a3f55,0x3ee63f043f133f22,0xbea1be163cc93e48,0xbf58bf3ebf1dbef1,0xbf7cbf67bf42bf0e,0xbf1dbf4ebf6fbf7f,0xbf1dbf5cbf7cbf7b,0x3f393edb3d97be95,0x3ecfbd49befcbf55,0x3f423f783f7a3f46,0x3f7f3f4e3eb8be48,0xbf13bd493efc3f62,0x3f093f713f733f0e,0xbf5fbf7dbf31bdc9
.quad 0xbefc3e793f583f7b,0x3ecfbeacbf65bf75,0xbf80bf2c3dfb3f55,0x3f733f5c3e2fbf22,0xbee6bf7dbf313e48,0xbe603f2c3f7e3ef1,0x3f13bedbbf7fbf0e,0xbf7ebf183ecf3f7f,0x3f7e3f04bf13bf7b,0x3cc9bf67bf423e95,0x3eb83f803e89bf55,0x3f7f3e79bf58bf46,0xbf273f183f6abe48,0x3e2f3f803e89bf62,0xbf7abeac3f653f0e,0xbf773e163f803dc9
.quad 0x3f653f673f6a3f6d,0x3f583f5c3f5f3f62,0x3e2f3e793ea13ec4,0xbdfbbd493cc93dc9,0xbf7ebf80bf7abf6d,0xbf31bf4ebf65bf75,0x3ecf3e16bdfbbec4,0x3f7f3f713f513f22,0x3f423f713f803f6d,0xbf13be793dfb3ef1,0xbf58bf04bd973ec4,0xbe89bf2cbf6fbf7f,0xbe89bf3ebf7cbf6d,0x3f6a3f7d3f423e95,0x3f803f4e3e89bec4,0xbf65bedb3e603f46
.quad 0xbea13edb3f6f3f6d,0x3e60bf04bf77bf62,0xbf51bf78bee63ec4,0x3f1d3f803f31bdc9,0x3f4abd49bf58bf6d,0xbf80bf183ea13f75,0x3eb83f7d3f1dbec4,0x3f27beacbf7cbf22,0xbf7fbeac3f393f6d,0x3e2f3f783f1dbef1,0x3e60bf5cbf423ec4,0xbf5fbf3e3ecf3f7f,0x3f5f3f2cbf13bf6d,0x3f6fbe16bf7fbe95,0xbf393f183f5fbec4,0xbea13f673f09bf46
.quad 0x3f4a3f4e3f513f55,0x3f393f3e3f423f46,0xbecfbeacbe89be48,0xbf27bf18bf09bef1,0xbd97be79becfbf0e,0x3f133edb3e893dc9,0x3f093f3e3f653f7b,0xbefcbe793cc93e95,0xbf5fbf7dbf7abf55,0x3ecf3d49bea1bf22,0x3f803f673f1d3e48,0xbea13e163f133f62,0xbf65bf043cc93f0e,0x3e60beacbf4abf7f,0x3f13bd49bf27bf7b,0xbdfb3f043f6f3f75
.quad 0xbdfb3f183f7c3f55,0x3cc9bf2cbf7fbf46,0xbeb8bf71bf5fbe48,0x3d973f4e3f7a3ef1,0x3f423f783eb8bf0e,0xbe2fbf67bf5fbdc9,0xbf7abf2c3ea13f7b,0x3e893f783f31be95,0x3f773e16bf58bf55,0xbeb8bf80bee63f22,0xbf393edb3f7e3e48,0x3ee63f7d3e2fbf62,0x3ea1bf5cbf313f0e,0xbf09bf713dfb3f7f,0x3e2f3f803d97bf7b,0x3f1d3f5cbecfbf75
.quad 0x3d973d493cc98000,0x3e2f3e163dfb3dc9,0xbe60be16bd978000,0xbefcbedbbeb8be95,0xbefcbeacbe2f8000,0xbf6fbf5cbf42bf22,0xbf39bf04be898000,0xbf73bf80bf7abf62,0xbf65bf2cbeb88000,0xbf09bf4ebf77bf7f,0xbf7cbf4ebee68000,0x3dfbbeacbf39bf75,0xbf7ebf67bf098000,0x3f393e79bea1bf46,0xbf6abf78bf1d8000,0x3f7f3f3e3e2fbef1
.quad 0xbf42bf80bf318000,0x3f513f7d3f1dbdc9,0xbf09bf7dbf428000,0x3e893f673f6a3e95,0xbe89bf71bf518000,0xbecf3f043f7f3f22,0x3cc9bf5cbf5f8000,0xbf65bd493f583f62,0x3ea1bf3ebf6a8000,0xbf7abf183efc3f7f,0x3f13bf18bf738000,0xbf1dbf713cc93f75,0x3f4abedbbf7a8000,0x3cc9bf78bee63f46,0x3f6fbe79bf7e8000,0x3f27bf2cbf513ef1
.quad 0x3e893e793e603e48,0x3eb83eac3ea13e95,0xbf39bf2cbf1dbf0e,0xbf65bf5cbf51bf46,0xbf73bf7dbf80bf7b,0xbf09bf2cbf4abf62,0xbe2fbedbbf27bf55,0x3f4a3f183eb83dc9,0x3f4a3f043e2fbe48,0x3f313f673f7f3f75,0x3f6a3f803f5f3f0e,0xbf27be793e603f22,0x3d973f183f6f3f7b,0xbf51bf80bf5fbef1,0xbf58beac3ea13f55,0x3efcbe16bf39bf7f
.quad 0xbf5fbf78bf093e48,0x3f6a3f713ee6be95,0x3cc9bf3ebf7ebf0e,0xbea13f043f7c3f46,0x3f653e16bf39bf7b,0xbf7abf3e3dfb3f62,0x3f513f673d97bf55,0x3dfbbf4ebf6abdc9,0xbdfb3f5c3f51be48,0x3f803edbbf27bf75,0xbf6f3d493f773f0e,0x3d973f783f09bf22,0xbf42bf4e3ecf3f7b,0xbf7cbd493f773ef1,0x3e60bf71bee63f55,0xbe89bf7d3cc93f7f
.quad 0x3ee63edb3ecf3ec4,0x3f093f043efc3ef1,0xbf7cbf78bf73bf6d,0xbf7ebf80bf80bf7f,0x3dfbbd49be60bec4,0x3f393f183ee63e95,0x3f6a3f7d3f7e3f6d,0x3d973eac3f133f46,0xbf27beac3cc93ec4,0xbf51bf78bf7ebf62,0xbf09bf5cbf7fbf6d,0x3f773f3e3eb8bdc9,0x3f773f2c3e2fbec4,0xbecf3e163f273f75,0xbcc93f183f773f6d,0xbee6bf67bf7abf22
.quad 0xbf73bf67beb83ec4,0x3f7a3f5c3e89bef1,0x3f13be79bf65bf6d,0xbf4abd493f393f7f,0x3f1d3f803f09bec4,0x3cc9bf4ebf73be95,0xbf6fbe163f4a3f6d,0x3f423f713e2fbf46,0xbd97bf71bf313ec4,0xbf7cbe793f4a3f62,0x3f7a3f04bf27bf6d,0x3efcbf2cbf6a3dc9,0xbefc3f3e3f51bec4,0x3eb83f7d3d97bf75,0xbf31bf4e3efc3f6d,0xbf73bedb3f583f22
.quad 0x3f1d3f183f133f0e,0x3f313f2c3f273f22,0xbf6abf71bf77bf7b,0xbf42bf4ebf58bf62,0x3f7f3f783f6a3f55,0x3f513f673f773f7f,0xbf58bf2cbee6be48,0xbf5fbf78bf80bf75,0x3efc3e16be60bf0e,0x3f6a3f803f733f46,0xbcc93edb3f4a3f7b,0xbf73bf7dbf51bef1,0xbee6bf5cbf80bf55,0x3f7a3f713f1d3dc9,0x3f513f803f423e48,0xbf7ebf5cbeb83e95
.quad 0xbf7ebf4ebe2f3f0e,0x3f803f3e3d97bf22,0x3f6f3eacbefcbf7b,0xbf7fbf183e603f62,0xbf273e793f6f3f55,0x3f7c3edbbefcbf7f,0x3e60bf3ebf73be48,0xbf77be793f393f75,0x3e893f7d3f09bf0e,0x3f6f3d49bf65bf46,0xbf31bf673dfb3f7b,0xbf653e163f7c3ef1,0x3f733f04bf39bf55,0x3f58beacbf7ebdc9,0xbf7c3d493f7f3e48,0xbf4a3f043f6abe95
.quad 0x3f273f2c3f313f35,0x3f133f183f1d3f22,0xbf58bf4ebf42bf35,0xbf77bf71bf6abf62,0x3f773f673f513f35,0x3f6a3f783f7f3f7f,0xbf80bf78bf5fbf35,0xbee6bf2cbf58bf75,0x3f733f803f6a3f35,0xbe603e163efc3f46,0xbf51bf7dbf73bf35,0x3f4a3edbbcc9bef1,0x3f1d3f713f7a3f35,0xbf80bf5cbee63dc9,0xbeb8bf5cbf7ebf35,0x3f423f803f513e95
.quad 0x3d973f3e3f803f35,0xbe2fbf4ebf7ebf22,0x3e60bf18bf7fbf35,0xbefc3eac3f6f3f62,0xbefc3edb3f7c3f35,0x3f6f3e79bf27bf7f,0x3f39be79bf77bf35,0xbf73bf3e3e603f75,0xbf653d493f6f3f35,0x3f093f7d3e89bf46,0x3f7c3e16bf65bf35,0x3dfbbf67bf313ef1,0xbf7ebeac3f583f35,0xbf393f043f73bdc9,0x3f6a3f04bf4abf35,0x3f7f3d49bf7cbe95
.quad 0x3efc3f043f093f0e,0x3ecf3edb3ee63ef1,0xbf80bf80bf7ebf7b,0xbf73bf78bf7cbf7f,0x3ee63f183f393f55,0xbe60bd493dfb3e95,0x3f133eac3d97be48,0x3f7e3f7d3f6a3f46,0xbf7ebf78bf51bf0e,0x3cc9beacbf27bf62,0x3eb83f3e3f773f7b,0xbf7fbf5cbf09bdc9,0x3f273e16becfbf55,0x3e2f3f2c3f773f75,0xbf7abf67bee63e48,0x3f773f18bcc9bf22
.quad 0x3e893f5c3f7a3f0e,0xbeb8bf67bf73bef1,0x3f39bd49bf4abf7b,0xbf65be793f133f7f,0xbf73bf4e3cc93f55,0x3f093f803f1dbe95,0x3e2f3f713f42be48,0x3f4abe16bf6fbf46,0x3f4abe79bf7cbf0e,0xbf31bf71bd973f62,0xbf6abf2c3efc3f7b,0xbf273f043f7a3dc9,0x3d973f7d3eb8bf55,0x3f513f3ebefcbf75,0x3f58bedbbf733e48,0x3efcbf4ebf313f22
.quad 0x3ea13eac3eb83ec4,0x3e603e793e893e95,0xbf51bf5cbf65bf6d,0xbf1dbf2cbf39bf46,0xbf4abf2cbf09bec4,0xbf80bf7dbf73bf62,0x3eb83f183f4a3f6d,0xbf27bedbbe2f3dc9,0x3f7f3f673f313ec4,0x3e2f3f043f4a3f75,0x3e60be79bf27bf6d,0x3f5f3f803f6a3f22,0xbf5fbf80bf51bec4,0x3f6f3f183d97bef1,0xbf39be163efc3f6d,0x3ea1beacbf58bf7f
.quad 0x3ee63f713f6a3ec4,0xbf09bf78bf5fbe95,0x3f7c3f04bea1bf6d,0xbf7ebf3e3cc93f46,0x3dfbbf3ebf7abec4,0xbf393e163f653f62,0xbf6abf4e3dfb3f6d,0x3d973f673f51bdc9,0xbf273edb3f803ec4,0x3f513f5cbdfbbf75,0x3f093f783d97bf6d,0x3f773d49bf6fbf22,0x3f77bd49bf7cbec4,0x3ecfbf4ebf423ef1,0x3cc9bf7dbe893f6d,0xbee6bf713e603f7f
.quad 0x3dfb3e163e2f3e48,0x3cc93d493d973dc9,0xbeb8bedbbefcbf0e,0xbd97be16be60be95,0xbf42bf5cbf6fbf7b,0xbe2fbeacbefcbf22,0xbf7abf80bf73bf55,0xbe89bf04bf39bf62,0xbf77bf4ebf09be48,0xbeb8bf2cbf65bf7f,0xbf39beac3dfb3f0e,0xbee6bf4ebf7cbf75,0xbea13e793f393f7b,0xbf09bf67bf7ebf46,0x3e2f3f3e3f7f3f55,0xbf1dbf78bf6abef1
.quad 0x3f1d3f7d3f513e48,0xbf31bf80bf42bdc9,0x3f6a3f673e89bf0e,0xbf42bf7dbf093e95,0x3f7f3f04becfbf7b,0xbf51bf71be893f22,0x3f58bd49bf65bf55,0xbf5fbf5c3cc93f62,0x3efcbf18bf7abe48,0xbf6abf3e3ea13f7f,0x3cc9bf71bf1d3f0e,0xbf73bf183f133f75,0xbee6bf783cc93f7b,0xbf7abedb3f4a3f46,0xbf51bf2c3f273f55,0xbf7ebe793f6f3ef1
.quad 0x3f423f3e3f393f35,0x3f513f4e3f4a3f46,0xbf09bf18bf27bf35,0xbe89beacbecfbef1,0x3e893edb3f133f35,0xbecfbe79bd973dc9,0x3cc9be79befcbf35,0x3f653f3e3f093e95,0xbea13d493ecf3f35,0xbf7abf7dbf5fbf22,0x3f133e16bea1bf35,0x3f1d3f673f803f62,0xbf4abeac3e603f35,0x3cc9bf04bf65bf7f,0x3f6f3f04bdfbbf35,0xbf27bd493f133f75
.quad 0xbf7fbf2c3cc93f35,0x3f7c3f18bdfbbf46,0x3f7a3f4e3d97bf35,0xbf5fbf71beb83ef1,0xbf5fbf67be2f3f35,0x3eb83f783f42bdc9,0x3f313f783e89bf35,0x3ea1bf2cbf7abe95,0xbee6bf80beb83f35,0xbf583e163f773f22,0x3e2f3f7d3ee6bf35,0x3f7e3edbbf39bf62,0x3dfbbf71bf093f35,0xbf31bf5c3ea13f7f,0xbecf3f5c3f1dbf35,0x3d973f803e2fbf75
.quad 0x3f5f3f5c3f583f55,0x3f6a3f673f653f62,0x3cc9bd49bdfbbe48,0x3ea13e793e2f3dc9,0xbf65bf4ebf31bf0e,0xbf7abf80bf7ebf75,0x3f513f713f7f3f7b,0xbdfb3e163ecf3f22,0x3dfbbe79bf13bf55,0x3f803f713f423ef1,0xbf6fbf2cbe893e48,0xbd97bf04bf58bf7f,0x3f423f7d3f6a3f0e,0xbf7cbf3ebe893e95,0x3e60bedbbf65bf7b,0x3e893f4e3f803f46
.quad 0xbf77bf043e603f55,0x3f6f3edbbea1bf62,0x3f313f803f1dbe48,0xbee6bf78bf51bdc9,0x3ea1bf18bf80bf0e,0xbf58bd493f4a3f75,0xbf7cbeac3f273f7b,0x3f1d3f7d3eb8bf22,0x3f1d3f783e2fbf55,0x3f39beacbf7fbef1,0x3ecfbf3ebf5f3e48,0xbf42bf5c3e603f7f,0xbf7fbe163f6f3f0e,0xbf133f2c3f5fbe95,0x3f093f67bea1bf7b,0x3f5f3f18bf39bf46
.quad 0x3f733f713f6f3f6d,0x3f7a3f783f773f75,0x3f133f043ee63ec4,0x3f4a3f3e3f313f22,0xbf1dbf3ebf58bf6d,0x3cc9be16bea1bef1,0xbf6fbf4ebf1dbec4,0xbf42bf67bf7cbf7f,0x3d973edb3f393f6d,0xbf7cbf5cbf1dbe95,0x3f7a3f783f423ec4,0xbefcbd493ecf3f46,0x3efcbd49bf13bf6d,0x3eb83f4e3f7f3f62,0xbf31bf7dbf5fbec4,0x3f733f713f09bdc9
.quad 0xbf65beac3ecf3f6d,0x3f583e79befcbf75,0x3e2f3f5c3f733ec4,0x3dfbbf2cbf80bf22,0x3f7e3f2cbe60bf6d,0xbf31bf7dbee63ef1,0x3ecfbf18bf7ebec4,0xbf7fbedb3f133f7f,0xbf42bf673cc93f6d,0xbf133f043f7e3e95,0xbf583e793f7f3ec4,0x3e893f803eb8bf46,0x3e893f803e2fbf6d,0x3f6a3f18bf27bf62,0x3f803e16bf77bec4,0x3f65beacbf7a3dc9
.quad 0x3f7e3f7d3f7c3f7b,0x3f803f803f7f3f7f,0x3f6f3f673f5f3f55,0x3f7f3f7d3f7a3f75,0x3f273f043eb83e48,0x3f7c3f713f5f3f46,0x3e60bd49bea1bf0e,0x3f773f5c3f313ef1,0xbe89bf18bf58bf7b,0x3f6f3f3e3ee63dc9,0xbf31bf71bf7ebf55,0x3f653f183e2fbe95,0xbf73bf78bf31be48,0x3f583edbbdfbbf22,0xbf7cbf2cbd973f0e,0x3f4a3e79becfbf62
.quad 0xbf4abe163f133f7b,0x3f393d49bf27bf7f,0xbecf3edb3f773f55,0x3f27be16bf58bf75,0x3d973f5c3f6a3e48,0x3f13beacbf77bf46,0x3f093f803ee6bf0e,0x3efcbf04bf80bef1,0x3f5f3f4ebe60bf7b,0x3ecfbf2cbf73bdc9,0x3f803eacbf4abf55,0x3ea1bf4ebf513e95,0x3f65be79bf80be48,0x3e60bf67bf1d3f22,0x3f13bf3ebf423f0e,0x3dfbbf78beb83f62
.quad 0x3f803f803f803f80,0x8000800080008000,0x3f773f7c3f7f3f80,0xbe89be2fbd973cc9,0x3f5c3f713f7d3f80,0xbf04beacbe163d49,0x3f313f5f3f7a3f7f,0xbf39befcbe603d97,0x3ef13f463f753f7f,0xbf62bf22be953dc9,0x3e603f273f6f3f7e,0xbf7abf42beb83dfb,0xbd493f043f673f7d,0xbf80bf5cbedb3e16,0xbea13eb83f5f3f7c,0xbf73bf6fbefc3e2f
.quad 0xbf0e3e483f553f7b,0xbf55bf7bbf0e3e48,0xbf423cc93f4a3f7a,0xbf27bf80bf1d3e60,0xbf67be163f3e3f78,0xbedbbf7dbf2c3e79,0xbf7cbea13f313f77,0xbe2fbf73bf393e89,0xbf7fbef13f223f75,0x3dc9bf62bf463e95,0xbf6fbf1d3f133f73,0x3eb8bf4abf513ea1,0xbf4ebf3e3f043f71,0x3f18bf2cbf5c3eac,0xbf1dbf583ee63f6f,0x3f4abf09bf653eb8
.quad 0x3f803f803f803f80,0x8000800080008000,0x3f4a3f583f653f6f,0xbf1dbf09bee6beb8,0x3e793edb3f183f3e,0xbf78bf67bf4ebf2c,0xbecfbdfb3e2f3ee6,0xbf6abf7ebf7cbf65,0xbf62bf22be953dc9,0xbef1bf46bf75bf7f,0xbf7cbf73bf31be89,0x3e2fbea1bf39bf77,0xbf2cbf78bf71bf18,0x3f3e3e79beacbf4e,0xbd97bf31bf7ebf58,0x3f7f3f393dfbbf09
.quad 0x3f0ebe48bf55bf7b,0x3f553f7b3f0ebe48,0x3f733eb8befcbf7c,0x3ea13f6f3f5f3e2f,0x3f713f4ebd49bf5c,0xbeac3f183f803f04,0x3f093f7f3ecfbf1d,0xbf583d973f6a3f4a,0xbdc93f623f46be95,0xbf7fbef13f223f75,0xbf313efc3f7a3d97,0xbf39bf5f3e603f7f,0xbf7dbd493f783edb,0xbe16bf80be793f67,0xbf5fbf133f423f39,0x3efcbf51bf273f31
.quad 0x3f803f803f803f80,0x8000800080008000,0x3efc3f133f273f39,0xbf5fbf51bf42bf31,0xbf04beacbe163d49,0xbf5cbf71bf7dbf80,0xbf80bf77bf58bf27,0x3cc9be89bf09bf42,0xbef1bf46bf75bf7f,0x3f623f223e95bdc9,0x3f093d97becfbf4a,0x3f583f7f3f6a3f1d,0x3f803f5c3edbbe16,0xbd493f043f673f7d,0x3ee63f6a3f773f13,0xbf65becf3e893f51
.quad 0xbf0e3e483f553f7b,0xbf55bf7bbf0e3e48,0xbf7fbf313dfb3f58,0x3d97bf39bf7ebf09,0xbedbbf7dbf2c3e79,0x3f673e16bf3ebf78,0x3f13bee6bf80befc,0x3f513f653cc9bf5f,0x3f7f3ef1bf22bf75,0xbdc93f623f46be95,0x3ecf3f7e3e2fbf65,0xbf6a3dfb3f7c3ee6,0xbf183f2c3f5cbeac,0xbf4ebf3e3f043f71,0xbf7ebe603f733ecf,0x3dfbbf7abea13f6a
.quad 0x3f803f803f803f80,0x8000800080008000,0x3dfb3e603ea13ecf,0xbf7ebf7abf73bf6a,0xbf78bf67bf4ebf2c,0xbe79bedbbf18bf3e,0xbeb8bf1dbf51bf73,0x3f6f3f4a3f133ea1,0x3f623f223e95bdc9,0x3ef13f463f753f7f,0x3f133f653f803f5f,0xbf51bee63cc93efc,0xbf3ebe793eac3f4e,0xbf2cbf78bf71bf18,0xbf42bf80bf4abe60,0x3f273cc9bf1dbf7a
.quad 0x3f0ebe48bf55bf7b,0x3f553f7b3f0ebe48,0x3f653f6a3e89bf13,0xbee63ecf3f773f51,0xbeac3f183f803f04,0xbf71bf4e3d493f5c,0xbf7abf273eb83f7e,0x3e60bf42bf6fbdfb,0x3dc9bf62bf463e95,0x3f7f3ef1bf22bf75,0x3f803e89bf58bf42,0x3cc93f773f09bf27,0x3e163f803e79bf67,0xbf7dbd493f783edb,0xbf773e2f3f7f3cc9,0xbe89bf7c3d973f80
.quad 0x3f803f803f803f80,0x8000800080008000,0xbe89be2fbd973cc9,0xbf77bf7cbf7fbf80,0xbf5cbf71bf7dbf80,0x3f043eac3e16bd49,0x3f393efc3e60bd97,0x3f313f5f3f7a3f7f,0x3ef13f463f753f7f,0xbf62bf22be953dc9,0xbf7abf42beb83dfb,0xbe60bf27bf6fbf7e,0x3d49bf04bf67bf7d,0x3f803f5c3edbbe16,0x3f733f6f3efcbe2f,0xbea13eb83f5f3f7c
.quad 0xbf0e3e483f553f7b,0xbf55bf7bbf0e3e48,0xbf27bf80bf1d3e60,0x3f42bcc9bf4abf7a,0x3f673e16bf3ebf78,0x3edb3f7d3f2cbe79,0x3e2f3f733f39be89,0xbf7cbea13f313f77,0xbf7fbef13f223f75,0x3dc9bf62bf463e95,0x3eb8bf4abf513ea1,0x3f6f3f1dbf13bf73,0x3f4e3f3ebf04bf71,0xbf183f2c3f5cbeac,0xbf4a3f093f65beb8,0xbf1dbf583ee63f6f
.quad 0x3f803f803f803f80,0x8000800080008000,0xbf1dbf09bee6beb8,0xbf4abf58bf65bf6f,0xbe79bedbbf18bf3e,0x3f783f673f4e3f2c,0x3f6a3f7e3f7c3f65,0xbecfbdfb3e2f3ee6,0xbf62bf22be953dc9,0xbef1bf46bf75bf7f,0x3e2fbea1bf39bf77,0x3f7c3f733f313e89,0x3f2c3f783f713f18,0xbf3ebe793eac3f4e,0xbf7fbf39bdfb3f09,0xbd97bf31bf7ebf58
.quad 0x3f0ebe48bf55bf7b,0x3f553f7b3f0ebe48,0x3ea13f6f3f5f3e2f,0xbf73beb83efc3f7c,0xbf71bf4e3d493f5c,0x3eacbf18bf80bf04,0x3f58bd97bf6abf4a,0x3f093f7f3ecfbf1d,0xbdc93f623f46be95,0xbf7fbef13f223f75,0xbf39bf5f3e603f7f,0x3f31befcbf7abd97,0x3f7d3d49bf78bedb,0x3e163f803e79bf67,0xbefc3f513f27bf31,0xbf5fbf133f423f39
.quad 0x3f803f803f803f80,0x8000800080008000,0xbf5fbf51bf42bf31,0xbefcbf13bf27bf39,0x3f043eac3e16bd49,0x3f5c3f713f7d3f80,0xbcc93e893f093f42,0xbf80bf77bf58bf27,0xbef1bf46bf75bf7f,0x3f623f223e95bdc9,0x3f583f7f3f6a3f1d,0xbf09bd973ecf3f4a,0xbf80bf5cbedb3e16,0x3d49bf04bf67bf7d,0x3f653ecfbe89bf51,0x3ee63f6a3f773f13
.quad 0xbf0e3e483f553f7b,0xbf55bf7bbf0e3e48,0x3d97bf39bf7ebf09,0x3f7f3f31bdfbbf58,0x3edb3f7d3f2cbe79,0xbf67be163f3e3f78,0xbf51bf65bcc93f5f,0x3f13bee6bf80befc,0x3f7f3ef1bf22bf75,0xbdc93f623f46be95,0xbf6a3dfb3f7c3ee6,0xbecfbf7ebe2f3f65,0x3f18bf2cbf5c3eac,0x3f4e3f3ebf04bf71,0xbdfb3f7a3ea1bf6a,0xbf7ebe603f733ecf
.quad 0x3f803f803f803f80,0x8000800080008000,0xbf7ebf7abf73bf6a,0xbdfbbe60bea1becf,0x3f783f673f4e3f2c,0x3e793edb3f183f3e,0xbf6fbf4abf13bea1,0xbeb8bf1dbf51bf73,0x3f623f223e95bdc9,0x3ef13f463f753f7f,0xbf51bee63cc93efc,0xbf13bf65bf80bf5f,0x3f3e3e79beacbf4e,0x3f2c3f783f713f18,0xbf27bcc93f1d3f7a,0xbf42bf80bf4abe60
.quad 0x3f0ebe48bf55bf7b,0x3f553f7b3f0ebe48,0xbee63ecf3f773f51,0xbf65bf6abe893f13,0x3eacbf18bf80bf04,0x3f713f4ebd49bf5c,0xbe603f423f6f3dfb,0xbf7abf273eb83f7e,0x3dc9bf62bf463e95,0x3f7f3ef1bf22bf75,0x3cc93f773f09bf27,0xbf80be893f583f42,0xbe16bf80be793f67,0x3f7d3d49bf78bedb,0x3e893f7cbd97bf80,0xbf773e2f3f7f3cc9
.quad 0x3f803f803f803f80,0x8000800080008000,0xbf77bf7cbf7fbf80,0x3e893e2f3d97bcc9,0x3f5c3f713f7d3f80,0xbf04beacbe163d49,0xbf31bf5fbf7abf7f,0x3f393efc3e60bd97,0x3ef13f463f753f7f,0xbf62bf22be953dc9,0xbe60bf27bf6fbf7e,0x3f7a3f423eb8bdfb,0xbd493f043f673f7d,0xbf80bf5cbedb3e16,0x3ea1beb8bf5fbf7c,0x3f733f6f3efcbe2f
.quad 0xbf0e3e483f553f7b,0xbf55bf7bbf0e3e48,0x3f42bcc9bf4abf7a,0x3f273f803f1dbe60,0xbf67be163f3e3f78,0xbedbbf7dbf2c3e79,0x3f7c3ea1bf31bf77,0x3e2f3f733f39be89,0xbf7fbef13f223f75,0x3dc9bf62bf463e95,0x3f6f3f1dbf13bf73,0xbeb83f4a3f51bea1,0xbf4ebf3e3f043f71,0x3f18bf2cbf5c3eac,0x3f1d3f58bee6bf6f,0xbf4a3f093f65beb8
.quad 0x3f803f803f803f80,0x8000800080008000,0xbf4abf58bf65bf6f,0x3f1d3f093ee63eb8,0x3e793edb3f183f3e,0xbf78bf67bf4ebf2c,0x3ecf3dfbbe2fbee6,0x3f6a3f7e3f7c3f65,0xbf62bf22be953dc9,0xbef1bf46bf75bf7f,0x3f7c3f733f313e89,0xbe2f3ea13f393f77,0xbf2cbf78bf71bf18,0x3f3e3e79beacbf4e,0x3d973f313f7e3f58,0xbf7fbf39bdfb3f09
.quad 0x3f0ebe48bf55bf7b,0x3f553f7b3f0ebe48,0xbf73beb83efc3f7c,0xbea1bf6fbf5fbe2f,0x3f713f4ebd49bf5c,0xbeac3f183f803f04,0xbf09bf7fbecf3f1d,0x3f58bd97bf6abf4a,0xbdc93f623f46be95,0xbf7fbef13f223f75,0x3f31befcbf7abd97,0x3f393f5fbe60bf7f,0xbf7dbd493f783edb,0xbe16bf80be793f67,0x3f5f3f13bf42bf39,0xbefc3f513f27bf31
.quad 0x3f803f803f803f80,0x8000800080008000,0xbefcbf13bf27bf39,0x3f5f3f513f423f31,0xbf04beacbe163d49,0xbf5cbf71bf7dbf80,0x3f803f773f583f27,0xbcc93e893f093f42,0xbef1bf46bf75bf7f,0x3f623f223e95bdc9,0xbf09bd973ecf3f4a,0xbf58bf7fbf6abf1d,0x3f803f5c3edbbe16,0xbd493f043f673f7d,0xbee6bf6abf77bf13,0x3f653ecfbe89bf51
.quad 0xbf0e3e483f553f7b,0xbf55bf7bbf0e3e48,0x3f7f3f31bdfbbf58,0xbd973f393f7e3f09,0xbedbbf7dbf2c3e79,0x3f673e16bf3ebf78,0xbf133ee63f803efc,0xbf51bf65bcc93f5f,0x3f7f3ef1bf22bf75,0xbdc93f623f46be95,0xbecfbf7ebe2f3f65,0x3f6abdfbbf7cbee6,0xbf183f2c3f5cbeac,0xbf4ebf3e3f043f71,0x3f7e3e60bf73becf,0xbdfb3f7a3ea1bf6a
.quad 0x3f803f803f803f80,0x8000800080008000,0xbdfbbe60bea1becf,0x3f7e3f7a3f733f6a,0xbf78bf67bf4ebf2c,0xbe79bedbbf18bf3e,0x3eb83f1d3f513f73,0xbf6fbf4abf13bea1,0x3f623f223e95bdc9,0x3ef13f463f753f7f,0xbf13bf65bf80bf5f,0x3f513ee6bcc9befc,0xbf3ebe793eac3f4e,0xbf2cbf78bf71bf18,0x3f423f803f4a3e60,0xbf27bcc93f1d3f7a
.quad 0x3f0ebe48bf55bf7b,0x3f553f7b3f0ebe48,0xbf65bf6abe893f13,0x3ee6becfbf77bf51,0xbeac3f183f803f04,0xbf71bf4e3d493f5c,0x3f7a3f27beb8bf7e,0xbe603f423f6f3dfb,0x3dc9bf62bf463e95,0x3f7f3ef1bf22bf75,0xbf80be893f583f42,0xbcc9bf77bf093f27,0x3e163f803e79bf67,0xbf7dbd493f783edb,0x3f77be2fbf7fbcc9,0x3e893f7cbd97bf80
.quad 0x3f803f803f803f80,0x8000800080008000,0x3e893e2f3d97bcc9,0x3f773f7c3f7f3f80,0xbf5cbf71bf7dbf80,0x3f043eac3e16bd49,0xbf39befcbe603d97,0xbf31bf5fbf7abf7f,0x3ef13f463f753f7f,0xbf62bf22be953dc9,0x3f7a3f423eb8bdfb,0x3e603f273f6f3f7e,0x3d49bf04bf67bf7d,0x3f803f5c3edbbe16,0xbf73bf6fbefc3e2f,0x3ea1beb8bf5fbf7c
.quad 0xbf0e3e483f553f7b,0xbf55bf7bbf0e3e48,0x3f273f803f1dbe60,0xbf423cc93f4a3f7a,0x3f673e16bf3ebf78,0x3edb3f7d3f2cbe79,0xbe2fbf73bf393e89,0x3f7c3ea1bf31bf77,0xbf7fbef13f223f75,0x3dc9bf62bf463e95,0xbeb83f4a3f51bea1,0xbf6fbf1d3f133f73,0x3f4e3f3ebf04bf71,0xbf183f2c3f5cbeac,0x3f4abf09bf653eb8,0x3f1d3f58bee6bf6f
.quad 0x3f803f803f803f80,0x8000800080008000,0x3f1d3f093ee63eb8,0x3f4a3f583f653f6f,0xbe79bedbbf18bf3e,0x3f783f673f4e3f2c,0xbf6abf7ebf7cbf65,0x3ecf3dfbbe2fbee6,0xbf62bf22be953dc9,0xbef1bf46bf75bf7f,0xbe2f3ea13f393f77,0xbf7cbf73bf31be89,0x3f2c3f783f713f18,0xbf3ebe793eac3f4e,0x3f7f3f393dfbbf09,0x3d973f313f7e3f58
.quad 0x3f0ebe48bf55bf7b,0x3f553f7b3f0ebe48,0xbea1bf6fbf5fbe2f,0x3f733eb8befcbf7c,0xbf71bf4e3d493f5c,0x3eacbf18bf80bf04,0xbf583d973f6a3f4a,0xbf09bf7fbecf3f1d,0xbdc93f623f46be95,0xbf7fbef13f223f75,0x3f393f5fbe60bf7f,0xbf313efc3f7a3d97,0x3f7d3d49bf78bedb,0x3e163f803e79bf67,0x3efcbf51bf273f31,0x3f5f3f13bf42bf39
.quad 0x3f803f803f803f80,0x8000800080008000,0x3f5f3f513f423f31,0x3efc3f133f273f39,0x3f043eac3e16bd49,0x3f5c3f713f7d3f80,0x3cc9be89bf09bf42,0x3f803f773f583f27,0xbef1bf46bf75bf7f,0x3f623f223e95bdc9,0xbf58bf7fbf6abf1d,0x3f093d97becfbf4a,0xbf80bf5cbedb3e16,0x3d49bf04bf67bf7d,0xbf65becf3e893f51,0xbee6bf6abf77bf13
.quad 0xbf0e3e483f553f7b,0xbf55bf7bbf0e3e48,0xbd973f393f7e3f09,0xbf7fbf313dfb3f58,0x3edb3f7d3f2cbe79,0xbf67be163f3e3f78,0x3f513f653cc9bf5f,0xbf133ee63f803efc,0x3f7f3ef1bf22bf75,0xbdc93f623f46be95,0x3f6abdfbbf7cbee6,0x3ecf3f7e3e2fbf65,0x3f18bf2cbf5c3eac,0x3f4e3f3ebf04bf71,0x3dfbbf7abea13f6a,0x3f7e3e60bf73becf
.quad 0x3f803f803f803f80,0x8000800080008000,0x3f7e3f7a3f733f6a,0x3dfb3e603ea13ecf,0x3f783f673f4e3f2c,0x3e793edb3f183f3e,0x3f6f3f4a3f133ea1,0x3eb83f1d3f513f73,0x3f623f223e95bdc9,0x3ef13f463f753f7f,0x3f513ee6bcc9befc,0x3f133f653f803f5f,0x3f3e3e79beacbf4e,0x3f2c3f783f713f18,0x3f273cc9bf1dbf7a,0x3f423f803f4a3e60
.quad 0x3f0ebe48bf55bf7b,0x3f553f7b3f0ebe48,0x3ee6becfbf77bf51,0x3f653f6a3e89bf13,0x3eacbf18bf80bf04,0x3f713f4ebd49bf5c,0x3e60bf42bf6fbdfb,0x3f7a3f27beb8bf7e,0x3dc9bf62bf463e95,0x3f7f3ef1bf22bf75,0xbcc9bf77bf093f27,0x3f803e89bf58bf42,0xbe16bf80be793f67,0x3f7d3d49bf78bedb,0xbe89bf7c3d973f80,0x3f77be2fbf7fbcc9
.quad 0x3f7ffffb3f800000,0x3f7fffd43f7fffec,0x3f7fffd43f800000,0x3f7ffe703f7fff4e,0x3f7fff0e3f800000,0x3f7ff7803f7ffc39,0x3f7ffdab3f800000,0x3f7feb023f7ff6ac,0x3f7ffbaa3f800000,0x3f7fd8f83f7feea7,0x3f7ff90b3f800000,0x3f7fc1613f7fe42b,0x3f7ff5ce3f800000,0x3f7fa43f3f7fd737,0x3f7ff1f33f800000,0x3f7f81913f7fc7cc
.quad 0x3f7fed7a3f800000,0x3f7f59593f7fb5ea,0x3f7fe8633f800000,0x3f7f2b973f7fa191,0x3f7fe2af3f800000,0x3f7ef84d3f7f8ac2,0x3f7fdc5c3f800000,0x3f7ebf7b3f7f717b,0x3f7fd56c3f800000,0x3f7e81233f7f55bf,0x3f7fcdde3f800000,0x3f7e3d463f7f378c,0x3f7fc5b23f800000,0x3f7df3e53f7f16e4,0x3f7fbce93f800000,0x3f7da5033f7ef3c7
.quad 0x3f7fff853f7fffb1,0x3f7fff0e3f7fff4e,0x3f7ffbaa3f7ffd39,0x3f7ff7803f7ff9c1,0x3f7fe8633f7ff0e3,0x3f7fd1b93f7fde00,0x3f7fc5b23f7fdaaf,0x3f7f8dbe3f7fac0d,0x3f7f93993f7fba9e,0x3f7f2b973f7f63ec,0x3f7f521b3f7f90b1,0x3f7eab503f7f05a4,0x3f7f013c3f7f5ce9,0x3f7e0cf73f7e913d,0x3f7ea1003f7f1f49,0x3f7d50a03f7e06c2
.quad 0x3f7e316d3f7ed7d4,0x3f7c76613f7d663d,0x3f7db28a3f7e868b,0x3f7b7e533f7cafbd,0x3f7d24603f7e2b72,0x3f7a68943f7be353,0x3f7c86f53f7dc68c,0x3f7935443f7b010e,0x3f7bda553f7d57de,0x3f77e4883f7a0904,0x3f7b1e883f7cdf6c,0x3f7676883f78fb4a,0x3f7a539b3f7c5d3a,0x3f74eb6f3f77d7f7,0x3f79799a3f7bd14d,0x3f73436b3f769f24
.quad 0x3f7ffe703f7ffec4,0x3f7ffdab3f7ffe13,0x3f7ff1f33f7ff4e6,0x3f7feb023f7feea7,0x3f7fb3823f7fc38f,0x3f7f8dbe3f7fa191,0x3f7f43293f7f6ac7,0x3f7ee5f93f7f16e4,0x3f7ea1003f7eea9d,0x3f7df3e53f7e4ec1,0x3f7dcd243f7e4323,0x3f7cb7c83f7d4959,0x3f7cc7c03f7d7474,0x3f7b31fe3f7c06e9,0x3f7b91073f7c7eb0,0x3f7962f93f7a87c1
.quad 0x3f7a29363f7b61fc,0x3f774b403f78cc3b,0x3f7890913f7a1e84,0x3f74eb6f3f76d4c4,0x3f76c76b3f78b47b,0x3f7244373f74a1d5,0x3f74ce1a3f772417,0x3f6f565e3f7233f4,0x3f72a5033f756d97,0x3f6c22bf3f6f8bb8,0x3f704c913f73913f,0x3f68aa493f6ca9c5,0x3f6dc5393f718f57,0x3f64edfe3f698ecc,0x3f6b0f793f6f6830,0x3f60eef63f663b8e
.quad 0x3f7ffcbe3f7ffd39,0x3f7ffbaa3f7ffc39,0x3f7fe2af3f7fe705,0x3f7fd8f83f7fde00,0x3f7f606f3f7f7808,0x3f7f2b973f7f46f4,0x3f7e76353f7eb069,0x3f7df3e53f7e375e,0x3f7d24603f7d906e,0x3f7c328b3f7cafbd,0x3f7b6b783f7c187a,0x3f79e87c3f7ab0cb,0x3f794c323f7a4910,0x3f7716f63f783b77,0x3f76c76b3f7822d1,0x3f73bf813f7550ed
.quad 0x3f73de283f75a67b,0x3f6fe3eb3f71f28c,0x3f70919b3f72d4eb,0x3f6b864c3f6e21eb,0x3f6ce31a3f6faf1b,0x3f66a9033f69e0d7,0x3f68d4263f6c3624,0x3f614eb13f653154,0x3f6466653f686b39,0x3f5b7a3e3f601596,0x3f5f9ba53f644fac,0x3f552ed43f5a9009,0x3f5a75d93f5fe4e9,0x3f4e6fda3f54a347,0x3f54f71a3f5b2c79,0x3f4740fa3f4e521c
.quad 0x3f7ffa6e3f7ffb11,0x3f7ff90b3f7ff9c1,0x3f7fcdde3f7fd397,0x3f7fc1613f7fc7cc,0x3f7eef373f7f0e58,0x3f7eab503f7ece34,0x3f7d5f133f7dabcc,0x3f7cb7c83f7d0dbc,0x3f7b1e883f7baccd,0x3f79e87c3f7a87c1,0x3f782f293f791298,0x3f763fde3f773e3c,0x3f7493003f75dec6,0x3f71c11b3f7333be,0x3f704c913f721352,0x3f6c701e3f6e6b6d
.quad 0x3f6b5ed53f6db293,0x3f6651843f68e907,0x3f65cd3b3f68bf3c,0x3f5f6aa13f62b0d7,0x3f5f9ba53f633c5a,0x3f57c1753f5bc7b8,0x3f58ce603f5d2d53,0x3f4f5ca93f54330f,0x3f516a2a3f5695e5,0x3f46438b3f4bf8c7,0x3f4974293f4f7a1f,0x3f3c7e033f431f4c,0x3f40f1e73f47de65,0x3f3214913f39ad85,0x3f37e9503f3fc767,0x3f2710433f2faad3
.quad 0x3f7ff7803f7ff84a,0x3f7ff5ce3f7ff6ac,0x3f7fb3823f7fba9e,0x3f7fa43f3f7fac0d,0x3f7e5fe53f7e868b,0x3f7e0cf73f7e375e,0x3f7bfe123f7c5d3a,0x3f7b31fe3f7b9a53,0x3f7890913f7940c0,0x3f7716f63f77d7f7,0x3f741b073f75341d,0x3f71c11b3f72f4ac,0x3f6ea22f3f703b37,0x3f6b37393f6cf624,0x3f682bda3f6a5ad9,0x3f6381a53f65e35e
.quad 0x3f60bee53f6398ac,0x3f5aaa313f5dc497,0x3f5863333f5bfb34,0x3f50bc213f54a347,0x3f4f21a53f5389c7,0x3f45c41c3f4a8a13,0x3f4504113f4a4c87,0x3f39d01d3f3f84c0,0x3f3a15353f404c5c,0x3f2cef5d3f33a029,0x3f2e60ae3f3592e7,0x3f1f32453f26ea2a,0x3f21f2ec3f2a2a80,0x3f10aa573f197194,0x3f14d9213f1e1e22,0x3f016a173f0b461c
.quad 0x3f7ff3f43f7ff4e6,0x3f7ff1f33f7ff2f8,0x3f7f93993f7f9c18,0x3f7f81913f7f8ac2,0x3f7db28a3f7de0b1,0x3f7d50a03f7d8285,0x3f7a539b3f7ac516,0x3f7962f93f79dd91,0x3f757bde3f764d97,0x3f73bf813f74a1d5,0x3f6f329e3f708066,0x3f6c701e3f6dd7d5,0x3f6781513f696591,0x3f6381a53f658aa0,0x3f5e738b3f6106f2,0x3f5903c53f5bc7b8
.quad 0x3f5416ed3f577026,0x3f4d08e83f509f03,0x3f487b103f4cae79,0x3f3fa6173f4422ab,0x3f3bb16d3f40d0da,0x3f30f2d33f366704,0x3f2dcd443f33e7bc,0x3f2108e93f278268,0x3f1ee37e3f26050a,0x3f1004493f178d18,0x3f0f0a8e3f173c07,0x3efc05aa3f06a10e,0x3efcb49b3f07a136,0x3ed6484f3ee9b3ae,0x3ed9d7b73eee9479,0x3eaf12c53ec4a8c8
.quad 0x3f7fefca3f7ff0e3,0x3f7fed7a3f7feea7,0x3f7f6e263f7f7808,0x3f7f59593f7f63ec,0x3f7ce73c3f7d1cdd,0x3f7c76613f7cafbd,0x3f78602a3f78e3d6,0x3f774b403f77d7f7,0x3f71e21a3f72d4eb,0x3f6fe3eb3f70e717,0x3f697a333f6afb8c,0x3f6651843f67ec29,0x3f5f397b3f61668a,0x3f5aaa313f5cfaa3,0x3f5334b53f5627fe,0x3f4d08e83f502a3b
.quad 0x3f4584373f495521,0x3f3d8d343f4196b7,0x3f3643bb3f3b0629,0x3f2c5ae73f315fad,0x3f2592243f2b561b,0x3f1999cd3f1fa841,0x3f1391403f1a6293,0x3f05754a3f0c96d7,0x3f0065853f084b92,0x3ee037f23ef0a985,0x3ed86b8b3eea6681,0x3eb37e823ec61bd2,0x3eae55c63ec27b55,0x3e8525bf3e99e0ce,0x3e82def43e9920fe,0x3e2b31cc3e58b0a4
.quad 0xba490fd900000000,0xbb16cbdbbac90fd5,0x3b16cbdb00000000,0x3be231603b96cbc1,0x3bafeda800000000,0x3c83f0f23c2fed02,0x3c0a3a7b00000000,0x3ccf52af3c8a3938,0x3c3c7dcc00000000,0x3d0d57f63cbc7a9b,0x3c6ec0aa00000000,0x3d3303853ceeba2c,0x3c90817a00000000,0x3d58ab313d107bb8,0x3ca9a24600000000,0x3d7e4e2b3d2998f6
.quad 0x3cc2c2a900000000,0x3d91f5d03d42b491,0x3cdbe29400000000,0x3da4c1613d5bce4c,0x3cf501f800000000,0x3db7895f3d74e5e9,0x3d07106200000000,0x3dca4d623d86fd94,0x3d139f7500000000,0x3ddd0d023d9386e7,0x3d202e2d00000000,0x3defc7d73da00ecf,0x3d2cbc8200000000,0x3e013ebc3dac952b,0x3d394a6c00000000,0x3e0a96bf3db919dd
.quad 0xbb7b53a9bb490fc6,0xbbafeda8bb96cbc1,0x3c3c7dcc3c16cb58,0x3c83f0f23c622fff,0x3cdbe2943cafea69,0x3d19e6dd3d03ec90,0x3d2cbc823d0a342f,0x3d71c3153d4f41af,0x3d6b7d513d3c6dd5,0x3da4c1613d8d426a,0x3d9517f93d6ea038,0x3dd08dc43db2d7bb,0x3db4684e3d9064b4,0x3dfc41873dd85d89,0x3dd3adc53da973ba,0x3e13ebc13dfdd092
.quad 0x3df2e67c3dc27c39,0x3e29a5483e1196cc,0x3e0908483ddb7d37,0x3e3f4ac73e2438ad,0x3e1895113df475c0,0x3e54d9b13e36cc50,0x3e2818aa3e06b26e,0x3e6a4f793e495018,0x3e3792223e1324ca,0x3e7fa9983e5bc26a,0x3e47008b3e1f917b,0x3e8a72c33e6e21ab,0x3e5662f83e2bf804,0x3e9500623e803622,0x3e65b87a3e3857ec,0x3e9f7c6a3e895050
.quad 0xbbe23160bbc90f88,0xbc0a3a7bbbfb5330,0x3ca9a2463c96c9b6,0x3ccf52af3cbc7a9b,0x3d45d7e43d2fe007,0x3d71c3153d5bce4c,0x3d9b5c053d8a200a,0x3dbdcb2c3dac952b,0x3dd3adc53dbc3ac3,0x3e013ebc3deb199a,0x3e05eb1b3dee3876,0x3e2372353e14b2b2,0x3e21e5303e1008b7,0x3e4576073e33b4c4,0x3e3dbfad3e28defc,0x3e6740483e528b89
.quad 0x3e5975223e419b37,0x3e84638f3e712f94,0x3e7500263e5a3997,0x3e9500623e87ccc1,0x3e882dad3e72b651,0x3ea571c53e96e100,0x3e95c0b33e8586ce,0x3eb5b2ec3ea5d0e5,0x3ea3367f3e919ddd,0x3ec5bf1b3eb498d6,0x3eb08c713e9d9e78,0x3ed591a43ec33544,0x3ebdbfee3ea986c4,0x3ee525e93ed1a2aa,0x3ecace633eb554ec,0x3ef477613edfdd8d
.quad 0xbc235c30bc16cb58,0xbc3c7dccbc2fed02,0x3cf501f83ce22a7a,0x3d0d57f63d03ec90,0x3d8ed3913d83db0a,0x3da4c1613d99cb0a,0x3de02c7d3dcefdb7,0x3e013ebc3df1572e,0x3e1895113e0cec4a,0x3e2fd6b93e2438ad,0x3e40d5c43e3228d4,0x3e5e0f653e4f7838,0x3e68c7f33e57278f,0x3e85e7d93e7a55cb,0x3e882dad3e7bdba4,0x3e9c7f6a3e925e94
.quad 0x3e9bbfee3e901c2c,0x3eb2c2273ea74d25,0x3eaf12c53ea21887,0x3ec8a3fd3ebbecb6,0x3ec21e533eb3dca5,0x3ede19123ed0338a,0x3ed4dad73ec5625c,0x3ef315c23ee4180e,0x3ee740b13ed6a399,0x3f03c7573ef790dc,0x3ef948623ee79a5d,0x3f0dbc5f3f054a62,0x3f05754a3ef840c8,0x3f1764933f0e8d65,0x3f0e100c3f044889,0x3f20bab63f178d18
.quad 0xbc559f4cbc490e90,0xbc6ec0aabc622fff,0x3d202e2d3d16c32c,0x3d3303853d2998f6,0x3dbaaa543dafb680,0x3dd08dc43dc59cc6,0x3e125dce3e09cf86,0x3e2372353e1ae96b,0x3e47008b3e3b6ecf,0x3e5e0f653e528b89,0x3e7b18bc3e6c9a7f,0x3e8bf5bd3e84c4aa,0x3e97410e3e8e9a22,0x3ea86a123e9fdbee,0x3eb08c713ea68f12,0x3ec44bf23eba766e
.quad 0x3ec95ce93ebe1d4a,0x3edf831f3ed47f64,0x3ee1a1303ed53641,0x3ef9f7ee3eede280,0x3ef948623eebcbbb,0x3f09c9ae3f0345f8,0x3f0821033f00e7e4,0x3f161f933f0f343b,0x3f133f0f3f0b9a6b,0x3f21f2ec3f1ab2b8,0x3f1df6973f15f6d9,0x3f2d396f3f25b877,0x3f2840263f1ff6cb,0x3f37e9503f303cde,0x3f3214913f299415,0x3f41f9423f3a37b7
.quad 0xbc83f0f2bc7b514b,0xbc90817abc8a3938,0x3d45d7e43d3c6dd5,0x3d58ab313d4f41af,0x3de66b0c3ddb7d37,0x3dfc41873df1572e,0x3e347ab23e2bf804,0x3e4576073e3cfa15,0x3e7500263e698bba,0x3e85e7d93e803622,0x3e9a40ad3e931f35,0x3ea86a123ea159c2,0x3eb95d6c3eb0eacb,0x3eca15b53ec1c148,0x3ed7b5433ece0bea,0x3eeabfdd3ee146ee
.quad 0x3ef527f83eea6681,0x3f051f753effc5f3,0x3f08cb203f02ef9f,0x3f14355e3f0e8d65,0x3f1670f63f102dd5,0x3f228e713f1c91a2,0x3f2376fd3f1ce11f,0x3f3018653f29df57,0x3f2fcf603f28fd41,0x3f3cc1fb3f366704,0x3f3b6d013f34768f,0x3f487b103f421a0b,0x3f46438b3f3f41fc,0x3f5334b53f4ceacb,0x3f5047793f495521,0x3f5ce13e3f56cca7
.quad 0xbc9d11ecbc96c9b6,0xbca9a246bca35a1c,0x3d6b7d513d621469,0x3d7e4e2b3d74e5e9,0x3e0908483e039502,0x3e13ebc13e0e7a8b,0x3e5662f83e4dee60,0x3e6740483e5ed3a8,0x3e913d793e8b9507,0x3e9c7f6a3e96e100,0x3eb66ed83eaf713a,0x3ec44bf23ebd628b,0x3eda8d9b3ed25a09,0x3eeabfdd3ee2afc4,0x3efd63653ef41f07,0x3f07cbd53f0345f8
.quad 0x3f0f5de23f0a48ad,0x3f1949553f145e58,0x3f1f32453f19c200,0x3f29b9b93f24852c,0x3f2e17073f286605,0x3f3900273f33a029,0x3f3bf5bc3f36206c,0x3f4701cc3f4196b7,0x3f48b9853f42de29,0x3f53a6123f4e521c,0x3f544f2a3f4e8d90,0x3f5ed6c83f59bd9c,0x3f5ea53a3f591e6a,0x3f6880473f63c6a1,0x3f67ac293f628210,0x3f70919b3f6c5cd4
.quad 0xbcb63286bcafea69,0xbcc2c2a9bcbc7a9b,0x3d888ed23d83db0a,0x3d91f5d03d8d426a,0x3e1ecadd3e195be0,0x3e29a5483e2438ad,0x3e780cbe3e6fa8b2,0x3e84638f3e803622,0x3ea7ac253ea21887,0x3eb2c2273ead3a15,0x3ed1fe5e3ecb2aae,0x3edf831f3ed8c6a3,0x3efaa7533ef2bd43,0x3f051f753f013eb5,0x3f10aa573f0c42c9,0x3f1949553f150204
.quad 0x3f22dc0e3f1e1e22,0x3f2c10853f278268,0x3f33c3f63f2ecef7,0x3f3d49933f3897cb,0x3f433fd23f3e35c5,0x3f4ccca63f481d27,0x3f5130473f4c3578,0x3f5a75d93f55f0d9,0x3f5d791b3f58b3a1,0x3f66258f3f61f4ea,0x3f68016d3f6398ac,0x3f6fc0bf3f6c0f50,0x3f70b3e93f6cd007,0x3f77312e3f742a27,0x3f777ef13f74484b,0x3f7c65a63f7a33dd
.quad 0x3f8000003f800000,0x3f8000003f800000,0x3f7fffd43f7ffffb,0x3f7ffdab3f7fff0e,0x3f7fff4e3f7fffec,0x3f7ff6ac3f7ffc39,0x3f7ffe703f7fffd4,0x3f7feb023f7ff780,0x3f7ffd393f7fffb1,0x3f7fdaaf3f7ff0e3,0x3f7ffbaa3f7fff85,0x3f7fc5b23f7fe863,0x3f7ff9c13f7fff4e,0x3f7fac0d3f7fde00,0x3f7ff7803f7fff0e,0x3f7f8dbe3f7fd1b9
.quad 0x3f7ff4e63f7ffec4,0x3f7f6ac73f7fc38f,0x3f7ff1f33f7ffe70,0x3f7f43293f7fb382,0x3f7feea73f7ffe13,0x3f7f16e43f7fa191,0x3f7feb023f7ffdab,0x3f7ee5f93f7f8dbe,0x3f7fe7053f7ffd39,0x3f7eb0693f7f7808,0x3f7fe2af3f7ffcbe,0x3f7e76353f7f606f,0x3f7fde003f7ffc39,0x3f7e375e3f7f46f4,0x3f7fd8f83f7ffbaa,0x3f7df3e53f7f2b97
.quad 0x3f8000003f800000,0x3f8000003f800000,0x3f7ff90b3f7ffbaa,0x3f7ff1f33f7ff5ce,0x3f7fe42b3f7feea7,0x3f7fc7cc3f7fd737,0x3f7fc1613f7fd8f8,0x3f7f81913f7fa43f,0x3f7f90b13f7fba9e,0x3f7f1f493f7f5ce9,0x3f7f521b3f7f9399,0x3f7ea1003f7f013c,0x3f7f05a43f7f63ec,0x3f7e06c23f7e913d,0x3f7eab503f7f2b97,0x3f7d50a03f7e0cf7
.quad 0x3f7e43233f7eea9d,0x3f7c7eb03f7d7474,0x3f7dcd243f7ea100,0x3f7b91073f7cc7c0,0x3f7d49593f7e4ec1,0x3f7a87c13f7c06e9,0x3f7cb7c83f7df3e5,0x3f7962f93f7b31fe,0x3f7c187a3f7d906e,0x3f7822d13f7a4910,0x3f7b6b783f7d2460,0x3f76c76b3f794c32,0x3f7ab0cb3f7cafbd,0x3f7550ed3f783b77,0x3f79e87c3f7c328b,0x3f73bf813f7716f6
.quad 0x3f8000003f800000,0x3f8000003f800000,0x3f7fe8633f7fed7a,0x3f7fdc5c3f7fe2af,0x3f7fa1913f7fb5ea,0x3f7f717b3f7f8ac2,0x3f7f2b973f7f5959,0x3f7ebf7b3f7ef84d,0x3f7e868b3f7ed7d4,0x3f7dc68c3f7e2b72,0x3f7db28a3f7e316d,0x3f7c86f53f7d2460,0x3f7cafbd3f7d663d,0x3f7b010e3f7be353,0x3f7b7e533f7c7661,0x3f7935443f7a6894
.quad 0x3f7a1e843f7b61fc,0x3f7724173f78b47b,0x3f7890913f7a2936,0x3f74ce1a3f76c76b,0x3f76d4c43f78cc3b,0x3f7233f43f74a1d5,0x3f74eb6f3f774b40,0x3f6f565e3f724437,0x3f72d4eb3f75a67b,0x3f6c36243f6faf1b,0x3f70919b3f73de28,0x3f68d4263f6ce31a,0x3f6e21eb3f71f28c,0x3f6531543f69e0d7,0x3f6b864c3f6fe3eb,0x3f614eb13f66a903
.quad 0x3f8000003f800000,0x3f8000003f800000,0x3f7fcdde3f7fd56c,0x3f7fbce93f7fc5b2,0x3f7f378c3f7f55bf,0x3f7ef3c73f7f16e4,0x3f7e3d463f7e8123,0x3f7da5033f7df3e5,0x3f7cdf6c3f7d57de,0x3f7bd14d3f7c5d3a,0x3f7b1e883f7bda55,0x3f79799a3f7a539b,0x3f78fb4a3f7a0904,0x3f769f243f77d7f7,0x3f7676883f77e488,0x3f73436b3f74eb6f
.quad 0x3f73913f3f756d97,0x3f6f68303f718f57,0x3f704c913f72a503,0x3f6b0f793f6dc539,0x3f6ca9c53f6f8bb8,0x3f663b8e3f698ecc,0x3f68aa493f6c22bf,0x3f60eef63f64edfe,0x3f644fac3f686b39,0x3f5b2c793f5fe4e9,0x3f5f9ba53f646665,0x3f54f71a3f5a75d9,0x3f5a90093f601596,0x3f4e521c3f54a347,0x3f552ed43f5b7a3e,0x3f4740fa3f4e6fda
.quad 0x3f7fd3973f7ffb11,0x3f7dabcc3f7f0e58,0x3f7fcdde3f7ffa6e,0x3f7d5f133f7eef37,0x3f7fc7cc3f7ff9c1,0x3f7d0dbc3f7ece34,0x3f7fc1613f7ff90b,0x3f7cb7c83f7eab50,0x3f7fba9e3f7ff84a,0x3f7c5d3a3f7e868b,0x3f7fb3823f7ff780,0x3f7bfe123f7e5fe5,0x3f7fac0d3f7ff6ac,0x3f7b9a533f7e375e,0x3f7fa43f3f7ff5ce,0x3f7b31fe3f7e0cf7
.quad 0x3f7f9c183f7ff4e6,0x3f7ac5163f7de0b1,0x3f7f93993f7ff3f4,0x3f7a539b3f7db28a,0x3f7f8ac23f7ff2f8,0x3f79dd913f7d8285,0x3f7f81913f7ff1f3,0x3f7962f93f7d50a0,0x3f7f78083f7ff0e3,0x3f78e3d63f7d1cdd,0x3f7f6e263f7fefca,0x3f78602a3f7ce73c,0x3f7f63ec3f7feea7,0x3f77d7f73f7cafbd,0x3f7f59593f7fed7a,0x3f774b403f7c7661
.quad 0x3f7912983f7baccd,0x3f7213523f75dec6,0x3f782f293f7b1e88,0x3f704c913f749300,0x3f773e3c3f7a87c1,0x3f6e6b6d3f7333be,0x3f763fde3f79e87c,0x3f6c701e3f71c11b,0x3f75341d3f7940c0,0x3f6a5ad93f703b37,0x3f741b073f789091,0x3f682bda3f6ea22f,0x3f72f4ac3f77d7f7,0x3f65e35e3f6cf624,0x3f71c11b3f7716f6,0x3f6381a53f6b3739
.quad 0x3f7080663f764d97,0x3f6106f23f696591,0x3f6f329e3f757bde,0x3f5e738b3f678151,0x3f6dd7d53f74a1d5,0x3f5bc7b83f658aa0,0x3f6c701e3f73bf81,0x3f5903c53f6381a5,0x3f6afb8c3f72d4eb,0x3f5627fe3f61668a,0x3f697a333f71e21a,0x3f5334b53f5f397b,0x3f67ec293f70e717,0x3f502a3b3f5cfaa3,0x3f6651843f6fe3eb,0x3f4d08e83f5aaa31
.quad 0x3f68bf3c3f6db293,0x3f5d2d533f633c5a,0x3f65cd3b3f6b5ed5,0x3f58ce603f5f9ba5,0x3f62b0d73f68e907,0x3f54330f3f5bc7b8,0x3f5f6aa13f665184,0x3f4f5ca93f57c175,0x3f5bfb343f6398ac,0x3f4a4c873f5389c7,0x3f5863333f60bee5,0x3f4504113f4f21a5,0x3f54a3473f5dc497,0x3f3f84c03f4a8a13,0x3f50bc213f5aaa31,0x3f39d01d3f45c41c
.quad 0x3f4cae793f577026,0x3f33e7bc3f40d0da,0x3f487b103f5416ed,0x3f2dcd443f3bb16d,0x3f4422ab3f509f03,0x3f2782683f366704,0x3f3fa6173f4d08e8,0x3f2108e93f30f2d3,0x3f3b06293f495521,0x3f1a62933f2b561b,0x3f3643bb3f458437,0x3f1391403f259224,0x3f315fad3f4196b7,0x3f0c96d73f1fa841,0x3f2c5ae73f3d8d34,0x3f05754a3f1999cd
.quad 0x3f4f7a1f3f5695e5,0x3f3fc7673f47de65,0x3f4974293f516a2a,0x3f37e9503f40f1e7,0x3f431f4c3f4bf8c7,0x3f2faad33f39ad85,0x3f3c7e033f46438b,0x3f2710433f321491,0x3f3592e73f404c5c,0x3f1e1e223f2a2a80,0x3f2e60ae3f3a1535,0x3f14d9213f21f2ec,0x3f26ea2a3f33a029,0x3f0b461c3f197194,0x3f1f32453f2cef5d,0x3f016a173f10aa57
.quad 0x3f173c073f26050a,0x3eee94793f07a136,0x3f0f0a8e3f1ee37e,0x3ed9d7b73efcb49b,0x3f06a10e3f178d18,0x3ec4a8c83ee9b3ae,0x3efc05aa3f100449,0x3eaf12c53ed6484f,0x3eea66813f084b92,0x3e9920fe3ec27b55,0x3ed86b8b3f006585,0x3e82def43eae55c6,0x3ec61bd23ef0a985,0x3e58b0a43e99e0ce,0x3eb37e823ee037f2,0x3e2b31cc3e8525bf
.quad 0,0,0x3b16cbdbba490fd9,0x3c0a3a7b3bafeda8,0x3b96cbc1bac90fd5,0x3c8a39383c2fed02,0x3be23160bb16cbdb,0x3ccf52af3c83f0f2,0x3c16cb58bb490fc6,0x3d0a342f3cafea69,0x3c3c7dccbb7b53a9,0x3d2cbc823cdbe294,0x3c622fffbb96cbc1,0x3d4f41af3d03ec90,0x3c83f0f2bbafeda8,0x3d71c3153d19e6dd
.quad 0x3c96c9b6bbc90f88,0x3d8a200a3d2fe007,0x3ca9a246bbe23160,0x3d9b5c053d45d7e4,0x3cbc7a9bbbfb5330,0x3dac952b3d5bce4c,0x3ccf52afbc0a3a7b,0x3dbdcb2c3d71c315,0x3ce22a7abc16cb58,0x3dcefdb73d83db0a,0x3cf501f8bc235c30,0x3de02c7d3d8ed391,0x3d03ec90bc2fed02,0x3df1572e3d99cb0a,0x3d0d57f6bc3c7dcc,0x3e013ebc3da4c161
.quad 0,0,0x3c6ec0aa3c3c7dcc,0x3ca9a2463c90817a,0x3ceeba2c3cbc7a9b,0x3d2998f63d107bb8,0x3d3303853d0d57f6,0x3d7e4e2b3d58ab31,0x3d6ea0383d3c6dd5,0x3da973ba3d9064b4,0x3d9517f93d6b7d51,0x3dd3adc53db4684e,0x3db2d7bb3d8d426a,0x3dfdd0923dd85d89,0x3dd08dc43da4c161,0x3e13ebc13dfc4187
.quad 0x3dee38763dbc3ac3,0x3e28defc3e1008b7,0x3e05eb1b3dd3adc5,0x3e3dbfad3e21e530,0x3e14b2b23deb199a,0x3e528b893e33b4c4,0x3e2372353e013ebc,0x3e6740483e457607,0x3e3228d43e0cec4a,0x3e7bdba43e57278f,0x3e40d5c43e189511,0x3e882dad3e68c7f3,0x3e4f78383e2438ad,0x3e925e943e7a55cb,0x3e5e0f653e2fd6b9,0x3e9c7f6a3e85e7d9
.quad 0,0,0x3cdbe2943cc2c2a9,0x3d0710623cf501f8,0x3d5bce4c3d42b491,0x3d86fd943d74e5e9,0x3da4c1613d91f5d0,0x3dca4d623db7895f,0x3ddb7d373dc27c39,0x3e06b26e3df475c0,0x3e0908483df2e67c,0x3e2818aa3e189511,0x3e2438ad3e1196cc,0x3e4950183e36cc50,0x3e3f4ac73e29a548,0x3e6a4f793e54d9b1
.quad 0x3e5a39973e419b37,0x3e8586ce3e72b651,0x3e7500263e597522,0x3e95c0b33e882dad,0x3e87ccc13e712f94,0x3ea5d0e53e96e100,0x3e9500623e84638f,0x3eb5b2ec3ea571c5,0x3ea218873e901c2c,0x3ec5625c3eb3dca5,0x3eaf12c53e9bbfee,0x3ed4dad73ec21e53,0x3ebbecb63ea74d25,0x3ee4180e3ed0338a,0x3ec8a3fd3eb2c227,0x3ef315c23ede1912
.quad 0,0,0x3d202e2d3d139f75,0x3d394a6c3d2cbc82,0x3da00ecf3d9386e7,0x3db919dd3dac952b,0x3defc7d73ddd0d02,0x3e0a96bf3e013ebc,0x3e1f917b3e1324ca,0x3e3857ec3e2bf804,0x3e47008b3e379222,0x3e65b87a3e5662f8,0x3e6e21ab3e5bc26a,0x3e8950503e803622,0x3e8a72c33e7fa998,0x3e9f7c6a3e950062
.quad 0x3e9d9e783e919ddd,0x3eb554ec3ea986c4,0x3eb08c713ea3367f,0x3ecace633ebdbfee,0x3ec335443eb498d6,0x3edfdd8d3ed1a2aa,0x3ed591a43ec5bf1b,0x3ef477613ee525e9,0x3ee79a5d3ed6a399,0x3f0448893ef840c8,0x3ef948623ee740b1,0x3f0e100c3f05754a,0x3f054a623ef790dc,0x3f178d183f0e8d65,0x3f0dbc5f3f03c757,0x3f20bab63f176493
.quad 0x3d16c32cbc490e90,0x3e09cf863dafb680,0x3d202e2dbc559f4c,0x3e125dce3dbaaa54,0x3d2998f6bc622fff,0x3e1ae96b3dc59cc6,0x3d330385bc6ec0aa,0x3e2372353dd08dc4,0x3d3c6dd5bc7b514b,0x3e2bf8043ddb7d37,0x3d45d7e4bc83f0f2,0x3e347ab23de66b0c,0x3d4f41afbc8a3938,0x3e3cfa153df1572e,0x3d58ab31bc90817a,0x3e4576073dfc4187
.quad 0x3d621469bc96c9b6,0x3e4dee603e039502,0x3d6b7d51bc9d11ec,0x3e5662f83e090848,0x3d74e5e9bca35a1c,0x3e5ed3a83e0e7a8b,0x3d7e4e2bbca9a246,0x3e6740483e13ebc1,0x3d83db0abcafea69,0x3e6fa8b23e195be0,0x3d888ed2bcb63286,0x3e780cbe3e1ecadd,0x3d8d426abcbc7a9b,0x3e8036223e2438ad,0x3d91f5d0bcc2c2a9,0x3e84638f3e29a548
.quad 0x3e6c9a7f3e3b6ecf,0x3ea68f123e8e9a22,0x3e7b18bc3e47008b,0x3eb08c713e97410e,0x3e84c4aa3e528b89,0x3eba766e3e9fdbee,0x3e8bf5bd3e5e0f65,0x3ec44bf23ea86a12,0x3e931f353e698bba,0x3ece0bea3eb0eacb,0x3e9a40ad3e750026,0x3ed7b5433eb95d6c,0x3ea159c23e803622,0x3ee146ee3ec1c148,0x3ea86a123e85e7d9,0x3eeabfdd3eca15b5
.quad 0x3eaf713a3e8b9507,0x3ef41f073ed25a09,0x3eb66ed83e913d79,0x3efd63653eda8d9b,0x3ebd628b3e96e100,0x3f0345f83ee2afc4,0x3ec44bf23e9c7f6a,0x3f07cbd53eeabfdd,0x3ecb2aae3ea21887,0x3f0c42c93ef2bd43,0x3ed1fe5e3ea7ac25,0x3f10aa573efaa753,0x3ed8c6a33ead3a15,0x3f1502043f013eb5,0x3edf831f3eb2c227,0x3f1949553f051f75
.quad 0x3ed536413ebe1d4a,0x3f00e7e43eebcbbb,0x3ee1a1303ec95ce9,0x3f0821033ef94862,0x3eede2803ed47f64,0x3f0f343b3f0345f8,0x3ef9f7ee3edf831f,0x3f161f933f09c9ae,0x3f02ef9f3eea6681,0x3f1ce11f3f102dd5,0x3f08cb203ef527f8,0x3f2376fd3f1670f6,0x3f0e8d653effc5f3,0x3f29df573f1c91a2,0x3f14355e3f051f75,0x3f3018653f228e71
.quad 0x3f19c2003f0a48ad,0x3f36206c3f286605,0x3f1f32453f0f5de2,0x3f3bf5bc3f2e1707,0x3f24852c3f145e58,0x3f4196b73f33a029,0x3f29b9b93f194955,0x3f4701cc3f390027,0x3f2ecef73f1e1e22,0x3f4c35783f3e35c5,0x3f33c3f63f22dc0e,0x3f5130473f433fd2,0x3f3897cb3f278268,0x3f55f0d93f481d27,0x3f3d49933f2c1085,0x3f5a75d93f4ccca6
.quad 0x3f15f6d93f0b9a6b,0x3f2994153f1ff6cb,0x3f1df6973f133f0f,0x3f3214913f284026,0x3f25b8773f1ab2b8,0x3f3a37b73f303cde,0x3f2d396f3f21f2ec,0x3f41f9423f37e950,0x3f34768f3f28fd41,0x3f4955213f3f41fc,0x3f3b6d013f2fcf60,0x3f5047793f46438b,0x3f421a0b3f366704,0x3f56cca73f4ceacb,0x3f487b103f3cc1fb,0x3f5ce13e3f5334b5
.quad 0x3f4e8d903f42de29,0x3f6282103f591e6a,0x3f544f2a3f48b985,0x3f67ac293f5ea53a,0x3f59bd9c3f4e521c,0x3f6c5cd43f63c6a1,0x3f5ed6c83f53a612,0x3f70919b3f688047,0x3f6398ac3f58b3a1,0x3f74484b3f6cd007,0x3f68016d3f5d791b,0x3f777ef13f70b3e9,0x3f6c0f503f61f4ea,0x3f7a33dd3f742a27,0x3f6fc0bf3f66258f,0x3f7c65a63f77312e
.quad 0xbf8000003f80,0xbf8000003f800000,0x3e95bf7bbdc93f80,0xbf75be483f7f0000,0x3f0ebf6dbe483f80,0xbf55bec43f7b0000,0x3f46bf55be953f80,0xbf22bf0e3f750000,0x3f6dbf35bec43f80,0xbec4bf353f6d0000,0x3f7fbf0ebef13f80,0xbdc9bf553f620000,0x3f7bbec4bf0e3f80,0x3e48bf6d3f550000,0x3f62be48bf223f80,0x3ef1bf7b3f460000
.quad 0x3f350000bf353f80,0x3f35bf803f350000,0x3ef13e48bf463f80,0x3f62bf7b3f220000,0x3e483ec4bf553f80,0x3f7bbf6d3f0e0000,0xbdc93f0ebf623f80,0x3f7fbf553ef10000,0xbec43f35bf6d3f80,0x3f6dbf353ec40000,0xbf223f55bf753f80,0x3f46bf0e3e950000,0xbf553f6dbf7b3f80,0x3f0ebec43e480000,0xbf753f7bbf7f3f80,0x3e95be483dc90000
.quad 0xbf8000003f80,0xbf8000003f800000,0x3f22bf55bef13f6d,0xbf46bf0e3f623ec4,0x3f7bbec4bf553f35,0xbe48bf6d3f0e3f35,0x3f623e48bf7f3ec4,0x3ef1bf7b3dc93f6d,0x3ec43f35bf6d0000,0x3f6dbf35bec43f80,0xbe953f7bbf22bec4,0x3f75be48bf463f6d,0xbf553f6dbe48bf35,0x3f0e3ec4bf7b3f35,0xbf7f3f0e3e95bf6d,0xbdc93f55bf753ec4
.quad 0xbf3500003f35bf80,0xbf353f80bf350000,0xbdc9bf0e3f75bf6d,0xbf7f3f55be95bec4,0x3f0ebf6d3f7bbf35,0xbf553ec43e48bf35,0x3f75bf7b3f46bec4,0xbe95be483f22bf6d,0x3f6dbf353ec40000,0x3ec4bf353f6dbf80,0x3ef1be48bdc93ec4,0x3f62bf7b3f7fbf6d,0xbe483ec4bf0e3f35,0x3f7bbf6d3f55bf35,0xbf463f55bf623f6d,0x3f22bf0e3ef1bec4
.quad 0xbf8000003f80,0xbf8000003f800000,0x3f62bf0ebf463f35,0xbef1bf553f223f35,0x3f553ec4bf7b0000,0x3f0ebf6dbe483f80,0xbdc93f7bbef1bf35,0x3f7fbe48bf623f35,0xbf6d3f353ec4bf80,0x3ec43f35bf6d0000,0xbf46be483f75bf35,0xbf223f7bbe95bf35,0x3e48bf6d3f550000,0xbf7b3ec43f0ebf80,0x3f75bf553dc93f35,0xbe95bf0e3f7fbf35
.quad 0x3f350000bf353f80,0x3f35bf803f350000,0xbe953f55bf7f3f35,0x3f75bf0ebdc93f35,0xbf7b3f6dbf0e0000,0x3e483ec4bf553f80,0xbf223e483e95bf35,0xbf463f7bbf753f35,0x3ec4bf353f6dbf80,0xbf6d3f35bec40000,0x3f7fbf7b3f62bf35,0xbdc9be483ef1bf35,0x3f0ebec43e480000,0x3f55bf6d3f7bbf80,0xbef13f0ebf223f35,0x3f62bf553f46bf35
.quad 0xbf8000003f80,0xbf8000003f800000,0x3f7fbe48bf753ec4,0xbdc9bf7b3e953f6d,0x3e483f6dbf0ebf35,0x3f7bbec4bf553f35,0xbf753f0e3f22bf6d,0x3e953f55bf46bec4,0xbec4bf353f6d0000,0xbf6d3f353ec4bf80,0x3f62bf55bdc93f6d,0xbef1bf0e3f7fbec4,0x3f0e3ec4bf7b3f35,0x3f55bf6d3e483f35,0xbf463f7bbef1bec4,0x3f223e48bf623f6d
.quad 0xbf3500003f35bf80,0xbf353f80bf350000,0x3f22bf7b3f62bec4,0xbf463e483ef1bf6d,0x3f55bec4be483f35,0x3f0ebf6d3f7bbf35,0xbef13f55bf7f3f6d,0x3f62bf0e3dc93ec4,0xbf6d3f35bec40000,0xbec43f35bf6d3f80,0x3e95bf0e3f46bf6d,0xbf753f55bf223ec4,0x3f7bbf6d3f55bf35,0x3e48bec43f0ebf35,0xbdc93e48be953ec4,0x3f7fbf7b3f75bf6d
.quad 0xbf8000003f80,0x3f808000bf808000,0x3e95bf7bbdc93f80,0x3f753e48bf7f8000,0x3f0ebf6dbe483f80,0x3f553ec4bf7b8000,0x3f46bf55be953f80,0x3f223f0ebf758000,0x3f6dbf35bec43f80,0x3ec43f35bf6d8000,0x3f7fbf0ebef13f80,0x3dc93f55bf628000,0x3f7bbec4bf0e3f80,0xbe483f6dbf558000,0x3f62be48bf223f80,0xbef13f7bbf468000
.quad 0x3f350000bf353f80,0xbf353f80bf358000,0x3ef13e48bf463f80,0xbf623f7bbf228000,0x3e483ec4bf553f80,0xbf7b3f6dbf0e8000,0xbdc93f0ebf623f80,0xbf7f3f55bef18000,0xbec43f35bf6d3f80,0xbf6d3f35bec48000,0xbf223f55bf753f80,0xbf463f0ebe958000,0xbf553f6dbf7b3f80,0xbf0e3ec4be488000,0xbf753f7bbf7f3f80,0xbe953e48bdc98000
.quad 0xbf8000003f80,0x3f808000bf808000,0x3f22bf55bef13f6d,0x3f463f0ebf62bec4,0x3f7bbec4bf553f35,0x3e483f6dbf0ebf35,0x3f623e48bf7f3ec4,0xbef13f7bbdc9bf6d,0x3ec43f35bf6d0000,0xbf6d3f353ec4bf80,0xbe953f7bbf22bec4,0xbf753e483f46bf6d,0xbf553f6dbe48bf35,0xbf0ebec43f7bbf35,0xbf7f3f0e3e95bf6d,0x3dc9bf553f75bec4
.quad 0xbf3500003f35bf80,0x3f35bf803f358000,0xbdc9bf0e3f75bf6d,0x3f7fbf553e953ec4,0x3f0ebf6d3f7bbf35,0x3f55bec4be483f35,0x3f75bf7b3f46bec4,0x3e953e48bf223f6d,0x3f6dbf353ec40000,0xbec43f35bf6d3f80,0x3ef1be48bdc93ec4,0xbf623f7bbf7f3f6d,0xbe483ec4bf0e3f35,0xbf7b3f6dbf553f35,0xbf463f55bf623f6d,0xbf223f0ebef13ec4
.quad 0xbf8000003f80,0x3f808000bf808000,0x3f62bf0ebf463f35,0x3ef13f55bf22bf35,0x3f553ec4bf7b0000,0xbf0e3f6d3e48bf80,0xbdc93f7bbef1bf35,0xbf7f3e483f62bf35,0xbf6d3f353ec4bf80,0xbec4bf353f6d8000,0xbf46be483f75bf35,0x3f22bf7b3e953f35,0x3e48bf6d3f550000,0x3f7bbec4bf0e3f80,0x3f75bf553dc93f35,0x3e953f0ebf7f3f35
.quad 0x3f350000bf353f80,0xbf353f80bf358000,0xbe953f55bf7f3f35,0xbf753f0e3dc9bf35,0xbf7b3f6dbf0e0000,0xbe48bec43f55bf80,0xbf223e483e95bf35,0x3f46bf7b3f75bf35,0x3ec4bf353f6dbf80,0x3f6dbf353ec48000,0x3f7fbf7b3f62bf35,0x3dc93e48bef13f35,0x3f0ebec43e480000,0xbf553f6dbf7b3f80,0xbef13f0ebf223f35,0xbf623f55bf463f35
.quad 0xbf8000003f80,0x3f808000bf808000,0x3f7fbe48bf753ec4,0x3dc93f7bbe95bf6d,0x3e483f6dbf0ebf35,0xbf7b3ec43f55bf35,0xbf753f0e3f22bf6d,0xbe95bf553f463ec4,0xbec4bf353f6d0000,0x3f6dbf35bec43f80,0x3f62bf55bdc93f6d,0x3ef13f0ebf7f3ec4,0x3f0e3ec4bf7b3f35,0xbf553f6dbe48bf35,0xbf463f7bbef1bec4,0xbf22be483f62bf6d
.quad 0xbf3500003f35bf80,0x3f35bf803f358000,0x3f22bf7b3f62bec4,0x3f46be48bef13f6d,0x3f55bec4be483f35,0xbf0e3f6dbf7b3f35,0xbef13f55bf7f3f6d,0xbf623f0ebdc9bec4,0xbf6d3f35bec40000,0x3ec4bf353f6dbf80,0x3e95bf0e3f46bf6d,0x3f75bf553f22bec4,0x3f7bbf6d3f55bf35,0xbe483ec4bf0e3f35,0xbdc93e48be953ec4,0xbf7f3f7bbf753f6d
.quad 0xbf8000003f80,0xbf8000003f80,0x3e95bf7bbdc93f80,0x3f753e48bf7f0000,0x3f0ebf6dbe483f80,0xbf0e3f6d3e48bf80,0x3f46bf55be953f80,0xbf22bf0e3f750000,0x3f6dbf35bec43f80,0x3f6dbf35bec43f80,0x3f7fbf0ebef13f80,0x3dc93f55bf620000,0x3f7bbec4bf0e3f80,0xbf7b3ec43f0ebf80,0x3f62be48bf223f80,0x3ef1bf7b3f460000
.quad 0x3f350000bf353f80,0x3f350000bf353f80,0x3ef13e48bf463f80,0xbf623f7bbf220000,0x3e483ec4bf553f80,0xbe48bec43f55bf80,0xbdc93f0ebf623f80,0x3f7fbf553ef10000,0xbec43f35bf6d3f80,0xbec43f35bf6d3f80,0xbf223f55bf753f80,0xbf463f0ebe950000,0xbf553f6dbf7b3f80,0x3f55bf6d3f7bbf80,0xbf753f7bbf7f3f80,0x3e95be483dc90000
.quad 0xbf8000003f80,0xbf8000003f80,0x3f22bf55bef13f6d,0x3f463f0ebf62bec4,0x3f7bbec4bf553f35,0xbf7b3ec43f55bf35,0x3f623e48bf7f3ec4,0x3ef1bf7b3dc93f6d,0x3ec43f35bf6d0000,0x3ec43f35bf6d0000,0xbe953f7bbf22bec4,0xbf753e483f46bf6d,0xbf553f6dbe48bf35,0x3f55bf6d3e483f35,0xbf7f3f0e3e95bf6d,0xbdc93f55bf753ec4
.quad 0xbf3500003f35bf80,0xbf3500003f35bf80,0xbdc9bf0e3f75bf6d,0x3f7fbf553e953ec4,0x3f0ebf6d3f7bbf35,0xbf0e3f6dbf7b3f35,0x3f75bf7b3f46bec4,0xbe95be483f22bf6d,0x3f6dbf353ec40000,0x3f6dbf353ec40000,0x3ef1be48bdc93ec4,0xbf623f7bbf7f3f6d,0xbe483ec4bf0e3f35,0x3e48bec43f0ebf35,0xbf463f55bf623f6d,0x3f22bf0e3ef1bec4
.quad 0xbf8000003f80,0xbf8000003f80,0x3f62bf0ebf463f35,0x3ef13f55bf22bf35,0x3f553ec4bf7b0000,0xbf55bec43f7b0000,0xbdc93f7bbef1bf35,0x3f7fbe48bf623f35,0xbf6d3f353ec4bf80,0xbf6d3f353ec4bf80,0xbf46be483f75bf35,0x3f22bf7b3e953f35,0x3e48bf6d3f550000,0xbe483f6dbf550000,0x3f75bf553dc93f35,0xbe95bf0e3f7fbf35
.quad 0x3f350000bf353f80,0x3f350000bf353f80,0xbe953f55bf7f3f35,0xbf753f0e3dc9bf35,0xbf7b3f6dbf0e0000,0x3f7bbf6d3f0e0000,0xbf223e483e95bf35,0xbf463f7bbf753f35,0x3ec4bf353f6dbf80,0x3ec4bf353f6dbf80,0x3f7fbf7b3f62bf35,0x3dc93e48bef13f35,0x3f0ebec43e480000,0xbf0e3ec4be480000,0xbef13f0ebf223f35,0x3f62bf553f46bf35
.quad 0xbf8000003f80,0xbf8000003f80,0x3f7fbe48bf753ec4,0x3dc93f7bbe95bf6d,0x3e483f6dbf0ebf35,0xbe48bf6d3f0e3f35,0xbf753f0e3f22bf6d,0x3e953f55bf46bec4,0xbec4bf353f6d0000,0xbec4bf353f6d0000,0x3f62bf55bdc93f6d,0x3ef13f0ebf7f3ec4,0x3f0e3ec4bf7b3f35,0xbf0ebec43f7bbf35,0xbf463f7bbef1bec4,0x3f223e48bf623f6d
.quad 0xbf3500003f35bf80,0xbf3500003f35bf80,0x3f22bf7b3f62bec4,0x3f46be48bef13f6d,0x3f55bec4be483f35,0xbf553ec43e48bf35,0xbef13f55bf7f3f6d,0x3f62bf0e3dc93ec4,0xbf6d3f35bec40000,0xbf6d3f35bec40000,0x3e95bf0e3f46bf6d,0x3f75bf553f22bec4,0x3f7bbf6d3f55bf35,0xbf7b3f6dbf553f35,0xbdc93e48be953ec4,0x3f7fbf7b3f75bf6d
.quad 0xbf8000003f800000,0xbf8000003f80,0x3e95bf7bbdc93f80,0x3f753e48bf7f0000,0x3f553ec4bf7b0000,0xbf0e3f6d3e48bf80,0xbf463f553e95bf80,0xbf22bf0e3f750000,0xbec4bf353f6d0000,0x3f6dbf35bec43f80,0x3f7fbf0ebef13f80,0x3dc93f55bf620000,0xbe483f6dbf550000,0xbf7b3ec43f0ebf80,0xbf623e483f22bf80,0x3ef1bf7b3f460000
.quad 0x3f35bf803f350000,0x3f350000bf353f80,0x3ef13e48bf463f80,0xbf623f7bbf220000,0xbf7b3f6dbf0e0000,0xbe48bec43f55bf80,0x3dc9bf0e3f62bf80,0x3f7fbf553ef10000,0x3f6dbf353ec40000,0xbec43f35bf6d3f80,0xbf223f55bf753f80,0xbf463f0ebe950000,0xbf0e3ec4be480000,0x3f55bf6d3f7bbf80,0x3f75bf7b3f7fbf80,0x3e95be483dc90000
.quad 0xbf8000003f800000,0xbf8000003f80,0x3f22bf55bef13f6d,0x3f463f0ebf62bec4,0x3e483f6dbf0ebf35,0xbf7b3ec43f55bf35,0xbf62be483f7fbec4,0x3ef1bf7b3dc93f6d,0x3f6dbf35bec43f80,0x3ec43f35bf6d0000,0xbe953f7bbf22bec4,0xbf753e483f46bf6d,0xbf0ebec43f7bbf35,0x3f55bf6d3e483f35,0x3f7fbf0ebe953f6d,0xbdc93f55bf753ec4
.quad 0xbf353f80bf350000,0xbf3500003f35bf80,0xbdc9bf0e3f75bf6d,0x3f7fbf553e953ec4,0x3f55bec4be483f35,0xbf0e3f6dbf7b3f35,0xbf753f7bbf463ec4,0xbe95be483f22bf6d,0x3ec4bf353f6dbf80,0x3f6dbf353ec40000,0x3ef1be48bdc93ec4,0xbf623f7bbf7f3f6d,0xbf7b3f6dbf553f35,0x3e48bec43f0ebf35,0x3f46bf553f62bf6d,0x3f22bf0e3ef1bec4
.quad 0xbf8000003f800000,0xbf8000003f80,0x3f62bf0ebf463f35,0x3ef13f55bf22bf35,0xbf0e3f6d3e48bf80,0xbf55bec43f7b0000,0x3dc9bf7b3ef13f35,0x3f7fbe48bf623f35,0x3ec43f35bf6d0000,0xbf6d3f353ec4bf80,0xbf46be483f75bf35,0x3f22bf7b3e953f35,0x3f7bbec4bf0e3f80,0xbe483f6dbf550000,0xbf753f55bdc9bf35,0xbe95bf0e3f7fbf35
.quad 0x3f35bf803f350000,0x3f350000bf353f80,0xbe953f55bf7f3f35,0xbf753f0e3dc9bf35,0xbe48bec43f55bf80,0x3f7bbf6d3f0e0000,0x3f22be48be953f35,0xbf463f7bbf753f35,0xbf6d3f35bec40000,0x3ec4bf353f6dbf80,0x3f7fbf7b3f62bf35,0x3dc93e48bef13f35,0xbf553f6dbf7b3f80,0xbf0e3ec4be480000,0x3ef1bf0e3f22bf35,0x3f62bf553f46bf35
.quad 0xbf8000003f800000,0xbf8000003f80,0x3f7fbe48bf753ec4,0x3dc93f7bbe95bf6d,0xbf7b3ec43f55bf35,0xbe48bf6d3f0e3f35,0x3f75bf0ebf223f6d,0x3e953f55bf46bec4,0xbf6d3f353ec4bf80,0xbec4bf353f6d0000,0x3f62bf55bdc93f6d,0x3ef13f0ebf7f3ec4,0xbf553f6dbe48bf35,0xbf0ebec43f7bbf35,0x3f46bf7b3ef13ec4,0x3f223e48bf623f6d
.quad 0xbf353f80bf350000,0xbf3500003f35bf80,0x3f22bf7b3f62bec4,0x3f46be48bef13f6d,0xbf0e3f6dbf7b3f35,0xbf553ec43e48bf35,0x3ef1bf553f7fbf6d,0x3f62bf0e3dc93ec4,0xbec43f35bf6d3f80,0xbf6d3f35bec40000,0x3e95bf0e3f46bf6d,0x3f75bf553f22bec4,0xbe483ec4bf0e3f35,0xbf7b3f6dbf553f35,0x3dc9be483e95bec4,0x3f7fbf7b3f75bf6d
.quad 0x3f808000bf808000,0xbf8000003f80,0xbe953f7b3dc9bf80,0x3f753e48bf7f0000,0xbf55bec43f7b8000,0xbf0e3f6d3e48bf80,0x3f46bf55be953f80,0xbf22bf0e3f750000,0x3ec43f35bf6d8000,0x3f6dbf35bec43f80,0xbf7f3f0e3ef1bf80,0x3dc93f55bf620000,0x3e48bf6d3f558000,0xbf7b3ec43f0ebf80,0x3f62be48bf223f80,0x3ef1bf7b3f460000
.quad 0xbf353f80bf358000,0x3f350000bf353f80,0xbef1be483f46bf80,0xbf623f7bbf220000,0x3f7bbf6d3f0e8000,0xbe48bec43f55bf80,0xbdc93f0ebf623f80,0x3f7fbf553ef10000,0xbf6d3f35bec48000,0xbec43f35bf6d3f80,0x3f22bf553f75bf80,0xbf463f0ebe950000,0x3f0ebec43e488000,0x3f55bf6d3f7bbf80,0xbf753f7bbf7f3f80,0x3e95be483dc90000
.quad 0x3f808000bf808000,0xbf8000003f80,0xbf223f553ef1bf6d,0x3f463f0ebf62bec4,0xbe48bf6d3f0e3f35,0xbf7b3ec43f55bf35,0x3f623e48bf7f3ec4,0x3ef1bf7b3dc93f6d,0xbf6d3f353ec4bf80,0x3ec43f35bf6d0000,0x3e95bf7b3f223ec4,0xbf753e483f46bf6d,0x3f0e3ec4bf7b3f35,0x3f55bf6d3e483f35,0xbf7f3f0e3e95bf6d,0xbdc93f55bf753ec4
.quad 0x3f35bf803f358000,0xbf3500003f35bf80,0x3dc93f0ebf753f6d,0x3f7fbf553e953ec4,0xbf553ec43e48bf35,0xbf0e3f6dbf7b3f35,0x3f75bf7b3f46bec4,0xbe95be483f22bf6d,0xbec43f35bf6d3f80,0x3f6dbf353ec40000,0xbef13e483dc9bec4,0xbf623f7bbf7f3f6d,0x3f7bbf6d3f55bf35,0x3e48bec43f0ebf35,0xbf463f55bf623f6d,0x3f22bf0e3ef1bec4
.quad 0x3f808000bf808000,0xbf8000003f80,0xbf623f0e3f46bf35,0x3ef13f55bf22bf35,0x3f0ebf6dbe483f80,0xbf55bec43f7b0000,0xbdc93f7bbef1bf35,0x3f7fbe48bf623f35,0xbec4bf353f6d8000,0xbf6d3f353ec4bf80,0x3f463e48bf753f35,0x3f22bf7b3e953f35,0xbf7b3ec43f0ebf80,0xbe483f6dbf550000,0x3f75bf553dc93f35,0xbe95bf0e3f7fbf35
.quad 0xbf353f80bf358000,0x3f350000bf353f80,0x3e95bf553f7fbf35,0xbf753f0e3dc9bf35,0x3e483ec4bf553f80,0x3f7bbf6d3f0e0000,0xbf223e483e95bf35,0xbf463f7bbf753f35,0x3f6dbf353ec48000,0x3ec4bf353f6dbf80,0xbf7f3f7bbf623f35,0x3dc93e48bef13f35,0x3f55bf6d3f7bbf80,0xbf0e3ec4be480000,0xbef13f0ebf223f35,0x3f62bf553f46bf35
.quad 0x3f808000bf808000,0xbf8000003f80,0xbf7f3e483f75bec4,0x3dc93f7bbe95bf6d,0x3f7bbec4bf553f35,0xbe48bf6d3f0e3f35,0xbf753f0e3f22bf6d,0x3e953f55bf46bec4,0x3f6dbf35bec43f80,0xbec4bf353f6d0000,0xbf623f553dc9bf6d,0x3ef13f0ebf7f3ec4,0x3f55bf6d3e483f35,0xbf0ebec43f7bbf35,0xbf463f7bbef1bec4,0x3f223e48bf623f6d
.quad 0x3f35bf803f358000,0xbf3500003f35bf80,0xbf223f7bbf623ec4,0x3f46be48bef13f6d,0x3f0ebf6d3f7bbf35,0xbf553ec43e48bf35,0xbef13f55bf7f3f6d,0x3f62bf0e3dc93ec4,0x3ec4bf353f6dbf80,0xbf6d3f35bec40000,0xbe953f0ebf463f6d,0x3f75bf553f22bec4,0x3e48bec43f0ebf35,0xbf7b3f6dbf553f35,0xbdc93e48be953ec4,0x3f7fbf7b3f75bf6d
.quad 0xbf8000003f80,0xbf8000003f800000,0xbe953f7b3dc9bf80,0x3f753e48bf7f0000,0x3f0ebf6dbe483f80,0xbf55bec43f7b0000,0xbf463f553e95bf80,0x3f223f0ebf750000,0x3f6dbf35bec43f80,0xbec4bf353f6d0000,0xbf7f3f0e3ef1bf80,0x3dc93f55bf620000,0x3f7bbec4bf0e3f80,0x3e48bf6d3f550000,0xbf623e483f22bf80,0xbef13f7bbf460000
.quad 0x3f350000bf353f80,0x3f35bf803f350000,0xbef1be483f46bf80,0xbf623f7bbf220000,0x3e483ec4bf553f80,0x3f7bbf6d3f0e0000,0x3dc9bf0e3f62bf80,0xbf7f3f55bef10000,0xbec43f35bf6d3f80,0x3f6dbf353ec40000,0x3f22bf553f75bf80,0xbf463f0ebe950000,0xbf553f6dbf7b3f80,0x3f0ebec43e480000,0x3f75bf7b3f7fbf80,0xbe953e48bdc90000
.quad 0xbf8000003f80,0xbf8000003f800000,0xbf223f553ef1bf6d,0x3f463f0ebf62bec4,0x3f7bbec4bf553f35,0xbe48bf6d3f0e3f35,0xbf62be483f7fbec4,0xbef13f7bbdc9bf6d,0x3ec43f35bf6d0000,0x3f6dbf35bec43f80,0x3e95bf7b3f223ec4,0xbf753e483f46bf6d,0xbf553f6dbe48bf35,0x3f0e3ec4bf7b3f35,0x3f7fbf0ebe953f6d,0x3dc9bf553f75bec4
.quad 0xbf3500003f35bf80,0xbf353f80bf350000,0x3dc93f0ebf753f6d,0x3f7fbf553e953ec4,0x3f0ebf6d3f7bbf35,0xbf553ec43e48bf35,0xbf753f7bbf463ec4,0x3e953e48bf223f6d,0x3f6dbf353ec40000,0x3ec4bf353f6dbf80,0xbef13e483dc9bec4,0xbf623f7bbf7f3f6d,0xbe483ec4bf0e3f35,0x3f7bbf6d3f55bf35,0x3f46bf553f62bf6d,0xbf223f0ebef13ec4
.quad 0xbf8000003f80,0xbf8000003f800000,0xbf623f0e3f46bf35,0x3ef13f55bf22bf35,0x3f553ec4bf7b0000,0x3f0ebf6dbe483f80,0x3dc9bf7b3ef13f35,0xbf7f3e483f62bf35,0xbf6d3f353ec4bf80,0x3ec43f35bf6d0000,0x3f463e48bf753f35,0x3f22bf7b3e953f35,0x3e48bf6d3f550000,0xbf7b3ec43f0ebf80,0xbf753f55bdc9bf35,0x3e953f0ebf7f3f35
.quad 0x3f350000bf353f80,0x3f35bf803f350000,0x3e95bf553f7fbf35,0xbf753f0e3dc9bf35,0xbf7b3f6dbf0e0000,0x3e483ec4bf553f80,0x3f22be48be953f35,0x3f46bf7b3f75bf35,0x3ec4bf353f6dbf80,0xbf6d3f35bec40000,0xbf7f3f7bbf623f35,0x3dc93e48bef13f35,0x3f0ebec43e480000,0x3f55bf6d3f7bbf80,0x3ef1bf0e3f22bf35,0xbf623f55bf463f35
.quad 0xbf8000003f80,0xbf8000003f800000,0xbf7f3e483f75bec4,0x3dc93f7bbe95bf6d,0x3e483f6dbf0ebf35,0x3f7bbec4bf553f35,0x3f75bf0ebf223f6d,0xbe95bf553f463ec4,0xbec4bf353f6d0000,0xbf6d3f353ec4bf80,0xbf623f553dc9bf6d,0x3ef13f0ebf7f3ec4,0x3f0e3ec4bf7b3f35,0x3f55bf6d3e483f35,0x3f46bf7b3ef13ec4,0xbf22be483f62bf6d
.quad 0xbf3500003f35bf80,0xbf353f80bf350000,0xbf223f7bbf623ec4,0x3f46be48bef13f6d,0x3f55bec4be483f35,0x3f0ebf6d3f7bbf35,0x3ef1bf553f7fbf6d,0xbf623f0ebdc9bec4,0xbf6d3f35bec40000,0xbec43f35bf6d3f80,0xbe953f0ebf463f6d,0x3f75bf553f22bec4,0x3f7bbf6d3f55bf35,0x3e48bec43f0ebf35,0x3dc9be483e95bec4,0xbf7f3f7bbf753f6d
.quad 0xbf8000003f80,0x3f808000bf808000,0xbe953f7b3dc9bf80,0xbf75be483f7f8000,0x3f0ebf6dbe483f80,0x3f553ec4bf7b8000,0xbf463f553e95bf80,0xbf22bf0e3f758000,0x3f6dbf35bec43f80,0x3ec43f35bf6d8000,0xbf7f3f0e3ef1bf80,0xbdc9bf553f628000,0x3f7bbec4bf0e3f80,0xbe483f6dbf558000,0xbf623e483f22bf80,0x3ef1bf7b3f468000
.quad 0x3f350000bf353f80,0xbf353f80bf358000,0xbef1be483f46bf80,0x3f62bf7b3f228000,0x3e483ec4bf553f80,0xbf7b3f6dbf0e8000,0x3dc9bf0e3f62bf80,0x3f7fbf553ef18000,0xbec43f35bf6d3f80,0xbf6d3f35bec48000,0x3f22bf553f75bf80,0x3f46bf0e3e958000,0xbf553f6dbf7b3f80,0xbf0e3ec4be488000,0x3f75bf7b3f7fbf80,0x3e95be483dc98000
.quad 0xbf8000003f80,0x3f808000bf808000,0xbf223f553ef1bf6d,0xbf46bf0e3f623ec4,0x3f7bbec4bf553f35,0x3e483f6dbf0ebf35,0xbf62be483f7fbec4,0x3ef1bf7b3dc93f6d,0x3ec43f35bf6d0000,0xbf6d3f353ec4bf80,0x3e95bf7b3f223ec4,0x3f75be48bf463f6d,0xbf553f6dbe48bf35,0xbf0ebec43f7bbf35,0x3f7fbf0ebe953f6d,0xbdc93f55bf753ec4
.quad 0xbf3500003f35bf80,0x3f35bf803f358000,0x3dc93f0ebf753f6d,0xbf7f3f55be95bec4,0x3f0ebf6d3f7bbf35,0x3f55bec4be483f35,0xbf753f7bbf463ec4,0xbe95be483f22bf6d,0x3f6dbf353ec40000,0xbec43f35bf6d3f80,0xbef13e483dc9bec4,0x3f62bf7b3f7fbf6d,0xbe483ec4bf0e3f35,0xbf7b3f6dbf553f35,0x3f46bf553f62bf6d,0x3f22bf0e3ef1bec4
.quad 0xbf8000003f80,0x3f808000bf808000,0xbf623f0e3f46bf35,0xbef1bf553f223f35,0x3f553ec4bf7b0000,0xbf0e3f6d3e48bf80,0x3dc9bf7b3ef13f35,0x3f7fbe48bf623f35,0xbf6d3f353ec4bf80,0xbec4bf353f6d8000,0x3f463e48bf753f35,0xbf223f7bbe95bf35,0x3e48bf6d3f550000,0x3f7bbec4bf0e3f80,0xbf753f55bdc9bf35,0xbe95bf0e3f7fbf35
.quad 0x3f350000bf353f80,0xbf353f80bf358000,0x3e95bf553f7fbf35,0x3f75bf0ebdc93f35,0xbf7b3f6dbf0e0000,0xbe48bec43f55bf80,0x3f22be48be953f35,0xbf463f7bbf753f35,0x3ec4bf353f6dbf80,0x3f6dbf353ec48000,0xbf7f3f7bbf623f35,0xbdc9be483ef1bf35,0x3f0ebec43e480000,0xbf553f6dbf7b3f80,0x3ef1bf0e3f22bf35,0x3f62bf553f46bf35
.quad 0xbf8000003f80,0x3f808000bf808000,0xbf7f3e483f75bec4,0xbdc9bf7b3e953f6d,0x3e483f6dbf0ebf35,0xbf7b3ec43f55bf35,0x3f75bf0ebf223f6d,0x3e953f55bf46bec4,0xbec4bf353f6d0000,0x3f6dbf35bec43f80,0xbf623f553dc9bf6d,0xbef1bf0e3f7fbec4,0x3f0e3ec4bf7b3f35,0xbf553f6dbe48bf35,0x3f46bf7b3ef13ec4,0x3f223e48bf623f6d
.quad 0xbf3500003f35bf80,0x3f35bf803f358000,0xbf223f7bbf623ec4,0xbf463e483ef1bf6d,0x3f55bec4be483f35,0xbf0e3f6dbf7b3f35,0x3ef1bf553f7fbf6d,0x3f62bf0e3dc93ec4,0xbf6d3f35bec40000,0x3ec4bf353f6dbf80,0xbe953f0ebf463f6d,0xbf753f55bf223ec4,0x3f7bbf6d3f55bf35,0xbe483ec4bf0e3f35,0x3dc9be483e95bec4,0x3f7fbf7b3f75bf6d
.quad 0xbf8000003f80,0xbf8000003f80,0xbe953f7b3dc9bf80,0xbf75be483f7f0000,0x3f0ebf6dbe483f80,0xbf0e3f6d3e48bf80,0xbf463f553e95bf80,0x3f223f0ebf750000,0x3f6dbf35bec43f80,0x3f6dbf35bec43f80,0xbf7f3f0e3ef1bf80,0xbdc9bf553f620000,0x3f7bbec4bf0e3f80,0xbf7b3ec43f0ebf80,0xbf623e483f22bf80,0xbef13f7bbf460000
.quad 0x3f350000bf353f80,0x3f350000bf353f80,0xbef1be483f46bf80,0x3f62bf7b3f220000,0x3e483ec4bf553f80,0xbe48bec43f55bf80,0x3dc9bf0e3f62bf80,0xbf7f3f55bef10000,0xbec43f35bf6d3f80,0xbec43f35bf6d3f80,0x3f22bf553f75bf80,0x3f46bf0e3e950000,0xbf553f6dbf7b3f80,0x3f55bf6d3f7bbf80,0x3f75bf7b3f7fbf80,0xbe953e48bdc90000
.quad 0xbf8000003f80,0xbf8000003f80,0xbf223f553ef1bf6d,0xbf46bf0e3f623ec4,0x3f7bbec4bf553f35,0xbf7b3ec43f55bf35,0xbf62be483f7fbec4,0xbef13f7bbdc9bf6d,0x3ec43f35bf6d0000,0x3ec43f35bf6d0000,0x3e95bf7b3f223ec4,0x3f75be48bf463f6d,0xbf553f6dbe48bf35,0x3f55bf6d3e483f35,0x3f7fbf0ebe953f6d,0x3dc9bf553f75bec4
.quad 0xbf3500003f35bf80,0xbf3500003f35bf80,0x3dc93f0ebf753f6d,0xbf7f3f55be95bec4,0x3f0ebf6d3f7bbf35,0xbf0e3f6dbf7b3f35,0xbf753f7bbf463ec4,0x3e953e48bf223f6d,0x3f6dbf353ec40000,0x3f6dbf353ec40000,0xbef13e483dc9bec4,0x3f62bf7b3f7fbf6d,0xbe483ec4bf0e3f35,0x3e48bec43f0ebf35,0x3f46bf553f62bf6d,0xbf223f0ebef13ec4
.quad 0xbf8000003f80,0xbf8000003f80,0xbf623f0e3f46bf35,0xbef1bf553f223f35,0x3f553ec4bf7b0000,0xbf55bec43f7b0000,0x3dc9bf7b3ef13f35,0xbf7f3e483f62bf35,0xbf6d3f353ec4bf80,0xbf6d3f353ec4bf80,0x3f463e48bf753f35,0xbf223f7bbe95bf35,0x3e48bf6d3f550000,0xbe483f6dbf550000,0xbf753f55bdc9bf35,0x3e953f0ebf7f3f35
.quad 0x3f350000bf353f80,0x3f350000bf353f80,0x3e95bf553f7fbf35,0x3f75bf0ebdc93f35,0xbf7b3f6dbf0e0000,0x3f7bbf6d3f0e0000,0x3f22be48be953f35,0x3f46bf7b3f75bf35,0x3ec4bf353f6dbf80,0x3ec4bf353f6dbf80,0xbf7f3f7bbf623f35,0xbdc9be483ef1bf35,0x3f0ebec43e480000,0xbf0e3ec4be480000,0x3ef1bf0e3f22bf35,0xbf623f55bf463f35
.quad 0xbf8000003f80,0xbf8000003f80,0xbf7f3e483f75bec4,0xbdc9bf7b3e953f6d,0x3e483f6dbf0ebf35,0xbe48bf6d3f0e3f35,0x3f75bf0ebf223f6d,0xbe95bf553f463ec4,0xbec4bf353f6d0000,0xbec4bf353f6d0000,0xbf623f553dc9bf6d,0xbef1bf0e3f7fbec4,0x3f0e3ec4bf7b3f35,0xbf0ebec43f7bbf35,0x3f46bf7b3ef13ec4,0xbf22be483f62bf6d
.quad 0xbf3500003f35bf80,0xbf3500003f35bf80,0xbf223f7bbf623ec4,0xbf463e483ef1bf6d,0x3f55bec4be483f35,0xbf553ec43e48bf35,0x3ef1bf553f7fbf6d,0xbf623f0ebdc9bec4,0xbf6d3f35bec40000,0xbf6d3f35bec40000,0xbe953f0ebf463f6d,0xbf753f55bf223ec4,0x3f7bbf6d3f55bf35,0xbf7b3f6dbf553f35,0x3dc9be483e95bec4,0xbf7f3f7bbf753f6d
.quad 0xbf8000003f800000,0xbf8000003f80,0xbe953f7b3dc9bf80,0xbf75be483f7f0000,0x3f553ec4bf7b0000,0xbf0e3f6d3e48bf80,0x3f46bf55be953f80,0x3f223f0ebf750000,0xbec4bf353f6d0000,0x3f6dbf35bec43f80,0xbf7f3f0e3ef1bf80,0xbdc9bf553f620000,0xbe483f6dbf550000,0xbf7b3ec43f0ebf80,0x3f62be48bf223f80,0xbef13f7bbf460000
.quad 0x3f35bf803f350000,0x3f350000bf353f80,0xbef1be483f46bf80,0x3f62bf7b3f220000,0xbf7b3f6dbf0e0000,0xbe48bec43f55bf80,0xbdc93f0ebf623f80,0xbf7f3f55bef10000,0x3f6dbf353ec40000,0xbec43f35bf6d3f80,0x3f22bf553f75bf80,0x3f46bf0e3e950000,0xbf0e3ec4be480000,0x3f55bf6d3f7bbf80,0xbf753f7bbf7f3f80,0xbe953e48bdc90000
.quad 0xbf8000003f800000,0xbf8000003f80,0xbf223f553ef1bf6d,0xbf46bf0e3f623ec4,0x3e483f6dbf0ebf35,0xbf7b3ec43f55bf35,0x3f623e48bf7f3ec4,0xbef13f7bbdc9bf6d,0x3f6dbf35bec43f80,0x3ec43f35bf6d0000,0x3e95bf7b3f223ec4,0x3f75be48bf463f6d,0xbf0ebec43f7bbf35,0x3f55bf6d3e483f35,0xbf7f3f0e3e95bf6d,0x3dc9bf553f75bec4
.quad 0xbf353f80bf350000,0xbf3500003f35bf80,0x3dc93f0ebf753f6d,0xbf7f3f55be95bec4,0x3f55bec4be483f35,0xbf0e3f6dbf7b3f35,0x3f75bf7b3f46bec4,0x3e953e48bf223f6d,0x3ec4bf353f6dbf80,0x3f6dbf353ec40000,0xbef13e483dc9bec4,0x3f62bf7b3f7fbf6d,0xbf7b3f6dbf553f35,0x3e48bec43f0ebf35,0xbf463f55bf623f6d,0xbf223f0ebef13ec4
.quad 0xbf8000003f800000,0xbf8000003f80,0xbf623f0e3f46bf35,0xbef1bf553f223f35,0xbf0e3f6d3e48bf80,0xbf55bec43f7b0000,0xbdc93f7bbef1bf35,0xbf7f3e483f62bf35,0x3ec43f35bf6d0000,0xbf6d3f353ec4bf80,0x3f463e48bf753f35,0xbf223f7bbe95bf35,0x3f7bbec4bf0e3f80,0xbe483f6dbf550000,0x3f75bf553dc93f35,0x3e953f0ebf7f3f35
.quad 0x3f35bf803f350000,0x3f350000bf353f80,0x3e95bf553f7fbf35,0x3f75bf0ebdc93f35,0xbe48bec43f55bf80,0x3f7bbf6d3f0e0000,0xbf223e483e95bf35,0x3f46bf7b3f75bf35,0xbf6d3f35bec40000,0x3ec4bf353f6dbf80,0xbf7f3f7bbf623f35,0xbdc9be483ef1bf35,0xbf553f6dbf7b3f80,0xbf0e3ec4be480000,0xbef13f0ebf223f35,0xbf623f55bf463f35
.quad 0xbf8000003f800000,0xbf8000003f80,0xbf7f3e483f75bec4,0xbdc9bf7b3e953f6d,0xbf7b3ec43f55bf35,0xbe48bf6d3f0e3f35,0xbf753f0e3f22bf6d,0xbe95bf553f463ec4,0xbf6d3f353ec4bf80,0xbec4bf353f6d0000,0xbf623f553dc9bf6d,0xbef1bf0e3f7fbec4,0xbf553f6dbe48bf35,0xbf0ebec43f7bbf35,0xbf463f7bbef1bec4,0xbf22be483f62bf6d
.quad 0xbf353f80bf350000,0xbf3500003f35bf80,0xbf223f7bbf623ec4,0xbf463e483ef1bf6d,0xbf0e3f6dbf7b3f35,0xbf553ec43e48bf35,0xbef13f55bf7f3f6d,0xbf623f0ebdc9bec4,0xbec43f35bf6d3f80,0xbf6d3f35bec40000,0xbe953f0ebf463f6d,0xbf753f55bf223ec4,0xbe483ec4bf0e3f35,0xbf7b3f6dbf553f35,0xbdc93e48be953ec4,0xbf7f3f7bbf753f6d
.quad 0x3f808000bf808000,0xbf8000003f80,0x3e95bf7bbdc93f80,0xbf75be483f7f0000,0xbf55bec43f7b8000,0xbf0e3f6d3e48bf80,0xbf463f553e95bf80,0x3f223f0ebf750000,0x3ec43f35bf6d8000,0x3f6dbf35bec43f80,0x3f7fbf0ebef13f80,0xbdc9bf553f620000,0x3e48bf6d3f558000,0xbf7b3ec43f0ebf80,0xbf623e483f22bf80,0xbef13f7bbf460000
.quad 0xbf353f80bf358000,0x3f350000bf353f80,0x3ef13e48bf463f80,0x3f62bf7b3f220000,0x3f7bbf6d3f0e8000,0xbe48bec43f55bf80,0x3dc9bf0e3f62bf80,0xbf7f3f55bef10000,0xbf6d3f35bec48000,0xbec43f35bf6d3f80,0xbf223f55bf753f80,0x3f46bf0e3e950000,0x3f0ebec43e488000,0x3f55bf6d3f7bbf80,0x3f75bf7b3f7fbf80,0xbe953e48bdc90000
.quad 0x3f808000bf808000,0xbf8000003f80,0x3f22bf55bef13f6d,0xbf46bf0e3f623ec4,0xbe48bf6d3f0e3f35,0xbf7b3ec43f55bf35,0xbf62be483f7fbec4,0xbef13f7bbdc9bf6d,0xbf6d3f353ec4bf80,0x3ec43f35bf6d0000,0xbe953f7bbf22bec4,0x3f75be48bf463f6d,0x3f0e3ec4bf7b3f35,0x3f55bf6d3e483f35,0x3f7fbf0ebe953f6d,0x3dc9bf553f75bec4
.quad 0x3f35bf803f358000,0xbf3500003f35bf80,0xbdc9bf0e3f75bf6d,0xbf7f3f55be95bec4,0xbf553ec43e48bf35,0xbf0e3f6dbf7b3f35,0xbf753f7bbf463ec4,0x3e953e48bf223f6d,0xbec43f35bf6d3f80,0x3f6dbf353ec40000,0x3ef1be48bdc93ec4,0x3f62bf7b3f7fbf6d,0x3f7bbf6d3f55bf35,0x3e48bec43f0ebf35,0x3f46bf553f62bf6d,0xbf223f0ebef13ec4
.quad 0x3f808000bf808000,0xbf8000003f80,0x3f62bf0ebf463f35,0xbef1bf553f223f35,0x3f0ebf6dbe483f80,0xbf55bec43f7b0000,0x3dc9bf7b3ef13f35,0xbf7f3e483f62bf35,0xbec4bf353f6d8000,0xbf6d3f353ec4bf80,0xbf46be483f75bf35,0xbf223f7bbe95bf35,0xbf7b3ec43f0ebf80,0xbe483f6dbf550000,0xbf753f55bdc9bf35,0x3e953f0ebf7f3f35
.quad 0xbf353f80bf358000,0x3f350000bf353f80,0xbe953f55bf7f3f35,0x3f75bf0ebdc93f35,0x3e483ec4bf553f80,0x3f7bbf6d3f0e0000,0x3f22be48be953f35,0x3f46bf7b3f75bf35,0x3f6dbf353ec48000,0x3ec4bf353f6dbf80,0x3f7fbf7b3f62bf35,0xbdc9be483ef1bf35,0x3f55bf6d3f7bbf80,0xbf0e3ec4be480000,0x3ef1bf0e3f22bf35,0xbf623f55bf463f35
.quad 0x3f808000bf808000,0xbf8000003f80,0x3f7fbe48bf753ec4,0xbdc9bf7b3e953f6d,0x3f7bbec4bf553f35,0xbe48bf6d3f0e3f35,0x3f75bf0ebf223f6d,0xbe95bf553f463ec4,0x3f6dbf35bec43f80,0xbec4bf353f6d0000,0x3f62bf55bdc93f6d,0xbef1bf0e3f7fbec4,0x3f55bf6d3e483f35,0xbf0ebec43f7bbf35,0x3f46bf7b3ef13ec4,0xbf22be483f62bf6d
.quad 0x3f35bf803f358000,0xbf3500003f35bf80,0x3f22bf7b3f62bec4,0xbf463e483ef1bf6d,0x3f0ebf6d3f7bbf35,0xbf553ec43e48bf35,0x3ef1bf553f7fbf6d,0xbf623f0ebdc9bec4,0x3ec4bf353f6dbf80,0xbf6d3f35bec40000,0x3e95bf0e3f46bf6d,0xbf753f55bf223ec4,0x3e48bec43f0ebf35,0xbf7b3f6dbf553f35,0x3dc9be483e95bec4,0xbf7f3f7bbf753f6d
.quad 0x3f7fb10f3f800000,0x3f7d3aac3f7ec46d,0x3f7fa6e33f800000,0x3f7cdf6c3f7e9bc9,0x3f7f9c183f800000,0x3f7c7eb03f7e70b0,0x3f7f90b13f800000,0x3f7c187a3f7e4323,0x3f7f84ab3f800000,0x3f7baccd3f7e1324,0x3f7f78083f800000,0x3f7b3bab3f7de0b1,0x3f7f6ac73f800000,0x3f7ac5163f7dabcc,0x3f7f5ce93f800000,0x3f7a49103f7d7474
.quad 0x3f7f4e6d3f800000,0x3f79c79d3f7d3aac,0x3f7f3f543f800000,0x3f7940c03f7cfe73,0x3f7f2f9d3f800000,0x3f78b47b3f7cbfc9,0x3f7f1f493f800000,0x3f7822d13f7c7eb0,0x3f7f0e583f800000,0x3f778bc53f7c3b28,0x3f7efcc93f800000,0x3f76ef5b3f7bf531,0x3f7eea9d3f800000,0x3f764d973f7baccd,0x3f7ed7d43f800000,0x3f75a67b3f7b61fc
.quad 0x3f7853f83f7b14be,0x3f7109083f74fa0b,0x3f77583a3f7a7302,0x3f6f20b03f73913f,0x3f764d973f79c79d,0x3f6d1c1d3f721352,0x3f75341d3f791298,0x3f6afb8c3f708066,0x3f740bdd3f7853f8,0x3f68bf3c3f6ed89e,0x3f72d4eb3f778bc5,0x3f6667713f6d1c1d,0x3f718f573f76ba07,0x3f63f4733f6b4b0c,0x3f703b373f75dec6,0x3f61668a3f696591
.quad 0x3f6ed89e3f74fa0b,0x3f5ebe053f676bd8,0x3f6d67a13f740bdd,0x3f5bfb343f655e0b,0x3f6be8583f731447,0x3f591e6a3f633c5a,0x3f6a5ad93f721352,0x3f5627fe3f6106f2,0x3f68bf3c3f710908,0x3f5318493f5ebe05,0x3f6715993f6ff573,0x3f4fefa83f5c61c7,0x3f655e0b3f6ed89e,0x3f4cae793f59f26a,0x3f6398ac3f6db293,0x3f4955213f577026
.quad 0x3f676bd83f6c835e,0x3f5b941a3f61c598,0x3f644fac3f6a09a7,0x3f5703483f5df6be,0x3f6106f23f676bd8,0x3f5233c63f59f26a,0x3f5d924d3f64aa59,0x3f4d26fd3f55b993,0x3f59f26a3f61c598,0x3f47de653f514d3d,0x3f5627fe3f5ebe05,0x3f425b893f4cae79,0x3f5233c63f5b941a,0x3f3ca0033f47de65,0x3f4e16893f584853,0x3f36ad7f3f42de29
.quad 0x3f49d1123f54db31,0x3f3085bb3f3daef9,0x3f4564393f514d3d,0x3f2a2a803f385216,0x3f40d0da3f4d9f02,0x3f239da93f32c8c9,0x3f3c17d93f49d112,0x3f1ce11f3f2d1469,0x3f373a233f45e403,0x3f15f6d93f273656,0x3f3238aa3f41d870,0x3f0ee0db3f212ff9,0x3f2d14693f3daef9,0x3f07a1363f1b02c6,0x3f27ce613f396842,0x3f003a063f14b039
.quad 0x3f4d9f023f54db31,0x3f3daef93f45e403,0x3f4760853f4f7a1f,0x3f3592e73f3ebc1b,0x3f40d0da3f49d112,0x3f2d14693f373a23,0x3f39f2ac3f43e200,0x3f24381a3f2f61a5,0x3f32c8c93f3daef9,0x3f1b02c63f273656,0x3f2b561b3f373a23,0x3f11796b3f1ebc12,0x3f239da93f3085bb,0x3f07a1363f15f6d9,0x3f1ba2993f299415,0x3efafef73f0cead0
.quad 0x3f13682a3f226799,0x3ee633753f039c3d,0x3f0af1b73f1b02c6,0x3ed0eb2a3ef41f07,0x3f0242b13f13682a,0x3ebb31a03ee0924f,0x3ef2bd433f0b9a6b,0x3ea5129f3ecc9b8b,0x3ee0924f3f039c3d,0x3e8e9a223eb8442a,0x3ece0bea3ef6e0cb,0x3e6fa8b23ea395c5,0x3ebb31a03ee63375,0x3e419b373e8e9a22,0x3ea80b1f3ed53641,0x3e1324ca3e72b651
.quad 0x3f2beb4a3f3504f3,0x3f187fc03f226799,0x3f21cbfb3f2beb4a,0x3f0c42c93f173c07,0x3f173c073f226799,0x3eff17b23f0b9a6b,0x3f0c42c93f187fc0,0x3ee4cbfe3eff17b2,0x3f00e7e43f0e39da,0x3ec9b9533ee63375,0x3eea66813f039c3d,0x3eadf73c3ecc9b8b,0x3ed25a093ef15aea,0x3e919ddd3eb263ef,0x3eb9bb1e3edae880,0x3e698bba3e97a117
.quad 0x3ea09ae53ec3ef15,0x3e2f10a23e78cfcc,0x3e870ada3eac7cd4,0x3de7fa9a3e419b37,0x3e5a39973e94a031,0x3d6214693e09cf86,0x3e25c58c3e78cfcc,0xbb490fc63da3308c,0x3de1bc2e3e47c5c2,0xbd7b2b743cc90ab0,0x3d6ea0383e164083,0xbdf475c0bcfb49ba,0x3bc90f883dc8bd36,0xbe354098bdafb680,0xbd3c6dd53d48fb30,0xbe6fa8b2be1008b7
.quad 0x3f039c3d3f0e39da,0x3edae8803ef15aea,0x3eea66813f00e7e4,0x3eb9bb1e3ed25a09,0x3ecc9b8b3ee63375,0x3e97a1173eb263ef,0x3eadf73c3ec9b953,0x3e698bba3e919ddd,0x3e8e9a223eac7cd4,0x3e22abb63e605c13,0x3e5d4b1a3e8e9a22,0x3db5f8da3e1c76de,0x3e1c76de3e605c13,0x3c96c9b63dafb680,0x3db5f8da3e22abb6,0xbd55880e3c96c9b6
.quad 0x3cc90ab03dc8bd36,0xbdfab273bd48fb30,0xbd2351cb3d16c32c,0xbe44b0b9bdee3876,0xbdd53db9bcc90ab0,0xbe8586cebe3b6ecf,0xbe2bf804bdafb680,0xbea80b1fbe7ee6e1,0xbe6c9a7fbe164083,0xbec9b953bea09ae5,0xbe9620d2be541501,0xbeea6681bec1071e,0xbeb554ecbe888e93,0xbf04f484bee0924f,0xbed3c867bea68f12,0xbf140c5fbeff17b2
.quad 0x3eac7cd43ec3ef15,0x3e78cfcc3e94a031,0x3e870ada3ea09ae5,0x3e25c58c3e5a3997,0x3e419b373e78cfcc,0x3da3308c3e09cf86,0x3de7fa9a3e2f10a2,0xbb490fc63d621469,0x3d16c32c3dc8bd36,0xbdafb680bcc90ab0,0xbd2351cb3cc90ab0,0xbe2bf804bdd53db9,0xbdee3876bd48fb30,0xbe7ee6e1be3b6ecf,0xbe44b0b9bdfab273,0xbea80b1fbe8586ce
.quad 0xbe888e93be47c5c2,0xbecf7bcabeac7cd4,0xbeadf73cbe888e93,0xbef58035bed25a09,0xbed25a09beac7cd4,0xbf0cead0bef6e0cb,0xbef58035becf7bca,0xbf1e1e22bf0cead0,0xbf0b9a6bbef15aea,0xbf2e3bdebf1d7fd1,0xbf1ba299bf08f59b,0xbf3d27b8bf2d1469,0xbf2ac082bf187fc0,0xbf4ac77fbf3b8f3b,0xbf38dd65bf273656,0xbf570348bf48d8b3
.quad 0x3e1640833e47c5c2,0x3d48fb303dc8bd36,0x3d6ea0383de1bc2e,0xbd3c6dd53bc90f88,0xbcfb49ba3cc90ab0,0xbe1008b7bdafb680,0xbdf475c0bd7b2b74,0xbe6fa8b2be354098,0xbe541501be164083,0xbea68f12be888e93,0xbe9620d2be6c9a7f,0xbed3c867beb554ec,0xbec1071ebea09ae5,0xbeff17b2bee0924f,0xbeea6681bec9b953,0xbf140c5fbf04f484
.quad 0xbf08f59bbef15aea,0xbf273656bf187fc0,0xbf1ba299bf0b9a6b,0xbf38dd65bf2ac082,0xbf2d1469bf1d7fd1,0xbf48d8b3bf3b8f3b,0xbf3d27b8bf2e3bde,0xbf570348bf4ac77f,0xbf4bbbf8bf3daef9,0xbf633c5abf584853,0xbf58b3a1bf4bbbf8,0xbf6d67a1bf63f473,0xbf63f473bf584853,0xbf756d97bf6db293,0xbf6d67a1bf633c5a,0xbf7b3babbf756d97
.quad 0x3d48fb3000000000,0x3e1640833dc8bd36,0x3d55880e00000000,0x3e1f917b3dd53db9,0x3d62146900000000,0x3e28defc3de1bc2e,0x3d6ea03800000000,0x3e3228d43dee3876,0x3d7b2b7400000000,0x3e3b6ecf3dfab273,0x3d83db0a00000000,0x3e44b0b93e039502,0x3d8a200a00000000,0x3e4dee603e09cf86,0x3d9064b400000000,0x3e57278f3e1008b7
.quad 0x3d96a90500000000,0x3e605c133e164083,0x3d9cecf900000000,0x3e698bba3e1c76de,0x3da3308c00000000,0x3e72b6513e22abb6,0x3da973ba00000000,0x3e7bdba43e28defc,0x3dafb68000000000,0x3e827dc03e2f10a2,0x3db5f8da00000000,0x3e870ada3e354098,0x3dbc3ac300000000,0x3e8b95073e3b6ecf,0x3dc27c3900000000,0x3e901c2c3e419b37
.quad 0x3e78cfcc3e47c5c2,0x3eac7cd43e94a031,0x3e8402703e541501,0x3eb6ccc33e9d9e78,0x3e8b95073e605c13,0x3ec1071e3ea68f12,0x3e931f353e6c9a7f,0x3ecb2aae3eaf713a,0x3e9aa0863e78cfcc,0x3ed536413eb8442a,0x3ea218873e827dc0,0x3edf28a93ec1071e,0x3ea986c43e888e93,0x3ee900b73ec9b953,0x3eb0eacb3e8e9a22,0x3ef2bd433ed25a09
.quad 0x3eb8442a3e94a031,0x3efc5d273edae880,0x3ebf926f3e9aa086,0x3f02ef9f3ee363fa,0x3ec6d5293ea09ae5,0x3f07a1363eebcbbb,0x3ece0bea3ea68f12,0x3f0c42c93ef41f07,0x3ed536413eac7cd4,0x3f10d3cd3efc5d27,0x3edc53c13eb263ef,0x3f1553b73f0242b1,0x3ee363fa3eb8442a,0x3f19c2003f064b82,0x3eea66813ebe1d4a,0x3f1e1e223f0a48ad
.quad 0x3edae8803ec3ef15,0x3f039c3d3ef15aea,0x3ee79a5d3ecf7bca,0x3f0af1b73eff17b2,0x3ef41f073edae880,0x3f121eb03f064b82,0x3f003a063ee63375,0x3f19210f3f0cead0,0x3f064b823ef15aea,0x3f1ff6cb3f13682a,0x3f0c42c93efc5d27,0x3f269de33f19c200,0x3f121eb03f039c3d,0x3f2d14693f1ff6cb,0x3f17de123f08f59b,0x3f33587a3f26050a
.quad 0x3f1d7fd13f0e39da,0x3f3968423f2beb4a,0x3f2302d33f13682a,0x3f3f41fc3f31a81d,0x3f2866053f187fc0,0x3f44e3f53f373a23,0x3f2da8593f1d7fd1,0x3f4a4c873f3ca003,0x3f32c8c93f226799,0x3f4f7a1f3f41d870,0x3f37c6553f273656,0x3f546b3b3f46e22a,0x3f3ca0033f2beb4a,0x3f591e6a3f4bbbf8,0x3f4154e13f3085bb,0x3f5d924d3f5064af
.quad 0x3f187fc03f0e39da,0x3f2beb4a3f226799,0x3f2093933f15f6d9,0x3f34768f3f2ac082,0x3f2866053f1d7fd1,0x3f3ca0033f32c8c9,0x3f2ff3e63f24d225,0x3f4463373f3a7ca4,0x3f373a233f2beb4a,0x3f4bbbf83f41d870,0x3f3e35c53f32c8c9,0x3f52a6493f48d8b3,0x3f44e3f53f396842,0x3f591e6a3f4f7a1f,0x3f4b41fa3f3fc767,0x3f5f20db3f55b993
.quad 0x3f514d3d3f45e403,0x3f64aa593f5b941a,0x3f5703483f4bbbf8,0x3f69b7e43f6106f2,0x3f5c61c73f514d3d,0x3f6e46be3f660f88,0x3f61668a3f5695e5,0x3f7254703f6aab7b,0x3f660f883f5b941a,0x3f75dec63f6ed89e,0x3f6a5ad93f604621,0x3f78e3d63f7294f8,0x3f6e46be3f64aa59,0x3f7b61fc3f75dec6,0x3f71d19f3f68bf3c,0x3f7d57de3f78b47b
.quad 0x3f3daef93f3504f3,0x3f4d9f023f45e403,0x3f4663543f3daef9,0x3f5627fe3f4e8d90,0x3f4e8d903f45e403,0x3f5df6be3f5695e5,0x3f5627fe3f4d9f02,0x3f6504793f5df6be,0x3f5d2d533f54db31,0x3f6b4b0c3f64aa59,0x3f6398ac3f5b941a,0x3f70c5013f6aab7b,0x3f6965913f61c598,0x3f756d973f6ff573,0x3f6e8ff83f676bd8,0x3f7940c03f748422
.quad 0x3f7314473f6c835e,0x3f7c3b283f7853f8,0x3f76ef5b3f710908,0x3f7e5a383f7b61fc,0x3f7a1e843f74fa0b,0x3f7f9c183f7dabcc,0x3f7c9f8a3f7853f8,0x3f7fffb13f7f2f9d,0x3f7e70b03f7b14be,0x3f7f84ab3f7fec43,0x3f7f90b13f7d3aac,0x3f7e2b723f7fe129,0x3f7ffec43f7ec46d,0x3f7bf5313f7f0e58,0x3f7fba9e3f7fb10f,0x3f78e3d63f7d7474
.quad 0x3f5b941a3f54db31,0x3f676bd83f61c598,0x3f6398ac3f5d2d53,0x3f6e8ff83f696591,0x3f6aab7b3f64aa59,0x3f7484223f6ff573,0x3f70c5013f6b4b0c,0x3f7940c03f756d97,0x3f75dec63f710908,0x3f7cbfc93f79c79d,0x3f79f35e3f75dec6,0x3f7efcc93f7cfe73,0x3f7cfe733f79c79d,0x3f7ff4e63f7f0e58,0x3f7efcc93f7cbfc9,0x3f7fa6e33f7ff4e6
.quad 0x3f7fec433f7ec46d,0x3f7e13243f7fb10f,0x3f7fcbe23f7fd397,0x3f7b3bab3f7e4323,0x3f7e9bc93f7fec43,0x3f7724173f7baccd,0x3f7c5d3a3f7f0e58,0x3f71d19f3f77f110,0x3f7912983f7d3aac,0x3f6b4b0c3f731447,0x3f74bf623f7a7302,0x3f6398ac3f6d1c1d,0x3f6f68303f76ba07,0x3f5ac4503f660f88,0x3f6912ae3f721352,0x3f50d9373f5df6be
.quad 0x3f7109083f6c835e,0x3f7853f83f74fa0b,0x3f76ef5b3f731447,0x3f7c9f8a3f7a1e84,0x3f7b61fc3f7853f8,0x3f7f2f9d3f7dabcc,0x3f7e5a383f7c3b28,0x3f7fffb13f7f9c18,0x3f7fd3973f7ec46d,0x3f7f0e583f7fec43,0x3f7fcbe23f7fec43,0x3f7c5d3a3f7e9bc9,0x3f7e43233f7fb10f,0x3f77f1103f7baccd,0x3f7b3bab3f7e1324,0x3f71d19f3f772417
.quad 0x3f76ba073f7b14be,0x3f6a09a73f710908,0x3f70c5013f76ba07,0x3f60a6cf3f696591,0x3f6965913f710908,0x3f55b9933f604621,0x3f60a6cf3f6a09a7,0x3f4955213f55b993,0x3f5695e53f61c598,0x3f3b8f3b3f49d112,0x3f4b41fa3f584853,0x3f2c800f3f3ca003,0x3f3ebc1b3f4d9f02,0x3f1c420c3f2e3bde,0x3f3117223f41d870,0x3f0af1b73f1ebc12
.quad 0x3f7d3aac3f7b14be,0x3f7fb10f3f7ec46d,0x3f7f90b13f7e70b0,0x3f7fba9e3f7ffec4,0x3f7fe1293f7fec43,0x3f7d74743f7f0e58,0x3f7e2b723f7f84ab,0x3f78e3d63f7bf531,0x3f7a73023f7d3aac,0x3f7213523f76ba07,0x3f74bf623f791298,0x3f6912ae3f6f6830,0x3f6d1c1d3f731447,0x3f5df6be3f660f88,0x3f6398ac3f6b4b0c,0x3f50d9373f5ac450
.quad 0x3f5848533f61c598,0x3f41d8703f4d9f02,0x3f4b41fa3f5695e5,0x3f3117223f3ebc1b,0x3f3ca0033f49d112,0x3f1ebc123f2e3bde,0x3f2c800f3f3b8f3b,0x3f0af1b73f1c420c,0x3f1b02c63f2beb4a,0x3eebcbbb3f08f59b,0x3f084b923f1b02c6,0x3ebf926f3ee900b7,0x3ee900b73f08f59b,0x3e919ddd3ebe1d4a,0x3ebf926f3eebcbbb,0x3e44b0b93e919ddd
.quad 0x3f8000003f800000,0x3f8000003f800000,0x3f7fa6e33f7fb10f,0x3f7f90b13f7f9c18,0x3f7e9bc93f7ec46d,0x3f7e43233f7e70b0,0x3f7cdf6c3f7d3aac,0x3f7c187a3f7c7eb0,0x3f7a73023f7b14be,0x3f7912983f79c79d,0x3f77583a3f7853f8,0x3f75341d3f764d97,0x3f73913f3f74fa0b,0x3f7080663f721352,0x3f6f20b03f710908,0x3f6afb8c3f6d1c1d
.quad 0x3f6a09a73f6c835e,0x3f64aa593f676bd8,0x3f644fac3f676bd8,0x3f5d924d3f6106f2,0x3f5df6be3f61c598,0x3f55b9933f59f26a,0x3f5703483f5b941a,0x3f4d26fd3f5233c6,0x3f4f7a1f3f54db31,0x3f43e2003f49d112,0x3f4760853f4d9f02,0x3f39f2ac3f40d0da,0x3f3ebc1b3f45e403,0x3f2f61a53f373a23,0x3f3592e73f3daef9,0x3f24381a3f2d1469
.quad 0x3f8000003f800000,0x3f8000003f800000,0x3f7f78083f7f84ab,0x3f7f5ce93f7f6ac7,0x3f7de0b13f7e1324,0x3f7d74743f7dabcc,0x3f7b3bab3f7baccd,0x3f7a49103f7ac516,0x3f778bc53f7853f8,0x3f75dec63f76ba07,0x3f72d4eb3f740bdd,0x3f703b373f718f57,0x3f6d1c1d3f6ed89e,0x3f6965913f6b4b0c,0x3f6667713f68bf3c,0x3f61668a3f63f473
.quad 0x3f5ebe053f61c598,0x3f5848533f5b941a,0x3f5627fe3f59f26a,0x3f4e16893f5233c6,0x3f4cae793f514d3d,0x3f42de293f47de65,0x3f425b893f47de65,0x3f36ad7f3f3ca003,0x3f373a233f3daef9,0x3f2994153f3085bb,0x3f2b561b3f32c8c9,0x3f1ba2993f239da9,0x3f1ebc123f273656,0x3f0cead03f15f6d9,0x3f11796b3f1b02c6,0x3efafef73f07a136
.quad 0x3f8000003f800000,0x3f8000003f800000,0x3f7f3f543f7f4e6d,0x3f7f1f493f7f2f9d,0x3f7cfe733f7d3aac,0x3f7c7eb03f7cbfc9,0x3f7940c03f79c79d,0x3f7822d13f78b47b,0x3f740bdd3f74fa0b,0x3f7213523f731447,0x3f6d67a13f6ed89e,0x3f6a5ad93f6be858,0x3f655e0b3f676bd8,0x3f6106f23f633c5a,0x3f5bfb343f5ebe05,0x3f5627fe3f591e6a
.quad 0x3f514d3d3f54db31,0x3f49d1123f4d9f02,0x3f4564393f49d112,0x3f3c17d93f40d0da,0x3f3852163f3daef9,0x3f2d14693f32c8c9,0x3f2a2a803f3085bb,0x3f1ce11f3f239da9,0x3f1b02c63f226799,0x3f0b9a6b3f13682a,0x3f0af1b73f13682a,0x3ef2bd433f0242b1,0x3ef41f073f039c3d,0x3ecc9b8b3ee0924f,0x3ed0eb2a3ee63375,0x3ea5129f3ebb31a0
.quad 0x3f8000003f800000,0x3f8000003f800000,0x3f7efcc93f7f0e58,0x3f7ed7d43f7eea9d,0x3f7bf5313f7c3b28,0x3f7b61fc3f7baccd,0x3f76ef5b3f778bc5,0x3f75a67b3f764d97,0x3f6ff5733f710908,0x3f6db2933f6ed89e,0x3f6715993f68bf3c,0x3f6398ac3f655e0b,0x3f5c61c73f5ebe05,0x3f5770263f59f26a,0x3f4fefa83f531849,0x3f4955213f4cae79
.quad 0x3f41d8703f45e403,0x3f3968423f3daef9,0x3f3238aa3f373a23,0x3f27ce613f2d1469,0x3f212ff93f273656,0x3f14b0393f1b02c6,0x3f0ee0db3f15f6d9,0x3f003a063f07a136,0x3ef6e0cb3f039c3d,0x3ed536413ee63375,0x3ece0bea3ee0924f,0x3ea80b1f3ebb31a0,0x3ea395c53eb8442a,0x3e72b6513e8e9a22,0x3e6fa8b23e8e9a22,0x3e1324ca3e419b37
.quad 0x3f2beb4a3f3504f3,0x3f187fc03f226799,0x3f21cbfb3f2beb4a,0x3f0c42c93f173c07,0x3f173c073f226799,0x3eff17b23f0b9a6b,0x3f0c42c93f187fc0,0x3ee4cbfe3eff17b2,0x3f00e7e43f0e39da,0x3ec9b9533ee63375,0x3eea66813f039c3d,0x3eadf73c3ecc9b8b,0x3ed25a093ef15aea,0x3e919ddd3eb263ef,0x3eb9bb1e3edae880,0x3e698bba3e97a117
.quad 0x3ea09ae53ec3ef15,0x3e2f10a23e78cfcc,0x3e870ada3eac7cd4,0x3de7fa9a3e419b37,0x3e5a39973e94a031,0x3d6214693e09cf86,0x3e25c58c3e78cfcc,0xbb490fc63da3308c,0x3de1bc2e3e47c5c2,0xbd7b2b743cc90ab0,0x3d6ea0383e164083,0xbdf475c0bcfb49ba,0x3bc90f883dc8bd36,0xbe354098bdafb680,0xbd3c6dd53d48fb30,0xbe6fa8b2be1008b7
.quad 0x3f039c3d3f0e39da,0x3edae8803ef15aea,0x3eea66813f00e7e4,0x3eb9bb1e3ed25a09,0x3ecc9b8b3ee63375,0x3e97a1173eb263ef,0x3eadf73c3ec9b953,0x3e698bba3e919ddd,0x3e8e9a223eac7cd4,0x3e22abb63e605c13,0x3e5d4b1a3e8e9a22,0x3db5f8da3e1c76de,0x3e1c76de3e605c13,0x3c96c9b63dafb680,0x3db5f8da3e22abb6,0xbd55880e3c96c9b6
.quad 0x3cc90ab03dc8bd36,0xbdfab273bd48fb30,0xbd2351cb3d16c32c,0xbe44b0b9bdee3876,0xbdd53db9bcc90ab0,0xbe8586cebe3b6ecf,0xbe2bf804bdafb680,0xbea80b1fbe7ee6e1,0xbe6c9a7fbe164083,0xbec9b953bea09ae5,0xbe9620d2be541501,0xbeea6681bec1071e,0xbeb554ecbe888e93,0xbf04f484bee0924f,0xbed3c867bea68f12,0xbf140c5fbeff17b2
.quad 0x3eac7cd43ec3ef15,0x3e78cfcc3e94a031,0x3e870ada3ea09ae5,0x3e25c58c3e5a3997,0x3e419b373e78cfcc,0x3da3308c3e09cf86,0x3de7fa9a3e2f10a2,0xbb490fc63d621469,0x3d16c32c3dc8bd36,0xbdafb680bcc90ab0,0xbd2351cb3cc90ab0,0xbe2bf804bdd53db9,0xbdee3876bd48fb30,0xbe7ee6e1be3b6ecf,0xbe44b0b9bdfab273,0xbea80b1fbe8586ce
.quad 0xbe888e93be47c5c2,0xbecf7bcabeac7cd4,0xbeadf73cbe888e93,0xbef58035bed25a09,0xbed25a09beac7cd4,0xbf0cead0bef6e0cb,0xbef58035becf7bca,0xbf1e1e22bf0cead0,0xbf0b9a6bbef15aea,0xbf2e3bdebf1d7fd1,0xbf1ba299bf08f59b,0xbf3d27b8bf2d1469,0xbf2ac082bf187fc0,0xbf4ac77fbf3b8f3b,0xbf38dd65bf273656,0xbf570348bf48d8b3
.quad 0x3e1640833e47c5c2,0x3d48fb303dc8bd36,0x3d6ea0383de1bc2e,0xbd3c6dd53bc90f88,0xbcfb49ba3cc90ab0,0xbe1008b7bdafb680,0xbdf475c0bd7b2b74,0xbe6fa8b2be354098,0xbe541501be164083,0xbea68f12be888e93,0xbe9620d2be6c9a7f,0xbed3c867beb554ec,0xbec1071ebea09ae5,0xbeff17b2bee0924f,0xbeea6681bec9b953,0xbf140c5fbf04f484
.quad 0xbf08f59bbef15aea,0xbf273656bf187fc0,0xbf1ba299bf0b9a6b,0xbf38dd65bf2ac082,0xbf2d1469bf1d7fd1,0xbf48d8b3bf3b8f3b,0xbf3d27b8bf2e3bde,0xbf570348bf4ac77f,0xbf4bbbf8bf3daef9,0xbf633c5abf584853,0xbf58b3a1bf4bbbf8,0xbf6d67a1bf63f473,0xbf63f473bf584853,0xbf756d97bf6db293,0xbf6d67a1bf633c5a,0xbf7b3babbf756d97
.quad 0,0,0x3d55880e3d48fb30,0x3d6ea0383d621469,0x3dd53db93dc8bd36,0x3dee38763de1bc2e,0x3e1f917b3e164083,0x3e3228d43e28defc,0x3e5415013e47c5c2,0x3e6c9a7f3e605c13,0x3e8402703e78cfcc,0x3e931f353e8b9507,0x3e9d9e783e94a031,0x3eaf713a3ea68f12,0x3eb6ccc33eac7cd4,0x3ecb2aae3ec1071e
.quad 0x3ecf7bca3ec3ef15,0x3ee633753edae880,0x3ee79a5d3edae880,0x3f003a063ef41f07,0x3eff17b23ef15aea,0x3f0cead03f064b82,0x3f0af1b73f039c3d,0x3f19210f3f121eb0,0x3f15f6d93f0e39da,0x3f24d2253f1d7fd1,0x3f2093933f187fc0,0x3f2ff3e63f286605,0x3f2ac0823f226799,0x3f3a7ca43f32c8c9,0x3f34768f3f2beb4a,0x3f4463373f3ca003
.quad 0,0,0x3d83db0a3d7b2b74,0x3d9064b43d8a200a,0x3e0395023dfab273,0x3e1008b73e09cf86,0x3e44b0b93e3b6ecf,0x3e57278f3e4dee60,0x3e827dc03e78cfcc,0x3e8e9a223e888e93,0x3ea218873e9aa086,0x3eb0eacb3ea986c4,0x3ec1071e3eb8442a,0x3ed25a093ec9b953,0x3edf28a93ed53641,0x3ef2bd433ee900b7
.quad 0x3efc5d273ef15aea,0x3f08f59b3f039c3d,0x3f0c42c93f064b82,0x3f17de123f121eb0,0x3f19c2003f13682a,0x3f26050a3f1ff6cb,0x3f269de33f1ff6cb,0x3f33587a3f2d1469,0x3f32c8c93f2beb4a,0x3f3fc7673f396842,0x3f3e35c53f373a23,0x3f4b41fa3f44e3f5,0x3f48d8b33f41d870,0x3f55b9933f4f7a1f,0x3f52a6493f4bbbf8,0x3f5f20db3f591e6a
.quad 0,0,0x3d9cecf93d96a905,0x3da973ba3da3308c,0x3e1c76de3e164083,0x3e28defc3e22abb6,0x3e698bba3e605c13,0x3e7bdba43e72b651,0x3e9aa0863e94a031,0x3ea68f123ea09ae5,0x3ebf926f3eb8442a,0x3ece0bea3ec6d529,0x3ee363fa3edae880,0x3ef41f073eebcbbb,0x3f02ef9f3efc5d27,0x3f0c42c93f07a136
.quad 0x3f13682a3f0e39da,0x3f1d7fd13f187fc0,0x3f2302d33f1d7fd1,0x3f2da8593f286605,0x3f31a81d3f2beb4a,0x3f3ca0033f373a23,0x3f3f41fc3f396842,0x3f4a4c873f44e3f5,0x3f4bbbf83f45e403,0x3f5695e53f514d3d,0x3f5703483f514d3d,0x3f61668a3f5c61c7,0x3f6106f23f5b941a,0x3f6aab7b3f660f88,0x3f69b7e43f64aa59,0x3f7254703f6e46be
.quad 0,0,0x3db5f8da3dafb680,0x3dc27c393dbc3ac3,0x3e3540983e2f10a2,0x3e419b373e3b6ecf,0x3e870ada3e827dc0,0x3e901c2c3e8b9507,0x3eb263ef3eac7cd4,0x3ebe1d4a3eb8442a,0x3edc53c13ed53641,0x3eea66813ee363fa,0x3f0242b13efc5d27,0x3f0a48ad3f064b82,0x3f1553b73f10d3cd,0x3f1e1e223f19c200
.quad 0x3f2736563f226799,0x3f3085bb3f2beb4a,0x3f37c6553f32c8c9,0x3f4154e13f3ca003,0x3f46e22a3f41d870,0x3f5064af3f4bbbf8,0x3f546b3b3f4f7a1f,0x3f5d924d3f591e6a,0x3f6046213f5b941a,0x3f68bf3c3f64aa59,0x3f6a5ad93f660f88,0x3f71d19f3f6e46be,0x3f7294f83f6ed89e,0x3f78b47b3f75dec6,0x3f78e3d63f75dec6,0x3f7d57de3f7b61fc
.quad 0x3f3daef93f3504f3,0x3f4d9f023f45e403,0x3f4663543f3daef9,0x3f5627fe3f4e8d90,0x3f4e8d903f45e403,0x3f5df6be3f5695e5,0x3f5627fe3f4d9f02,0x3f6504793f5df6be,0x3f5d2d533f54db31,0x3f6b4b0c3f64aa59,0x3f6398ac3f5b941a,0x3f70c5013f6aab7b,0x3f6965913f61c598,0x3f756d973f6ff573,0x3f6e8ff83f676bd8,0x3f7940c03f748422
.quad 0x3f7314473f6c835e,0x3f7c3b283f7853f8,0x3f76ef5b3f710908,0x3f7e5a383f7b61fc,0x3f7a1e843f74fa0b,0x3f7f9c183f7dabcc,0x3f7c9f8a3f7853f8,0x3f7fffb13f7f2f9d,0x3f7e70b03f7b14be,0x3f7f84ab3f7fec43,0x3f7f90b13f7d3aac,0x3f7e2b723f7fe129,0x3f7ffec43f7ec46d,0x3f7bf5313f7f0e58,0x3f7fba9e3f7fb10f,0x3f78e3d63f7d7474
.quad 0x3f5b941a3f54db31,0x3f676bd83f61c598,0x3f6398ac3f5d2d53,0x3f6e8ff83f696591,0x3f6aab7b3f64aa59,0x3f7484223f6ff573,0x3f70c5013f6b4b0c,0x3f7940c03f756d97,0x3f75dec63f710908,0x3f7cbfc93f79c79d,0x3f79f35e3f75dec6,0x3f7efcc93f7cfe73,0x3f7cfe733f79c79d,0x3f7ff4e63f7f0e58,0x3f7efcc93f7cbfc9,0x3f7fa6e33f7ff4e6
.quad 0x3f7fec433f7ec46d,0x3f7e13243f7fb10f,0x3f7fcbe23f7fd397,0x3f7b3bab3f7e4323,0x3f7e9bc93f7fec43,0x3f7724173f7baccd,0x3f7c5d3a3f7f0e58,0x3f71d19f3f77f110,0x3f7912983f7d3aac,0x3f6b4b0c3f731447,0x3f74bf623f7a7302,0x3f6398ac3f6d1c1d,0x3f6f68303f76ba07,0x3f5ac4503f660f88,0x3f6912ae3f721352,0x3f50d9373f5df6be
.quad 0x3f7109083f6c835e,0x3f7853f83f74fa0b,0x3f76ef5b3f731447,0x3f7c9f8a3f7a1e84,0x3f7b61fc3f7853f8,0x3f7f2f9d3f7dabcc,0x3f7e5a383f7c3b28,0x3f7fffb13f7f9c18,0x3f7fd3973f7ec46d,0x3f7f0e583f7fec43,0x3f7fcbe23f7fec43,0x3f7c5d3a3f7e9bc9,0x3f7e43233f7fb10f,0x3f77f1103f7baccd,0x3f7b3bab3f7e1324,0x3f71d19f3f772417
.quad 0x3f76ba073f7b14be,0x3f6a09a73f710908,0x3f70c5013f76ba07,0x3f60a6cf3f696591,0x3f6965913f710908,0x3f55b9933f604621,0x3f60a6cf3f6a09a7,0x3f4955213f55b993,0x3f5695e53f61c598,0x3f3b8f3b3f49d112,0x3f4b41fa3f584853,0x3f2c800f3f3ca003,0x3f3ebc1b3f4d9f02,0x3f1c420c3f2e3bde,0x3f3117223f41d870,0x3f0af1b73f1ebc12
.quad 0x3f7d3aac3f7b14be,0x3f7fb10f3f7ec46d,0x3f7f90b13f7e70b0,0x3f7fba9e3f7ffec4,0x3f7fe1293f7fec43,0x3f7d74743f7f0e58,0x3f7e2b723f7f84ab,0x3f78e3d63f7bf531,0x3f7a73023f7d3aac,0x3f7213523f76ba07,0x3f74bf623f791298,0x3f6912ae3f6f6830,0x3f6d1c1d3f731447,0x3f5df6be3f660f88,0x3f6398ac3f6b4b0c,0x3f50d9373f5ac450
.quad 0x3f5848533f61c598,0x3f41d8703f4d9f02,0x3f4b41fa3f5695e5,0x3f3117223f3ebc1b,0x3f3ca0033f49d112,0x3f1ebc123f2e3bde,0x3f2c800f3f3b8f3b,0x3f0af1b73f1c420c,0x3f1b02c63f2beb4a,0x3eebcbbb3f08f59b,0x3f084b923f1b02c6,0x3ebf926f3ee900b7,0x3ee900b73f08f59b,0x3e919ddd3ebe1d4a,0x3ebf926f3eebcbbb,0x3e44b0b93e919ddd
.quad 0xbd97bf803cc93f80,0xbe2fbf7d3dfb3f7f,0x3e60bf7dbd973f80,0x3efcbf67beb83f75,0x3efcbf71be2f3f80,0x3f6fbf04bf423f46,0x3f39bf5cbe893f80,0x3f733d49bf7a3ef1,0x3f65bf3ebeb83f80,0x3f093f18bf773dc9,0x3f7cbf18bee63f80,0xbdfb3f71bf39be95,0x3f7ebedbbf093f80,0xbf393f78bea1bf22,0x3f6abe79bf1d3f80,0xbf7f3f2c3e2fbf62
.quad 0x3f42bd49bf313f80,0xbf513e163f1dbf7f,0x3f093e16bf423f80,0xbe89bedb3f6abf75,0x3e893eacbf513f80,0x3ecfbf5c3f7fbf46,0xbcc93f04bf5f3f80,0x3f65bf803f58bef1,0xbea13f2cbf6a3f80,0x3f7abf4e3efcbdc9,0xbf133f4ebf733f80,0x3f1dbeac3cc93e95,0xbf4a3f67bf7a3f80,0xbcc93e79bee63f22,0xbf6f3f78bf7e3f80,0xbf273f3ebf513f62
.quad 0xbe89bf783e603f7b,0xbeb8bf713ea13f75,0x3f39bf3ebf1d3f55,0x3f65bf04bf513f22,0x3f733e16bf803e48,0x3f093f3ebf4abef1,0x3e2f3f67bf27bf0e,0xbf4a3f4e3eb8bf7f,0xbf4a3f5c3e2fbf7b,0xbf31bedb3f7fbe95,0xbf6a3d493f5fbf55,0x3f27bf783e603f46,0xbd97bf4e3f6fbe48,0x3f513d49bf5f3f62,0x3f58bf713ea13f0e,0xbefc3f7dbf39bdc9
.quad 0x3f5fbe79bf093f7b,0xbf6a3eac3ee6bf75,0xbcc93f2cbf7e3f55,0x3ea1bf5c3f7cbf22,0xbf653f7dbf393e48,0x3f7abf2c3dfb3ef1,0xbf513edb3d97bf0e,0xbdfb3f18bf6a3f7f,0x3dfbbf043f51bf7b,0xbf803f67bf273e95,0x3f6fbf803f77bf55,0xbd97be793f09bf46,0x3f42bf183ecfbe48,0x3f7cbf803f77bf62,0xbe603eacbee63f0e,0x3e89be163cc93dc9
.quad 0xbee6bf673ecf3f6d,0xbf09bf5c3efc3f62,0x3f7cbe79bf733ec4,0x3f7e3d49bf803dc9,0xbdfb3f80be60bf6d,0xbf393f4e3ee6bf75,0xbf6abe163f7ebec4,0xbd97bf713f133f22,0x3f27bf713cc93f6d,0x3f513e79bf7e3ef1,0x3f093f04bf7f3ec4,0xbf773f2c3eb8bf7f,0xbf773f3e3e2fbf6d,0x3ecfbf7d3f273e95,0x3cc9bf4e3f77bec4,0x3ee63edbbf7a3f46
.quad 0x3f73bedbbeb83f6d,0xbf7a3f043e89bf62,0xbf133f78bf653ec4,0x3f4abf803f39bdc9,0xbf1d3d493f09bf6d,0xbcc93f18bf733f75,0x3f6fbf7d3f4abec4,0xbf423eac3e2fbf22,0x3d973eacbf313f6d,0x3f7cbf783f4abef1,0xbf7a3f5cbf273ec4,0xbefc3f3ebf6a3f7f,0x3efcbf2c3f51bf6d,0xbeb83e163d97be95,0x3f31bf183efcbec4,0x3f73bf673f58bf46
.quad 0xbf1dbf4e3f133f55,0xbf31bf3e3f273f46,0x3f6a3eacbf77be48,0x3f423f18bf58bef1,0xbf7f3e793f6abf0e,0xbf51bedb3f773dc9,0x3f58bf3ebee63f7b,0x3f5f3e79bf803e95,0xbefc3f7dbe60bf55,0xbf6abd493f73bf22,0x3cc9bf673f4a3e48,0x3f73be16bf513f62,0x3ee63f04bf803f0e,0xbf7a3eac3f1dbf7f,0xbf513d493f42bf7b,0x3f7ebf04beb83f75
.quad 0x3f7ebf18be2f3f55,0xbf803f2c3d97bf46,0xbf6f3f71befcbe48,0x3f7fbf4e3e603ef1,0x3f27bf783f6fbf0e,0xbf7c3f67befcbdc9,0xbe603f2cbf733f7b,0x3f77bf783f39be95,0xbe89be163f09bf55,0xbf6f3f80bf653f22,0x3f31bedb3dfb3e48,0x3f65bf7d3f7cbf62,0xbf733f5cbf393f0e,0xbf583f71bf7e3f7f,0x3f7cbf803f7fbf7b,0x3f4abf5c3f6abf75
.quad 0x3f7fbd49bf808000,0x3f7cbe16bf7e3dc9,0x3f7a3e16bf7f8000,0x3f5f3edbbf6fbe95,0x3f5f3eacbf7c8000,0x3eb83f5cbf27bf22,0x3f313f04bf778000,0xbea13f80be60bf62,0x3ee63f2cbf6f8000,0xbf583f4e3e89bf7f,0x3e2f3f4ebf658000,0xbf7e3eac3f31bf75,0xbdfb3f67bf588000,0xbf31be793f73bf46,0xbecf3f78bf4a8000,0xbd97bf3e3f7cbef1
.quad 0xbf273f80bf398000,0x3f13bf7d3f4abdc9,0xbf583f7dbf278000,0x3f77bf673ecf3e95,0xbf773f71bf138000,0x3f6abf04bd973f22,0xbf803f5cbefc8000,0x3ee63d49bf093f62,0xbf733f3ebecf8000,0xbe603f18bf5f3f7f,0xbf513f18bea18000,0xbf4a3f71bf803f75,0xbf1d3edbbe608000,0xbf803f78bf653f46,0xbeb83e79bdfb8000,0xbf423f2cbf133ef1
.quad 0x3f77be79bf7a3e48,0x3f6fbeacbf733e95,0x3f313f2cbf4abf0e,0x3ee63f5cbf13bf46,0xbea13f7dbcc9bf7b,0xbf583f2c3f1dbf62,0xbf7c3edb3f42bf55,0xbf1dbf183f6f3dc9,0xbf1dbf043f7cbe48,0x3f39bf67bd973f75,0x3ecfbf803efc3f0e,0x3f423e79bf7a3f22,0x3f7fbf18beb83f7b,0xbf133f80befcbef1,0x3f093eacbf733f55,0xbf5f3e163f31bf7f
.quad 0xbefc3f78bf583e48,0x3ecfbf713f65be95,0xbf803f3ebdfbbf0e,0x3f73bf04be2f3f46,0xbee6be163f31bf7b,0xbe603f3ebf7e3f62,0x3f13bf673f7fbf55,0xbf7e3f4ebecfbdc9,0x3f7ebf5c3f13be48,0x3cc9bedb3f42bf75,0x3eb8bd49be893f0e,0x3f7fbf783f58bf22,0xbf273f4ebf6a3f7b,0x3e2f3d49be893ef1,0xbf7a3f71bf653f55,0xbf773f7dbf803f7f
.quad 0x3f65bedbbf6a3ec4,0x3f58bf04bf5f3ef1,0x3e2f3f78bea1bf6d,0xbdfb3f80bcc9bf7f,0xbf7e3d493f7abec4,0xbf31bf183f653e95,0x3ecfbf7d3dfb3f6d,0x3f7fbeacbf513f46,0x3f423eacbf803ec4,0xbf133f78bdfbbf62,0xbf583f5c3d97bf6d,0xbe89bf3e3f6fbdc9,0xbe89bf2c3f7cbec4,0x3f6abe16bf423f75,0x3f80bf18be893f6d,0xbf653f67be60bf22
.quad 0xbea13f67bf6f3ec4,0x3e60bf5c3f77bef1,0xbf513e793ee6bf6d,0x3f1d3d49bf313f7f,0x3f4abf803f58bec4,0xbf803f4ebea1be95,0x3eb83e16bf1d3f6d,0x3f27bf713f7cbf46,0xbf7f3f71bf393ec4,0x3e2f3e79bf1d3f62,0x3e60bf043f42bf6d,0xbf5f3f2cbecf3dc9,0x3f5fbf3e3f13bec4,0x3f6fbf7d3f7fbf75,0xbf393f4ebf5f3f6d,0xbea13edbbf093f22
.quad 0x3f4abf18bf513f0e,0x3f39bf2cbf423f22,0xbecf3f713e89bf7b,0xbf273f4e3f09bf62,0xbd97bf783ecf3f55,0x3f13bf67be893f7f,0x3f093f2cbf65be48,0xbefc3f78bcc9bf75,0xbf5fbe163f7abf0e,0x3ecfbf803ea13f46,0x3f80bedbbf1d3f7b,0xbea13f7dbf13bef1,0xbf653f5cbcc9bf55,0x3e60bf713f4a3dc9,0x3f13bf803f273e48,0xbdfb3f5cbf6f3e95
.quad 0xbdfb3f4ebf7c3f0e,0x3cc9bf3e3f7fbf22,0xbeb8beac3f5fbf7b,0x3d973f18bf7a3f62,0x3f42be79beb83f55,0xbe2fbedb3f5fbf7f,0xbf7a3f3ebea1be48,0x3e893e79bf313f75,0x3f77bf7d3f58bf0e,0xbeb8bd493ee6bf46,0xbf393f67bf7e3f7b,0x3ee6be16be2f3ef1,0x3ea1bf043f31bf55,0xbf093eacbdfbbdc9,0x3e2fbd49bd973e48,0x3f1dbf043ecfbe95
.quad 0xbf42bf2c3f393f35,0xbf51bf183f4a3f22,0x3f093f4ebf27bf35,0x3e893f71becfbf62,0xbe89bf673f133f35,0x3ecfbf78bd973f7f,0xbcc93f78befcbf35,0xbf653f2c3f09bf75,0x3ea1bf803ecf3f35,0x3f7abe16bf5f3f46,0xbf133f7dbea1bf35,0xbf1dbedb3f80bef1,0x3f4abf713e603f35,0xbcc93f5cbf653dc9,0xbf6f3f5cbdfbbf35,0x3f27bf803f133e95
.quad 0x3f7fbf3e3cc93f35,0xbf7c3f4ebdfbbf22,0xbf7a3f183d97bf35,0x3f5fbeacbeb83f62,0x3f5fbedbbe2f3f35,0xbeb8be793f42bf7f,0xbf313e793e89bf35,0xbea13f3ebf7a3f75,0x3ee6bd49beb83f35,0x3f58bf7d3f77bf46,0xbe2fbe163ee6bf35,0xbf7e3f67bf393ef1,0xbdfb3eacbf093f35,0x3f31bf043ea1bdc9,0x3ecfbf043f1dbf35,0xbd97bd493e2fbe95
.quad 0xbf5fbf043f583f0e,0xbf6abedb3f653ef1,0xbcc93f80bdfbbf7b,0xbea13f783e2fbf7f,0x3f65bf18bf313f55,0x3f7a3d49bf7e3e95,0xbf51beac3f7fbe48,0x3dfbbf7d3ecf3f46,0xbdfb3f78bf13bf0e,0xbf803eac3f42bf62,0x3f6fbf3ebe893f7b,0x3d973f5cbf58bdc9,0xbf42be163f6abf55,0x3f7cbf2cbe893f75,0xbe603f67bf653e48,0xbe89bf183f80bf22
.quad 0x3f77bf5c3e603f0e,0xbf6f3f67bea1bef1,0xbf313d493f1dbf7b,0x3ee63e79bf513f7f,0xbea13f4ebf803f55,0x3f58bf803f4abe95,0x3f7cbf713f27be48,0xbf1d3e163eb8bf46,0xbf1d3e793e2fbf0e,0xbf393f71bf7f3f62,0xbecf3f2cbf5f3f7b,0x3f42bf043e603dc9,0x3f7fbf7d3f6fbf55,0x3f13bf3e3f5fbf75,0xbf093edbbea13e48,0xbf5f3f4ebf393f22
.quad 0xbf73beac3f6f3ec4,0xbf7abe793f773e95,0xbf133f5c3ee6bf6d,0xbf4a3f2c3f31bf46,0x3f1d3f2cbf58bec4,0xbcc93f7dbea1bf62,0x3f6fbf18bf1d3f6d,0x3f423edbbf7c3dc9,0xbd97bf673f393ec4,0x3f7cbf04bf1d3f75,0xbf7a3e793f42bf6d,0x3efcbf803ecf3f22,0xbefc3f80bf13bec4,0xbeb8bf183f7fbef1,0x3f313e16bf5f3f6d,0xbf733eac3f09bf7f
.quad 0x3f65bf713ecf3ec4,0xbf583f78befcbe95,0xbe2fbf043f73bf6d,0xbdfb3f3ebf803f46,0xbf7e3f3ebe60bec4,0x3f31be16bee63f62,0xbecf3f4ebf7e3f6d,0x3f7fbf673f13bdc9,0x3f42bedb3cc93ec4,0x3f13bf5c3f7ebf75,0x3f58bf783f7fbf6d,0xbe89bd493eb8bf22,0xbe893d493e2fbec4,0xbf6a3f4ebf273ef1,0xbf803f7dbf773f6d,0xbf653f71bf7a3f7f
.quad 0xbf7ebe163f7c3e48,0xbf80bd493f7f3dc9,0xbf6f3edb3f5fbf0e,0xbf7f3e163f7abe95,0xbf273f5c3eb8bf7b,0xbf7c3eac3f5fbf22,0xbe603f80bea1bf55,0xbf773f043f31bf62,0x3e893f4ebf58be48,0xbf6f3f2c3ee6bf7f,0x3f313eacbf7e3f0e,0xbf653f4e3e2fbf75,0x3f73be79bf313f7b,0xbf583f67bdfbbf46,0x3f7cbf3ebd973f55,0xbf4a3f78becfbef1
.quad 0x3f4abf7d3f133e48,0xbf393f80bf27bdc9,0x3ecfbf673f77bf0e,0xbf273f7dbf583e95,0xbd97bf043f6abf7b,0xbf133f71bf773f22,0xbf093d493ee6bf55,0xbefc3f5cbf803f62,0xbf5f3f18be60be48,0xbecf3f3ebf733f7f,0xbf803f71bf4a3f0e,0xbea13f18bf513f75,0xbf653f78bf803f7b,0xbe603edbbf1d3f46,0xbf133f2cbf423f55,0xbdfb3e79beb83ef1
.quad 0x3f27bf3ebf313f35,0x3f13bf4ebf1d3f46,0xbf583f183f42bf35,0xbf773eac3f6abef1,0x3f77bedbbf513f35,0x3f6a3e79bf7f3dc9,0xbf803e793f5fbf35,0xbee6bf3e3f583e95,0x3f73bd49bf6a3f35,0xbe603f7dbefcbf22,0xbf51be163f73bf35,0x3f4abf673cc93f62,0x3f1d3eacbf7a3f35,0xbf803f043ee6bf7f,0xbeb8bf043f7ebf35,0x3f423d49bf513f75
.quad 0x3d973f2cbf803f35,0xbe2fbf183f7ebf46,0x3e60bf4e3f7fbf35,0xbefc3f71bf6f3ef1,0xbefc3f67bf7c3f35,0x3f6fbf783f27bdc9,0x3f39bf783f77bf35,0xbf733f2cbe60be95,0xbf653f80bf6f3f35,0x3f09be16be893f22,0x3f7cbf7d3f65bf35,0x3dfbbedb3f31bf62,0xbf7e3f71bf583f35,0xbf393f5cbf733f7f,0x3f6abf5c3f4abf35,0x3f7fbf803f7cbf75
.quad 0x3efcbf5cbf093f55,0x3ecfbf67bee63f62,0xbf803d493f7ebe48,0xbf73be793f7c3dc9,0x3ee63f4ebf39bf0e,0xbe603f80bdfbbf75,0x3f13bf71bd973f7b,0x3f7ebe16bf6a3f22,0xbf7e3e793f51bf55,0x3cc9bf713f273ef1,0x3eb83f2cbf773e48,0xbf7f3f043f09bf7f,0x3f27bf7d3ecf3f0e,0x3e2f3f3ebf773e95,0xbf7a3edb3ee6bf7b,0x3f77bf4e3cc93f46
.quad 0x3e893f04bf7a3f55,0xbeb8bedb3f73bf62,0x3f39bf803f4abe48,0xbf653f78bf13bdc9,0xbf733f18bcc9bf0e,0x3f093d49bf1d3f75,0x3e2f3eacbf423f7b,0x3f4abf7d3f6fbf22,0x3f4abf783f7cbf55,0xbf313eac3d97bef1,0xbf6a3f3ebefc3e48,0xbf273f5cbf7a3f7f,0x3d973e16beb83f0e,0x3f51bf2c3efcbe95,0x3f58bf673f73bf7b,0x3efcbf183f31bf46
.quad 0x3ea1bf71beb83f6d,0x3e60bf78be893f75,0xbf51bf043f653ec4,0xbf1dbf3e3f393f22,0xbf4a3f3e3f09bf6d,0xbf803e163f73bef1,0x3eb83f4ebf4abec4,0xbf273f673e2fbf7f,0x3f7fbedbbf313f6d,0x3e2f3f5cbf4abe95,0x3e60bf783f273ec4,0x3f5f3d49bf6a3f46,0xbf5f3d493f51bf6d,0x3f6fbf4ebd973f62,0xbf393f7dbefcbec4,0x3ea1bf713f58bdc9
.quad 0x3ee63eacbf6a3f6d,0xbf09be793f5fbf75,0x3f7cbf5c3ea13ec4,0xbf7e3f2cbcc9bf22,0x3dfbbf2c3f7abf6d,0xbf393f7dbf653ef1,0xbf6a3f18bdfbbec4,0x3d973edbbf513f7f,0xbf273f67bf803f6d,0x3f51bf043dfb3e95,0x3f09be79bd973ec4,0x3f77bf803f6fbf46,0x3f77bf803f7cbf6d,0x3ecfbf183f42bf62,0x3cc9be163e89bec4,0xbee63eacbe603dc9
.quad 0x3dfbbf7dbe2f3f7b,0x3cc9bf80bd973f7f,0xbeb8bf673efc3f55,0xbd97bf7d3e603f75,0xbf42bf043f6f3e48,0xbe2fbf713efc3f46,0xbf7a3d493f73bf0e,0xbe89bf5c3f393ef1,0xbf773f183f09bf7b,0xbeb8bf3e3f653dc9,0xbf393f71bdfbbf55,0xbee6bf183f7cbe95,0xbea13f78bf39be48,0xbf09bedb3f7ebf22,0x3e2f3f2cbf7f3f0e,0xbf1dbe793f6abf62
.quad 0x3f1d3e16bf513f7b,0xbf31bd493f42bf7f,0x3f6abedbbe893f55,0xbf423e163f09bf75,0x3f7fbf5c3ecf3e48,0xbf513eac3e89bf46,0x3f58bf803f65bf0e,0xbf5f3f04bcc9bef1,0x3efcbf4e3f7abf7b,0xbf6a3f2cbea1bdc9,0x3cc9beac3f1dbf55,0xbf733f4ebf133e95,0xbee63e79bcc9be48,0xbf7a3f67bf4a3f22,0xbf513f3ebf273f0e,0xbf7e3f78bf6f3f62
.quad 0xbec4bf6d3ec43f6d,0x3f6dbec4bf6d3ec4,0xbdfbbf7a3ea13f6a,0x3f7ebe60bf733ecf,0x3e16bf803e793f67,0x3f7dbd49bf783edb,0x3ecfbf7e3e2f3f65,0x3f6a3dfbbf7c3ee6,0x3f22bf753dc93f62,0x3f463e95bf7f3ef1,0x3f51bf653cc93f5f,0x3f133ee6bf803efc,0x3f71bf4ebd493f5c,0x3eac3f18bf803f04,0x3f7fbf31bdfb3f58,0x3d973f39bf7e3f09
.quad 0x3f7bbf0ebe483f55,0xbe483f55bf7b3f0e,0x3f65becfbe893f51,0xbee63f6abf773f13,0x3f3ebe79beac3f4e,0xbf2c3f78bf713f18,0x3f09bd97becf3f4a,0xbf583f7fbf6a3f1d,0x3e953dc9bef13f46,0xbf753f7fbf623f22,0x3cc93e89bf093f42,0xbf803f77bf583f27,0xbe793edbbf183f3e,0xbf783f67bf4e3f2c,0xbefc3f13bf273f39,0xbf5f3f51bf423f31
.quad 0xbec4bf6d3ec43f6d,0x3f6dbec4bf6d3ec4,0x3e89bf7cbd973f80,0x3f773e2fbf7f3cc9,0x3f4ebf3ebf043f71,0x3f183f2cbf5cbeac,0x3f80be89bf583f42,0xbcc93f77bf09bf27,0x3f463e95bf7f3ef1,0xbf223f75bdc9bf62,0x3e603f42bf6f3dfb,0xbf7a3f273eb8bf7e,0xbedb3f7dbf2cbe79,0xbf673e163f3ebf78,0xbf653f6abe89bf13,0xbee6becf3f77bf51
.quad 0xbf7b3f0e3e48bf55,0x3e48bf553f7bbf0e,0xbf273cc93f1dbf7a,0x3f42bf803f4abe60,0xbd49bf043f67bf7d,0x3f80bf5c3edb3e16,0x3f13bf653f80bf5f,0x3f51bee6bcc93efc,0x3f75bf7f3f62bf22,0x3e953dc9bef13f46,0x3f6fbf4a3f13bea1,0xbeb83f1dbf513f73,0x3f04beac3e163d49,0xbf5c3f71bf7d3f80,0xbdfb3e60bea13ecf,0xbf7e3f7abf733f6a
.quad 0xbec4bf6d3ec43f6d,0x3f6dbec4bf6d3ec4,0x3f1dbf58bee63f6f,0x3f4a3f09bf65beb8,0x3f7dbd49bf783edb,0xbe163f80be79bf67,0x3eb83f4abf51bea1,0xbf6f3f1d3f13bf73,0xbf223f75bdc9bf62,0xbf46be953f7fbef1,0xbf7c3ea13f31bf77,0x3e2fbf733f393e89,0xbeacbf183f80bf04,0x3f71bf4ebd493f5c,0x3f27bf803f1d3e60,0x3f423cc9bf4a3f7a
.quad 0x3f7bbf0ebe483f55,0xbe483f55bf7b3f0e,0x3ea13eb8bf5f3f7c,0xbf733f6fbefcbe2f,0xbf2c3f78bf713f18,0xbf3e3e793eacbf4e,0xbf7a3f42beb8bdfb,0x3e60bf273f6fbf7e,0xbe95bdc93ef1bf46,0x3f75bf7f3f62bf22,0x3f31bf5f3f7abf7f,0x3f39befc3e603d97,0x3f78bf673f4ebf2c,0xbe793edbbf183f3e,0x3e89be2f3d973cc9,0xbf773f7cbf7f3f80
.quad 0xbec4bf6d3ec43f6d,0x3f6dbec4bf6d3ec4,0x3f5fbf13bf423f39,0x3efc3f51bf27bf31,0x3f183f2cbf5cbeac,0xbf4e3f3e3f04bf71,0xbf393f5f3e60bf7f,0xbf31befc3f7abd97,0xbf46be953f7fbef1,0x3f22bf753dc93f62,0x3f09bf7f3ecf3f1d,0x3f583d97bf6a3f4a,0x3f67be16bf3e3f78,0xbedb3f7dbf2cbe79,0xbea13f6fbf5f3e2f,0xbf733eb83efcbf7c
.quad 0xbf7b3f0e3e48bf55,0x3e48bf553f7bbf0e,0x3d97bf313f7ebf58,0x3f7fbf393dfb3f09,0x3f80bf5c3edb3e16,0x3d493f04bf673f7d,0x3e2f3ea1bf393f77,0xbf7c3f73bf313e89,0xbf753f7fbf623f22,0xbe95bdc93ef1bf46,0xbecf3dfb3e2fbee6,0x3f6abf7e3f7cbf65,0x3f5cbf713f7dbf80,0x3f04beac3e163d49,0x3f1dbf093ee6beb8,0xbf4a3f58bf653f6f
.quad 0xbec4bf6d3ec43f6d,0x3f6dbec4bf6d3ec4,0x3f7ebe60bf733ecf,0x3dfb3f7abea1bf6a,0xbe163f80be79bf67,0xbf7d3d493f78bedb,0xbf6abdfb3f7cbee6,0x3ecfbf7e3e2f3f65,0x3f22bf753dc93f62,0x3f463e95bf7f3ef1,0x3f133ee6bf803efc,0xbf513f65bcc9bf5f,0xbf713f4e3d49bf5c,0xbeacbf183f80bf04,0xbd97bf393f7ebf09,0x3f7fbf31bdfb3f58
.quad 0x3f7bbf0ebe483f55,0xbe483f55bf7b3f0e,0xbee63f6abf773f13,0xbf653ecf3e89bf51,0xbf3e3e793eacbf4e,0x3f2cbf783f71bf18,0x3f58bf7f3f6abf1d,0x3f09bd97becf3f4a,0x3e953dc9bef13f46,0xbf753f7fbf623f22,0xbf803f77bf583f27,0xbcc9be893f09bf42,0x3e79bedb3f18bf3e,0x3f78bf673f4ebf2c,0x3f5fbf513f42bf31,0xbefc3f13bf273f39
.quad 0xbec4bf6d3ec43f6d,0x3f6dbec4bf6d3ec4,0x3f773e2fbf7f3cc9,0xbe893f7c3d97bf80,0xbf4e3f3e3f04bf71,0xbf18bf2c3f5c3eac,0x3cc9bf773f093f27,0x3f80be89bf583f42,0x3f463e95bf7f3ef1,0xbf223f75bdc9bf62,0xbf7a3f273eb8bf7e,0xbe60bf423f6fbdfb,0x3edbbf7d3f2c3e79,0x3f67be16bf3e3f78,0x3ee63ecfbf773f51,0xbf653f6abe89bf13
.quad 0xbf7b3f0e3e48bf55,0x3e48bf553f7bbf0e,0x3f42bf803f4abe60,0x3f27bcc9bf1d3f7a,0x3d493f04bf673f7d,0xbf803f5cbedbbe16,0xbf513ee63cc9befc,0x3f13bf653f80bf5f,0x3f75bf7f3f62bf22,0x3e953dc9bef13f46,0xbeb83f1dbf513f73,0xbf6f3f4abf133ea1,0xbf043eacbe16bd49,0x3f5cbf713f7dbf80,0x3f7ebf7a3f73bf6a,0xbdfb3e60bea13ecf
.quad 0xbec4bf6d3ec43f6d,0x3f6dbec4bf6d3ec4,0x3f4a3f09bf65beb8,0xbf1d3f583ee6bf6f,0xbf7d3d493f78bedb,0x3e16bf803e793f67,0x3f6fbf1dbf133f73,0x3eb83f4abf51bea1,0xbf223f75bdc9bf62,0xbf46be953f7fbef1,0x3e2fbf733f393e89,0x3f7cbea1bf313f77,0x3eac3f18bf803f04,0xbf713f4e3d49bf5c,0xbf42bcc93f4abf7a,0x3f27bf803f1d3e60
.quad 0x3f7bbf0ebe483f55,0xbe483f55bf7b3f0e,0xbf733f6fbefcbe2f,0xbea1beb83f5fbf7c,0x3f2cbf783f71bf18,0x3f3ebe79beac3f4e,0xbe603f27bf6f3f7e,0xbf7a3f42beb8bdfb,0xbe95bdc93ef1bf46,0x3f75bf7f3f62bf22,0x3f39befc3e603d97,0xbf313f5fbf7a3f7f,0xbf783f67bf4e3f2c,0x3e79bedb3f18bf3e,0x3f77bf7c3f7fbf80,0x3e89be2f3d973cc9
.quad 0xbec4bf6d3ec43f6d,0x3f6dbec4bf6d3ec4,0x3efc3f51bf27bf31,0xbf5f3f133f42bf39,0xbf18bf2c3f5c3eac,0x3f4ebf3ebf043f71,0x3f313efcbf7a3d97,0xbf393f5f3e60bf7f,0xbf46be953f7fbef1,0x3f22bf753dc93f62,0x3f583d97bf6a3f4a,0xbf093f7fbecfbf1d,0xbf673e163f3ebf78,0x3edbbf7d3f2c3e79,0x3f73beb8befc3f7c,0xbea13f6fbf5f3e2f
.quad 0xbf7b3f0e3e48bf55,0x3e48bf553f7bbf0e,0x3f7fbf393dfb3f09,0xbd973f31bf7e3f58,0xbf803f5cbedbbe16,0xbd49bf043f67bf7d,0x3f7cbf733f31be89,0x3e2f3ea1bf393f77,0xbf753f7fbf623f22,0xbe95bdc93ef1bf46,0x3f6abf7e3f7cbf65,0x3ecfbdfbbe2f3ee6,0xbf5c3f71bf7d3f80,0xbf043eacbe16bd49,0x3f4abf583f65bf6f,0x3f1dbf093ee6beb8
.quad 0xbec4bf6d3ec43f6d,0x3f6dbec4bf6d3ec4,0x3dfb3f7abea1bf6a,0xbf7e3e603f73becf,0x3e16bf803e793f67,0x3f7dbd49bf783edb,0xbecf3f7ebe2fbf65,0xbf6abdfb3f7cbee6,0x3f22bf753dc93f62,0x3f463e95bf7f3ef1,0xbf513f65bcc9bf5f,0xbf13bee63f80befc,0x3f71bf4ebd493f5c,0x3eac3f18bf803f04,0xbf7f3f313dfbbf58,0xbd97bf393f7ebf09
.quad 0x3f7bbf0ebe483f55,0xbe483f55bf7b3f0e,0xbf653ecf3e89bf51,0x3ee6bf6a3f77bf13,0x3f3ebe79beac3f4e,0xbf2c3f78bf713f18,0xbf093d973ecfbf4a,0x3f58bf7f3f6abf1d,0x3e953dc9bef13f46,0xbf753f7fbf623f22,0xbcc9be893f09bf42,0x3f80bf773f58bf27,0xbe793edbbf183f3e,0xbf783f67bf4e3f2c,0x3efcbf133f27bf39,0x3f5fbf513f42bf31
.quad 0xbec4bf6d3ec43f6d,0x3f6dbec4bf6d3ec4,0xbe893f7c3d97bf80,0xbf77be2f3f7fbcc9,0x3f4ebf3ebf043f71,0x3f183f2cbf5cbeac,0xbf803e893f58bf42,0x3cc9bf773f093f27,0x3f463e95bf7f3ef1,0xbf223f75bdc9bf62,0xbe60bf423f6fbdfb,0x3f7abf27beb83f7e,0xbedb3f7dbf2cbe79,0xbf673e163f3ebf78,0x3f65bf6a3e893f13,0x3ee63ecfbf773f51
.quad 0xbf7b3f0e3e48bf55,0x3e48bf553f7bbf0e,0x3f27bcc9bf1d3f7a,0xbf423f80bf4a3e60,0xbd49bf043f67bf7d,0x3f80bf5c3edb3e16,0xbf133f65bf803f5f,0xbf513ee63cc9befc,0x3f75bf7f3f62bf22,0x3e953dc9bef13f46,0xbf6f3f4abf133ea1,0x3eb8bf1d3f51bf73,0x3f04beac3e163d49,0xbf5c3f71bf7d3f80,0x3dfbbe603ea1becf,0x3f7ebf7a3f73bf6a
.quad 0xbec4bf6d3ec43f6d,0x3f6dbec4bf6d3ec4,0xbf1d3f583ee6bf6f,0xbf4abf093f653eb8,0x3f7dbd49bf783edb,0xbe163f80be79bf67,0xbeb8bf4a3f513ea1,0x3f6fbf1dbf133f73,0xbf223f75bdc9bf62,0xbf46be953f7fbef1,0x3f7cbea1bf313f77,0xbe2f3f73bf39be89,0xbeacbf183f80bf04,0x3f71bf4ebd493f5c,0xbf273f80bf1dbe60,0xbf42bcc93f4abf7a
.quad 0x3f7bbf0ebe483f55,0xbe483f55bf7b3f0e,0xbea1beb83f5fbf7c,0x3f73bf6f3efc3e2f,0xbf2c3f78bf713f18,0xbf3e3e793eacbf4e,0x3f7abf423eb83dfb,0xbe603f27bf6f3f7e,0xbe95bdc93ef1bf46,0x3f75bf7f3f62bf22,0xbf313f5fbf7a3f7f,0xbf393efcbe60bd97,0x3f78bf673f4ebf2c,0xbe793edbbf183f3e,0xbe893e2fbd97bcc9,0x3f77bf7c3f7fbf80
.quad 0xbec4bf6d3ec43f6d,0x3f6dbec4bf6d3ec4,0xbf5f3f133f42bf39,0xbefcbf513f273f31,0x3f183f2cbf5cbeac,0xbf4e3f3e3f04bf71,0x3f39bf5fbe603f7f,0x3f313efcbf7a3d97,0xbf46be953f7fbef1,0x3f22bf753dc93f62,0xbf093f7fbecfbf1d,0xbf58bd973f6abf4a,0x3f67be16bf3e3f78,0xbedb3f7dbf2cbe79,0x3ea1bf6f3f5fbe2f,0x3f73beb8befc3f7c
.quad 0xbf7b3f0e3e48bf55,0x3e48bf553f7bbf0e,0xbd973f31bf7e3f58,0xbf7f3f39bdfbbf09,0x3f80bf5c3edb3e16,0x3d493f04bf673f7d,0xbe2fbea13f39bf77,0x3f7cbf733f31be89,0xbf753f7fbf623f22,0xbe95bdc93ef1bf46,0x3ecfbdfbbe2f3ee6,0xbf6a3f7ebf7c3f65,0x3f5cbf713f7dbf80,0x3f04beac3e163d49,0xbf1d3f09bee63eb8,0x3f4abf583f65bf6f
.quad 0xbec4bf6d3ec43f6d,0x3f6dbec4bf6d3ec4,0xbf7e3e603f73becf,0xbdfbbf7a3ea13f6a,0xbe163f80be79bf67,0xbf7d3d493f78bedb,0x3f6a3dfbbf7c3ee6,0xbecf3f7ebe2fbf65,0x3f22bf753dc93f62,0x3f463e95bf7f3ef1,0xbf13bee63f80befc,0x3f51bf653cc93f5f,0xbf713f4e3d49bf5c,0xbeacbf183f80bf04,0x3d973f39bf7e3f09,0xbf7f3f313dfbbf58
.quad 0x3f7bbf0ebe483f55,0xbe483f55bf7b3f0e,0x3ee6bf6a3f77bf13,0x3f65becfbe893f51,0xbf3e3e793eacbf4e,0x3f2cbf783f71bf18,0xbf583f7fbf6a3f1d,0xbf093d973ecfbf4a,0x3e953dc9bef13f46,0xbf753f7fbf623f22,0x3f80bf773f58bf27,0x3cc93e89bf093f42,0x3e79bedb3f18bf3e,0x3f78bf673f4ebf2c,0xbf5f3f51bf423f31,0x3efcbf133f27bf39
.quad 0xbec4bf6d3ec43f6d,0x3f6dbec4bf6d3ec4,0xbf77be2f3f7fbcc9,0x3e89bf7cbd973f80,0xbf4e3f3e3f04bf71,0xbf18bf2c3f5c3eac,0xbcc93f77bf09bf27,0xbf803e893f58bf42,0x3f463e95bf7f3ef1,0xbf223f75bdc9bf62,0x3f7abf27beb83f7e,0x3e603f42bf6f3dfb,0x3edbbf7d3f2c3e79,0x3f67be16bf3e3f78,0xbee6becf3f77bf51,0x3f65bf6a3e893f13
.quad 0xbf7b3f0e3e48bf55,0x3e48bf553f7bbf0e,0xbf423f80bf4a3e60,0xbf273cc93f1dbf7a,0x3d493f04bf673f7d,0xbf803f5cbedbbe16,0x3f51bee6bcc93efc,0xbf133f65bf803f5f,0x3f75bf7f3f62bf22,0x3e953dc9bef13f46,0x3eb8bf1d3f51bf73,0x3f6fbf4a3f13bea1,0xbf043eacbe16bd49,0x3f5cbf713f7dbf80,0xbf7e3f7abf733f6a,0x3dfbbe603ea1becf
.quad 0xbec4bf6d3ec43f6d,0x3f6dbec4bf6d3ec4,0xbf4abf093f653eb8,0x3f1dbf58bee63f6f,0xbf7d3d493f78bedb,0x3e16bf803e793f67,0xbf6f3f1d3f13bf73,0xbeb8bf4a3f513ea1,0xbf223f75bdc9bf62,0xbf46be953f7fbef1,0xbe2f3f73bf39be89,0xbf7c3ea13f31bf77,0x3eac3f18bf803f04,0xbf713f4e3d49bf5c,0x3f423cc9bf4a3f7a,0xbf273f80bf1dbe60
.quad 0x3f7bbf0ebe483f55,0xbe483f55bf7b3f0e,0x3f73bf6f3efc3e2f,0x3ea13eb8bf5f3f7c,0x3f2cbf783f71bf18,0x3f3ebe79beac3f4e,0x3e60bf273f6fbf7e,0x3f7abf423eb83dfb,0xbe95bdc93ef1bf46,0x3f75bf7f3f62bf22,0xbf393efcbe60bd97,0x3f31bf5f3f7abf7f,0xbf783f67bf4e3f2c,0x3e79bedb3f18bf3e,0xbf773f7cbf7f3f80,0xbe893e2fbd97bcc9
.quad 0xbec4bf6d3ec43f6d,0x3f6dbec4bf6d3ec4,0xbefcbf513f273f31,0x3f5fbf13bf423f39,0xbf18bf2c3f5c3eac,0x3f4ebf3ebf043f71,0xbf31befc3f7abd97,0x3f39bf5fbe603f7f,0xbf46be953f7fbef1,0x3f22bf753dc93f62,0xbf58bd973f6abf4a,0x3f09bf7f3ecf3f1d,0xbf673e163f3ebf78,0x3edbbf7d3f2c3e79,0xbf733eb83efcbf7c,0x3ea1bf6f3f5fbe2f
.quad 0xbf7b3f0e3e48bf55,0x3e48bf553f7bbf0e,0xbf7f3f39bdfbbf09,0x3d97bf313f7ebf58,0xbf803f5cbedbbe16,0xbd49bf043f67bf7d,0xbf7c3f73bf313e89,0xbe2fbea13f39bf77,0xbf753f7fbf623f22,0xbe95bdc93ef1bf46,0xbf6a3f7ebf7c3f65,0xbecf3dfb3e2fbee6,0xbf5c3f71bf7d3f80,0xbf043eacbe16bd49,0xbf4a3f58bf653f6f,0xbf1d3f09bee63eb8
.quad 0x3f7fb3823f800000,0x3f7d50a03f7ece34,0x3f7fa97d3f800000,0x3f7cf6c03f7ea62d,0x3f7f9eda3f800000,0x3f7c97623f7e7bb1,0x3f7f93993f800000,0x3f7c328b3f7e4ec1,0x3f7f87bb3f800000,0x3f7bc83b3f7e1f5e,0x3f7f7b403f800000,0x3f7b58763f7ded88,0x3f7f6e263f800000,0x3f7ae33d3f7db940,0x3f7f606f3f800000,0x3f7a68943f7d8285
.quad 0x3f7f521b3f800000,0x3f79e87c3f7d4959,0x3f7f43293f800000,0x3f7962f93f7d0dbc,0x3f7f339a3f800000,0x3f78d80e3f7ccfae,0x3f7f236d3f800000,0x3f7847bc3f7c8f31,0x3f7f12a33f800000,0x3f77b2093f7c4c44,0x3f7f013c3f800000,0x3f7716f63f7c06e9,0x3f7eef373f800000,0x3f7676883f7bbf20,0x3f7edc953f800000,0x3f75d0c23f7b74ea
.quad 0x3f7890913f7b3bab,0x3f717eae3f7550ed,0x3f7798903f7a9c59,0x3f6f9d6e3f73ed6e,0x3f7691a43f79f35e,0x3f6d9fe43f7274c7,0x3f757bde3f7940c0,0x3f6b864c3f70e717,0x3f74574f3f788486,0x3f6950e63f6f4483,0x3f7324073f77beb7,0x3f66fff33f6d8d2d,0x3f71e21a3f76ef5b,0x3f6493bb3f6bc13b,0x3f70919b3f76167a,0x3f620c863f69e0d7
.quad 0x3f6f329e3f75341d,0x3f5f6aa13f67ec29,0x3f6dc5393f74484b,0x3f5cae5b3f65e35e,0x3f6c49803f73530e,0x3f59d8073f63c6a1,0x3f6abf8c3f725470,0x3f56e7fb3f619622,0x3f6927743f714c7a,0x3f53de903f5f5212,0x3f6781513f703b37,0x3f50bc213f5cfaa3,0x3f65cd3b3f6f20b0,0x3f4d810d3f5a9009,0x3f640b4e3f6dfcf2,0x3f4a2db63f581279
.quad 0x3f682bda3f6d1c1d,0x3f5cae5b3f62b0d7,0x3f651aeb3f6aab7b,0x3f582d6a3f5eef81,0x3f61dd453f6816a8,0x3f536d743f5af875,0x3f5e738b3f655e0b,0x3f4e6fda3f56cca7,0x3f5ade673f628210,0x3f4936113f526d18,0x3f571e8c3f5f8327,0x3f43c1a03f4ddad5,0x3f5334b53f5c61c7,0x3f3e141d3f4916fa,0x3f4f21a53f591e6a,0x3f382f303f4422ab
.quad 0x3f4ae62a3f55b993,0x3f3214913f3eff1b,0x3f4683153f5233c6,0x3f2bc6083f39ad85,0x3f41f9423f4e8d90,0x3f25456b3f342f34,0x3f3d49933f4ac77f,0x3f1e949f3f2e8578,0x3f3874f43f46e22a,0x3f17b5983f28b1b0,0x3f337c553f42de29,0x3f10aa573f22b543,0x3f2e60ae3f3ebc1b,0x3f0974e93f1c91a2,0x3f2923003f3a7ca4,0x3f0217693f164847
.quad 0x3f4f21a53f5627fe,0x3f3fa6173f479f84,0x3f48f7da3f50d937,0x3f37a3533f408ea9,0x3f427c3c3f4b41fa,0x3f2f3d033f3922e1,0x3f3bb16d3f456439,0x3f2677b73f315fad,0x3f349a333f3f41fc,0x3f1d582e3f2948b8,0x3f2d396f3f38dd65,0x3f13e35b3f20e1d2,0x3f2592243f3238aa,0x3f0a1e5e3f182ef5,0x3f1da76f3f2b561b,0x3f000e823f0f343b
.quad 0x3f157c883f24381a,0x3eeb727a3f05f5e2,0x3f0d14c53f1ce11f,0x3ed6484f3ef8f08e,0x3f04738f3f1553b7,0x3ec0a9fd3ee57fcb,0x3ef738d83f0d9281,0x3eaaa33b3ed1a2aa,0x3ee525e93f05a02c,0x3e943ffb3ebd628b,0x3ed2b5ad3efafef7,0x3e7b18bc3ea8c8fe,0x3ebfefa53eea6681,0x3e4d29673e93dfbf,0x3eacdb783ed97cb9,0x3e1ecadd3e7d6156
.quad 0x3f2e60ae3f373a23,0x3f1b7aad3f251f04,0x3f245ea63f2e3bde,0x3f0f5de23f1a1255,0x3f19ea2e3f24d225,0x3f02c46b3f0e8d65,0x3f0f0a8e3f1b02c6,0x3eeb727a3f029932,0x3f03c7573f10d3cd,0x3ed08f5e3eec7e21,0x3ef050c53f064b82,0x3eb4f6e53ed31148,0x3ed86b8b3ef6e0cb,0x3e98c10d3eb8ffb2,0x3ebfefa53ee0924f,0x3e780cbe3e9e5db8
.quad 0x3ea6ee1f3ec9b953,0x3e3dbfad3e834022,0x3e8d78613eb263ef,0x3e02cd9b3e4f7838,0x3e6740483e9aa086,0x3d8ed3913e17ce3d,0x3e32eecf3e827dc0,0x3c3c7dcc3dbf5b8d,0x3dfc41873e541501,0xbd3f91373d1d0a88,0x3d91f5d03e22abb6,0xbdd6cda5bc8a3938,0x3c9d11ec3de1bc2e,0xbe268bf2bd9386e7,0xbd0710623d7b2b74,0xbe61203cbe02062e
.quad 0x3f07213a3f11796b,0x3ee309e33ef8f08e,0x3ef1b38e3f044889,0x3ec21e533eda32ad,0x3ed423ea3eed3063,0x3ea03b6d3eba766e,0x3eb5b2ec3ed0eb2a,0x3e7b18bc3e99e0ce,0x3e9680ec3eb3dca5,0x3e347ab23e712f94,0x3e6d5e1a3e9620d2,0x3dd9ed643e2d8461,0x3e2cbe363e6fa8b2,0x3d139f753dd21dc8,0x3dd6cda53e3228d4,0xbd0d57f63d107bb8
.quad 0x3d2675643de7fa9a,0xbdd6cda5bd03ec90,0xbcc2c2a93d55880e,0xbe32eecfbdcbdd86,0xbdb4684ebc16cb58,0xbe7992d0be2a6b8d,0xbe1bb027bd9064b4,0xbe9f7c6abe6e21ab,0xbe5c86c6be06b26e,0xbec16437be986116,0xbe8e3992be44b0b9,0xbee2559bbeb8ffb2,0xbead98acbe80f8c0,0xbf01134fbed8c6a3,0xbecc3f60be9f1cdf,0xbf10575bbef790dc
.quad 0x3eb5b2ec3ecc9b8b,0x3e86a9df3e9e5db8,0x3e907ca13ea986c4,0x3e3aa9213e6e21ab,0x3e54d9b13e8586ce,0x3dcd6da33e1e0438,0x3e0779bc3e419b37,0x3c90817a3d99cb0a,0x3d65376a3dee3876,0xbd856c52bb96cbc1,0xbca9a2463d2fe007,0xbe170763bdac952b,0xbdc72d02bcfb49ba,0xbe6a4f79be275251,0xbe3162d2bdd53db9,0xbe9dfe1bbe7749a6
.quad 0xbe7e2420be354098,0xbec5bf1bbea2d733,0xbea4b372be7ee6e1,0xbeec24f3bec90077,0xbec95ce9bea395c5,0xbf08761cbeede280,0xbeecd747bec6d529,0xbf19ea2ebf08a0a1,0xbf077692bee900b7,0xbf2a500abf197194,0xbf17b598bf04f484,0xbf398ae7bf2948b8,0xbf271043bf14b039,0xbf478008bf380c43,0xbf356f75bf239da9,0xbf5416edbf45a42d
.quad 0x3e2cbe363e5d4b1a,0x3d9517f93df7942c,0x3da4c1613e06b26e,0xbcb632863ceeba2c,0xbc0a3a7b3d3c6dd5,0xbdefc7d7bd80b86c,0xbdc72d02bd2351cb,0xbe57ec1dbe1e0438,0xbe3dbfadbe007745,0xbe9b0059be7a55cb,0xbe8b344bbe57278f,0xbec8a3fdbeaa446f,0xbeb66ed8be9620d2,0xbef47761bed5ecfd,0xbee037f2bebf926f,0xbf0f0a8ebeffc5f3
.quad 0xbf041d7ebee79a5d,0xbf228e71bf13ba50,0xbf171376bf06f686,0xbf349a33bf265184,0xbf28d77cbf19210f,0xbf450411bf37804a,0xbf394595bf2a2a80,0xbf53a612bf472167,0xbf483c7cbf39f2ac,0xbf605e5abf5512fb,0xbf559de3bf485bca,0xbf6b0f79bf6136d0,0xbf614eb1bf554aa4,0xbf73a0b4bf6b7295,0xbf6b3739bf60a6cf,0xbf79fe36bf73b01f
.quad 0x3d45d7e400000000,0x3e13ebc13dc59cc6,0x3d5264e200000000,0x3e1d3d8e3dd21dc8,0x3d5ef15f00000000,0x3e268bf23dde9cc4,0x3d6b7d5100000000,0x3e2fd6b93deb199a,0x3d7808b300000000,0x3e391db03df7942c,0x3d8249be00000000,0x3e4260a33e02062e,0x3d888ed200000000,0x3e4b9f5f3e084105,0x3d8ed39100000000,0x3e54d9b13e0e7a8b
.quad 0x3d9517f900000000,0x3e5e0f653e14b2b2,0x3d9b5c0500000000,0x3e6740483e1ae96b,0x3da19fb000000000,0x3e706c283e211ea5,0x3da7e2f800000000,0x3e7992d03e275251,0x3dae25d900000000,0x3e815a083e2d8461,0x3db4684e00000000,0x3e85e7d93e33b4c4,0x3dbaaa5400000000,0x3e8a72c33e39e36c,0x3dc0ebe600000000,0x3e8efaad3e401049
.quad 0x3e7500263e44b0b9,0x3ea9e59d3e925e94,0x3e821c883e5101f1,0x3eb43ac13e9b6027,0x3e89b1263e5d4b1a,0x3ebe7a9e3ea4543f,0x3e913d793e698bba,0x3ec8a3fd3ead3a15,0x3e98c10d3e75c35a,0x3ed2b5ad3eb610e6,0x3ea03b6d3e80f8c0,0x3edcae7c3ebed7eb,0x3ea7ac253e870ada,0x3ee68d3c3ec78e62,0x3eaf12c53e8d17c0,0x3ef050c53ed0338a
.quad 0x3eb66ed83e931f35,0x3ef9f7ee3ed8c6a3,0x3ebdbfee3e9920fe,0x3f01c0ca3ee146ee,0x3ec505963e9f1cdf,0x3f06764b3ee9b3ae,0x3ecc3f603ea5129f,0x3f0b1bec3ef20c29,0x3ed36cdb3eab0201,0x3f0fb1213efa4fa5,0x3eda8d9b3eb0eacb,0x3f14355e3f013eb5,0x3ee1a1303eb6ccc3,0x3f18a81d3f054a62,0x3ee8a72e3ebca7af,0x3f1d08d53f094a7f
.quad 0x3ed7b5433ec1071e,0x3f01c0ca3eede280,0x3ee4720a3ecc9b8b,0x3f0920103efbae22,0x3ef1023c3ed8106b,0x3f10575b3f049e91,0x3efd63653ee363fa,0x3f1764933f0b461c,0x3f04c98d3eee9479,0x3f1e45a73f11cc19,0x3f0ac77d3ef9a02d,0x3f24f8983f182ef5,0x3f10aa573f0242b1,0x3f2b7b703f1e6d26,0x3f1670f63f07a136,0x3f31cc4b3f24852c
.quad 0x3f1c1a383f0cead0,0x3f37e9503f2a758e,0x3f21a5043f121eb0,0x3f3dd0b73f303cde,0x3f2710433f173c07,0x3f4380c83f35d9b8,0x3f2c5ae73f1c420c,0x3f48f7da3f3b4ac1,0x3f3183e93f212ff9,0x3f4e34563f408ea9,0x3f368a453f26050a,0x3f5334b53f45a42d,0x3f3b6d013f2ac082,0x3f57f7803f4a8a13,0x3f402b2a3f2f61a5,0x3f5c7b563f4f3f2b
.quad 0x3f1670f63f0c42c9,0x3f29b9b93f20453b,0x3f1e949f3f140c5f,0x3f325cbc3f28b1b0,0x3f2677b73f1ba299,0x3f3a9f103f30ce7c,0x3f2e17073f2302d3,0x3f427c3c3f3897cb,0x3f356f753f2a2a80,0x3f49effb3f4009f0,0x3f3c7e033f311722,0x3f50f6443f472167,0x3f433fd23f37c655,0x3f578b483f4ddad5,0x3f49b2223f3e35c5,0x3f5dab763f54330f
.quad 0x3f4fd2523f446337,0x3f63537b3f5a2716,0x3f559de33f4a4c87,0x3f6880473f5fb419,0x3f5b127b3f4fefa8,0x3f6d2f0c3f64d77b,0x3f602de03f554aa4,0x3f715d3f3f698ecc,0x3f64edfe3f5a5ba0,0x3f75089d3f6dd7d5,0x3f6950e63f5f20db,0x3f782f293f71b08e,0x3f6d54ce3f6398ac,0x3f7acf2d3f751727,0x3f70f8143f67c187,0x3f7ce73c3f780a04
.quad 0x3f3b6d013f32c8c9,0x3f4b60853f43a138,0x3f4442f53f3b8f3b,0x3f5416ed3f4c7208,0x3f4c90453f43e200,0x3f5c14e63f54a347,0x3f544f2a3f4bbbf8,0x3f63537b3f5c2e8e,0x3f5b7a3e3f531849,0x3f69cc623f630dfc,0x3f620c863f59f26a,0x3f6f79f83f693c32,0x3f68016d3f604621,0x3f74574f3f6eb45d,0x3f6d54ce3f660f88,0x3f78602a3f737239
.quad 0x3f7202f43f6b4b0c,0x3f7b91073f777213,0x3f76089c3f6ff573,0x3f7de7213f7ab0cb,0x3f7962f93f740bdd,0x3f7f606f3f7d2bd8,0x3f7c0fb73f778bc5,0x3f7ffbaa3f7ee14c,0x3f7e0cf73f7a7302,0x3f7fb8493f7fcfd1,0x3f7f59593f7cbfc9,0x3f7e96883f7ff6ac,0x3f7ff3f43f7e70b0,0x3f7c97623f7f55bf,0x3f7fdc5c3f7f84ab,0x3f79bc953f7ded88
.quad 0x3f596e293f52a649,0x3f65745a3f5fb419,0x3f61ade13f5b2c79,0x3f6ce31a3f6796c1,0x3f68fddf3f62df7b,0x3f7324073f6e6b6d,0x3f6f565e3f69b7e4,0x3f782f293f742a27,0x3f74b0a03f6faf1b,0x3f7bfe123f78cc3b,0x3f7906f63f74bf62,0x3f7e8be93f7c4c44,0x3f7c54c43f78e3d6,0x3f7fd56c3f7ea62d,0x3f7e96883f7c187a,0x3f7fd8f83f7fd737
.quad 0x3f7fc9dc3f7e5a38,0x3f7e96883f7fde00,0x3f7fed7a3f7fa6e3,0x3f7c0fb73f7eba7f,0x3f7f013c3f7ffd39,0x3f7847bc3f7c6e08,0x3f7d061c3f7f5ce9,0x3f73436b3f78fb4a,0x3f79fe363f7dc68c,0x3f6d09253f746649,0x3f75ecc23f7b3bab,0x3f65a0dc3f6eb45d,0x3f70d6113f77beb7,0x3f5d13ff3f67ec29,0x3f6abf8c3f73530e,0x3f536d743f601596
.quad 0x3f6f565e3f6aab7b,0x3f76fc993f737239,0x3f7598503f718f57,0x3f7bb5fc3f78fb4a,0x3f7a68943f772417,0x3f7eb5793f7cef03,0x3f7dbfeb3f7b61fc,0x3f7ff5ce3f7f46f4,0x3f7f994d3f7e4323,0x3f7f74c73f7fff4e,0x3f7ff1f33f7fc38f,0x3f7d33473f7f16e4,0x3f7ec9553f7fe129,0x3f7935443f7c8f31,0x3f7c21343f7e9bc9,0x3f7381c13f786c52
.quad 0x3f77fd8f3f7bf531,0x3f6c22bf3f72b504,0x3f7264a03f77f110,0x3f63252f3f6b7295,0x3f6b5ed53f7294f8,0x3f5898da3f62b0d7,0x3f62f6c03f6be858,0x3f4c90453f587e0b,0x3f5939083f63f473,0x3f3f208f3f4ceacb,0x3f4e34563f5ac450,0x3f3061503f4009f0,0x3f41f9423f5064af,0x3f206c6a3f31f071,0x3f349a333f44e3f5,0x3f0f5de23f22b543
.quad 0x3f7c54c43f79f35e,0x3f7f521b3f7e1f5e,0x3f7f2b973f7dc68c,0x3f7fefca3f7fe42b,0x3f7ffdab3f7fba9e,0x3f7e3d463f7f7e6d,0x3f7ec9553f7fcbe2,0x3f7a3e7c3f7cef03,0x3f7b91073f7dfa38,0x3f73fcaa3f783b77,0x3f765b463f7a4910,0x3f6b864c3f716dfb,0x3f6f329e3f74bf62,0x3f60eef63f68954c,0x3f66258f3f6d67a1,0x3f544f2a3f5dc497
.quad 0x3f5b466e3f644fac,0x3f45c41c3f51134a,0x3f4eab3e3f5988ad,0x3f356f753f429ce8,0x3f406d863f4d26fd,0x3f2376fd3f3280c7,0x3f30aa1f3f3f41fc,0x3f1004493f20e1d2,0x3f1f80f33f2ff3e6,0x3ef688b33f0de638,0x3f0d14c53f1f599f,0x3ecace633ef36e38,0x3ef315c23f0d9281,0x3e9d3ecf3ec90077,0x3eca15b53ef58035,0x3e5c86c63e9cdf20
.quad 0x3f8000003f800000,0x3f8000003f800000,0x3f7fa97d3f7fb382,0x3f7f93993f7f9eda,0x3f7ea62d3f7ece34,0x3f7e4ec13f7e7bb1,0x3f7cf6c03f7d50a0,0x3f7c328b3f7c9762,0x3f7a9c593f7b3bab,0x3f7940c03f79f35e,0x3f7798903f789091,0x3f757bde3f7691a4,0x3f73ed6e3f7550ed,0x3f70e7173f7274c7,0x3f6f9d6e3f717eae,0x3f6b864c3f6d9fe4
.quad 0x3f6aab7b3f6d1c1d,0x3f655e0b3f6816a8,0x3f651aeb3f682bda,0x3f5e738b3f61dd45,0x3f5eef813f62b0d7,0x3f56cca73f5af875,0x3f582d6a3f5cae5b,0x3f4e6fda3f536d74,0x3f50d9373f5627fe,0x3f4564393f4b41fa,0x3f48f7da3f4f21a5,0x3f3bb16d3f427c3c,0x3f408ea93f479f84,0x3f315fad3f3922e1,0x3f37a3533f3fa617,0x3f2677b73f2f3d03
.quad 0x3f8000003f800000,0x3f8000003f800000,0x3f7f7b403f7f87bb,0x3f7f606f3f7f6e26,0x3f7ded883f7e1f5e,0x3f7d82853f7db940,0x3f7b58763f7bc83b,0x3f7a68943f7ae33d,0x3f77beb73f788486,0x3f76167a3f76ef5b,0x3f7324073f74574f,0x3f70919b3f71e21a,0x3f6d8d2d3f6f4483,0x3f69e0d73f6bc13b,0x3f66fff33f6950e6,0x3f620c863f6493bb
.quad 0x3f5f83273f628210,0x3f591e6a3f5c61c7,0x3f571e8c3f5ade67,0x3f4f21a53f5334b5,0x3f4ddad53f526d18,0x3f4422ab3f4916fa,0x3f43c1a03f493611,0x3f382f303f3e141d,0x3f38dd653f3f41fc,0x3f2b561b3f3238aa,0x3f2d396f3f349a33,0x3f1da76f3f259224,0x3f20e1d23f2948b8,0x3f0f343b3f182ef5,0x3f13e35b3f1d582e,0x3f000e823f0a1e5e
.quad 0x3f8000003f800000,0x3f8000003f800000,0x3f7f43293f7f521b,0x3f7f236d3f7f339a,0x3f7d0dbc3f7d4959,0x3f7c8f313f7ccfae,0x3f7962f93f79e87c,0x3f7847bc3f78d80e,0x3f74484b3f75341d,0x3f7254703f73530e,0x3f6dc5393f6f329e,0x3f6abf8c3f6c4980,0x3f65e35e3f67ec29,0x3f6196223f63c6a1,0x3f5cae5b3f5f6aa1,0x3f56e7fb3f59d807
.quad 0x3f5233c63f55b993,0x3f4ac77f3f4e8d90,0x3f4683153f4ae62a,0x3f3d49933f41f942,0x3f39ad853f3eff1b,0x3f2e85783f342f34,0x3f2bc6083f321491,0x3f1e949f3f25456b,0x3f1ce11f3f24381a,0x3f0d92813f1553b7,0x3f0d14c53f157c88,0x3ef738d83f04738f,0x3ef8f08e3f05f5e2,0x3ed1a2aa3ee57fcb,0x3ed6484f3eeb727a,0x3eaaa33b3ec0a9fd
.quad 0x3f8000003f800000,0x3f8000003f800000,0x3f7f013c3f7f12a3,0x3f7edc953f7eef37,0x3f7c06e93f7c4c44,0x3f7b74ea3f7bbf20,0x3f7716f63f77b209,0x3f75d0c23f767688,0x3f703b373f714c7a,0x3f6dfcf23f6f20b0,0x3f6781513f692774,0x3f640b4e3f65cd3b,0x3f5cfaa33f5f5212,0x3f5812793f5a9009,0x3f50bc213f53de90,0x3f4a2db63f4d810d
.quad 0x3f42de293f46e22a,0x3f3a7ca43f3ebc1b,0x3f337c553f3874f4,0x3f2923003f2e60ae,0x3f22b5433f28b1b0,0x3f1648473f1c91a2,0x3f10aa573f17b598,0x3f0217693f0974e9,0x3efafef73f05a02c,0x3ed97cb93eea6681,0x3ed2b5ad3ee525e9,0x3eacdb783ebfefa5,0x3ea8c8fe3ebd628b,0x3e7d61563e93dfbf,0x3e7b18bc3e943ffb,0x3e1ecadd3e4d2967
.quad 0x3f2e3bde3f373a23,0x3f1b02c63f24d225,0x3f245ea63f2e60ae,0x3f0f0a8e3f19ea2e,0x3f1a12553f251f04,0x3f0299323f0e8d65,0x3f0f5de23f1b7aad,0x3eeb727a3f02c46b,0x3f0448893f11796b,0x3ed0eb2a3eed3063,0x3ef1b38e3f07213a,0x3eb5b2ec3ed423ea,0x3eda32ad3ef8f08e,0x3e99e0ce3eba766e,0x3ec21e533ee309e3,0x3e7b18bc3ea03b6d
.quad 0x3ea986c43ecc9b8b,0x3e419b373e8586ce,0x3e907ca13eb5b2ec,0x3e0779bc3e54d9b1,0x3e6e21ab3e9e5db8,0x3d99cb0a3e1e0438,0x3e3aa9213e86a9df,0x3c90817a3dcd6da3,0x3e06b26e3e5d4b1a,0xbd2351cb3d3c6dd5,0x3da4c1613e2cbe36,0xbdc72d02bc0a3a7b,0x3ceeba2c3df7942c,0xbe1e0438bd80b86c,0xbcb632863d9517f9,0xbe57ec1dbdefc7d7
.quad 0x3f064b823f10d3cd,0x3ee0924f3ef6e0cb,0x3ef050c53f03c757,0x3ebfefa53ed86b8b,0x3ed311483eec7e21,0x3e9e5db83eb8ffb2,0x3eb4f6e53ed08f5e,0x3e780cbe3e98c10d,0x3e9620d23eb3dca5,0x3e3228d43e6fa8b2,0x3e6d5e1a3e9680ec,0x3dd6cda53e2cbe36,0x3e2d84613e712f94,0x3d107bb83dd21dc8,0x3dd9ed643e347ab2,0xbd0d57f63d139f75
.quad 0x3d2fe0073dee3876,0xbdd53db9bcfb49ba,0xbca9a2463d65376a,0xbe3162d2bdc72d02,0xbdac952bbb96cbc1,0xbe7749a6be275251,0xbe170763bd856c52,0xbe9dfe1bbe6a4f79,0xbe57278fbe007745,0xbebf926fbe9620d2,0xbe8b344bbe3dbfad,0xbee037f2beb66ed8,0xbeaa446fbe7a55cb,0xbeffc5f3bed5ecfd,0xbec8a3fdbe9b0059,0xbf0f0a8ebef47761
.quad 0x3eb263ef3ec9b953,0x3e827dc03e9aa086,0x3e8d78613ea6ee1f,0x3e32eecf3e674048,0x3e4f78383e834022,0x3dbf5b8d3e17ce3d,0x3e02cd9b3e3dbfad,0x3c3c7dcc3d8ed391,0x3d55880e3de7fa9a,0xbd9064b4bc16cb58,0xbcc2c2a93d267564,0xbe1bb027bdb4684e,0xbdcbdd86bd03ec90,0xbe6e21abbe2a6b8d,0xbe32eecfbdd6cda5,0xbe9f7c6abe7992d0
.quad 0xbe7ee6e1be354098,0xbec6d529bea395c5,0xbea4b372be7e2420,0xbeecd747bec95ce9,0xbec90077bea2d733,0xbf08a0a1beede280,0xbeec24f3bec5bf1b,0xbf19ea2ebf08761c,0xbf06f686bee79a5d,0xbf2a2a80bf19210f,0xbf171376bf041d7e,0xbf394595bf28d77c,0xbf265184bf13ba50,0xbf472167bf37804a,0xbf349a33bf228e71,0xbf53a612bf450411
.quad 0x3e22abb63e541501,0x3d7b2b743de1bc2e,0x3d91f5d03dfc4187,0xbd0710623c9d11ec,0xbc8a39383d1d0a88,0xbe02062ebd9386e7,0xbdd6cda5bd3f9137,0xbe61203cbe268bf2,0xbe44b0b9be06b26e,0xbe9f1cdfbe80f8c0,0xbe8e3992be5c86c6,0xbecc3f60bead98ac,0xbeb8ffb2be986116,0xbef790dcbed8c6a3,0xbee2559bbec16437,0xbf10575bbf01134f
.quad 0xbf04f484bee900b7,0xbf239da9bf14b039,0xbf17b598bf077692,0xbf356f75bf271043,0xbf2948b8bf197194,0xbf45a42dbf380c43,0xbf398ae7bf2a500a,0xbf5416edbf478008,0xbf485bcabf39f2ac,0xbf60a6cfbf554aa4,0xbf559de3bf483c7c,0xbf6b3739bf614eb1,0xbf6136d0bf5512fb,0xbf73b01fbf6b7295,0xbf6b0f79bf605e5a,0xbf79fe36bf73a0b4
.quad 0,0,0x3d5264e23d45d7e4,0x3d6b7d513d5ef15f,0x3dd21dc83dc59cc6,0x3deb199a3dde9cc4,0x3e1d3d8e3e13ebc1,0x3e2fd6b93e268bf2,0x3e5101f13e44b0b9,0x3e698bba3e5d4b1a,0x3e821c883e750026,0x3e913d793e89b126,0x3e9b60273e925e94,0x3ead3a153ea4543f,0x3eb43ac13ea9e59d,0x3ec8a3fd3ebe7a9e
.quad 0x3ecc9b8b3ec1071e,0x3ee363fa3ed8106b,0x3ee4720a3ed7b543,0x3efd63653ef1023c,0x3efbae223eede280,0x3f0b461c3f049e91,0x3f0920103f01c0ca,0x3f1764933f10575b,0x3f140c5f3f0c42c9,0x3f2302d33f1ba299,0x3f1e949f3f1670f6,0x3f2e17073f2677b7,0x3f28b1b03f20453b,0x3f3897cb3f30ce7c,0x3f325cbc3f29b9b9,0x3f427c3c3f3a9f10
.quad 0,0,0x3d8249be3d7808b3,0x3d8ed3913d888ed2,0x3e02062e3df7942c,0x3e0e7a8b3e084105,0x3e4260a33e391db0,0x3e54d9b13e4b9f5f,0x3e80f8c03e75c35a,0x3e8d17c03e870ada,0x3ea03b6d3e98c10d,0x3eaf12c53ea7ac25,0x3ebed7eb3eb610e6,0x3ed0338a3ec78e62,0x3edcae7c3ed2b5ad,0x3ef050c53ee68d3c
.quad 0x3ef9a02d3eee9479,0x3f07a1363f0242b1,0x3f0ac77d3f04c98d,0x3f1670f63f10aa57,0x3f182ef53f11cc19,0x3f24852c3f1e6d26,0x3f24f8983f1e45a7,0x3f31cc4b3f2b7b70,0x3f3117223f2a2a80,0x3f3e35c53f37c655,0x3f3c7e033f356f75,0x3f49b2223f433fd2,0x3f4721673f4009f0,0x3f54330f3f4ddad5,0x3f50f6443f49effb,0x3f5dab763f578b48
.quad 0,0,0x3d9b5c053d9517f9,0x3da7e2f83da19fb0,0x3e1ae96b3e14b2b2,0x3e2752513e211ea5,0x3e6740483e5e0f65,0x3e7992d03e706c28,0x3e9920fe3e931f35,0x3ea5129f3e9f1cdf,0x3ebdbfee3eb66ed8,0x3ecc3f603ec50596,0x3ee146ee3ed8c6a3,0x3ef20c293ee9b3ae,0x3f01c0ca3ef9f7ee,0x3f0b1bec3f06764b
.quad 0x3f121eb03f0cead0,0x3f1c420c3f173c07,0x3f21a5043f1c1a38,0x3f2c5ae73f271043,0x3f303cde3f2a758e,0x3f3b4ac13f35d9b8,0x3f3dd0b73f37e950,0x3f48f7da3f4380c8,0x3f4a4c873f446337,0x3f554aa43f4fefa8,0x3f559de33f4fd252,0x3f602de03f5b127b,0x3f5fb4193f5a2716,0x3f698ecc3f64d77b,0x3f6880473f63537b,0x3f715d3f3f6d2f0c
.quad 0,0,0x3db4684e3dae25d9,0x3dc0ebe63dbaaa54,0x3e33b4c43e2d8461,0x3e4010493e39e36c,0x3e85e7d93e815a08,0x3e8efaad3e8a72c3,0x3eb0eacb3eab0201,0x3ebca7af3eb6ccc3,0x3eda8d9b3ed36cdb,0x3ee8a72e3ee1a130,0x3f013eb53efa4fa5,0x3f094a7f3f054a62,0x3f14355e3f0fb121,0x3f1d08d53f18a81d
.quad 0x3f26050a3f212ff9,0x3f2f61a53f2ac082,0x3f368a453f3183e9,0x3f402b2a3f3b6d01,0x3f45a42d3f408ea9,0x3f4f3f2b3f4a8a13,0x3f5334b53f4e3456,0x3f5c7b563f57f780,0x3f5f20db3f5a5ba0,0x3f67c1873f6398ac,0x3f6950e63f64edfe,0x3f70f8143f6d54ce,0x3f71b08e3f6dd7d5,0x3f780a043f751727,0x3f782f293f75089d,0x3f7ce73c3f7acf2d
.quad 0x3f3b8f3b3f32c8c9,0x3f4bbbf83f43e200,0x3f4442f53f3b6d01,0x3f544f2a3f4c9045,0x3f4c72083f43a138,0x3f5c2e8e3f54a347,0x3f5416ed3f4b6085,0x3f63537b3f5c14e6,0x3f5b2c793f52a649,0x3f69b7e43f62df7b,0x3f61ade13f596e29,0x3f6f565e3f68fddf,0x3f6796c13f5fb419,0x3f742a273f6e6b6d,0x3f6ce31a3f65745a,0x3f782f293f732407
.quad 0x3f718f573f6aab7b,0x3f7b61fc3f772417,0x3f7598503f6f565e,0x3f7dbfeb3f7a6894,0x3f78fb4a3f737239,0x3f7f46f43f7cef03,0x3f7bb5fc3f76fc99,0x3f7ff5ce3f7eb579,0x3f7dc68c3f79f35e,0x3f7fcbe23f7fba9e,0x3f7f2b973f7c54c4,0x3f7ec9553f7ffdab,0x3f7fe42b3f7e1f5e,0x3f7cef033f7f7e6d,0x3f7fefca3f7f521b,0x3f7a3e7c3f7e3d46
.quad 0x3f59f26a3f531849,0x3f660f883f604621,0x3f620c863f5b7a3e,0x3f6d54ce3f68016d,0x3f693c323f630dfc,0x3f7372393f6eb45d,0x3f6f79f83f69cc62,0x3f78602a3f74574f,0x3f74bf623f6faf1b,0x3f7c187a3f78e3d6,0x3f7906f63f74b0a0,0x3f7e96883f7c54c4,0x3f7c4c443f78cc3b,0x3f7fd7373f7ea62d,0x3f7e8be93f7bfe12,0x3f7fd8f83f7fd56c
.quad 0x3f7fc38f3f7e4323,0x3f7e9bc93f7fe129,0x3f7ff1f33f7f994d,0x3f7c21343f7ec955,0x3f7f16e43f7fff4e,0x3f786c523f7c8f31,0x3f7d33473f7f74c7,0x3f7381c13f793544,0x3f7a49103f7dfa38,0x3f6d67a13f74bf62,0x3f765b463f7b9107,0x3f66258f3f6f329e,0x3f716dfb3f783b77,0x3f5dc4973f68954c,0x3f6b864c3f73fcaa,0x3f544f2a3f60eef6
.quad 0x3f6ff5733f6b4b0c,0x3f778bc53f740bdd,0x3f76089c3f7202f4,0x3f7c0fb73f7962f9,0x3f7ab0cb3f777213,0x3f7ee14c3f7d2bd8,0x3f7de7213f7b9107,0x3f7ffbaa3f7f606f,0x3f7fa6e33f7e5a38,0x3f7f5ce93f7ffd39,0x3f7fed7a3f7fc9dc,0x3f7d061c3f7f013c,0x3f7eba7f3f7fde00,0x3f78fb4a3f7c6e08,0x3f7c0fb73f7e9688,0x3f73436b3f7847bc
.quad 0x3f77f1103f7bf531,0x3f6be8583f7294f8,0x3f7264a03f77fd8f,0x3f62f6c03f6b5ed5,0x3f6b72953f72b504,0x3f587e0b3f62b0d7,0x3f63252f3f6c22bf,0x3f4c90453f5898da,0x3f5988ad3f644fac,0x3f3f41fc3f4d26fd,0x3f4eab3e3f5b466e,0x3f30aa1f3f406d86,0x3f429ce83f51134a,0x3f20e1d23f3280c7,0x3f356f753f45c41c,0x3f1004493f2376fd
.quad 0x3f7cbfc93f7a7302,0x3f7f84ab3f7e70b0,0x3f7f59593f7e0cf7,0x3f7fdc5c3f7ff3f4,0x3f7ff6ac3f7fcfd1,0x3f7ded883f7f55bf,0x3f7e96883f7fb849,0x3f79bc953f7c9762,0x3f7b3bab3f7dc68c,0x3f73530e3f77beb7,0x3f75ecc23f79fe36,0x3f6abf8c3f70d611,0x3f6eb45d3f746649,0x3f6015963f67ec29,0x3f65a0dc3f6d0925,0x3f536d743f5d13ff
.quad 0x3f5ac4503f63f473,0x3f44e3f53f5064af,0x3f4e34563f593908,0x3f349a333f41f942,0x3f4009f03f4ceacb,0x3f22b5433f31f071,0x3f3061503f3f208f,0x3f0f5de23f206c6a,0x3f1f599f3f2ff3e6,0x3ef580353f0d9281,0x3f0d14c53f1f80f3,0x3eca15b53ef315c2,0x3ef36e383f0de638,0x3e9cdf203ec90077,0x3ecace633ef688b3,0x3e5c86c63e9d3ecf
.quad 0xbf803f80bf803f80,0,0xbf753f7bbf7f3f80,0xbe953e48bdc90000,0xbf553f6dbf7b3f80,0xbf0e3ec4be480000,0xbf223f55bf753f80,0xbf463f0ebe950000,0xbec43f35bf6d3f80,0xbf6d3f35bec40000,0xbdc93f0ebf623f80,0xbf7f3f55bef10000,0x3e483ec4bf553f80,0xbf7b3f6dbf0e0000,0x3ef13e48bf463f80,0xbf623f7bbf220000
.quad 0x3f350000bf353f80,0xbf353f80bf350000,0x3f62be48bf223f80,0xbef13f7bbf460000,0x3f7bbec4bf0e3f80,0xbe483f6dbf550000,0x3f7fbf0ebef13f80,0x3dc93f55bf620000,0x3f6dbf35bec43f80,0x3ec43f35bf6d0000,0x3f46bf55be953f80,0x3f223f0ebf750000,0x3f0ebf6dbe483f80,0x3f553ec4bf7b0000,0x3e95bf7bbdc93f80,0x3f753e48bf7f0000
.quad 0xbf803f80bf803f80,0,0xbf463f55bf623f6d,0xbf223f0ebef13ec4,0xbe483ec4bf0e3f35,0xbf7b3f6dbf553f35,0x3ef1be48bdc93ec4,0xbf623f7bbf7f3f6d,0x3f6dbf353ec40000,0xbec43f35bf6d3f80,0x3f75bf7b3f46bec4,0x3e953e48bf223f6d,0x3f0ebf6d3f7bbf35,0x3f55bec4be483f35,0xbdc9bf0e3f75bf6d,0x3f7fbf553e953ec4
.quad 0xbf3500003f35bf80,0x3f35bf803f350000,0xbf7f3f0e3e95bf6d,0x3dc9bf553f75bec4,0xbf553f6dbe48bf35,0xbf0ebec43f7bbf35,0xbe953f7bbf22bec4,0xbf753e483f46bf6d,0x3ec43f35bf6d0000,0xbf6d3f353ec4bf80,0x3f623e48bf7f3ec4,0xbef13f7bbdc9bf6d,0x3f7bbec4bf553f35,0x3e483f6dbf0ebf35,0x3f22bf55bef13f6d,0x3f463f0ebf62bec4
.quad 0xbf803f80bf803f80,0,0xbef13f0ebf223f35,0xbf623f55bf463f35,0x3f0ebec43e480000,0xbf553f6dbf7b3f80,0x3f7fbf7b3f62bf35,0x3dc93e48bef13f35,0x3ec4bf353f6dbf80,0x3f6dbf353ec40000,0xbf223e483e95bf35,0x3f46bf7b3f75bf35,0xbf7b3f6dbf0e0000,0xbe48bec43f55bf80,0xbe953f55bf7f3f35,0xbf753f0e3dc9bf35
.quad 0x3f350000bf353f80,0xbf353f80bf350000,0x3f75bf553dc93f35,0x3e953f0ebf7f3f35,0x3e48bf6d3f550000,0x3f7bbec4bf0e3f80,0xbf46be483f75bf35,0x3f22bf7b3e953f35,0xbf6d3f353ec4bf80,0xbec4bf353f6d0000,0xbdc93f7bbef1bf35,0xbf7f3e483f62bf35,0x3f553ec4bf7b0000,0xbf0e3f6d3e48bf80,0x3f62bf0ebf463f35,0x3ef13f55bf22bf35
.quad 0xbf803f80bf803f80,0,0xbdc93e48be953ec4,0xbf7f3f7bbf753f6d,0x3f7bbf6d3f55bf35,0xbe483ec4bf0e3f35,0x3e95bf0e3f46bf6d,0x3f75bf553f22bec4,0xbf6d3f35bec40000,0x3ec4bf353f6dbf80,0xbef13f55bf7f3f6d,0xbf623f0ebdc9bec4,0x3f55bec4be483f35,0xbf0e3f6dbf7b3f35,0x3f22bf7b3f62bec4,0x3f46be48bef13f6d
.quad 0xbf3500003f35bf80,0x3f35bf803f350000,0xbf463f7bbef1bec4,0xbf22be483f62bf6d,0x3f0e3ec4bf7b3f35,0xbf553f6dbe48bf35,0x3f62bf55bdc93f6d,0x3ef13f0ebf7f3ec4,0xbec4bf353f6d0000,0x3f6dbf35bec43f80,0xbf753f0e3f22bf6d,0xbe95bf553f463ec4,0x3e483f6dbf0ebf35,0xbf7b3ec43f55bf35,0x3f7fbe48bf753ec4,0x3dc93f7bbe95bf6d
.quad 0xbf803f80bf803f80,0x8000800080008000,0xbf753f7bbf7f3f80,0x3e95be483dc98000,0xbf553f6dbf7b3f80,0x3f0ebec43e488000,0xbf223f55bf753f80,0x3f46bf0e3e958000,0xbec43f35bf6d3f80,0x3f6dbf353ec48000,0xbdc93f0ebf623f80,0x3f7fbf553ef18000,0x3e483ec4bf553f80,0x3f7bbf6d3f0e8000,0x3ef13e48bf463f80,0x3f62bf7b3f228000
.quad 0x3f350000bf353f80,0x3f35bf803f358000,0x3f62be48bf223f80,0x3ef1bf7b3f468000,0x3f7bbec4bf0e3f80,0x3e48bf6d3f558000,0x3f7fbf0ebef13f80,0xbdc9bf553f628000,0x3f6dbf35bec43f80,0xbec4bf353f6d8000,0x3f46bf55be953f80,0xbf22bf0e3f758000,0x3f0ebf6dbe483f80,0xbf55bec43f7b8000,0x3e95bf7bbdc93f80,0xbf75be483f7f8000
.quad 0xbf803f80bf803f80,0x8000800080008000,0xbf463f55bf623f6d,0x3f22bf0e3ef1bec4,0xbe483ec4bf0e3f35,0x3f7bbf6d3f55bf35,0x3ef1be48bdc93ec4,0x3f62bf7b3f7fbf6d,0x3f6dbf353ec40000,0x3ec4bf353f6dbf80,0x3f75bf7b3f46bec4,0xbe95be483f22bf6d,0x3f0ebf6d3f7bbf35,0xbf553ec43e48bf35,0xbdc9bf0e3f75bf6d,0xbf7f3f55be95bec4
.quad 0xbf3500003f35bf80,0xbf353f80bf358000,0xbf7f3f0e3e95bf6d,0xbdc93f55bf753ec4,0xbf553f6dbe48bf35,0x3f0e3ec4bf7b3f35,0xbe953f7bbf22bec4,0x3f75be48bf463f6d,0x3ec43f35bf6d0000,0x3f6dbf35bec43f80,0x3f623e48bf7f3ec4,0x3ef1bf7b3dc93f6d,0x3f7bbec4bf553f35,0xbe48bf6d3f0e3f35,0x3f22bf55bef13f6d,0xbf46bf0e3f623ec4
.quad 0xbf803f80bf803f80,0x8000800080008000,0xbef13f0ebf223f35,0x3f62bf553f46bf35,0x3f0ebec43e480000,0x3f55bf6d3f7bbf80,0x3f7fbf7b3f62bf35,0xbdc9be483ef1bf35,0x3ec4bf353f6dbf80,0xbf6d3f35bec48000,0xbf223e483e95bf35,0xbf463f7bbf753f35,0xbf7b3f6dbf0e0000,0x3e483ec4bf553f80,0xbe953f55bf7f3f35,0x3f75bf0ebdc93f35
.quad 0x3f350000bf353f80,0x3f35bf803f358000,0x3f75bf553dc93f35,0xbe95bf0e3f7fbf35,0x3e48bf6d3f550000,0xbf7b3ec43f0ebf80,0xbf46be483f75bf35,0xbf223f7bbe95bf35,0xbf6d3f353ec4bf80,0x3ec43f35bf6d8000,0xbdc93f7bbef1bf35,0x3f7fbe48bf623f35,0x3f553ec4bf7b0000,0x3f0ebf6dbe483f80,0x3f62bf0ebf463f35,0xbef1bf553f223f35
.quad 0xbf803f80bf803f80,0x8000800080008000,0xbdc93e48be953ec4,0x3f7fbf7b3f75bf6d,0x3f7bbf6d3f55bf35,0x3e48bec43f0ebf35,0x3e95bf0e3f46bf6d,0xbf753f55bf223ec4,0xbf6d3f35bec40000,0xbec43f35bf6d3f80,0xbef13f55bf7f3f6d,0x3f62bf0e3dc93ec4,0x3f55bec4be483f35,0x3f0ebf6d3f7bbf35,0x3f22bf7b3f62bec4,0xbf463e483ef1bf6d
.quad 0xbf3500003f35bf80,0xbf353f80bf358000,0xbf463f7bbef1bec4,0x3f223e48bf623f6d,0x3f0e3ec4bf7b3f35,0x3f55bf6d3e483f35,0x3f62bf55bdc93f6d,0xbef1bf0e3f7fbec4,0xbec4bf353f6d0000,0xbf6d3f353ec4bf80,0xbf753f0e3f22bf6d,0x3e953f55bf46bec4,0x3e483f6dbf0ebf35,0x3f7bbec4bf553f35,0x3f7fbe48bf753ec4,0xbdc9bf7b3e953f6d
.quad 0xbf803f80bf803f80,0xbf803f80bf803f80,0xbf753f7bbf7f3f80,0x3e95be483dc90000,0xbf553f6dbf7b3f80,0x3f55bf6d3f7bbf80,0xbf223f55bf753f80,0xbf463f0ebe950000,0xbec43f35bf6d3f80,0xbec43f35bf6d3f80,0xbdc93f0ebf623f80,0x3f7fbf553ef10000,0x3e483ec4bf553f80,0xbe48bec43f55bf80,0x3ef13e48bf463f80,0xbf623f7bbf220000
.quad 0x3f350000bf353f80,0x3f350000bf353f80,0x3f62be48bf223f80,0x3ef1bf7b3f460000,0x3f7bbec4bf0e3f80,0xbf7b3ec43f0ebf80,0x3f7fbf0ebef13f80,0x3dc93f55bf620000,0x3f6dbf35bec43f80,0x3f6dbf35bec43f80,0x3f46bf55be953f80,0xbf22bf0e3f750000,0x3f0ebf6dbe483f80,0xbf0e3f6d3e48bf80,0x3e95bf7bbdc93f80,0x3f753e48bf7f0000
.quad 0xbf803f80bf803f80,0xbf803f80bf803f80,0xbf463f55bf623f6d,0x3f22bf0e3ef1bec4,0xbe483ec4bf0e3f35,0x3e48bec43f0ebf35,0x3ef1be48bdc93ec4,0xbf623f7bbf7f3f6d,0x3f6dbf353ec40000,0x3f6dbf353ec40000,0x3f75bf7b3f46bec4,0xbe95be483f22bf6d,0x3f0ebf6d3f7bbf35,0xbf0e3f6dbf7b3f35,0xbdc9bf0e3f75bf6d,0x3f7fbf553e953ec4
.quad 0xbf3500003f35bf80,0xbf3500003f35bf80,0xbf7f3f0e3e95bf6d,0xbdc93f55bf753ec4,0xbf553f6dbe48bf35,0x3f55bf6d3e483f35,0xbe953f7bbf22bec4,0xbf753e483f46bf6d,0x3ec43f35bf6d0000,0x3ec43f35bf6d0000,0x3f623e48bf7f3ec4,0x3ef1bf7b3dc93f6d,0x3f7bbec4bf553f35,0xbf7b3ec43f55bf35,0x3f22bf55bef13f6d,0x3f463f0ebf62bec4
.quad 0xbf803f80bf803f80,0xbf803f80bf803f80,0xbef13f0ebf223f35,0x3f62bf553f46bf35,0x3f0ebec43e480000,0xbf0e3ec4be480000,0x3f7fbf7b3f62bf35,0x3dc93e48bef13f35,0x3ec4bf353f6dbf80,0x3ec4bf353f6dbf80,0xbf223e483e95bf35,0xbf463f7bbf753f35,0xbf7b3f6dbf0e0000,0x3f7bbf6d3f0e0000,0xbe953f55bf7f3f35,0xbf753f0e3dc9bf35
.quad 0x3f350000bf353f80,0x3f350000bf353f80,0x3f75bf553dc93f35,0xbe95bf0e3f7fbf35,0x3e48bf6d3f550000,0xbe483f6dbf550000,0xbf46be483f75bf35,0x3f22bf7b3e953f35,0xbf6d3f353ec4bf80,0xbf6d3f353ec4bf80,0xbdc93f7bbef1bf35,0x3f7fbe48bf623f35,0x3f553ec4bf7b0000,0xbf55bec43f7b0000,0x3f62bf0ebf463f35,0x3ef13f55bf22bf35
.quad 0xbf803f80bf803f80,0xbf803f80bf803f80,0xbdc93e48be953ec4,0x3f7fbf7b3f75bf6d,0x3f7bbf6d3f55bf35,0xbf7b3f6dbf553f35,0x3e95bf0e3f46bf6d,0x3f75bf553f22bec4,0xbf6d3f35bec40000,0xbf6d3f35bec40000,0xbef13f55bf7f3f6d,0x3f62bf0e3dc93ec4,0x3f55bec4be483f35,0xbf553ec43e48bf35,0x3f22bf7b3f62bec4,0x3f46be48bef13f6d
.quad 0xbf3500003f35bf80,0xbf3500003f35bf80,0xbf463f7bbef1bec4,0x3f223e48bf623f6d,0x3f0e3ec4bf7b3f35,0xbf0ebec43f7bbf35,0x3f62bf55bdc93f6d,0x3ef13f0ebf7f3ec4,0xbec4bf353f6d0000,0xbec4bf353f6d0000,0xbf753f0e3f22bf6d,0x3e953f55bf46bec4,0x3e483f6dbf0ebf35,0xbe48bf6d3f0e3f35,0x3f7fbe48bf753ec4,0x3dc93f7bbe95bf6d
.quad 0,0xbf803f80bf803f80,0xbf753f7bbf7f3f80,0x3e95be483dc90000,0x3f0ebec43e480000,0x3f55bf6d3f7bbf80,0x3f22bf553f75bf80,0xbf463f0ebe950000,0xbf6d3f35bec40000,0xbec43f35bf6d3f80,0xbdc93f0ebf623f80,0x3f7fbf553ef10000,0x3f7bbf6d3f0e0000,0xbe48bec43f55bf80,0xbef1be483f46bf80,0xbf623f7bbf220000
.quad 0xbf353f80bf350000,0x3f350000bf353f80,0x3f62be48bf223f80,0x3ef1bf7b3f460000,0x3e48bf6d3f550000,0xbf7b3ec43f0ebf80,0xbf7f3f0e3ef1bf80,0x3dc93f55bf620000,0x3ec43f35bf6d0000,0x3f6dbf35bec43f80,0x3f46bf55be953f80,0xbf22bf0e3f750000,0xbf55bec43f7b0000,0xbf0e3f6d3e48bf80,0xbe953f7b3dc9bf80,0x3f753e48bf7f0000
.quad 0,0xbf803f80bf803f80,0xbf463f55bf623f6d,0x3f22bf0e3ef1bec4,0x3f7bbf6d3f55bf35,0x3e48bec43f0ebf35,0xbef13e483dc9bec4,0xbf623f7bbf7f3f6d,0xbec43f35bf6d3f80,0x3f6dbf353ec40000,0x3f75bf7b3f46bec4,0xbe95be483f22bf6d,0xbf553ec43e48bf35,0xbf0e3f6dbf7b3f35,0x3dc93f0ebf753f6d,0x3f7fbf553e953ec4
.quad 0x3f35bf803f350000,0xbf3500003f35bf80,0xbf7f3f0e3e95bf6d,0xbdc93f55bf753ec4,0x3f0e3ec4bf7b3f35,0x3f55bf6d3e483f35,0x3e95bf7b3f223ec4,0xbf753e483f46bf6d,0xbf6d3f353ec4bf80,0x3ec43f35bf6d0000,0x3f623e48bf7f3ec4,0x3ef1bf7b3dc93f6d,0xbe48bf6d3f0e3f35,0xbf7b3ec43f55bf35,0xbf223f553ef1bf6d,0x3f463f0ebf62bec4
.quad 0,0xbf803f80bf803f80,0xbef13f0ebf223f35,0x3f62bf553f46bf35,0x3f55bf6d3f7bbf80,0xbf0e3ec4be480000,0xbf7f3f7bbf623f35,0x3dc93e48bef13f35,0x3f6dbf353ec40000,0x3ec4bf353f6dbf80,0xbf223e483e95bf35,0xbf463f7bbf753f35,0x3e483ec4bf553f80,0x3f7bbf6d3f0e0000,0x3e95bf553f7fbf35,0xbf753f0e3dc9bf35
.quad 0xbf353f80bf350000,0x3f350000bf353f80,0x3f75bf553dc93f35,0xbe95bf0e3f7fbf35,0xbf7b3ec43f0ebf80,0xbe483f6dbf550000,0x3f463e48bf753f35,0x3f22bf7b3e953f35,0xbec4bf353f6d0000,0xbf6d3f353ec4bf80,0xbdc93f7bbef1bf35,0x3f7fbe48bf623f35,0x3f0ebf6dbe483f80,0xbf55bec43f7b0000,0xbf623f0e3f46bf35,0x3ef13f55bf22bf35
.quad 0,0xbf803f80bf803f80,0xbdc93e48be953ec4,0x3f7fbf7b3f75bf6d,0x3e48bec43f0ebf35,0xbf7b3f6dbf553f35,0xbe953f0ebf463f6d,0x3f75bf553f22bec4,0x3ec4bf353f6dbf80,0xbf6d3f35bec40000,0xbef13f55bf7f3f6d,0x3f62bf0e3dc93ec4,0x3f0ebf6d3f7bbf35,0xbf553ec43e48bf35,0xbf223f7bbf623ec4,0x3f46be48bef13f6d
.quad 0x3f35bf803f350000,0xbf3500003f35bf80,0xbf463f7bbef1bec4,0x3f223e48bf623f6d,0x3f55bf6d3e483f35,0xbf0ebec43f7bbf35,0xbf623f553dc9bf6d,0x3ef13f0ebf7f3ec4,0x3f6dbf35bec43f80,0xbec4bf353f6d0000,0xbf753f0e3f22bf6d,0x3e953f55bf46bec4,0x3f7bbec4bf553f35,0xbe48bf6d3f0e3f35,0xbf7f3e483f75bec4,0x3dc93f7bbe95bf6d
.quad 0x8000800080008000,0xbf803f80bf803f80,0x3f75bf7b3f7fbf80,0x3e95be483dc90000,0xbf0e3ec4be488000,0x3f55bf6d3f7bbf80,0xbf223f55bf753f80,0xbf463f0ebe950000,0x3f6dbf353ec48000,0xbec43f35bf6d3f80,0x3dc9bf0e3f62bf80,0x3f7fbf553ef10000,0xbf7b3f6dbf0e8000,0xbe48bec43f55bf80,0x3ef13e48bf463f80,0xbf623f7bbf220000
.quad 0x3f35bf803f358000,0x3f350000bf353f80,0xbf623e483f22bf80,0x3ef1bf7b3f460000,0xbe483f6dbf558000,0xbf7b3ec43f0ebf80,0x3f7fbf0ebef13f80,0x3dc93f55bf620000,0xbec4bf353f6d8000,0x3f6dbf35bec43f80,0xbf463f553e95bf80,0xbf22bf0e3f750000,0x3f553ec4bf7b8000,0xbf0e3f6d3e48bf80,0x3e95bf7bbdc93f80,0x3f753e48bf7f0000
.quad 0x8000800080008000,0xbf803f80bf803f80,0x3f46bf553f62bf6d,0x3f22bf0e3ef1bec4,0xbf7b3f6dbf553f35,0x3e48bec43f0ebf35,0x3ef1be48bdc93ec4,0xbf623f7bbf7f3f6d,0x3ec4bf353f6dbf80,0x3f6dbf353ec40000,0xbf753f7bbf463ec4,0xbe95be483f22bf6d,0x3f55bec4be483f35,0xbf0e3f6dbf7b3f35,0xbdc9bf0e3f75bf6d,0x3f7fbf553e953ec4
.quad 0xbf353f80bf358000,0xbf3500003f35bf80,0x3f7fbf0ebe953f6d,0xbdc93f55bf753ec4,0xbf0ebec43f7bbf35,0x3f55bf6d3e483f35,0xbe953f7bbf22bec4,0xbf753e483f46bf6d,0x3f6dbf35bec43f80,0x3ec43f35bf6d0000,0xbf62be483f7fbec4,0x3ef1bf7b3dc93f6d,0x3e483f6dbf0ebf35,0xbf7b3ec43f55bf35,0x3f22bf55bef13f6d,0x3f463f0ebf62bec4
.quad 0x8000800080008000,0xbf803f80bf803f80,0x3ef1bf0e3f22bf35,0x3f62bf553f46bf35,0xbf553f6dbf7b3f80,0xbf0e3ec4be480000,0x3f7fbf7b3f62bf35,0x3dc93e48bef13f35,0xbf6d3f35bec48000,0x3ec4bf353f6dbf80,0x3f22be48be953f35,0xbf463f7bbf753f35,0xbe48bec43f55bf80,0x3f7bbf6d3f0e0000,0xbe953f55bf7f3f35,0xbf753f0e3dc9bf35
.quad 0x3f35bf803f358000,0x3f350000bf353f80,0xbf753f55bdc9bf35,0xbe95bf0e3f7fbf35,0x3f7bbec4bf0e3f80,0xbe483f6dbf550000,0xbf46be483f75bf35,0x3f22bf7b3e953f35,0x3ec43f35bf6d8000,0xbf6d3f353ec4bf80,0x3dc9bf7b3ef13f35,0x3f7fbe48bf623f35,0xbf0e3f6d3e48bf80,0xbf55bec43f7b0000,0x3f62bf0ebf463f35,0x3ef13f55bf22bf35
.quad 0x8000800080008000,0xbf803f80bf803f80,0x3dc9be483e95bec4,0x3f7fbf7b3f75bf6d,0xbe483ec4bf0e3f35,0xbf7b3f6dbf553f35,0x3e95bf0e3f46bf6d,0x3f75bf553f22bec4,0xbec43f35bf6d3f80,0xbf6d3f35bec40000,0x3ef1bf553f7fbf6d,0x3f62bf0e3dc93ec4,0xbf0e3f6dbf7b3f35,0xbf553ec43e48bf35,0x3f22bf7b3f62bec4,0x3f46be48bef13f6d
.quad 0xbf353f80bf358000,0xbf3500003f35bf80,0x3f46bf7b3ef13ec4,0x3f223e48bf623f6d,0xbf553f6dbe48bf35,0xbf0ebec43f7bbf35,0x3f62bf55bdc93f6d,0x3ef13f0ebf7f3ec4,0xbf6d3f353ec4bf80,0xbec4bf353f6d0000,0x3f75bf0ebf223f6d,0x3e953f55bf46bec4,0xbf7b3ec43f55bf35,0xbe48bf6d3f0e3f35,0x3f7fbe48bf753ec4,0x3dc93f7bbe95bf6d
.quad 0xbf803f80bf803f80,0,0x3f75bf7b3f7fbf80,0x3e95be483dc90000,0xbf553f6dbf7b3f80,0xbf0e3ec4be480000,0x3f22bf553f75bf80,0x3f46bf0e3e950000,0xbec43f35bf6d3f80,0xbf6d3f35bec40000,0x3dc9bf0e3f62bf80,0x3f7fbf553ef10000,0x3e483ec4bf553f80,0xbf7b3f6dbf0e0000,0xbef1be483f46bf80,0x3f62bf7b3f220000
.quad 0x3f350000bf353f80,0xbf353f80bf350000,0xbf623e483f22bf80,0x3ef1bf7b3f460000,0x3f7bbec4bf0e3f80,0xbe483f6dbf550000,0xbf7f3f0e3ef1bf80,0xbdc9bf553f620000,0x3f6dbf35bec43f80,0x3ec43f35bf6d0000,0xbf463f553e95bf80,0xbf22bf0e3f750000,0x3f0ebf6dbe483f80,0x3f553ec4bf7b0000,0xbe953f7b3dc9bf80,0xbf75be483f7f0000
.quad 0xbf803f80bf803f80,0,0x3f46bf553f62bf6d,0x3f22bf0e3ef1bec4,0xbe483ec4bf0e3f35,0xbf7b3f6dbf553f35,0xbef13e483dc9bec4,0x3f62bf7b3f7fbf6d,0x3f6dbf353ec40000,0xbec43f35bf6d3f80,0xbf753f7bbf463ec4,0xbe95be483f22bf6d,0x3f0ebf6d3f7bbf35,0x3f55bec4be483f35,0x3dc93f0ebf753f6d,0xbf7f3f55be95bec4
.quad 0xbf3500003f35bf80,0x3f35bf803f350000,0x3f7fbf0ebe953f6d,0xbdc93f55bf753ec4,0xbf553f6dbe48bf35,0xbf0ebec43f7bbf35,0x3e95bf7b3f223ec4,0x3f75be48bf463f6d,0x3ec43f35bf6d0000,0xbf6d3f353ec4bf80,0xbf62be483f7fbec4,0x3ef1bf7b3dc93f6d,0x3f7bbec4bf553f35,0x3e483f6dbf0ebf35,0xbf223f553ef1bf6d,0xbf46bf0e3f623ec4
.quad 0xbf803f80bf803f80,0,0x3ef1bf0e3f22bf35,0x3f62bf553f46bf35,0x3f0ebec43e480000,0xbf553f6dbf7b3f80,0xbf7f3f7bbf623f35,0xbdc9be483ef1bf35,0x3ec4bf353f6dbf80,0x3f6dbf353ec40000,0x3f22be48be953f35,0xbf463f7bbf753f35,0xbf7b3f6dbf0e0000,0xbe48bec43f55bf80,0x3e95bf553f7fbf35,0x3f75bf0ebdc93f35
.quad 0x3f350000bf353f80,0xbf353f80bf350000,0xbf753f55bdc9bf35,0xbe95bf0e3f7fbf35,0x3e48bf6d3f550000,0x3f7bbec4bf0e3f80,0x3f463e48bf753f35,0xbf223f7bbe95bf35,0xbf6d3f353ec4bf80,0xbec4bf353f6d0000,0x3dc9bf7b3ef13f35,0x3f7fbe48bf623f35,0x3f553ec4bf7b0000,0xbf0e3f6d3e48bf80,0xbf623f0e3f46bf35,0xbef1bf553f223f35
.quad 0xbf803f80bf803f80,0,0x3dc9be483e95bec4,0x3f7fbf7b3f75bf6d,0x3f7bbf6d3f55bf35,0xbe483ec4bf0e3f35,0xbe953f0ebf463f6d,0xbf753f55bf223ec4,0xbf6d3f35bec40000,0x3ec4bf353f6dbf80,0x3ef1bf553f7fbf6d,0x3f62bf0e3dc93ec4,0x3f55bec4be483f35,0xbf0e3f6dbf7b3f35,0xbf223f7bbf623ec4,0xbf463e483ef1bf6d
.quad 0xbf3500003f35bf80,0x3f35bf803f350000,0x3f46bf7b3ef13ec4,0x3f223e48bf623f6d,0x3f0e3ec4bf7b3f35,0xbf553f6dbe48bf35,0xbf623f553dc9bf6d,0xbef1bf0e3f7fbec4,0xbec4bf353f6d0000,0x3f6dbf35bec43f80,0x3f75bf0ebf223f6d,0x3e953f55bf46bec4,0x3e483f6dbf0ebf35,0xbf7b3ec43f55bf35,0xbf7f3e483f75bec4,0xbdc9bf7b3e953f6d
.quad 0xbf803f80bf803f80,0x8000800080008000,0x3f75bf7b3f7fbf80,0xbe953e48bdc98000,0xbf553f6dbf7b3f80,0x3f0ebec43e488000,0x3f22bf553f75bf80,0xbf463f0ebe958000,0xbec43f35bf6d3f80,0x3f6dbf353ec48000,0x3dc9bf0e3f62bf80,0xbf7f3f55bef18000,0x3e483ec4bf553f80,0x3f7bbf6d3f0e8000,0xbef1be483f46bf80,0xbf623f7bbf228000
.quad 0x3f350000bf353f80,0x3f35bf803f358000,0xbf623e483f22bf80,0xbef13f7bbf468000,0x3f7bbec4bf0e3f80,0x3e48bf6d3f558000,0xbf7f3f0e3ef1bf80,0x3dc93f55bf628000,0x3f6dbf35bec43f80,0xbec4bf353f6d8000,0xbf463f553e95bf80,0x3f223f0ebf758000,0x3f0ebf6dbe483f80,0xbf55bec43f7b8000,0xbe953f7b3dc9bf80,0x3f753e48bf7f8000
.quad 0xbf803f80bf803f80,0x8000800080008000,0x3f46bf553f62bf6d,0xbf223f0ebef13ec4,0xbe483ec4bf0e3f35,0x3f7bbf6d3f55bf35,0xbef13e483dc9bec4,0xbf623f7bbf7f3f6d,0x3f6dbf353ec40000,0x3ec4bf353f6dbf80,0xbf753f7bbf463ec4,0x3e953e48bf223f6d,0x3f0ebf6d3f7bbf35,0xbf553ec43e48bf35,0x3dc93f0ebf753f6d,0x3f7fbf553e953ec4
.quad 0xbf3500003f35bf80,0xbf353f80bf358000,0x3f7fbf0ebe953f6d,0x3dc9bf553f75bec4,0xbf553f6dbe48bf35,0x3f0e3ec4bf7b3f35,0x3e95bf7b3f223ec4,0xbf753e483f46bf6d,0x3ec43f35bf6d0000,0x3f6dbf35bec43f80,0xbf62be483f7fbec4,0xbef13f7bbdc9bf6d,0x3f7bbec4bf553f35,0xbe48bf6d3f0e3f35,0xbf223f553ef1bf6d,0x3f463f0ebf62bec4
.quad 0xbf803f80bf803f80,0x8000800080008000,0x3ef1bf0e3f22bf35,0xbf623f55bf463f35,0x3f0ebec43e480000,0x3f55bf6d3f7bbf80,0xbf7f3f7bbf623f35,0x3dc93e48bef13f35,0x3ec4bf353f6dbf80,0xbf6d3f35bec48000,0x3f22be48be953f35,0x3f46bf7b3f75bf35,0xbf7b3f6dbf0e0000,0x3e483ec4bf553f80,0x3e95bf553f7fbf35,0xbf753f0e3dc9bf35
.quad 0x3f350000bf353f80,0x3f35bf803f358000,0xbf753f55bdc9bf35,0x3e953f0ebf7f3f35,0x3e48bf6d3f550000,0xbf7b3ec43f0ebf80,0x3f463e48bf753f35,0x3f22bf7b3e953f35,0xbf6d3f353ec4bf80,0x3ec43f35bf6d8000,0x3dc9bf7b3ef13f35,0xbf7f3e483f62bf35,0x3f553ec4bf7b0000,0x3f0ebf6dbe483f80,0xbf623f0e3f46bf35,0x3ef13f55bf22bf35
.quad 0xbf803f80bf803f80,0x8000800080008000,0x3dc9be483e95bec4,0xbf7f3f7bbf753f6d,0x3f7bbf6d3f55bf35,0x3e48bec43f0ebf35,0xbe953f0ebf463f6d,0x3f75bf553f22bec4,0xbf6d3f35bec40000,0xbec43f35bf6d3f80,0x3ef1bf553f7fbf6d,0xbf623f0ebdc9bec4,0x3f55bec4be483f35,0x3f0ebf6d3f7bbf35,0xbf223f7bbf623ec4,0x3f46be48bef13f6d
.quad 0xbf3500003f35bf80,0xbf353f80bf358000,0x3f46bf7b3ef13ec4,0xbf22be483f62bf6d,0x3f0e3ec4bf7b3f35,0x3f55bf6d3e483f35,0xbf623f553dc9bf6d,0x3ef13f0ebf7f3ec4,0xbec4bf353f6d0000,0xbf6d3f353ec4bf80,0x3f75bf0ebf223f6d,0xbe95bf553f463ec4,0x3e483f6dbf0ebf35,0x3f7bbec4bf553f35,0xbf7f3e483f75bec4,0x3dc93f7bbe95bf6d
.quad 0xbf803f80bf803f80,0xbf803f80bf803f80,0x3f75bf7b3f7fbf80,0xbe953e48bdc90000,0xbf553f6dbf7b3f80,0x3f55bf6d3f7bbf80,0x3f22bf553f75bf80,0x3f46bf0e3e950000,0xbec43f35bf6d3f80,0xbec43f35bf6d3f80,0x3dc9bf0e3f62bf80,0xbf7f3f55bef10000,0x3e483ec4bf553f80,0xbe48bec43f55bf80,0xbef1be483f46bf80,0x3f62bf7b3f220000
.quad 0x3f350000bf353f80,0x3f350000bf353f80,0xbf623e483f22bf80,0xbef13f7bbf460000,0x3f7bbec4bf0e3f80,0xbf7b3ec43f0ebf80,0xbf7f3f0e3ef1bf80,0xbdc9bf553f620000,0x3f6dbf35bec43f80,0x3f6dbf35bec43f80,0xbf463f553e95bf80,0x3f223f0ebf750000,0x3f0ebf6dbe483f80,0xbf0e3f6d3e48bf80,0xbe953f7b3dc9bf80,0xbf75be483f7f0000
.quad 0xbf803f80bf803f80,0xbf803f80bf803f80,0x3f46bf553f62bf6d,0xbf223f0ebef13ec4,0xbe483ec4bf0e3f35,0x3e48bec43f0ebf35,0xbef13e483dc9bec4,0x3f62bf7b3f7fbf6d,0x3f6dbf353ec40000,0x3f6dbf353ec40000,0xbf753f7bbf463ec4,0x3e953e48bf223f6d,0x3f0ebf6d3f7bbf35,0xbf0e3f6dbf7b3f35,0x3dc93f0ebf753f6d,0xbf7f3f55be95bec4
.quad 0xbf3500003f35bf80,0xbf3500003f35bf80,0x3f7fbf0ebe953f6d,0x3dc9bf553f75bec4,0xbf553f6dbe48bf35,0x3f55bf6d3e483f35,0x3e95bf7b3f223ec4,0x3f75be48bf463f6d,0x3ec43f35bf6d0000,0x3ec43f35bf6d0000,0xbf62be483f7fbec4,0xbef13f7bbdc9bf6d,0x3f7bbec4bf553f35,0xbf7b3ec43f55bf35,0xbf223f553ef1bf6d,0xbf46bf0e3f623ec4
.quad 0xbf803f80bf803f80,0xbf803f80bf803f80,0x3ef1bf0e3f22bf35,0xbf623f55bf463f35,0x3f0ebec43e480000,0xbf0e3ec4be480000,0xbf7f3f7bbf623f35,0xbdc9be483ef1bf35,0x3ec4bf353f6dbf80,0x3ec4bf353f6dbf80,0x3f22be48be953f35,0x3f46bf7b3f75bf35,0xbf7b3f6dbf0e0000,0x3f7bbf6d3f0e0000,0x3e95bf553f7fbf35,0x3f75bf0ebdc93f35
.quad 0x3f350000bf353f80,0x3f350000bf353f80,0xbf753f55bdc9bf35,0x3e953f0ebf7f3f35,0x3e48bf6d3f550000,0xbe483f6dbf550000,0x3f463e48bf753f35,0xbf223f7bbe95bf35,0xbf6d3f353ec4bf80,0xbf6d3f353ec4bf80,0x3dc9bf7b3ef13f35,0xbf7f3e483f62bf35,0x3f553ec4bf7b0000,0xbf55bec43f7b0000,0xbf623f0e3f46bf35,0xbef1bf553f223f35
.quad 0xbf803f80bf803f80,0xbf803f80bf803f80,0x3dc9be483e95bec4,0xbf7f3f7bbf753f6d,0x3f7bbf6d3f55bf35,0xbf7b3f6dbf553f35,0xbe953f0ebf463f6d,0xbf753f55bf223ec4,0xbf6d3f35bec40000,0xbf6d3f35bec40000,0x3ef1bf553f7fbf6d,0xbf623f0ebdc9bec4,0x3f55bec4be483f35,0xbf553ec43e48bf35,0xbf223f7bbf623ec4,0xbf463e483ef1bf6d
.quad 0xbf3500003f35bf80,0xbf3500003f35bf80,0x3f46bf7b3ef13ec4,0xbf22be483f62bf6d,0x3f0e3ec4bf7b3f35,0xbf0ebec43f7bbf35,0xbf623f553dc9bf6d,0xbef1bf0e3f7fbec4,0xbec4bf353f6d0000,0xbec4bf353f6d0000,0x3f75bf0ebf223f6d,0xbe95bf553f463ec4,0x3e483f6dbf0ebf35,0xbe48bf6d3f0e3f35,0xbf7f3e483f75bec4,0xbdc9bf7b3e953f6d
.quad 0,0xbf803f80bf803f80,0x3f75bf7b3f7fbf80,0xbe953e48bdc90000,0x3f0ebec43e480000,0x3f55bf6d3f7bbf80,0xbf223f55bf753f80,0x3f46bf0e3e950000,0xbf6d3f35bec40000,0xbec43f35bf6d3f80,0x3dc9bf0e3f62bf80,0xbf7f3f55bef10000,0x3f7bbf6d3f0e0000,0xbe48bec43f55bf80,0x3ef13e48bf463f80,0x3f62bf7b3f220000
.quad 0xbf353f80bf350000,0x3f350000bf353f80,0xbf623e483f22bf80,0xbef13f7bbf460000,0x3e48bf6d3f550000,0xbf7b3ec43f0ebf80,0x3f7fbf0ebef13f80,0xbdc9bf553f620000,0x3ec43f35bf6d0000,0x3f6dbf35bec43f80,0xbf463f553e95bf80,0x3f223f0ebf750000,0xbf55bec43f7b0000,0xbf0e3f6d3e48bf80,0x3e95bf7bbdc93f80,0xbf75be483f7f0000
.quad 0,0xbf803f80bf803f80,0x3f46bf553f62bf6d,0xbf223f0ebef13ec4,0x3f7bbf6d3f55bf35,0x3e48bec43f0ebf35,0x3ef1be48bdc93ec4,0x3f62bf7b3f7fbf6d,0xbec43f35bf6d3f80,0x3f6dbf353ec40000,0xbf753f7bbf463ec4,0x3e953e48bf223f6d,0xbf553ec43e48bf35,0xbf0e3f6dbf7b3f35,0xbdc9bf0e3f75bf6d,0xbf7f3f55be95bec4
.quad 0x3f35bf803f350000,0xbf3500003f35bf80,0x3f7fbf0ebe953f6d,0x3dc9bf553f75bec4,0x3f0e3ec4bf7b3f35,0x3f55bf6d3e483f35,0xbe953f7bbf22bec4,0x3f75be48bf463f6d,0xbf6d3f353ec4bf80,0x3ec43f35bf6d0000,0xbf62be483f7fbec4,0xbef13f7bbdc9bf6d,0xbe48bf6d3f0e3f35,0xbf7b3ec43f55bf35,0x3f22bf55bef13f6d,0xbf46bf0e3f623ec4
.quad 0,0xbf803f80bf803f80,0x3ef1bf0e3f22bf35,0xbf623f55bf463f35,0x3f55bf6d3f7bbf80,0xbf0e3ec4be480000,0x3f7fbf7b3f62bf35,0xbdc9be483ef1bf35,0x3f6dbf353ec40000,0x3ec4bf353f6dbf80,0x3f22be48be953f35,0x3f46bf7b3f75bf35,0x3e483ec4bf553f80,0x3f7bbf6d3f0e0000,0xbe953f55bf7f3f35,0x3f75bf0ebdc93f35
.quad 0xbf353f80bf350000,0x3f350000bf353f80,0xbf753f55bdc9bf35,0x3e953f0ebf7f3f35,0xbf7b3ec43f0ebf80,0xbe483f6dbf550000,0xbf46be483f75bf35,0xbf223f7bbe95bf35,0xbec4bf353f6d0000,0xbf6d3f353ec4bf80,0x3dc9bf7b3ef13f35,0xbf7f3e483f62bf35,0x3f0ebf6dbe483f80,0xbf55bec43f7b0000,0x3f62bf0ebf463f35,0xbef1bf553f223f35
.quad 0,0xbf803f80bf803f80,0x3dc9be483e95bec4,0xbf7f3f7bbf753f6d,0x3e48bec43f0ebf35,0xbf7b3f6dbf553f35,0x3e95bf0e3f46bf6d,0xbf753f55bf223ec4,0x3ec4bf353f6dbf80,0xbf6d3f35bec40000,0x3ef1bf553f7fbf6d,0xbf623f0ebdc9bec4,0x3f0ebf6d3f7bbf35,0xbf553ec43e48bf35,0x3f22bf7b3f62bec4,0xbf463e483ef1bf6d
.quad 0x3f35bf803f350000,0xbf3500003f35bf80,0x3f46bf7b3ef13ec4,0xbf22be483f62bf6d,0x3f55bf6d3e483f35,0xbf0ebec43f7bbf35,0x3f62bf55bdc93f6d,0xbef1bf0e3f7fbec4,0x3f6dbf35bec43f80,0xbec4bf353f6d0000,0x3f75bf0ebf223f6d,0xbe95bf553f463ec4,0x3f7bbec4bf553f35,0xbe48bf6d3f0e3f35,0x3f7fbe48bf753ec4,0xbdc9bf7b3e953f6d
.quad 0x8000800080008000,0xbf803f80bf803f80,0xbf753f7bbf7f3f80,0xbe953e48bdc90000,0xbf0e3ec4be488000,0x3f55bf6d3f7bbf80,0x3f22bf553f75bf80,0x3f46bf0e3e950000,0x3f6dbf353ec48000,0xbec43f35bf6d3f80,0xbdc93f0ebf623f80,0xbf7f3f55bef10000,0xbf7b3f6dbf0e8000,0xbe48bec43f55bf80,0xbef1be483f46bf80,0x3f62bf7b3f220000
.quad 0x3f35bf803f358000,0x3f350000bf353f80,0x3f62be48bf223f80,0xbef13f7bbf460000,0xbe483f6dbf558000,0xbf7b3ec43f0ebf80,0xbf7f3f0e3ef1bf80,0xbdc9bf553f620000,0xbec4bf353f6d8000,0x3f6dbf35bec43f80,0x3f46bf55be953f80,0x3f223f0ebf750000,0x3f553ec4bf7b8000,0xbf0e3f6d3e48bf80,0xbe953f7b3dc9bf80,0xbf75be483f7f0000
.quad 0x8000800080008000,0xbf803f80bf803f80,0xbf463f55bf623f6d,0xbf223f0ebef13ec4,0xbf7b3f6dbf553f35,0x3e48bec43f0ebf35,0xbef13e483dc9bec4,0x3f62bf7b3f7fbf6d,0x3ec4bf353f6dbf80,0x3f6dbf353ec40000,0x3f75bf7b3f46bec4,0x3e953e48bf223f6d,0x3f55bec4be483f35,0xbf0e3f6dbf7b3f35,0x3dc93f0ebf753f6d,0xbf7f3f55be95bec4
.quad 0xbf353f80bf358000,0xbf3500003f35bf80,0xbf7f3f0e3e95bf6d,0x3dc9bf553f75bec4,0xbf0ebec43f7bbf35,0x3f55bf6d3e483f35,0x3e95bf7b3f223ec4,0x3f75be48bf463f6d,0x3f6dbf35bec43f80,0x3ec43f35bf6d0000,0x3f623e48bf7f3ec4,0xbef13f7bbdc9bf6d,0x3e483f6dbf0ebf35,0xbf7b3ec43f55bf35,0xbf223f553ef1bf6d,0xbf46bf0e3f623ec4
.quad 0x8000800080008000,0xbf803f80bf803f80,0xbef13f0ebf223f35,0xbf623f55bf463f35,0xbf553f6dbf7b3f80,0xbf0e3ec4be480000,0xbf7f3f7bbf623f35,0xbdc9be483ef1bf35,0xbf6d3f35bec48000,0x3ec4bf353f6dbf80,0xbf223e483e95bf35,0x3f46bf7b3f75bf35,0xbe48bec43f55bf80,0x3f7bbf6d3f0e0000,0x3e95bf553f7fbf35,0x3f75bf0ebdc93f35
.quad 0x3f35bf803f358000,0x3f350000bf353f80,0x3f75bf553dc93f35,0x3e953f0ebf7f3f35,0x3f7bbec4bf0e3f80,0xbe483f6dbf550000,0x3f463e48bf753f35,0xbf223f7bbe95bf35,0x3ec43f35bf6d8000,0xbf6d3f353ec4bf80,0xbdc93f7bbef1bf35,0xbf7f3e483f62bf35,0xbf0e3f6d3e48bf80,0xbf55bec43f7b0000,0xbf623f0e3f46bf35,0xbef1bf553f223f35
.quad 0x8000800080008000,0xbf803f80bf803f80,0xbdc93e48be953ec4,0xbf7f3f7bbf753f6d,0xbe483ec4bf0e3f35,0xbf7b3f6dbf553f35,0xbe953f0ebf463f6d,0xbf753f55bf223ec4,0xbec43f35bf6d3f80,0xbf6d3f35bec40000,0xbef13f55bf7f3f6d,0xbf623f0ebdc9bec4,0xbf0e3f6dbf7b3f35,0xbf553ec43e48bf35,0xbf223f7bbf623ec4,0xbf463e483ef1bf6d
.quad 0xbf353f80bf358000,0xbf3500003f35bf80,0xbf463f7bbef1bec4,0xbf22be483f62bf6d,0xbf553f6dbe48bf35,0xbf0ebec43f7bbf35,0xbf623f553dc9bf6d,0xbef1bf0e3f7fbec4,0xbf6d3f353ec4bf80,0xbec4bf353f6d0000,0xbf753f0e3f22bf6d,0xbe95bf553f463ec4,0xbf7b3ec43f55bf35,0xbe48bf6d3f0e3f35,0xbf7f3e483f75bec4,0xbdc9bf7b3e953f6d
.quad 0x3f7ec46d3f800000,0x3f74fa0b3f7b14be,0x3f7eb0693f800000,0x3f74484b3f7ac516,0x3f7e9bc93f800000,0x3f73913f3f7a7302,0x3f7e868b3f800000,0x3f72d4eb3f7a1e84,0x3f7e70b03f800000,0x3f7213523f79c79d,0x3f7e5a383f800000,0x3f714c7a3f796e4e,0x3f7e43233f800000,0x3f7080663f791298,0x3f7e2b723f800000,0x3f6faf1b3f78b47b
.quad 0x3f7e13243f800000,0x3f6ed89e3f7853f8,0x3f7dfa383f800000,0x3f6dfcf23f77f110,0x3f7de0b13f800000,0x3f6d1c1d3f778bc5,0x3f7dc68c3f800000,0x3f6c36243f772417,0x3f7dabcc3f800000,0x3f6b4b0c3f76ba07,0x3f7d906e3f800000,0x3f6a5ad93f764d97,0x3f7d74743f800000,0x3f6965913f75dec6,0x3f7d57de3f800000,0x3f686b393f756d97
.quad 0x3f61c5983f6c835e,0x3f45e4033f54db31,0x3f5fe4e93f6b4b0c,0x3f425b893f5233c6,0x3f5df6be3f6a09a7,0x3f3ebc1b3f4f7a1f,0x3f5bfb343f68bf3c,0x3f3b06293f4cae79,0x3f59f26a3f676bd8,0x3f373a233f49d112,0x3f57dc7f3f660f88,0x3f33587a3f46e22a,0x3f55b9933f64aa59,0x3f2f61a53f43e200,0x3f5389c73f633c5a,0x3f2b561b3f40d0da
.quad 0x3f514d3d3f61c598,0x3f2736563f3daef9,0x3f4f04173f604621,0x3f2302d33f3a7ca4,0x3f4cae793f5ebe05,0x3f1ebc123f373a23,0x3f4a4c873f5d2d53,0x3f1a62933f33e7bc,0x3f47de653f5b941a,0x3f15f6d93f3085bb,0x3f4564393f59f26a,0x3f11796b3f2d1469,0x3f42de293f584853,0x3f0cead03f299415,0x3f404c5c3f5695e5,0x3f084b923f26050a
.quad 0x3f2267993f3504f3,0x3ef15aea3f0e39da,0x3f1ce11f3f3085bb,0x3ee1fb6a3f07a136,0x3f173c073f2beb4a,0x3ed25a093f00e7e4,0x3f11796b3f273656,0x3ec27b553ef41f07,0x3f0b9a6b3f226799,0x3eb263ef3ee63375,0x3f05a02c3f1d7fd1,0x3ea218873ed8106b,0x3eff17b23f187fc0,0x3e919ddd3ec9b953,0x3ef2bd433f13682a,0x3e80f8c03ebb31a0
.quad 0x3ee633753f0e39da,0x3e605c133eac7cd4,0x3ed97cb93f08f59b,0x3e3e853e3e9d9e78,0x3ecc9b8b3f039c3d,0x3e1c76de3e8e9a22,0x3ebf926f3efc5d27,0x3df475c03e7ee6e1,0x3eb263ef3ef15aea,0x3dafb6803e605c13,0x3ea5129f3ee63375,0x3d55880e3e419b37,0x3e97a1173edae880,0x3c96c9b63e22abb6,0x3e8a11f73ecf7bca,0xbc7b514b3e039502
.quad 0x3e94a0313ec3ef15,0x3dc8bd363e47c5c2,0x3e80f8c03eb263ef,0x3d55880e3e1c76de,0x3e5a39973ea09ae5,0x3bc90f883de1bc2e,0x3e3228d43e8e9a22,0xbd2351cb3d8a200a,0x3e09cf863e78cfcc,0xbdafb6803cc90ab0,0x3dc27c393e541501,0xbe06b26ebc96c9b6,0x3d6214693e2f10a2,0xbe354098bd7b2b74,0x3c7b514b3e09cf86,0xbe636c83bdd53db9
.quad 0xbcc90ab03dc8bd36,0xbe888e93be164083,0xbd83db0a3d7b2b74,0xbe9f1cdfbe419b37,0xbdd53db93cc90ab0,0xbeb554ecbe6c9a7f,0xbe1324cabc490e90,0xbecb2aaebe8b9507,0xbe3b6ecfbd48fb30,0xbee0924fbea09ae5,0xbe636c83bdafb680,0xbef58035beb554ec,0xbe8586cebdfab273,0xbf04f484bec9b953,0xbe9920febe22abb6,0xbf0ee0dbbeddbe79
.quad 0xbdc8bd3600000000,0xbe94a031be47c5c2,0xbe195be0bd48fb30,0xbeb0eacbbe7ee6e1,0xbe4dee60bdc8bd36,0xbecc9b8bbe9aa086,0xbe80f8c0be164083,0xbee79a5dbeb554ec,0xbe9aa086be47c5c2,0xbf00e7e4becf7bca,0xbeb3dca5be78cfcc,0xbf0d9281bee900b7,0xbecc9b8bbe94a031,0xbf19c200bf00e7e4,0xbee4cbfebeac7cd4,0xbf256bcbbf0cead0
.quad 0xbefc5d27bec3ef15,0xbf3085bbbf187fc0,0xbf099f4ebedae880,0xbf3b0629bf239da9,0xbf14b039bef15aea,0xbf44e3f5bf2e3bde,0xbf1f599fbf039c3d,0xbf4e1689bf385216,0xbf299415bf0e39da,0xbf5695e5bf41d870,0xbf33587abf187fc0,0xbf5e5aa6bf4ac77f,0xbf3ca003bf226799,0xbf655e0bbf531849,0xbf456439bf2beb4a,0xbf6b99fbbf5ac450
.quad 0xbef15aeabec3ef15,0xbf226799bf0e39da,0xbf06f686bee0924f,0xbf2ff3e6bf1c420c,0xbf14b039befc5d27,0xbf3ca003bf299415,0xbf21cbfbbf0b9a6b,0xbf485bcabf36206c,0xbf2e3bdebf187fc0,0xbf531849bf41d870,0xbf39f2acbf24d225,0xbf5cc7d1bf4cae79,0xbf44e3f5bf3085bb,0xbf655e0bbf5695e5,0xbf4f0417bf3b8f3b,0xbf6cd007bf5f8327
.quad 0xbf584853bf45e403,0xbf731447bf676bd8,0xbf60a6cfbf4f7a1f,0xbf7822d1bf6e46be,0xbf6816a8bf584853,0xbf7bf531bf740bdd,0xbf6e8ff8bf604621,0xbf7e868bbf78b47b,0xbf740bddbf676bd8,0xbf7fd397bf7c3b28,0xbf788486bf6db293,0xbf7fdaafbf7e9bc9,0xbf7bf531bf731447,0xbf7e9bc9bf7fd397,0xbf7e5a38bf778bc5,0xbf7c187abf7fe129
.quad 0xbf45e403bf3504f3,0xbf61c598bf54db31,0xbf51c0c2bf41d870,0xbf6afb8cbf5f8327,0xbf5c61c7bf4d9f02,0xbf7294f8bf68bf3c,0xbf65b710bf584853,0xbf788486bf708066,0xbf6db293bf61c598,0xbf7cbfc9bf76ba07,0xbf74484bbf6a09a7,0xbf7f3f54bf7b61fc,0xbf796e4ebf710908,0xbf7ffec4bf7e70b0,0xbf7d1cddbf76ba07,0xbf7efcc9bf7fe129
.quad 0xbf7f4e6dbf7b14be,0xbf7c3b28bf7fb10f,0xbf7fffb1bf7e1324,0xbf77beb7bf7de0b1,0xbf7f2f9dbf7fb10f,0xbf718f57bf7a7302,0xbf7cdf6cbf7fec43,0xbf69b7e4bf756d97,0xbf791298bf7ec46d,0xbf604621bf6ed89e,0xbf73ced9bf7c3b28,0xbf554aa4bf66becc,0xbf6d1c1dbf7853f8,0xbf48d8b3bf5d2d53,0xbf650479bf731447,0xbf3b0629bf5233c6
.quad 0xbf74fa0bbf6c835e,0xbf7ec46dbf7b14be,0xbf7a9c59bf740bdd,0xbf7fffb1bf7e9bc9,0xbf7e4323bf79c79d,0xbf7eea9dbf7ffb11,0xbf7fe705bf7dabcc,0xbf7b87b2bf7f2f9d,0xbf7f84abbf7fb10f,0xbf75dec6bf7c3b28,0xbf7d1cddbf7fd397,0xbf6dfcf2bf772417,0xbf78b47bbf7e1324,0xbf63f473bf6ff573,0xbf725470bf7a7302,0xbf57dc7fbf66becc
.quad 0xbf6a09a7bf74fa0b,0xbf49d112bf5b941a,0xbf5fe4e9bf6db293,0xbf39f2acbf4e8d90,0xbf53fac3bf64aa59,0xbf286605bf3fc767,0xbf466354bf59f26a,0xbf1553b7bf2f61a5,0xbf373a23bf4d9f02,0xbf00e7e4bf1d7fd1,0xbf269de3bf3fc767,0xbed6a399bf0a48ad,0xbf14b039bf3085bb,0xbea986c4beebcbbb,0xbf019573bf1ff6cb,0xbe75c35abec1071e
.quad 0x3dc8bd3600000000,0x3e94a0313e47c5c2,0x3dcefdb700000000,0x3e9920fe3e4dee60,0x3dd53db900000000,0x3e9d9e783e541501,0x3ddb7d3700000000,0x3ea218873e5a3997,0x3de1bc2e00000000,0x3ea68f123e605c13,0x3de7fa9a00000000,0x3eab02013e667c66,0x3dee387600000000,0x3eaf713a3e6c9a7f,0x3df475c000000000,0x3eb3dca53e72b651
.quad 0x3dfab27300000000,0x3eb8442a3e78cfcc,0x3e00774500000000,0x3ebca7af3e7ee6e1,0x3e03950200000000,0x3ec1071e3e827dc0,0x3e06b26e00000000,0x3ec5625c3e8586ce,0x3e09cf8600000000,0x3ec9b9533e888e93,0x3e0cec4a00000000,0x3ece0bea3e8b9507,0x3e1008b700000000,0x3ed25a093e8e9a22,0x3e1324ca00000000,0x3ed6a3993e919ddd
.quad 0x3ef15aea3ec3ef15,0x3f2267993f0e39da,0x3ef840c83ec9b953,0x3f269de33f121eb0,0x3eff17b23ecf7bca,0x3f2ac0823f15f6d9,0x3f02ef9f3ed53641,0x3f2ecef73f19c200,0x3f064b823edae880,0x3f32c8c93f1d7fd1,0x3f099f4e3ee0924f,0x3f36ad7f3f212ff9,0x3f0cead03ee63375,0x3f3a7ca43f24d225,0x3f102dd53eebcbbb,0x3f3e35c53f286605
.quad 0x3f13682a3ef15aea,0x3f41d8703f2beb4a,0x3f16999f3ef6e0cb,0x3f4564393f2f61a5,0x3f19c2003efc5d27,0x3f48d8b33f32c8c9,0x3f1ce11f3f00e7e4,0x3f4c35783f36206c,0x3f1ff6cb3f039c3d,0x3f4f7a1f3f396842,0x3f2302d33f064b82,0x3f52a6493f3ca003,0x3f26050a3f08f59b,0x3f55b9933f3fc767,0x3f28fd413f0b9a6b,0x3f58b3a13f42de29
.quad 0x3f45e4033f3504f3,0x3f61c5983f54db31,0x3f4a4c873f396842,0x3f65b7103f591e6a,0x3f4e8d903f3daef9,0x3f6965913f5d2d53,0x3f52a6493f41d870,0x3f6cd0073f6106f2,0x3f5695e53f45e403,0x3f6ff5733f64aa59,0x3f5a5ba03f49d112,0x3f72d4eb3f6816a8,0x3f5df6be3f4d9f02,0x3f756d973f6b4b0c,0x3f61668a3f514d3d,0x3f77beb73f6e46be
.quad 0x3f64aa593f54db31,0x3f79c79d3f710908,0x3f67c1873f584853,0x3f7b87b23f73913f,0x3f6aab7b3f5b941a,0x3f7cfe733f75dec6,0x3f6d67a13f5ebe05,0x3f7e2b723f77f110,0x3f6ff5733f61c598,0x3f7f0e583f79c79d,0x3f7254703f64aa59,0x3f7fa6e33f7b61fc,0x3f7484223f676bd8,0x3f7ff4e63f7cbfc9,0x3f76841b3f6a09a7,0x3f7ff84a3f7de0b1
.quad 0x3f74fa0b3f6c835e,0x3f7ec46d3f7b14be,0x3f77beb73f6ff573,0x3f7fa6e33f7cfe73,0x3f7a1e843f731447,0x3f7ffec43f7e70b0,0x3f7c187a3f75dec6,0x3f7fcbe23f7f6ac7,0x3f7dabcc3f7853f8,0x3f7f0e583f7fec43,0x3f7ed7d43f7a7302,0x3f7dc68c3f7ff4e6,0x3f7f9c183f7c3b28,0x3f7bf5313f7f84ab,0x3f7ff84a3f7dabcc,0x3f799b433f7e9bc9
.quad 0x3f7fec433f7ec46d,0x3f76ba073f7d3aac,0x3f7f78083f7f84ab,0x3f73530e3f7b61fc,0x3f7e9bc93f7fec43,0x3f6f68303f791298,0x3f7d57de3f7ffb11,0x3f6afb8c3f764d97,0x3f7baccd3f7fb10f,0x3f660f883f731447,0x3f799b433f7f0e58,0x3f60a6cf3f6f6830,0x3f7724173f7e1324,0x3f5ac4503f6b4b0c,0x3f74484b3f7cbfc9,0x3f546b3b3f66becc
.quad 0x3f7ec46d3f800000,0x3f74fa0b3f7b14be,0x3f7d1cdd3f7fb10f,0x3f703b373f77f110,0x3f7ac5163f7ec46d,0x3f6aab7b3f740bdd,0x3f77beb73f7d3aac,0x3f644fac3f6f6830,0x3f740bdd3f7b14be,0x3f5d2d533f6a09a7,0x3f6faf1b3f7853f8,0x3f554aa43f63f473,0x3f6aab7b3f74fa0b,0x3f4cae793f5d2d53,0x3f6504793f710908,0x3f4360513f55b993
.quad 0x3f5ebe053f6c835e,0x3f3968423f4d9f02,0x3f57dc7f3f676bd8,0x3f2ecef73f44e3f5,0x3f5064af3f61c598,0x3f239da93f3b8f3b,0x3f485bca3f5b941a,0x3f17de123f31a81d,0x3f3fc7673f54db31,0x3f0b9a6b3f273656,0x3f36ad7f3f4d9f02,0x3efdbabb3f1c420c,0x3f2d14693f45e403,0x3ee363fa3f10d3cd,0x3f2302d33f3daef9,0x3ec8477c3f04f484
.quad 0x3f61c5983f6c835e,0x3f45e4033f54db31,0x3f5988ad3f660f88,0x3f39f2ac3f4ac77f,0x3f5064af3f5ebe05,0x3f2d14693f3fc767,0x3f4663543f5695e5,0x3f1f599f3f33e7bc,0x3f3b8f3b3f4d9f02,0x3f10d3cd3f273656,0x3f2ff3e63f43e200,0x3f0195733f19c200,0x3f239da93f396842,0x3ee363fa3f0b9a6b,0x3f16999f3f2e3bde,0x3ec27b553ef9a02d
.quad 0x3f08f59b3f226799,0x3ea09ae53edae880,0x3ef580353f15f6d9,0x3e7bdba43ebb31a0,0x3ed8106b3f08f59b,0x3e3540983e9aa086,0x3eb9bb1e3ef6e0cb,0x3ddb7d373e72b651,0x3e9aa0863edae880,0x3d16c32c3e2f10a2,0x3e75c35a3ebe1d4a,0xbd0a342f3dd53db9,0x3e3540983ea09ae5,0xbdd53db93d16c32c,0x3de7fa9a3e827dc0,0xbe3228d4bcfb49ba
.quad 0x3f2267993f3504f3,0x3ef15aea3f0e39da,0x3f12c39a3f273656,0x3ecb2aae3ef9a02d,0x3f0242b13f187fc0,0x3ea395c53ed53641,0x3ee1fb6a3f08f59b,0x3e75c35a3eaf713a,0x3ebe1d4a3ef15aea,0x3e22abb63e888e93,0x3e9920fe3ecf7bca,0x3d9cecf93e419b37,0x3e667c663eac7cd4,0xbbc90f883de1bc2e,0x3e195be03e888e93,0xbdb5f8da3cfb49ba
.quad 0x3d96a9053e47c5c2,0xbe2f10a2bd48fb30,0xbb490fc63dfab273,0xbe80f8c0be039502,0xbda3308c3d48fb30,0xbea986c4be541501,0xbe1f917bbcc90ab0,0xbed0eb2abe919ddd,0xbe6c9a7fbdc8bd36,0xbef6e0cbbeb8442a,0xbe9c1fafbe2f10a2,0xbf0d9281beddbe79,0xbec1071ebe78cfcc,0xbf1ebc12bf00e7e4,0xbee4cbfebea09ae5,0xbf2ecef7bf121eb0
.quad 0x3e94a0313ec3ef15,0x3dc8bd363e47c5c2,0x3e5101f13e9aa086,0x3b490fc63dd53db9,0x3dee38763e605c13,0xbdbc3ac33c490e90,0x3ce22a7a3e09cf86,0xbe3e853ebda3308c,0xbd7b2b743d48fb30,0xbe8e9a22be2f10a2,0xbe195be0bd16c32c,0xbebca7afbe8586ce,0xbe72b651bdfab273,0xbee900b7beb263ef,0xbea5129fbe541501,0xbf099f4ebeddbe79
.quad 0xbecf7bcabe94a031,0xbf1d7fd1bf039c3d,0xbef840c8bebe1d4a,0xbf2ff3e6bf173c07,0xbf0f8784bee63375,0xbf40d0dabf299415,0xbf21cbfbbf064b82,0xbf4fefa8bf3a7ca4,0xbf32c8c9bf187fc0,0xbf5d2d53bf49d112,0xbf425b89bf299415,0xbf686b39bf577026,0xbf5064afbf396842,0xbf718f57bf633c5a,0xbf5cc7d1bf47de65,0xbf788486bf6d1c1d
.quad 0x3f8000003f800000,0x3f8000003f800000,0x3f7eb0693f7ec46d,0x3f7e868b3f7e9bc9,0x3f7ac5163f7b14be,0x3f7a1e843f7a7302,0x3f74484b3f74fa0b,0x3f72d4eb3f73913f,0x3f6b4b0c3f6c835e,0x3f68bf3c3f6a09a7,0x3f5fe4e93f61c598,0x3f5bfb343f5df6be,0x3f5233c63f54db31,0x3f4cae793f4f7a1f,0x3f425b893f45e403,0x3f3b06293f3ebc1b
.quad 0x3f3085bb3f3504f3,0x3f2736563f2beb4a,0x3f1ce11f3f226799,0x3f11796b3f173c07,0x3f07a1363f0e39da,0x3ef41f073f00e7e4,0x3ee1fb6a3ef15aea,0x3ec27b553ed25a09,0x3eb263ef3ec3ef15,0x3e8e9a223ea09ae5,0x3e80f8c03e94a031,0x3e3228d43e5a3997,0x3e1c76de3e47c5c2,0x3d8a200a3de1bc2e,0x3d55880e3dc8bd36,0xbd2351cb3bc90f88
.quad 0x3f8000003f800000,0x3f8000003f800000,0x3f7e5a383f7e70b0,0x3f7e2b723f7e4323,0x3f796e4e3f79c79d,0x3f78b47b3f791298,0x3f714c7a3f721352,0x3f6faf1b3f708066,0x3f660f883f676bd8,0x3f633c5a3f64aa59,0x3f57dc7f3f59f26a,0x3f5389c73f55b993,0x3f46e22a3f49d112,0x3f40d0da3f43e200,0x3f33587a3f373a23,0x3f2b561b3f2f61a5
.quad 0x3f1d7fd13f226799,0x3f13682a3f187fc0,0x3f05a02c3f0b9a6b,0x3ef2bd433eff17b2,0x3ed8106b3ee63375,0x3ebb31a03ec9b953,0x3ea218873eb263ef,0x3e80f8c03e919ddd,0x3e5415013e78cfcc,0x3e09cf863e2f10a2,0x3dc27c393e09cf86,0x3c7b514b3d621469,0xbc96c9b63cc90ab0,0xbdd53db9bd7b2b74,0xbe06b26ebdafb680,0xbe636c83be354098
.quad 0x3f8000003f800000,0x3f8000003f800000,0x3f7dfa383f7e1324,0x3f7dc68c3f7de0b1,0x3f77f1103f7853f8,0x3f7724173f778bc5,0x3f6dfcf23f6ed89e,0x3f6c36243f6d1c1d,0x3f6046213f61c598,0x3f5d2d533f5ebe05,0x3f4f04173f514d3d,0x3f4a4c873f4cae79,0x3f3a7ca43f3daef9,0x3f33e7bc3f373a23,0x3f2302d33f273656,0x3f1a62933f1ebc12
.quad 0x3f08f59b3f0e39da,0x3efc5d273f039c3d,0x3ed97cb93ee63375,0x3ebf926f3ecc9b8b,0x3e9d9e783eac7cd4,0x3e7ee6e13e8e9a22,0x3e3e853e3e605c13,0x3df475c03e1c76de,0x3d7b2b743dc8bd36,0xbc490e903cc90ab0,0xbd83db0abcc90ab0,0xbe1324cabdd53db9,0xbe419b37be164083,0xbe8b9507be6c9a7f,0xbe9f1cdfbe888e93,0xbecb2aaebeb554ec
.quad 0x3f8000003f800000,0x3f8000003f800000,0x3f7d906e3f7dabcc,0x3f7d57de3f7d7474,0x3f764d973f76ba07,0x3f756d973f75dec6,0x3f6a5ad93f6b4b0c,0x3f686b393f696591,0x3f59f26a3f5b941a,0x3f5695e53f584853,0x3f4564393f47de65,0x3f404c5c3f42de29,0x3f2d14693f3085bb,0x3f26050a3f299415,0x3f11796b3f15f6d9,0x3f084b923f0cead0
.quad 0x3ee633753ef15aea,0x3ecf7bca3edae880,0x3ea5129f3eb263ef,0x3e8a11f73e97a117,0x3e419b373e605c13,0x3e0395023e22abb6,0x3d55880e3dafb680,0xbc7b514b3c96c9b6,0xbdafb680bd48fb30,0xbe22abb6bdfab273,0xbe636c83be3b6ecf,0xbe9920febe8586ce,0xbeb554ecbea09ae5,0xbeddbe79bec9b953,0xbef58035bee0924f,0xbf0ee0dbbf04f484
.quad 0xbd48fb3000000000,0xbe164083bdc8bd36,0xbe195be0bdc8bd36,0xbe80f8c0be4dee60,0xbe7ee6e1be47c5c2,0xbeb554ecbe9aa086,0xbeb0eacbbe94a031,0xbee79a5dbecc9b8b,0xbee0924fbec3ef15,0xbf0b9a6bbefc5d27,0xbf06f686bef15aea,0xbf21cbfbbf14b039,0xbf1c420cbf0e39da,0xbf36206cbf299415,0xbf2ff3e6bf226799,0xbf485bcabf3ca003
.quad 0xbf41d870bf3504f3,0xbf584853bf4d9f02,0xbf51c0c2bf45e403,0xbf65b710bf5c61c7,0xbf5f8327bf54db31,0xbf708066bf68bf3c,0xbf6afb8cbf61c598,0xbf788486bf7294f8,0xbf740bddbf6c835e,0xbf7dabccbf79c79d,0xbf7a9c59bf74fa0b,0xbf7fe705bf7e4323,0xbf7e9bc9bf7b14be,0xbf7f2f9dbf7ffb11,0xbf7fffb1bf7ec46d,0xbf7b87b2bf7eea9d
.quad 0xbe78cfccbe47c5c2,0xbeac7cd4be94a031,0xbeb3dca5be9aa086,0xbee4cbfebecc9b8b,0xbee900b7becf7bca,0xbf0cead0bf00e7e4,0xbf0d9281bf00e7e4,0xbf256bcbbf19c200,0xbf24d225bf187fc0,0xbf3b8f3bbf3085bb,0xbf39f2acbf2e3bde,0xbf4f0417bf44e3f5,0xbf4cae79bf41d870,0xbf5f8327bf5695e5,0xbf5cc7d1bf531849,0xbf6cd007bf655e0b
.quad 0xbf6a09a7bf61c598,0xbf76ba07bf710908,0xbf74484bbf6db293,0xbf7d1cddbf796e4e,0xbf7b61fcbf76ba07,0xbf7fe129bf7e70b0,0xbf7f3f54bf7cbfc9,0xbf7efcc9bf7ffec4,0xbf7fd397bf7fb10f,0xbf7a7302bf7e1324,0xbf7d1cddbf7f84ab,0xbf725470bf78b47b,0xbf772417bf7c3b28,0xbf66beccbf6ff573,0xbf6dfcf2bf75dec6,0xbf57dc7fbf63f473
.quad 0xbedae880bec3ef15,0xbf039c3dbef15aea,0xbf099f4ebefc5d27,0xbf1f599fbf14b039,0xbf239da9bf187fc0,0xbf385216bf2e3bde,0xbf3b0629bf3085bb,0xbf4e1689bf44e3f5,0xbf4f7a1fbf45e403,0xbf604621bf584853,0xbf60a6cfbf584853,0xbf6e8ff8bf6816a8,0xbf6e46bebf676bd8,0xbf78b47bbf740bdd,0xbf7822d1bf731447,0xbf7e868bbf7bf531
.quad 0xbf7e1324bf7b14be,0xbf7fec43bf7fb10f,0xbf7fffb1bf7f4e6d,0xbf7cdf6cbf7f2f9d,0xbf7de0b1bf7fb10f,0xbf756d97bf7a7302,0xbf77beb7bf7c3b28,0xbf69b7e4bf718f57,0xbf6db293bf74fa0b,0xbf59f26abf64aa59,0xbf5fe4e9bf6a09a7,0xbf466354bf53fac3,0xbf4e8d90bf5b941a,0xbf2f61a5bf3fc767,0xbf39f2acbf49d112,0xbf1553b7bf286605
.quad 0xbf187fc0bf0e39da,0xbf2beb4abf226799,0xbf33587abf299415,0xbf456439bf3ca003,0xbf4ac77fbf41d870,0xbf5ac450bf531849,0xbf5e5aa6bf5695e5,0xbf6b99fbbf655e0b,0xbf6db293bf676bd8,0xbf778bc5bf731447,0xbf788486bf740bdd,0xbf7e5a38bf7bf531,0xbf7e9bc9bf7c3b28,0xbf7fe129bf7fd397,0xbf7fdaafbf7fd397,0xbf7c187abf7e9bc9
.quad 0xbf7c3b28bf7ec46d,0xbf731447bf7853f8,0xbf73ced9bf791298,0xbf650479bf6d1c1d,0xbf66beccbf6ed89e,0xbf5233c6bf5d2d53,0xbf554aa4bf604621,0xbf3b0629bf48d8b3,0xbf3fc767bf4d9f02,0xbf1ff6cbbf3085bb,0xbf269de3bf373a23,0xbf019573bf14b039,0xbf0a48adbf1d7fd1,0xbec1071ebeebcbbb,0xbed6a399bf00e7e4,0xbe75c35abea986c4
.quad 0,0,0x3dcefdb73dc8bd36,0x3ddb7d373dd53db9,0x3e4dee603e47c5c2,0x3e5a39973e541501,0x3e9920fe3e94a031,0x3ea218873e9d9e78,0x3ec9b9533ec3ef15,0x3ed536413ecf7bca,0x3ef840c83ef15aea,0x3f02ef9f3eff17b2,0x3f121eb03f0e39da,0x3f19c2003f15f6d9,0x3f269de33f226799,0x3f2ecef73f2ac082
.quad 0x3f3968423f3504f3,0x3f41d8703f3daef9,0x3f4a4c873f45e403,0x3f52a6493f4e8d90,0x3f591e6a3f54db31,0x3f6106f23f5d2d53,0x3f65b7103f61c598,0x3f6cd0073f696591,0x3f6ff5733f6c835e,0x3f75dec63f731447,0x3f77beb73f74fa0b,0x3f7c187a3f7a1e84,0x3f7cfe733f7b14be,0x3f7f6ac73f7e70b0,0x3f7fa6e33f7ec46d,0x3f7fcbe23f7ffec4
.quad 0,0,0x3de7fa9a3de1bc2e,0x3df475c03dee3876,0x3e667c663e605c13,0x3e72b6513e6c9a7f,0x3eab02013ea68f12,0x3eb3dca53eaf713a,0x3ee0924f3edae880,0x3eebcbbb3ee63375,0x3f099f4e3f064b82,0x3f102dd53f0cead0,0x3f212ff93f1d7fd1,0x3f2866053f24d225,0x3f36ad7f3f32c8c9,0x3f3e35c53f3a7ca4
.quad 0x3f49d1123f45e403,0x3f514d3d3f4d9f02,0x3f5a5ba03f5695e5,0x3f61668a3f5df6be,0x3f6816a83f64aa59,0x3f6e46be3f6b4b0c,0x3f72d4eb3f6ff573,0x3f77beb73f756d97,0x3f7a73023f7853f8,0x3f7dabcc3f7c3b28,0x3f7ed7d43f7dabcc,0x3f7ff84a3f7f9c18,0x3f7ff4e63f7fec43,0x3f7e9bc93f7f84ab,0x3f7dc68c3f7f0e58,0x3f799b433f7bf531
.quad 0,0,0x3e0077453dfab273,0x3e06b26e3e039502,0x3e7ee6e13e78cfcc,0x3e8586ce3e827dc0,0x3ebca7af3eb8442a,0x3ec5625c3ec1071e,0x3ef6e0cb3ef15aea,0x3f00e7e43efc5d27,0x3f16999f3f13682a,0x3f1ce11f3f19c200,0x3f2f61a53f2beb4a,0x3f36206c3f32c8c9,0x3f4564393f41d870,0x3f4c35783f48d8b3
.quad 0x3f5848533f54db31,0x3f5ebe053f5b941a,0x3f67c1873f64aa59,0x3f6d67a13f6aab7b,0x3f73913f3f710908,0x3f77f1103f75dec6,0x3f7b87b23f79c79d,0x3f7e2b723f7cfe73,0x3f7f84ab3f7ec46d,0x3f7ffb113f7fec43,0x3f7f78083f7fec43,0x3f7d57de3f7e9bc9,0x3f7b61fc3f7d3aac,0x3f764d973f791298,0x3f73530e3f76ba07,0x3f6afb8c3f6f6830
.quad 0,0,0x3e0cec4a3e09cf86,0x3e1324ca3e1008b7,0x3e8b95073e888e93,0x3e919ddd3e8e9a22,0x3ece0bea3ec9b953,0x3ed6a3993ed25a09,0x3f064b823f039c3d,0x3f0b9a6b3f08f59b,0x3f2302d33f1ff6cb,0x3f28fd413f26050a,0x3f3ca0033f396842,0x3f42de293f3fc767,0x3f52a6493f4f7a1f,0x3f58b3a13f55b993
.quad 0x3f64aa593f61c598,0x3f6a09a73f676bd8,0x3f7254703f6ff573,0x3f76841b3f748422,0x3f7b61fc3f79c79d,0x3f7de0b13f7cbfc9,0x3f7fa6e33f7f0e58,0x3f7ff84a3f7ff4e6,0x3f7f0e583f7fb10f,0x3f7cbfc93f7e1324,0x3f799b433f7baccd,0x3f74484b3f772417,0x3f6f68303f731447,0x3f66becc3f6b4b0c,0x3f60a6cf3f660f88,0x3f546b3b3f5ac450
.quad 0x3f7fb10f3f800000,0x3f7d3aac3f7ec46d,0x3f7d1cdd3f7ec46d,0x3f77beb73f7ac516,0x3f77f1103f7b14be,0x3f6f68303f740bdd,0x3f703b373f74fa0b,0x3f644fac3f6aab7b,0x3f660f883f6c835e,0x3f5695e53f5ebe05,0x3f5988ad3f61c598,0x3f4663543f5064af,0x3f4ac77f3f54db31,0x3f33e7bc3f3fc767,0x3f39f2ac3f45e403,0x3f1f599f3f2d1469
.quad 0x3f2736563f3504f3,0x3f08f59b3f187fc0,0x3f12c39a3f226799,0x3ee1fb6a3f0242b1,0x3ef9a02d3f0e39da,0x3eaf713a3ed53641,0x3ecb2aae3ef15aea,0x3e75c35a3ea395c5,0x3e9aa0863ec3ef15,0x3e09cf863e605c13,0x3e5101f13e94a031,0x3ce22a7a3dee3876,0x3dd53db93e47c5c2,0xbda3308c3c490e90,0x3b490fc63dc8bd36,0xbe3e853ebdbc3ac3
.quad 0x3f7853f83f7b14be,0x3f7109083f74fa0b,0x3f6faf1b3f740bdd,0x3f6504793f6aab7b,0x3f63f4733f6a09a7,0x3f55b9933f5d2d53,0x3f554aa43f5d2d53,0x3f4360513f4cae79,0x3f43e2003f4d9f02,0x3f2e3bde3f396842,0x3f2ff3e63f3b8f3b,0x3f16999f3f239da9,0x3f19c2003f273656,0x3ef9a02d3f0b9a6b,0x3f0195733f10d3cd,0x3ec27b553ee363fa
.quad 0x3ecf7bca3ef15aea,0x3e888e933eac7cd4,0x3e9920fe3ebe1d4a,0x3e195be03e667c66,0x3e419b373e888e93,0x3cfb49ba3de1bc2e,0x3d9cecf93e22abb6,0xbdb5f8dabbc90f88,0xbd16c32c3d48fb30,0xbe541501bdfab273,0xbe195be0bd7b2b74,0xbea5129fbe72b651,0xbe8586cebe2f10a2,0xbeddbe79beb263ef,0xbebca7afbe8e9a22,0xbf099f4ebee900b7
.quad 0x3f676bd83f6c835e,0x3f5b941a3f61c598,0x3f57dc7f3f5ebe05,0x3f485bca3f5064af,0x3f44e3f53f4d9f02,0x3f31a81d3f3b8f3b,0x3f2ecef73f396842,0x3f17de123f239da9,0x3f15f6d93f226799,0x3ef6e0cb3f08f59b,0x3ef580353f08f59b,0x3eb9bb1e3ed8106b,0x3ebb31a03edae880,0x3e72b6513e9aa086,0x3e7bdba43ea09ae5,0x3ddb7d373e354098
.quad 0x3dfab2733e47c5c2,0xbcc90ab03d48fb30,0xbb490fc63d96a905,0xbe1f917bbda3308c,0xbe039502bd48fb30,0xbe919dddbe541501,0xbe80f8c0be2f10a2,0xbed0eb2abea986c4,0xbebe1d4abe94a031,0xbf064b82bee63375,0xbef840c8becf7bca,0xbf21cbfbbf0f8784,0xbf173c07bf039c3d,0xbf3a7ca4bf299415,0xbf2ff3e6bf1d7fd1,0xbf4fefa8bf40d0da
.quad 0x3f4d9f023f54db31,0x3f3daef93f45e403,0x3f36ad7f3f3fc767,0x3f2302d33f2d1469,0x3f1c420c3f273656,0x3f04f4843f10d3cd,0x3efdbabb3f0b9a6b,0x3ec8477c3ee363fa,0x3ebe1d4a3edae880,0x3e827dc03ea09ae5,0x3e75c35a3e9aa086,0x3de7fa9a3e354098,0x3dd53db93e2f10a2,0xbcfb49ba3d16c32c,0xbd0a342f3d16c32c,0xbe3228d4bdd53db9
.quad 0xbe2f10a2bdc8bd36,0xbea09ae5be78cfcc,0xbe9c1fafbe6c9a7f,0xbee4cbfebec1071e,0xbeddbe79beb8442a,0xbf121eb0bf00e7e4,0xbf0d9281bef6e0cb,0xbf2ecef7bf1ebc12,0xbf299415bf187fc0,0xbf47de65bf396842,0xbf425b89bf32c8c9,0xbf5cc7d1bf5064af,0xbf577026bf49d112,0xbf6d1c1dbf633c5a,0xbf686b39bf5d2d53,0xbf788486bf718f57
.quad 0xbf7f3f80bf803f80,0xbf7c3f7dbf7e3f7f,0xbf7a3f7dbf7f3f80,0xbf5f3f67bf6f3f75,0xbf5f3f71bf7c3f80,0xbeb83f04bf273f46,0xbf313f5cbf773f80,0x3ea1bd49be603ef1,0xbee63f3ebf6f3f80,0x3f58bf183e893dc9,0xbe2f3f18bf653f80,0x3f7ebf713f31be95,0x3dfb3edbbf583f80,0x3f31bf783f73bf22,0x3ecf3e79bf4a3f80,0x3d97bf2c3f7cbf62
.quad 0x3f273d49bf393f80,0xbf13be163f4abf7f,0x3f58be16bf273f80,0xbf773edb3ecfbf75,0x3f77beacbf133f80,0xbf6a3f5cbd97bf46,0x3f80bf04befc3f80,0xbee63f80bf09bef1,0x3f73bf2cbecf3f80,0x3e603f4ebf5fbdc9,0x3f51bf4ebea13f80,0x3f4a3eacbf803e95,0x3f1dbf67be603f80,0x3f80be79bf653f22,0x3eb8bf78bdfb3f80,0x3f42bf3ebf133f62
.quad 0xbf773f78bf7a3f7b,0xbf6f3f71bf733f75,0xbf313f3ebf4a3f55,0xbee63f04bf133f22,0x3ea1be16bcc93e48,0x3f58bf3e3f1dbef1,0x3f7cbf673f42bf0e,0x3f1dbf4e3f6fbf7f,0x3f1dbf5c3f7cbf7b,0xbf393edbbd97be95,0xbecfbd493efcbf55,0xbf423f78bf7a3f46,0xbf7f3f4ebeb8be48,0x3f13bd49befc3f62,0xbf093f71bf733f0e,0x3f5fbf7d3f31bdc9
.quad 0x3efc3e79bf583f7b,0xbecfbeac3f65bf75,0x3f80bf2cbdfb3f55,0xbf733f5cbe2fbf22,0x3ee6bf7d3f313e48,0x3e603f2cbf7e3ef1,0xbf13bedb3f7fbf0e,0x3f7ebf18becf3f7f,0xbf7e3f043f13bf7b,0xbcc9bf673f423e95,0xbeb83f80be89bf55,0xbf7f3e793f58bf46,0x3f273f18bf6abe48,0xbe2f3f80be89bf62,0x3f7abeacbf653f0e,0x3f773e16bf803dc9
.quad 0xbf653f67bf6a3f6d,0xbf583f5cbf5f3f62,0xbe2f3e79bea13ec4,0x3dfbbd49bcc93dc9,0x3f7ebf803f7abf6d,0x3f31bf4e3f65bf75,0xbecf3e163dfbbec4,0xbf7f3f71bf513f22,0xbf423f71bf803f6d,0x3f13be79bdfb3ef1,0x3f58bf043d973ec4,0x3e89bf2c3f6fbf7f,0x3e89bf3e3f7cbf6d,0xbf6a3f7dbf423e95,0xbf803f4ebe89bec4,0x3f65bedbbe603f46
.quad 0x3ea13edbbf6f3f6d,0xbe60bf043f77bf62,0x3f51bf783ee63ec4,0xbf1d3f80bf31bdc9,0xbf4abd493f58bf6d,0x3f80bf18bea13f75,0xbeb83f7dbf1dbec4,0xbf27beac3f7cbf22,0x3f7fbeacbf393f6d,0xbe2f3f78bf1dbef1,0xbe60bf5c3f423ec4,0x3f5fbf3ebecf3f7f,0xbf5f3f2c3f13bf6d,0xbf6fbe163f7fbe95,0x3f393f18bf5fbec4,0x3ea13f67bf09bf46
.quad 0xbf4a3f4ebf513f55,0xbf393f3ebf423f46,0x3ecfbeac3e89be48,0x3f27bf183f09bef1,0x3d97be793ecfbf0e,0xbf133edbbe893dc9,0xbf093f3ebf653f7b,0x3efcbe79bcc93e95,0x3f5fbf7d3f7abf55,0xbecf3d493ea1bf22,0xbf803f67bf1d3e48,0x3ea13e16bf133f62,0x3f65bf04bcc93f0e,0xbe60beac3f4abf7f,0xbf13bd493f27bf7b,0x3dfb3f04bf6f3f75
.quad 0x3dfb3f18bf7c3f55,0xbcc9bf2c3f7fbf46,0x3eb8bf713f5fbe48,0xbd973f4ebf7a3ef1,0xbf423f78beb8bf0e,0x3e2fbf673f5fbdc9,0x3f7abf2cbea13f7b,0xbe893f78bf31be95,0xbf773e163f58bf55,0x3eb8bf803ee63f22,0x3f393edbbf7e3e48,0xbee63f7dbe2fbf62,0xbea1bf5c3f313f0e,0x3f09bf71bdfb3f7f,0xbe2f3f80bd97bf7b,0xbf1d3f5c3ecfbf75
.quad 0xbd973d49bcc98000,0xbe2f3e16bdfb3dc9,0x3e60be163d978000,0x3efcbedb3eb8be95,0x3efcbeac3e2f8000,0x3f6fbf5c3f42bf22,0x3f39bf043e898000,0x3f73bf803f7abf62,0x3f65bf2c3eb88000,0x3f09bf4e3f77bf7f,0x3f7cbf4e3ee68000,0xbdfbbeac3f39bf75,0x3f7ebf673f098000,0xbf393e793ea1bf46,0x3f6abf783f1d8000,0xbf7f3f3ebe2fbef1
.quad 0x3f42bf803f318000,0xbf513f7dbf1dbdc9,0x3f09bf7d3f428000,0xbe893f67bf6a3e95,0x3e89bf713f518000,0x3ecf3f04bf7f3f22,0xbcc9bf5c3f5f8000,0x3f65bd49bf583f62,0xbea1bf3e3f6a8000,0x3f7abf18befc3f7f,0xbf13bf183f738000,0x3f1dbf71bcc93f75,0xbf4abedb3f7a8000,0xbcc9bf783ee63f46,0xbf6fbe793f7e8000,0xbf27bf2c3f513ef1
.quad 0xbe893e79be603e48,0xbeb83eacbea13e95,0x3f39bf2c3f1dbf0e,0x3f65bf5c3f51bf46,0x3f73bf7d3f80bf7b,0x3f09bf2c3f4abf62,0x3e2fbedb3f27bf55,0xbf4a3f18beb83dc9,0xbf4a3f04be2fbe48,0xbf313f67bf7f3f75,0xbf6a3f80bf5f3f0e,0x3f27be79be603f22,0xbd973f18bf6f3f7b,0x3f51bf803f5fbef1,0x3f58beacbea13f55,0xbefcbe163f39bf7f
.quad 0x3f5fbf783f093e48,0xbf6a3f71bee6be95,0xbcc9bf3e3f7ebf0e,0x3ea13f04bf7c3f46,0xbf653e163f39bf7b,0x3f7abf3ebdfb3f62,0xbf513f67bd97bf55,0xbdfbbf4e3f6abdc9,0x3dfb3f5cbf51be48,0xbf803edb3f27bf75,0x3f6f3d49bf773f0e,0xbd973f78bf09bf22,0x3f42bf4ebecf3f7b,0x3f7cbd49bf773ef1,0xbe60bf713ee63f55,0x3e89bf7dbcc93f7f
.quad 0xbee63edbbecf3ec4,0xbf093f04befc3ef1,0x3f7cbf783f73bf6d,0x3f7ebf803f80bf7f,0xbdfbbd493e60bec4,0xbf393f18bee63e95,0xbf6a3f7dbf7e3f6d,0xbd973eacbf133f46,0x3f27beacbcc93ec4,0x3f51bf783f7ebf62,0x3f09bf5c3f7fbf6d,0xbf773f3ebeb8bdc9,0xbf773f2cbe2fbec4,0x3ecf3e16bf273f75,0x3cc93f18bf773f6d,0x3ee6bf673f7abf22
.quad 0x3f73bf673eb83ec4,0xbf7a3f5cbe89bef1,0xbf13be793f65bf6d,0x3f4abd49bf393f7f,0xbf1d3f80bf09bec4,0xbcc9bf4e3f73be95,0x3f6fbe16bf4a3f6d,0xbf423f71be2fbf46,0x3d97bf713f313ec4,0x3f7cbe79bf4a3f62,0xbf7a3f043f27bf6d,0xbefcbf2c3f6a3dc9,0x3efc3f3ebf51bec4,0xbeb83f7dbd97bf75,0x3f31bf4ebefc3f6d,0x3f73bedbbf583f22
.quad 0xbf1d3f18bf133f0e,0xbf313f2cbf273f22,0x3f6abf713f77bf7b,0x3f42bf4e3f58bf62,0xbf7f3f78bf6a3f55,0xbf513f67bf773f7f,0x3f58bf2c3ee6be48,0x3f5fbf783f80bf75,0xbefc3e163e60bf0e,0xbf6a3f80bf733f46,0x3cc93edbbf4a3f7b,0x3f73bf7d3f51bef1,0x3ee6bf5c3f80bf55,0xbf7a3f71bf1d3dc9,0xbf513f80bf423e48,0x3f7ebf5c3eb83e95
.quad 0x3f7ebf4e3e2f3f0e,0xbf803f3ebd97bf22,0xbf6f3eac3efcbf7b,0x3f7fbf18be603f62,0x3f273e79bf6f3f55,0xbf7c3edb3efcbf7f,0xbe60bf3e3f73be48,0x3f77be79bf393f75,0xbe893f7dbf09bf0e,0xbf6f3d493f65bf46,0x3f31bf67bdfb3f7b,0x3f653e16bf7c3ef1,0xbf733f043f39bf55,0xbf58beac3f7ebdc9,0x3f7c3d49bf7f3e48,0x3f4a3f04bf6abe95
.quad 0xbf273f2cbf313f35,0xbf133f18bf1d3f22,0x3f58bf4e3f42bf35,0x3f77bf713f6abf62,0xbf773f67bf513f35,0xbf6a3f78bf7f3f7f,0x3f80bf783f5fbf35,0x3ee6bf2c3f58bf75,0xbf733f80bf6a3f35,0x3e603e16befc3f46,0x3f51bf7d3f73bf35,0xbf4a3edb3cc9bef1,0xbf1d3f71bf7a3f35,0x3f80bf5c3ee63dc9,0x3eb8bf5c3f7ebf35,0xbf423f80bf513e95
.quad 0xbd973f3ebf803f35,0x3e2fbf4e3f7ebf22,0xbe60bf183f7fbf35,0x3efc3eacbf6f3f62,0x3efc3edbbf7c3f35,0xbf6f3e793f27bf7f,0xbf39be793f77bf35,0x3f73bf3ebe603f75,0x3f653d49bf6f3f35,0xbf093f7dbe89bf46,0xbf7c3e163f65bf35,0xbdfbbf673f313ef1,0x3f7ebeacbf583f35,0x3f393f04bf73bdc9,0xbf6a3f043f4abf35,0xbf7f3d493f7cbe95
.quad 0xbefc3f04bf093f0e,0xbecf3edbbee63ef1,0x3f80bf803f7ebf7b,0x3f73bf783f7cbf7f,0xbee63f18bf393f55,0x3e60bd49bdfb3e95,0xbf133eacbd97be48,0xbf7e3f7dbf6a3f46,0x3f7ebf783f51bf0e,0xbcc9beac3f27bf62,0xbeb83f3ebf773f7b,0x3f7fbf5c3f09bdc9,0xbf273e163ecfbf55,0xbe2f3f2cbf773f75,0x3f7abf673ee63e48,0xbf773f183cc9bf22
.quad 0xbe893f5cbf7a3f0e,0x3eb8bf673f73bef1,0xbf39bd493f4abf7b,0x3f65be79bf133f7f,0x3f73bf4ebcc93f55,0xbf093f80bf1dbe95,0xbe2f3f71bf42be48,0xbf4abe163f6fbf46,0xbf4abe793f7cbf0e,0x3f31bf713d973f62,0x3f6abf2cbefc3f7b,0x3f273f04bf7a3dc9,0xbd973f7dbeb8bf55,0xbf513f3e3efcbf75,0xbf58bedb3f733e48,0xbefcbf4e3f313f22
.quad 0xbea13eacbeb83ec4,0xbe603e79be893e95,0x3f51bf5c3f65bf6d,0x3f1dbf2c3f39bf46,0x3f4abf2c3f09bec4,0x3f80bf7d3f73bf62,0xbeb83f18bf4a3f6d,0x3f27bedb3e2f3dc9,0xbf7f3f67bf313ec4,0xbe2f3f04bf4a3f75,0xbe60be793f27bf6d,0xbf5f3f80bf6a3f22,0x3f5fbf803f51bec4,0xbf6f3f18bd97bef1,0x3f39be16befc3f6d,0xbea1beac3f58bf7f
.quad 0xbee63f71bf6a3ec4,0x3f09bf783f5fbe95,0xbf7c3f043ea1bf6d,0x3f7ebf3ebcc93f46,0xbdfbbf3e3f7abec4,0x3f393e16bf653f62,0x3f6abf4ebdfb3f6d,0xbd973f67bf51bdc9,0x3f273edbbf803ec4,0xbf513f5c3dfbbf75,0xbf093f78bd97bf6d,0xbf773d493f6fbf22,0xbf77bd493f7cbec4,0xbecfbf4e3f423ef1,0xbcc9bf7d3e893f6d,0x3ee6bf71be603f7f
.quad 0xbdfb3e16be2f3e48,0xbcc93d49bd973dc9,0x3eb8bedb3efcbf0e,0x3d97be163e60be95,0x3f42bf5c3f6fbf7b,0x3e2fbeac3efcbf22,0x3f7abf803f73bf55,0x3e89bf043f39bf62,0x3f77bf4e3f09be48,0x3eb8bf2c3f65bf7f,0x3f39beacbdfb3f0e,0x3ee6bf4e3f7cbf75,0x3ea13e79bf393f7b,0x3f09bf673f7ebf46,0xbe2f3f3ebf7f3f55,0x3f1dbf783f6abef1
.quad 0xbf1d3f7dbf513e48,0x3f31bf803f42bdc9,0xbf6a3f67be89bf0e,0x3f42bf7d3f093e95,0xbf7f3f043ecfbf7b,0x3f51bf713e893f22,0xbf58bd493f65bf55,0x3f5fbf5cbcc93f62,0xbefcbf183f7abe48,0x3f6abf3ebea13f7f,0xbcc9bf713f1d3f0e,0x3f73bf18bf133f75,0x3ee6bf78bcc93f7b,0x3f7abedbbf4a3f46,0x3f51bf2cbf273f55,0x3f7ebe79bf6f3ef1
.quad 0xbf423f3ebf393f35,0xbf513f4ebf4a3f46,0x3f09bf183f27bf35,0x3e89beac3ecfbef1,0xbe893edbbf133f35,0x3ecfbe793d973dc9,0xbcc9be793efcbf35,0xbf653f3ebf093e95,0x3ea13d49becf3f35,0x3f7abf7d3f5fbf22,0xbf133e163ea1bf35,0xbf1d3f67bf803f62,0x3f4abeacbe603f35,0xbcc9bf043f65bf7f,0xbf6f3f043dfbbf35,0x3f27bd49bf133f75
.quad 0x3f7fbf2cbcc93f35,0xbf7c3f183dfbbf46,0xbf7a3f4ebd97bf35,0x3f5fbf713eb83ef1,0x3f5fbf673e2f3f35,0xbeb83f78bf42bdc9,0xbf313f78be89bf35,0xbea1bf2c3f7abe95,0x3ee6bf803eb83f35,0x3f583e16bf773f22,0xbe2f3f7dbee6bf35,0xbf7e3edb3f39bf62,0xbdfbbf713f093f35,0x3f31bf5cbea13f7f,0x3ecf3f5cbf1dbf35,0xbd973f80be2fbf75
.quad 0xbf5f3f5cbf583f55,0xbf6a3f67bf653f62,0xbcc9bd493dfbbe48,0xbea13e79be2f3dc9,0x3f65bf4e3f31bf0e,0x3f7abf803f7ebf75,0xbf513f71bf7f3f7b,0x3dfb3e16becf3f22,0xbdfbbe793f13bf55,0xbf803f71bf423ef1,0x3f6fbf2c3e893e48,0x3d97bf043f58bf7f,0xbf423f7dbf6a3f0e,0x3f7cbf3e3e893e95,0xbe60bedb3f65bf7b,0xbe893f4ebf803f46
.quad 0x3f77bf04be603f55,0xbf6f3edb3ea1bf62,0xbf313f80bf1dbe48,0x3ee6bf783f51bdc9,0xbea1bf183f80bf0e,0x3f58bd49bf4a3f75,0x3f7cbeacbf273f7b,0xbf1d3f7dbeb8bf22,0xbf1d3f78be2fbf55,0xbf39beac3f7fbef1,0xbecfbf3e3f5f3e48,0x3f42bf5cbe603f7f,0x3f7fbe16bf6f3f0e,0x3f133f2cbf5fbe95,0xbf093f673ea1bf7b,0xbf5f3f183f39bf46
.quad 0xbf733f71bf6f3f6d,0xbf7a3f78bf773f75,0xbf133f04bee63ec4,0xbf4a3f3ebf313f22,0x3f1dbf3e3f58bf6d,0xbcc9be163ea1bef1,0x3f6fbf4e3f1dbec4,0x3f42bf673f7cbf7f,0xbd973edbbf393f6d,0x3f7cbf5c3f1dbe95,0xbf7a3f78bf423ec4,0x3efcbd49becf3f46,0xbefcbd493f13bf6d,0xbeb83f4ebf7f3f62,0x3f31bf7d3f5fbec4,0xbf733f71bf09bdc9
.quad 0x3f65beacbecf3f6d,0xbf583e793efcbf75,0xbe2f3f5cbf733ec4,0xbdfbbf2c3f80bf22,0xbf7e3f2c3e60bf6d,0x3f31bf7d3ee63ef1,0xbecfbf183f7ebec4,0x3f7fbedbbf133f7f,0x3f42bf67bcc93f6d,0x3f133f04bf7e3e95,0x3f583e79bf7f3ec4,0xbe893f80beb8bf46,0xbe893f80be2fbf6d,0xbf6a3f183f27bf62,0xbf803e163f77bec4,0xbf65beac3f7a3dc9
.quad 0xbf7e3f7dbf7c3f7b,0xbf803f80bf7f3f7f,0xbf6f3f67bf5f3f55,0xbf7f3f7dbf7a3f75,0xbf273f04beb83e48,0xbf7c3f71bf5f3f46,0xbe60bd493ea1bf0e,0xbf773f5cbf313ef1,0x3e89bf183f58bf7b,0xbf6f3f3ebee63dc9,0x3f31bf713f7ebf55,0xbf653f18be2fbe95,0x3f73bf783f31be48,0xbf583edb3dfbbf22,0x3f7cbf2c3d973f0e,0xbf4a3e793ecfbf62
.quad 0x3f4abe16bf133f7b,0xbf393d493f27bf7f,0x3ecf3edbbf773f55,0xbf27be163f58bf75,0xbd973f5cbf6a3e48,0xbf13beac3f77bf46,0xbf093f80bee6bf0e,0xbefcbf043f80bef1,0xbf5f3f4e3e60bf7b,0xbecfbf2c3f73bdc9,0xbf803eac3f4abf55,0xbea1bf4e3f513e95,0xbf65be793f80be48,0xbe60bf673f1d3f22,0xbf13bf3e3f423f0e,0xbdfbbf783eb83f62
.quad 0xbf353f35bf353f35,0xbf353f35bf353f35,0xbf5f3f51bf423f31,0xbefc3f13bf273f39,0xbf783f67bf4e3f2c,0xbe793edbbf183f3e,0xbf803f77bf583f27,0x3cc93e89bf093f42,0xbf753f7fbf623f22,0x3e953dc9bef13f46,0xbf583f7fbf6a3f1d,0x3f09bd97becf3f4a,0xbf2c3f78bf713f18,0x3f3ebe79beac3f4e,0xbee63f6abf773f13,0x3f65becfbe893f51
.quad 0xbe483f55bf7b3f0e,0x3f7bbf0ebe483f55,0x3d973f39bf7e3f09,0x3f7fbf31bdfb3f58,0x3eac3f18bf803f04,0x3f71bf4ebd493f5c,0x3f133ee6bf803efc,0x3f51bf653cc93f5f,0x3f463e95bf7f3ef1,0x3f22bf753dc93f62,0x3f6a3dfbbf7c3ee6,0x3ecfbf7e3e2f3f65,0x3f7dbd49bf783edb,0x3e16bf803e793f67,0x3f7ebe60bf733ecf,0xbdfbbf7a3ea13f6a
.quad 0xbf353f35bf353f35,0xbf353f35bf353f35,0xbf7e3f7abf733f6a,0xbdfb3e60bea13ecf,0xbf5c3f71bf7d3f80,0x3f04beac3e163d49,0xbeb83f1dbf513f73,0x3f6fbf4a3f13bea1,0x3e953dc9bef13f46,0x3f75bf7f3f62bf22,0x3f51bee6bcc93efc,0x3f13bf653f80bf5f,0x3f80bf5c3edb3e16,0xbd49bf043f67bf7d,0x3f42bf803f4abe60,0xbf273cc93f1dbf7a
.quad 0x3e48bf553f7bbf0e,0xbf7b3f0e3e48bf55,0xbee6becf3f77bf51,0xbf653f6abe89bf13,0xbf673e163f3ebf78,0xbedb3f7dbf2cbe79,0xbf7a3f273eb8bf7e,0x3e603f42bf6f3dfb,0xbf223f75bdc9bf62,0x3f463e95bf7f3ef1,0xbcc93f77bf09bf27,0x3f80be89bf583f42,0x3f183f2cbf5cbeac,0x3f4ebf3ebf043f71,0x3f773e2fbf7f3cc9,0x3e89bf7cbd973f80
.quad 0xbf353f35bf353f35,0xbf353f35bf353f35,0xbf773f7cbf7f3f80,0x3e89be2f3d973cc9,0xbe793edbbf183f3e,0x3f78bf673f4ebf2c,0x3f39befc3e603d97,0x3f31bf5f3f7abf7f,0x3f75bf7f3f62bf22,0xbe95bdc93ef1bf46,0x3e60bf273f6fbf7e,0xbf7a3f42beb8bdfb,0xbf3e3e793eacbf4e,0xbf2c3f78bf713f18,0xbf733f6fbefcbe2f,0x3ea13eb8bf5f3f7c
.quad 0xbe483f55bf7b3f0e,0x3f7bbf0ebe483f55,0x3f423cc9bf4a3f7a,0x3f27bf803f1d3e60,0x3f71bf4ebd493f5c,0xbeacbf183f80bf04,0x3e2fbf733f393e89,0xbf7c3ea13f31bf77,0xbf46be953f7fbef1,0xbf223f75bdc9bf62,0xbf6f3f1d3f13bf73,0x3eb83f4abf51bea1,0xbe163f80be79bf67,0x3f7dbd49bf783edb,0x3f4a3f09bf65beb8,0x3f1dbf58bee63f6f
.quad 0xbf353f35bf353f35,0xbf353f35bf353f35,0xbf4a3f58bf653f6f,0x3f1dbf093ee6beb8,0x3f04beac3e163d49,0x3f5cbf713f7dbf80,0x3f6abf7e3f7cbf65,0xbecf3dfb3e2fbee6,0xbe95bdc93ef1bf46,0xbf753f7fbf623f22,0xbf7c3f73bf313e89,0x3e2f3ea1bf393f77,0x3d493f04bf673f7d,0x3f80bf5c3edb3e16,0x3f7fbf393dfb3f09,0x3d97bf313f7ebf58
.quad 0x3e48bf553f7bbf0e,0xbf7b3f0e3e48bf55,0xbf733eb83efcbf7c,0xbea13f6fbf5f3e2f,0xbedb3f7dbf2cbe79,0x3f67be16bf3e3f78,0x3f583d97bf6a3f4a,0x3f09bf7f3ecf3f1d,0x3f22bf753dc93f62,0xbf46be953f7fbef1,0xbf31befc3f7abd97,0xbf393f5f3e60bf7f,0xbf4e3f3e3f04bf71,0x3f183f2cbf5cbeac,0x3efc3f51bf27bf31,0x3f5fbf13bf423f39
.quad 0xbf353f35bf353f35,0xbf353f35bf353f35,0xbefc3f13bf273f39,0x3f5fbf513f42bf31,0x3f78bf673f4ebf2c,0x3e79bedb3f18bf3e,0xbcc9be893f09bf42,0xbf803f77bf583f27,0xbf753f7fbf623f22,0x3e953dc9bef13f46,0x3f09bd97becf3f4a,0x3f58bf7f3f6abf1d,0x3f2cbf783f71bf18,0xbf3e3e793eacbf4e,0xbf653ecf3e89bf51,0xbee63f6abf773f13
.quad 0xbe483f55bf7b3f0e,0x3f7bbf0ebe483f55,0x3f7fbf31bdfb3f58,0xbd97bf393f7ebf09,0xbeacbf183f80bf04,0xbf713f4e3d49bf5c,0xbf513f65bcc9bf5f,0x3f133ee6bf803efc,0x3f463e95bf7f3ef1,0x3f22bf753dc93f62,0x3ecfbf7e3e2f3f65,0xbf6abdfb3f7cbee6,0xbf7d3d493f78bedb,0xbe163f80be79bf67,0x3dfb3f7abea1bf6a,0x3f7ebe60bf733ecf
.quad 0xbf353f35bf353f35,0xbf353f35bf353f35,0xbdfb3e60bea13ecf,0x3f7ebf7a3f73bf6a,0x3f5cbf713f7dbf80,0xbf043eacbe16bd49,0xbf6f3f4abf133ea1,0xbeb83f1dbf513f73,0x3e953dc9bef13f46,0x3f75bf7f3f62bf22,0x3f13bf653f80bf5f,0xbf513ee63cc9befc,0xbf803f5cbedbbe16,0x3d493f04bf673f7d,0x3f27bcc9bf1d3f7a,0x3f42bf803f4abe60
.quad 0x3e48bf553f7bbf0e,0xbf7b3f0e3e48bf55,0xbf653f6abe89bf13,0x3ee63ecfbf773f51,0x3f67be16bf3e3f78,0x3edbbf7d3f2c3e79,0xbe60bf423f6fbdfb,0xbf7a3f273eb8bf7e,0xbf223f75bdc9bf62,0x3f463e95bf7f3ef1,0x3f80be89bf583f42,0x3cc9bf773f093f27,0xbf18bf2c3f5c3eac,0xbf4e3f3e3f04bf71,0xbe893f7c3d97bf80,0x3f773e2fbf7f3cc9
.quad 0xbf353f35bf353f35,0xbf353f35bf353f35,0x3e89be2f3d973cc9,0x3f77bf7c3f7fbf80,0x3e79bedb3f18bf3e,0xbf783f67bf4e3f2c,0xbf313f5fbf7a3f7f,0x3f39befc3e603d97,0x3f75bf7f3f62bf22,0xbe95bdc93ef1bf46,0xbf7a3f42beb8bdfb,0xbe603f27bf6f3f7e,0x3f3ebe79beac3f4e,0x3f2cbf783f71bf18,0xbea1beb83f5fbf7c,0xbf733f6fbefcbe2f
.quad 0xbe483f55bf7b3f0e,0x3f7bbf0ebe483f55,0x3f27bf803f1d3e60,0xbf42bcc93f4abf7a,0xbf713f4e3d49bf5c,0x3eac3f18bf803f04,0x3f7cbea1bf313f77,0x3e2fbf733f393e89,0xbf46be953f7fbef1,0xbf223f75bdc9bf62,0x3eb83f4abf51bea1,0x3f6fbf1dbf133f73,0x3e16bf803e793f67,0xbf7d3d493f78bedb,0xbf1d3f583ee6bf6f,0x3f4a3f09bf65beb8
.quad 0xbf353f35bf353f35,0xbf353f35bf353f35,0x3f1dbf093ee6beb8,0x3f4abf583f65bf6f,0xbf043eacbe16bd49,0xbf5c3f71bf7d3f80,0x3ecfbdfbbe2f3ee6,0x3f6abf7e3f7cbf65,0xbe95bdc93ef1bf46,0xbf753f7fbf623f22,0x3e2f3ea1bf393f77,0x3f7cbf733f31be89,0xbd49bf043f67bf7d,0xbf803f5cbedbbe16,0xbd973f31bf7e3f58,0x3f7fbf393dfb3f09
.quad 0x3e48bf553f7bbf0e,0xbf7b3f0e3e48bf55,0xbea13f6fbf5f3e2f,0x3f73beb8befc3f7c,0x3edbbf7d3f2c3e79,0xbf673e163f3ebf78,0xbf093f7fbecfbf1d,0x3f583d97bf6a3f4a,0x3f22bf753dc93f62,0xbf46be953f7fbef1,0xbf393f5f3e60bf7f,0x3f313efcbf7a3d97,0x3f4ebf3ebf043f71,0xbf18bf2c3f5c3eac,0xbf5f3f133f42bf39,0x3efc3f51bf27bf31
.quad 0xbf353f35bf353f35,0xbf353f35bf353f35,0x3f5fbf513f42bf31,0x3efcbf133f27bf39,0xbf783f67bf4e3f2c,0xbe793edbbf183f3e,0x3f80bf773f58bf27,0xbcc9be893f09bf42,0xbf753f7fbf623f22,0x3e953dc9bef13f46,0x3f58bf7f3f6abf1d,0xbf093d973ecfbf4a,0xbf2c3f78bf713f18,0x3f3ebe79beac3f4e,0x3ee6bf6a3f77bf13,0xbf653ecf3e89bf51
.quad 0xbe483f55bf7b3f0e,0x3f7bbf0ebe483f55,0xbd97bf393f7ebf09,0xbf7f3f313dfbbf58,0x3eac3f18bf803f04,0x3f71bf4ebd493f5c,0xbf13bee63f80befc,0xbf513f65bcc9bf5f,0x3f463e95bf7f3ef1,0x3f22bf753dc93f62,0xbf6abdfb3f7cbee6,0xbecf3f7ebe2fbf65,0x3f7dbd49bf783edb,0x3e16bf803e793f67,0xbf7e3e603f73becf,0x3dfb3f7abea1bf6a
.quad 0xbf353f35bf353f35,0xbf353f35bf353f35,0x3f7ebf7a3f73bf6a,0x3dfbbe603ea1becf,0xbf5c3f71bf7d3f80,0x3f04beac3e163d49,0x3eb8bf1d3f51bf73,0xbf6f3f4abf133ea1,0x3e953dc9bef13f46,0x3f75bf7f3f62bf22,0xbf513ee63cc9befc,0xbf133f65bf803f5f,0x3f80bf5c3edb3e16,0xbd49bf043f67bf7d,0xbf423f80bf4a3e60,0x3f27bcc9bf1d3f7a
.quad 0x3e48bf553f7bbf0e,0xbf7b3f0e3e48bf55,0x3ee63ecfbf773f51,0x3f65bf6a3e893f13,0xbf673e163f3ebf78,0xbedb3f7dbf2cbe79,0x3f7abf27beb83f7e,0xbe60bf423f6fbdfb,0xbf223f75bdc9bf62,0x3f463e95bf7f3ef1,0x3cc9bf773f093f27,0xbf803e893f58bf42,0x3f183f2cbf5cbeac,0x3f4ebf3ebf043f71,0xbf77be2f3f7fbcc9,0xbe893f7c3d97bf80
.quad 0xbf353f35bf353f35,0xbf353f35bf353f35,0x3f77bf7c3f7fbf80,0xbe893e2fbd97bcc9,0xbe793edbbf183f3e,0x3f78bf673f4ebf2c,0xbf393efcbe60bd97,0xbf313f5fbf7a3f7f,0x3f75bf7f3f62bf22,0xbe95bdc93ef1bf46,0xbe603f27bf6f3f7e,0x3f7abf423eb83dfb,0xbf3e3e793eacbf4e,0xbf2c3f78bf713f18,0x3f73bf6f3efc3e2f,0xbea1beb83f5fbf7c
.quad 0xbe483f55bf7b3f0e,0x3f7bbf0ebe483f55,0xbf42bcc93f4abf7a,0xbf273f80bf1dbe60,0x3f71bf4ebd493f5c,0xbeacbf183f80bf04,0xbe2f3f73bf39be89,0x3f7cbea1bf313f77,0xbf46be953f7fbef1,0xbf223f75bdc9bf62,0x3f6fbf1dbf133f73,0xbeb8bf4a3f513ea1,0xbe163f80be79bf67,0x3f7dbd49bf783edb,0xbf4abf093f653eb8,0xbf1d3f583ee6bf6f
.quad 0xbf353f35bf353f35,0xbf353f35bf353f35,0x3f4abf583f65bf6f,0xbf1d3f09bee63eb8,0x3f04beac3e163d49,0x3f5cbf713f7dbf80,0xbf6a3f7ebf7c3f65,0x3ecfbdfbbe2f3ee6,0xbe95bdc93ef1bf46,0xbf753f7fbf623f22,0x3f7cbf733f31be89,0xbe2fbea13f39bf77,0x3d493f04bf673f7d,0x3f80bf5c3edb3e16,0xbf7f3f39bdfbbf09,0xbd973f31bf7e3f58
.quad 0x3e48bf553f7bbf0e,0xbf7b3f0e3e48bf55,0x3f73beb8befc3f7c,0x3ea1bf6f3f5fbe2f,0xbedb3f7dbf2cbe79,0x3f67be16bf3e3f78,0xbf58bd973f6abf4a,0xbf093f7fbecfbf1d,0x3f22bf753dc93f62,0xbf46be953f7fbef1,0x3f313efcbf7a3d97,0x3f39bf5fbe603f7f,0xbf4e3f3e3f04bf71,0x3f183f2cbf5cbeac,0xbefcbf513f273f31,0xbf5f3f133f42bf39
.quad 0xbf353f35bf353f35,0xbf353f35bf353f35,0x3efcbf133f27bf39,0xbf5f3f51bf423f31,0x3f78bf673f4ebf2c,0x3e79bedb3f18bf3e,0x3cc93e89bf093f42,0x3f80bf773f58bf27,0xbf753f7fbf623f22,0x3e953dc9bef13f46,0xbf093d973ecfbf4a,0xbf583f7fbf6a3f1d,0x3f2cbf783f71bf18,0xbf3e3e793eacbf4e,0x3f65becfbe893f51,0x3ee6bf6a3f77bf13
.quad 0xbe483f55bf7b3f0e,0x3f7bbf0ebe483f55,0xbf7f3f313dfbbf58,0x3d973f39bf7e3f09,0xbeacbf183f80bf04,0xbf713f4e3d49bf5c,0x3f51bf653cc93f5f,0xbf13bee63f80befc,0x3f463e95bf7f3ef1,0x3f22bf753dc93f62,0xbecf3f7ebe2fbf65,0x3f6a3dfbbf7c3ee6,0xbf7d3d493f78bedb,0xbe163f80be79bf67,0xbdfbbf7a3ea13f6a,0xbf7e3e603f73becf
.quad 0xbf353f35bf353f35,0xbf353f35bf353f35,0x3dfbbe603ea1becf,0xbf7e3f7abf733f6a,0x3f5cbf713f7dbf80,0xbf043eacbe16bd49,0x3f6fbf4a3f13bea1,0x3eb8bf1d3f51bf73,0x3e953dc9bef13f46,0x3f75bf7f3f62bf22,0xbf133f65bf803f5f,0x3f51bee6bcc93efc,0xbf803f5cbedbbe16,0x3d493f04bf673f7d,0xbf273cc93f1dbf7a,0xbf423f80bf4a3e60
.quad 0x3e48bf553f7bbf0e,0xbf7b3f0e3e48bf55,0x3f65bf6a3e893f13,0xbee6becf3f77bf51,0x3f67be16bf3e3f78,0x3edbbf7d3f2c3e79,0x3e603f42bf6f3dfb,0x3f7abf27beb83f7e,0xbf223f75bdc9bf62,0x3f463e95bf7f3ef1,0xbf803e893f58bf42,0xbcc93f77bf09bf27,0xbf18bf2c3f5c3eac,0xbf4e3f3e3f04bf71,0x3e89bf7cbd973f80,0xbf77be2f3f7fbcc9
.quad 0xbf353f35bf353f35,0xbf353f35bf353f35,0xbe893e2fbd97bcc9,0xbf773f7cbf7f3f80,0x3e79bedb3f18bf3e,0xbf783f67bf4e3f2c,0x3f31bf5f3f7abf7f,0xbf393efcbe60bd97,0x3f75bf7f3f62bf22,0xbe95bdc93ef1bf46,0x3f7abf423eb83dfb,0x3e60bf273f6fbf7e,0x3f3ebe79beac3f4e,0x3f2cbf783f71bf18,0x3ea13eb8bf5f3f7c,0x3f73bf6f3efc3e2f
.quad 0xbe483f55bf7b3f0e,0x3f7bbf0ebe483f55,0xbf273f80bf1dbe60,0x3f423cc9bf4a3f7a,0xbf713f4e3d49bf5c,0x3eac3f18bf803f04,0xbf7c3ea13f31bf77,0xbe2f3f73bf39be89,0xbf46be953f7fbef1,0xbf223f75bdc9bf62,0xbeb8bf4a3f513ea1,0xbf6f3f1d3f13bf73,0x3e16bf803e793f67,0xbf7d3d493f78bedb,0x3f1dbf58bee63f6f,0xbf4abf093f653eb8
.quad 0xbf353f35bf353f35,0xbf353f35bf353f35,0xbf1d3f09bee63eb8,0xbf4a3f58bf653f6f,0xbf043eacbe16bd49,0xbf5c3f71bf7d3f80,0xbecf3dfb3e2fbee6,0xbf6a3f7ebf7c3f65,0xbe95bdc93ef1bf46,0xbf753f7fbf623f22,0xbe2fbea13f39bf77,0xbf7c3f73bf313e89,0xbd49bf043f67bf7d,0xbf803f5cbedbbe16,0x3d97bf313f7ebf58,0xbf7f3f39bdfbbf09
.quad 0x3e48bf553f7bbf0e,0xbf7b3f0e3e48bf55,0x3ea1bf6f3f5fbe2f,0xbf733eb83efcbf7c,0x3edbbf7d3f2c3e79,0xbf673e163f3ebf78,0x3f09bf7f3ecf3f1d,0xbf58bd973f6abf4a,0x3f22bf753dc93f62,0xbf46be953f7fbef1,0x3f39bf5fbe603f7f,0xbf31befc3f7abd97,0x3f4ebf3ebf043f71,0xbf18bf2c3f5c3eac,0x3f5fbf13bf423f39,0xbefcbf513f273f31
.quad 0x3f7ec9553f800000,0x3f7525a63f7b2848,0x3f7eb5793f800000,0x3f74753a3f7ad93a,0x3f7ea1003f800000,0x3f73bf813f7a87c1,0x3f7e8be93f800000,0x3f73047e3f7a33dd,0x3f7e76353f800000,0x3f7244373f79dd91,0x3f7e5fe53f800000,0x3f717eae3f7984dc,0x3f7e48f73f800000,0x3f70b3e93f7929bf,0x3f7e316d3f800000,0x3f6fe3eb3f78cc3b
.quad 0x3f7e19463f800000,0x3f6f0eba3f786c52,0x3f7e00823f800000,0x3f6e34593f780a04,0x3f7de7213f800000,0x3f6d54ce3f77a551,0x3f7dcd243f800000,0x3f6c701e3f773e3c,0x3f7db28a3f800000,0x3f6b864c3f76d4c4,0x3f7d97543f800000,0x3f6a97603f7668ec,0x3f7d7b823f800000,0x3f69a35d3f75fab3,0x3f7d5f133f800000,0x3f68aa493f758a1c
.quad 0x3f623ba43f6cd007,0x3f46c2803f55822c,0x3f605e5a3f6b99fb,0x3f433fd23f52df59,0x3f5e738b3f6a5ad9,0x3f3fa6173f502a3b,0x3f5c7b563f6912ae,0x3f3bf5bc3f4d6310,0x3f5a75d93f67c187,0x3f382f303f4a8a13,0x3f5863333f666771,0x3f3452e53f479f84,0x3f5643843f650479,0x3f3061503f44a3a5,0x3f5416ed3f6398ac,0x3f2c5ae73f4196b7
.quad 0x3f51dd8f3f62241a,0x3f2840263f3e78ff,0x3f4f978d3f60a6cf,0x3f2411873f3b4ac1,0x3f4d450a3f5f20db,0x3f1fcf893f380c43,0x3f4ae62a3f5d924d,0x3f1b7aad3f34bdcf,0x3f487b103f5bfb34,0x3f1713763f315fad,0x3f4603e33f5a5ba0,0x3f129a683f2df229,0x3f4380c83f58b3a1,0x3f0e100c3f2a758e,0x3f40f1e73f570348,0x3f0974e93f26ea2a
.quad 0x3f23c44f3f36206c,0x3ef527f83f0fdab8,0x3f1e45a73f31a81d,0x3ee5d9a43f094a7f,0x3f18a81d3f2d1469,0x3ed6484f3f029932,0x3f12ecc73f286605,0x3ec678823ef790dc,0x3f0d14c53f239da9,0x3eb66ed83ee9b3ae,0x3f07213a3f1ebc12,0x3ea62fff3edb9e31,0x3f01134f3f19c200,0x3e95c0b33ecd53ca,0x3ef5d8683f14b039,0x3e8525bf3ebed7eb
.quad 0x3ee95a373f0f8784,0x3e68c7f33eb02e10,0x3edcae7c3f0a48ad,0x3e47008b3ea159c2,0x3ecfd7ae3f04f484,0x3e24ff203e925e94,0x3ec2d8513eff17b2,0x3e02cd9b3e834022,0x3eb5b2ec3ef41f07,0x3dc0ebe63e680422,0x3ea86a123ee900b7,0x3d7808b33e495018,0x3e9b00593eddbe79,0x3cdbe2943e2a6b8d,0x3e8d78613ed25a09,0xbbe231603e0b5df3
.quad 0x3e9980e93ec8477c,0x3de02c7d3e528b89,0x3e85e7d93eb6ccc3,0x3d8249be3e275251,0x3e6430893ea5129f,0x3c90817a3df7942c,0x3e3c34763e931f35,0xbce872583da00ecf,0x3e13ebc13e80f8c0,0xbd983a0a3d107bb8,0x3dd6cda53e5d4b1a,0xbdf604fbbbfb5330,0x3d856c523e3857ec,0xbe29a548bd4f41af,0x3ccf52af3e1324ca,0xbe57ec1dbdbf5b8d
.quad 0xbc6ec0aa3ddb7d37,0xbe82def4be0b5df3,0xbd5ef15f3d9064b4,0xbe9980e9be36cc50,0xbdc0ebe63d0a342f,0xbeafcfa8be61e45c,0xbe090848bb490fc6,0xbec5bf1bbe8648df,0xbe3162d2bd2351cb,0xbedb435dbe9b6027,0xbe597522bd9cecf9,0xbef050c5beb02e10,0xbe809774bde7fa9a,0xbf026df4bec4a8c8,0xbe943ffbbe195be0,0xbf0c6cd3bed8c6a3
.quad 0xbdae25d93c490e90,0xbe8d7861be39e36c,0xbe0c2521bd16c32c,0xbea9e59dbe712f94,0xbe40d5c4bdafb680,0xbec5bf1bbe93dfbf,0xbe750026be09cf86,0xbee0eca3beaeb449,0xbe943ffbbe3b6ecf,0xbefb5692bec90077,0xbead98acbe6c9a7f,0xbf0a72f8bee2afc4,0xbec67882be8e9a22,0xbf16c241befbae22,0xbedece2abea68f12,0xbf228e71bf09f409
.quad 0xbef688b3bebe1d4a,0xbf2dcd44bf15a554,0xbf06cbcdbed53641,0xbf3874f4bf20e1d2,0xbf11f567beebcbbb,0xbf427c3cbf2ba0bf,0xbf1cb963bf00e7e4,0xbf4bda63bf35d9b8,0xbf271043bf0b9a6b,0xbf548745bf3f84c0,0xbf30f2d3bf15f6d9,0xbf5c7b56bf489a4e,0xbf3a5a31bf1ff6cb,0xbf63afabbf51134a,0xbf433fd2bf299415,0xbf6a1e01bf58e916
.quad 0xbeea0d1cbebca7af,0xbf1ee37ebf0a9d3d,0xbf03711dbed97cb9,0xbf2ca52fbf18d073,0xbf11500cbef58035,0xbf398ae7bf265184,0xbf1e949fbf084b92,0xbf458437bf3310af,0xbf2b30bebf1553b7,0xbf5081ddbf3eff1b,0xbf371704bf21cbfb,0xbf5a75d9bf4a0edc,0xbf423acebf2da859,0xbf63537bbf54330f,0xbf4c9045bf38dd65,0xbf6b0f79bf5d5fe1
.quad 0xbf560c70bf436051,0xbf719ff7bf658aa0,0xbf5ea53abf4d26fd,0xbf76fc99bf6ca9c5,0xbf665184bf5627fe,0xbf7b1e88bf72b504,0xbf6d0925bf5e5aa6,0xbf7e0082bf77a551,0xbf72c4fcbf65b710,0xbf7f9edabf7b74ea,0xbf777ef1bf6c3624,0xbf7ff780bf7e1f5e,0xbf7b31febf71d19f,0xbf7f0a03bf7fa191,0xbf7dda36bf76841b,0xbf7cd792bf7ff9c1
.quad 0xbf42bd8cbf31a81d,0xbf5f397bbf51fa54,0xbf4ee681bf3ebc1b,0xbf68d426bf5cfaa3,0xbf59d807bf4ac77f,0xbf70d611bf669330,0xbf6381a5bf55b993,0xbf77312ebf6eb45d,0xbf6bd4cebf5f8327,0xbf7bda55bf7550ed,0xbf72c4fcbf6816a8,0xbf7ec955bf7a5e1c,0xbf7847bcbf6f6830,0xbf7ff90bbf7dd3b2,0xbf7c54c4bf756d97,0xbf7f675fbf7fac0d
.quad 0xbf7ee5f9bf7a1e84,0xbf7d1551bf7fe42b,0xbf7ff780bf7d7474,0xbf7906f6bf7e7bb1,0xbf7f87bbbf7f6ac7,0xbf73436bbf7b74ea,0xbf7d9754bf7ffec4,0xbf6bd4cebf76d4c4,0xbf7a2936bf7f2f9d,0xbf62c82dbf70a2c6,0xbf754289bf7cfe73,0xbf582d6abf68e907,0xbf6eeab0bf796e4e,0xbf4c1723bf5fb419,0xbf672b36bf748422,0xbf3e9a91bf5512fb
.quad 0xbf73436bbf6a5ad9,0xbf7e1946bf79dd91,0xbf7962f9bf725470,0xbf7fe863bf7ded88,0xbf7d897ebf788486,0xbf7f675fbf7fd737,0xbf7fae93bf7cdf6c,0xbf7c9762bf7f9678,0xbf7fcddebf7f5ce9,0xbf777ef1bf7d2bd8,0xbf7de721bf7ff84a,0xbf7029d4bf789c93,0xbf79fe36bf7eb069,0xbf66a903bf71f28c,0xbf741b07bf7b87b2,0xbf5b127bbf693c32
.quad 0xbf6c4980bf76841b,0xbf4d810dbf5e8c67,0xbf629978bf6faf1b,0xbf3e141dbf51fa54,0xbf571e8cbf671599,0xbf2cef5dbf43a138,0xbf49effbbf5cc7d1,0xbf1a3a77bf33a029,0xbf3b2879bf50d937,0xbf0620b5bf2219d7,0xbf2ae5f2bf436051,0xbee1a130bf0f343b,0xbf194955bf34768f,0xbeb4f6e5bef63093,0xbf06764bbf24381a,0xbe86a9dfbecbe32c
.quad 0x3dc72d0200000000,0x3e937f7d3e463b4d,0x3dcd6da300000000,0x3e9801193e4c6467,0x3dd3adc500000000,0x3e9c7f6a3e528b89,0x3dd9ed6400000000,0x3ea0fa573e58b0a4,0x3de02c7d00000000,0x3ea571c53e5ed3a8,0x3de66b0c00000000,0x3ea9e59d3e64f486,0x3deca90d00000000,0x3eae55c63e6b132f,0x3df2e67c00000000,0x3eb2c2273e712f94
.quad 0x3df9235400000000,0x3eb72aa73e7749a6,0x3dff5f9400000000,0x3ebb8f2f3e7d6156,0x3e02cd9b00000000,0x3ebfefa53e81bb4a,0x3e05eb1b00000000,0x3ec44bf23e84c4aa,0x3e09084800000000,0x3ec8a3fd3e87ccc1,0x3e0c252100000000,0x3eccf7af3e8ad38a,0x3e0f41a400000000,0x3ed146ee3e8dd8fc,0x3e125dce00000000,0x3ed591a43e90dd10
.quad 0x3eef9f283ec27b55,0x3f2157033f0d3eb3,0x3ef688b33ec8477c,0x3f2592243f1126a7,0x3efd63653ece0bea,0x3f29b9b93f150204,0x3f0217693ed3c867,0x3f2dcd443f18d073,0x3f05754a3ed97cb9,0x3f31cc4b3f1c91a2,0x3f08cb203edf28a9,0x3f35b6533f20453b,0x3f0c18ba3ee4cbfe,0x3f398ae73f23eaee,0x3f0f5de23eea6681,0x3f3d49933f278268
.quad 0x3f129a683eeff7fb,0x3f40f1e73f2b0b5b,0x3f15ce193ef58035,0x3f4483723f2e8578,0x3f18f8c43efafef7,0x3f47fdca3f31f071,0x3f1c1a383f003a06,0x3f4b60853f354bfb,0x3f1f32453f02ef9f,0x3f4eab3e3f3897cb,0x3f2240bb3f05a02c,0x3f51dd8f3f3bd398,0x3f25456b3f084b92,0x3f54f71a3f3eff1b,0x3f2840263f0af1b7,0x3f57f7803f421a0b
.quad 0x3f44c3d13f33e7bc,0x3f60bee53f53c255,0x3f4936113f385216,0x3f64c0ee3f581279,0x3f4d810d3f3ca003,0x3f6880473f5c2e8e,0x3f51a3ed3f40d0da,0x3f6bfbd93f601596,0x3f559de33f44e3f5,0x3f6f329e3f63c6a1,0x3f596e293f48d8b3,0x3f7223a83f6740ca,0x3f5d13ff3f4cae79,0x3f74ce1a3f6a833c,0x3f608eb03f5064af,0x3f77312e3f6d8d2d
.quad 0x3f63dd8e3f53fac3,0x3f794c323f705de1,0x3f66fff33f577026,0x3f7b1e883f72f4ac,0x3f69f5433f5ac450,0x3f7ca7a93f7550ed,0x3f6cbcea3f5df6be,0x3f7de7213f777213,0x3f6f565e3f6106f2,0x3f7edc953f79579a,0x3f71c11b3f63f473,0x3f7f87bb3f7b010e,0x3f73fcaa3f66becc,0x3f7fe8633f7c6e08,0x3f76089c3f696591,0x3f7ffe703f7d9e30
.quad 0x3f74393e3f6b99fb,0x3f7e76353f7a87c1,0x3f7716f63f6f20b0,0x3f7f7b403f7c8f31,0x3f7990143f725470,0x3f7ff5ce3f7e1f5e,0x3f7ba3953f75341d,0x3f7fe59d3f7f378c,0x3f7d50a03f77beb7,0x3f7f4ab63f7fd737,0x3f7e96883f79f35e,0x3f7e256d3f7ffe13,0x3f7f74c73f7bd14d,0x3f7c76613f7fac0d,0x3f7feb023f7d57de,0x3f7a3e7c3f7ee14c
.quad 0x3f7ff90b3f7e868b,0x3f777ef13f7d9e30,0x3f7f9eda3f7f5ce9,0x3f74393e3f7be353,0x3f7edc953f7fdaaf,0x3f706f283f79b183,0x3f7db28a3f7fffb1,0x3f6c22bf3f7709cc,0x3f7c21343f7fcbe2,0x3f6756553f73ed6e,0x3f7a29363f7f3f54,0x3f620c863f705de1,0x3f77cb5c3f7e5a38,0x3f5c482f3f6c5cd4,0x3f75089d3f7d1cdd,0x3f560c703f67ec29
.quad 0x3f7f12a33f7ffb11,0x3f76089c3f7bbf20,0x3f7d97543f7fd397,0x3f717eae3f78cc3b,0x3f7b6b783f7f0e58,0x3f6c22bf3f751727,0x3f7890913f7dabcc,0x3f65f9773f70a2c6,0x3f75089d3f7baccd,0x3f5f08333f6b7295,0x3f70d6113f791298,0x3f5754fb3f658aa0,0x3f6bfbd93f75dec6,0x3f4ee6813f5eef81,0x3f667d553f721352,0x3f45c41c3f57a663
.quad 0x3f605e5a3f6db293,0x3f3bf5bc3f4fb4f4,0x3f59a3293f68bf3c,0x3f3183e93f472167,0x3f5250733f633c5a,0x3f2677b73f3df26e,0x3f4a6b513f5d2d53,0x3f1adac23f342f34,0x3f41f9423f5695e5,0x3f0eb7233f29df57,0x3f3900273f4f7a1f,0x3f0217693f1f0ae5,0x3f2f863f3f47de65,0x3eea0d1c3f13ba50,0x3f2592243f3fc767,0x3ecf1fde3f07f66f
.quad 0x3f63afab3f6dfcf2,0x3f48b9853f5739c7,0x3f5baded3f67c187,0x3f3d05d63f4d6310,0x3f52c2d53f60a6cf,0x3f3061503f429ce8,0x3f48f7da3f58b3a1,0x3f22dc0e3f36f3df,0x3f3e57663f4fefa8,0x3f14874b3f2a758e,0x3f32ecc03f466354,0x3f05754a3f1d3084,0x3f26c40a3f3c17d9,0x3eeb727a3f0f343b,0x3f19ea2e3f311722,0x3ecace633f0090ff
.quad 0x3f0c6cd33f256bcb,0x3ea927e53ee2afc4,0x3efcb49b3f19210f,0x3e86a9df3ec33544,0x3edf831f3f0c42c9,0x3e47008b3ea2d733,0x3ec164373efdbabb,0x3dff5f943e81bb4a,0x3ea277e03ee1fb6a,0x3d5ef15f3e401049,0x3e82def43ec5625c,0xbc83f0f23df7942c,0x3e4576073ea80b1f,0xbdb147213d5bce4c,0x3e045c653e8a11f7,0xbe205813bc622fff
.quad 0x3f262b4a3f385216,0x3efaa7533f127130,0x3f16c2413f2ac082,0x3ed4dad73f013eb5,0x3f06764b3f1c420c,0x3ead98ac3ede73a2,0x3eeabfdd3f0cead0,0x3e8525bf3eb8ffb2,0x3ec731ca3ef9a02d,0x3e3792223e925e94,0x3ea277e03ed8106b,0x3dc72d023e559e58,0x3e7992d03eb554ec,0x3c6ec0aa3e0523c2,0x3e2cbe363e919ddd,0xbd8bb13c3d4f41af
.quad 0x3dbdcb2c3e5a3997,0xbe1a22a8bceeba2c,0x3c83f0f23e1008b7,0xbe6d5e1abdde9cc4,0xbd7808b33d8a200a,0xbe9f7c6abe401049,0xbe0c2521bbc90f88,0xbec731cabe87ccc1,0xbe597522bda3308c,0xbeed8976beaeb449,0xbe92bee7be1c76de,0xbf092010bed47f64,0xbeb7e65bbe667c66,0xbf1a8aa8bef8f08e,0xbedbf8fdbe97a117,0xbf2ae5f2bf0de638
.quad 0x3e9f7c6a3ece0bea,0x3df923543e5ed3a8,0x3e6740483ea5129f,0x3cdbe2943e02062e,0x3e0db36d3e75c35a,0xbd8bb13c3d107bb8,0x3d4c1e733e1f917b,0xbe268bf2bd685a62,0xbd202e2d3d9064b4,0xbe82def4be17ce3d,0xbe02cd9bbc7b514b,0xbeb1491ebe743ce8,0xbe5c86c6bdcefdb7,0xbede1912bea74d25,0xbe9a40adbe3e853e,0xbf04738fbed31148
.quad 0xbec50596be8a11f7,0xbf18a81dbefd0c04,0xbeee3b81beb3dca5,0xbf2b7b70bf127130,0xbf0ac77dbedc53c1,0xbf3cc1fbbf251f04,0xbf1d582ebf019573,0xbf4c53c4bf366704,0xbf2eaa3bbf140c5f,0xbf5a0cc4bf4623bb,0xbf3e9a91bf256bcb,0xbf65cd3bbf54330f,0xbf4d08e8bf3592e7,0xbf6f79f8bf607689,0xbf59d807bf446337,0xbf76fc99bf6ad395
.quad 0x3f8000003f800000,0x3f8000003f800000,0x3f7eb5793f7ec955,0x3f7e8be93f7ea100,0x3f7ad93a3f7b2848,0x3f7a33dd3f7a87c1,0x3f74753a3f7525a6,0x3f73047e3f73bf81,0x3f6b99fb3f6cd007,0x3f6912ae3f6a5ad9,0x3f605e5a3f623ba4,0x3f5c7b563f5e738b,0x3f52df593f55822c,0x3f4d63103f502a3b,0x3f433fd23f46c280,0x3f3bf5bc3f3fa617
.quad 0x3f31a81d3f36206c,0x3f2866053f2d1469,0x3f1e45a73f23c44f,0x3f12ecc73f18a81d,0x3f094a7f3f0fdab8,0x3ef790dc3f029932,0x3ee5d9a43ef527f8,0x3ec678823ed6484f,0x3eb6ccc33ec8477c,0x3e931f353ea5129f,0x3e85e7d93e9980e9,0x3e3c34763e643089,0x3e2752513e528b89,0x3da00ecf3df7942c,0x3d8249be3de02c7d,0xbce872583c90817a
.quad 0x3f8000003f800000,0x3f8000003f800000,0x3f7e5fe53f7e7635,0x3f7e316d3f7e48f7,0x3f7984dc3f79dd91,0x3f78cc3b3f7929bf,0x3f717eae3f724437,0x3f6fe3eb3f70b3e9,0x3f6667713f67c187,0x3f6398ac3f650479,0x3f5863333f5a75d9,0x3f5416ed3f564384,0x3f479f843f4a8a13,0x3f4196b73f44a3a5,0x3f3452e53f382f30,0x3f2c5ae73f306150
.quad 0x3f1ebc123f239da9,0x3f14b0393f19c200,0x3f07213a3f0d14c5,0x3ef5d8683f01134f,0x3edb9e313ee9b3ae,0x3ebed7eb3ecd53ca,0x3ea62fff3eb66ed8,0x3e8525bf3e95c0b3,0x3e5d4b1a3e80f8c0,0x3e1324ca3e3857ec,0x3dd6cda53e13ebc1,0x3ccf52af3d856c52,0xbbfb53303d107bb8,0xbdbf5b8dbd4f41af,0xbdf604fbbd983a0a,0xbe57ec1dbe29a548
.quad 0x3f8000003f800000,0x3f8000003f800000,0x3f7e00823f7e1946,0x3f7dcd243f7de721,0x3f780a043f786c52,0x3f773e3c3f77a551,0x3f6e34593f6f0eba,0x3f6c701e3f6d54ce,0x3f60a6cf3f62241a,0x3f5d924d3f5f20db,0x3f4f978d3f51dd8f,0x3f4ae62a3f4d450a,0x3f3b4ac13f3e78ff,0x3f34bdcf3f380c43,0x3f2411873f284026,0x3f1b7aad3f1fcf89
.quad 0x3f0a48ad3f0f8784,0x3eff17b23f04f484,0x3edcae7c3ee95a37,0x3ec2d8513ecfd7ae,0x3ea159c23eb02e10,0x3e8340223e925e94,0x3e47008b3e68c7f3,0x3e02cd9b3e24ff20,0x3d9064b43ddb7d37,0xbb490fc63d0a342f,0xbd5ef15fbc6ec0aa,0xbe090848bdc0ebe6,0xbe36cc50be0b5df3,0xbe8648dfbe61e45c,0xbe9980e9be82def4,0xbec5bf1bbeafcfa8
.quad 0x3f8000003f800000,0x3f8000003f800000,0x3f7d97543f7db28a,0x3f7d5f133f7d7b82,0x3f7668ec3f76d4c4,0x3f758a1c3f75fab3,0x3f6a97603f6b864c,0x3f68aa493f69a35d,0x3f5a5ba03f5bfb34,0x3f5703483f58b3a1,0x3f4603e33f487b10,0x3f40f1e73f4380c8,0x3f2df2293f315fad,0x3f26ea2a3f2a758e,0x3f129a683f171376,0x3f0974e93f0e100c
.quad 0x3ee900b73ef41f07,0x3ed25a093eddbe79,0x3ea86a123eb5b2ec,0x3e8d78613e9b0059,0x3e4950183e680422,0x3e0b5df33e2a6b8d,0x3d7808b33dc0ebe6,0xbbe231603cdbe294,0xbd9cecf9bd2351cb,0xbe195be0bde7fa9a,0xbe597522be3162d2,0xbe943ffbbe809774,0xbeb02e10be9b6027,0xbed8c6a3bec4a8c8,0xbef050c5bedb435d,0xbf0c6cd3bf026df4
.quad 0xbd16c32c3c490e90,0xbe09cf86bdafb680,0xbe0c2521bdae25d9,0xbe750026be40d5c4,0xbe712f94be39e36c,0xbeaeb449be93dfbf,0xbea9e59dbe8d7861,0xbee0eca3bec5bf1b,0xbed97cb9bebca7af,0xbf084b92bef58035,0xbf03711dbeea0d1c,0xbf1e949fbf11500c,0xbf18d073bf0a9d3d,0xbf3310afbf265184,0xbf2ca52fbf1ee37e,0xbf458437bf398ae7
.quad 0xbf3ebc1bbf31a81d,0xbf55b993bf4ac77f,0xbf4ee681bf42bd8c,0xbf6381a5bf59d807,0xbf5cfaa3bf51fa54,0xbf6eb45dbf669330,0xbf68d426bf5f397b,0xbf77312ebf70d611,0xbf725470bf6a5ad9,0xbf7cdf6cbf788486,0xbf7962f9bf73436b,0xbf7fae93bf7d897e,0xbf7ded88bf79dd91,0xbf7f9678bf7fd737,0xbf7fe863bf7e1946,0xbf7c9762bf7f675f
.quad 0xbe6c9a7fbe3b6ecf,0xbea68f12be8e9a22,0xbead98acbe943ffb,0xbedece2abec67882,0xbee2afc4bec90077,0xbf09f409befbae22,0xbf0a72f8befb5692,0xbf228e71bf16c241,0xbf21cbfbbf1553b7,0xbf38dd65bf2da859,0xbf371704bf2b30be,0xbf4c9045bf423ace,0xbf4a0edcbf3eff1b,0xbf5d5fe1bf54330f,0xbf5a75d9bf5081dd,0xbf6b0f79bf63537b
.quad 0xbf6816a8bf5f8327,0xbf756d97bf6f6830,0xbf72c4fcbf6bd4ce,0xbf7c54c4bf7847bc,0xbf7a5e1cbf7550ed,0xbf7fac0dbf7dd3b2,0xbf7ec955bf7bda55,0xbf7f675fbf7ff90b,0xbf7ff84abf7f5ce9,0xbf7b87b2bf7eb069,0xbf7de721bf7fcdde,0xbf741b07bf79fe36,0xbf789c93bf7d2bd8,0xbf693c32bf71f28c,0xbf7029d4bf777ef1,0xbf5b127bbf66a903
.quad 0xbed53641bebe1d4a,0xbf00e7e4beebcbbb,0xbf06cbcdbef688b3,0xbf1cb963bf11f567,0xbf20e1d2bf15a554,0xbf35d9b8bf2ba0bf,0xbf3874f4bf2dcd44,0xbf4bda63bf427c3c,0xbf4d26fdbf436051,0xbf5e5aa6bf5627fe,0xbf5ea53abf560c70,0xbf6d0925bf665184,0xbf6ca9c5bf658aa0,0xbf77a551bf72b504,0xbf76fc99bf719ff7,0xbf7e0082bf7b1e88
.quad 0xbf7d7474bf7a1e84,0xbf7ffec4bf7f6ac7,0xbf7ff780bf7ee5f9,0xbf7d9754bf7f87bb,0xbf7e7bb1bf7fe42b,0xbf76d4c4bf7b74ea,0xbf7906f6bf7d1551,0xbf6bd4cebf73436b,0xbf6faf1bbf76841b,0xbf5cc7d1bf671599,0xbf629978bf6c4980,0xbf49effbbf571e8c,0xbf51fa54bf5e8c67,0xbf33a029bf43a138,0xbf3e141dbf4d810d,0xbf1a3a77bf2cef5d
.quad 0xbf15f6d9bf0b9a6b,0xbf299415bf1ff6cb,0xbf30f2d3bf271043,0xbf433fd2bf3a5a31,0xbf489a4ebf3f84c0,0xbf58e916bf51134a,0xbf5c7b56bf548745,0xbf6a1e01bf63afab,0xbf6c3624bf65b710,0xbf76841bbf71d19f,0xbf777ef1bf72c4fc,0xbf7dda36bf7b31fe,0xbf7e1f5ebf7b74ea,0xbf7ff9c1bf7fa191,0xbf7ff780bf7f9eda,0xbf7cd792bf7f0a03
.quad 0xbf7cfe73bf7f2f9d,0xbf748422bf796e4e,0xbf754289bf7a2936,0xbf672b36bf6eeab0,0xbf68e907bf70a2c6,0xbf5512fbbf5fb419,0xbf582d6abf62c82d,0xbf3e9a91bf4c1723,0xbf436051bf50d937,0xbf24381abf34768f,0xbf2ae5f2bf3b2879,0xbf06764bbf194955,0xbf0f343bbf2219d7,0xbecbe32cbef63093,0xbee1a130bf0620b5,0xbe86a9dfbeb4f6e5
.quad 0,0,0x3dcd6da33dc72d02,0x3dd9ed643dd3adc5,0x3e4c64673e463b4d,0x3e58b0a43e528b89,0x3e9801193e937f7d,0x3ea0fa573e9c7f6a,0x3ec8477c3ec27b55,0x3ed3c8673ece0bea,0x3ef688b33eef9f28,0x3f0217693efd6365,0x3f1126a73f0d3eb3,0x3f18d0733f150204,0x3f2592243f215703,0x3f2dcd443f29b9b9
.quad 0x3f3852163f33e7bc,0x3f40d0da3f3ca003,0x3f4936113f44c3d1,0x3f51a3ed3f4d810d,0x3f5812793f53c255,0x3f6015963f5c2e8e,0x3f64c0ee3f60bee5,0x3f6bfbd93f688047,0x3f6f20b03f6b99fb,0x3f75341d3f725470,0x3f7716f63f74393e,0x3f7ba3953f799014,0x3f7c8f313f7a87c1,0x3f7f378c3f7e1f5e,0x3f7f7b403f7e7635,0x3f7fe59d3f7ff5ce
.quad 0,0,0x3de66b0c3de02c7d,0x3df2e67c3deca90d,0x3e64f4863e5ed3a8,0x3e712f943e6b132f,0x3ea9e59d3ea571c5,0x3eb2c2273eae55c6,0x3edf28a93ed97cb9,0x3eea66813ee4cbfe,0x3f08cb203f05754a,0x3f0f5de23f0c18ba,0x3f20453b3f1c91a2,0x3f2782683f23eaee,0x3f35b6533f31cc4b,0x3f3d49933f398ae7
.quad 0x3f48d8b33f44e3f5,0x3f5064af3f4cae79,0x3f596e293f559de3,0x3f608eb03f5d13ff,0x3f6740ca3f63c6a1,0x3f6d8d2d3f6a833c,0x3f7223a83f6f329e,0x3f77312e3f74ce1a,0x3f79f35e3f77beb7,0x3f7d57de3f7bd14d,0x3f7e96883f7d50a0,0x3f7feb023f7f74c7,0x3f7ffe133f7fd737,0x3f7ee14c3f7fac0d,0x3f7e256d3f7f4ab6,0x3f7a3e7c3f7c7661
.quad 0,0,0x3dff5f943df92354,0x3e05eb1b3e02cd9b,0x3e7d61563e7749a6,0x3e84c4aa3e81bb4a,0x3ebb8f2f3eb72aa7,0x3ec44bf23ebfefa5,0x3ef580353eeff7fb,0x3f003a063efafef7,0x3f15ce193f129a68,0x3f1c1a383f18f8c4,0x3f2e85783f2b0b5b,0x3f354bfb3f31f071,0x3f4483723f40f1e7,0x3f4b60853f47fdca
.quad 0x3f5770263f53fac3,0x3f5df6be3f5ac450,0x3f66fff33f63dd8e,0x3f6cbcea3f69f543,0x3f72f4ac3f705de1,0x3f7772133f7550ed,0x3f7b1e883f794c32,0x3f7de7213f7ca7a9,0x3f7f5ce93f7e868b,0x3f7fffb13f7fdaaf,0x3f7f9eda3f7ff90b,0x3f7db28a3f7edc95,0x3f7be3533f7d9e30,0x3f7709cc3f79b183,0x3f74393e3f777ef1,0x3f6c22bf3f706f28
.quad 0,0,0x3e0c25213e090848,0x3e125dce3e0f41a4,0x3e8ad38a3e87ccc1,0x3e90dd103e8dd8fc,0x3eccf7af3ec8a3fd,0x3ed591a43ed146ee,0x3f05a02c3f02ef9f,0x3f0af1b73f084b92,0x3f2240bb3f1f3245,0x3f2840263f25456b,0x3f3bd3983f3897cb,0x3f421a0b3f3eff1b,0x3f51dd8f3f4eab3e,0x3f57f7803f54f71a
.quad 0x3f63f4733f6106f2,0x3f6965913f66becc,0x3f71c11b3f6f565e,0x3f76089c3f73fcaa,0x3f7b010e3f79579a,0x3f7d9e303f7c6e08,0x3f7f87bb3f7edc95,0x3f7ffe703f7fe863,0x3f7f3f543f7fcbe2,0x3f7d1cdd3f7e5a38,0x3f7a29363f7c2134,0x3f75089d3f77cb5c,0x3f705de13f73ed6e,0x3f67ec293f6c5cd4,0x3f620c863f675655,0x3f560c703f5c482f
.quad 0x3f7fd3973f7ffb11,0x3f7dabcc3f7f0e58,0x3f7d97543f7f12a3,0x3f7890913f7b6b78,0x3f78cc3b3f7bbf20,0x3f70a2c63f751727,0x3f717eae3f76089c,0x3f65f9773f6c22bf,0x3f67c1873f6dfcf2,0x3f58b3a13f60a6cf,0x3f5baded3f63afab,0x3f48f7da3f52c2d5,0x3f4d63103f5739c7,0x3f36f3df3f429ce8,0x3f3d05d63f48b985,0x3f22dc0e3f306150
.quad 0x3f2ac0823f385216,0x3f0cead03f1c420c,0x3f16c2413f262b4a,0x3eeabfdd3f06764b,0x3f013eb53f127130,0x3eb8ffb23ede73a2,0x3ed4dad73efaa753,0x3e8525bf3ead98ac,0x3ea5129f3ece0bea,0x3e1f917b3e75c35a,0x3e6740483e9f7c6a,0x3d4c1e733e0db36d,0x3e02062e3e5ed3a8,0xbd685a623d107bb8,0x3cdbe2943df92354,0xbe268bf2bd8bb13c
.quad 0x3f7912983f7baccd,0x3f7213523f75dec6,0x3f70d6113f75089d,0x3f667d553f6bfbd9,0x3f658aa03f6b7295,0x3f57a6633f5eef81,0x3f5754fb3f5f0833,0x3f45c41c3f4ee681,0x3f4663543f4fefa8,0x3f3117223f3c17d9,0x3f32ecc03f3e5766,0x3f19ea2e3f26c40a,0x3f1d30843f2a758e,0x3f0090ff3f0f343b,0x3f05754a3f14874b,0x3ecace633eeb727a
.quad 0x3ed8106b3ef9a02d,0x3e919ddd3eb554ec,0x3ea277e03ec731ca,0x3e2cbe363e7992d0,0x3e559e583e925e94,0x3d4f41af3e0523c2,0x3dc72d023e379222,0xbd8bb13c3c6ec0aa,0xbc7b514b3d9064b4,0xbe3e853ebdcefdb7,0xbe02cd9bbd202e2d,0xbe9a40adbe5c86c6,0xbe743ce8be17ce3d,0xbed31148bea74d25,0xbeb1491ebe82def4,0xbf04738fbede1912
.quad 0x3f68bf3c3f6db293,0x3f5d2d533f633c5a,0x3f59a3293f605e5a,0x3f4a6b513f525073,0x3f4721673f4fb4f4,0x3f342f343f3df26e,0x3f3183e93f3bf5bc,0x3f1adac23f2677b7,0x3f19210f3f256bcb,0x3efdbabb3f0c42c9,0x3efcb49b3f0c6cd3,0x3ec164373edf831f,0x3ec335443ee2afc4,0x3e81bb4a3ea2d733,0x3e86a9df3ea927e5,0x3dff5f943e47008b
.quad 0x3e1008b73e5a3997,0xbbc90f883d8a200a,0x3c83f0f23dbdcb2c,0xbe0c2521bd7808b3,0xbdde9cc4bceeba2c,0xbe87ccc1be401049,0xbe6d5e1abe1a22a8,0xbec731cabe9f7c6a,0xbeb3dca5be8a11f7,0xbf019573bedc53c1,0xbeee3b81bec50596,0xbf1d582ebf0ac77d,0xbf127130befd0c04,0xbf366704bf251f04,0xbf2b7b70bf18a81d,0xbf4c53c4bf3cc1fb
.quad 0x3f4f7a1f3f5695e5,0x3f3fc7673f47de65,0x3f3900273f41f942,0x3f2592243f2f863f,0x3f1f0ae53f29df57,0x3f07f66f3f13ba50,0x3f0217693f0eb723,0x3ecf1fde3eea0d1c,0x3ec5625c3ee1fb6a,0x3e8a11f73ea80b1f,0x3e82def43ea277e0,0x3e045c653e457607,0x3df7942c3e401049,0xbc622fff3d5bce4c,0xbc83f0f23d5ef15f,0xbe205813bdb14721
.quad 0xbe1c76debda3308c,0xbe97a117be667c66,0xbe92bee7be597522,0xbedbf8fdbeb7e65b,0xbed47f64beaeb449,0xbf0de638bef8f08e,0xbf092010beed8976,0xbf2ae5f2bf1a8aa8,0xbf256bcbbf140c5f,0xbf446337bf3592e7,0xbf3e9a91bf2eaa3b,0xbf59d807bf4d08e8,0xbf54330fbf4623bb,0xbf6ad395bf607689,0xbf65cd3bbf5a0cc4,0xbf76fc99bf6f79f8
.quad 0xbf8000003f80,0x3f800000bf800000,0xbe95bf7b3dc93f80,0x3f75be48bf7f0000,0xbf0ebf6d3e483f80,0x3f55bec4bf7b0000,0xbf46bf553e953f80,0x3f22bf0ebf750000,0xbf6dbf353ec43f80,0x3ec4bf35bf6d0000,0xbf7fbf0e3ef13f80,0x3dc9bf55bf620000,0xbf7bbec43f0e3f80,0xbe48bf6dbf550000,0xbf62be483f223f80,0xbef1bf7bbf460000
.quad 0xbf3500003f353f80,0xbf35bf80bf350000,0xbef13e483f463f80,0xbf62bf7bbf220000,0xbe483ec43f553f80,0xbf7bbf6dbf0e0000,0x3dc93f0e3f623f80,0xbf7fbf55bef10000,0x3ec43f353f6d3f80,0xbf6dbf35bec40000,0x3f223f553f753f80,0xbf46bf0ebe950000,0x3f553f6d3f7b3f80,0xbf0ebec4be480000,0x3f753f7b3f7f3f80,0xbe95be48bdc90000
.quad 0xbf8000003f80,0x3f800000bf800000,0xbf22bf553ef13f6d,0x3f46bf0ebf623ec4,0xbf7bbec43f553f35,0x3e48bf6dbf0e3f35,0xbf623e483f7f3ec4,0xbef1bf7bbdc93f6d,0xbec43f353f6d0000,0xbf6dbf353ec43f80,0x3e953f7b3f22bec4,0xbf75be483f463f6d,0x3f553f6d3e48bf35,0xbf0e3ec43f7b3f35,0x3f7f3f0ebe95bf6d,0x3dc93f553f753ec4
.quad 0x3f350000bf35bf80,0x3f353f803f350000,0x3dc9bf0ebf75bf6d,0x3f7f3f553e95bec4,0xbf0ebf6dbf7bbf35,0x3f553ec4be48bf35,0xbf75bf7bbf46bec4,0x3e95be48bf22bf6d,0xbf6dbf35bec40000,0xbec4bf35bf6dbf80,0xbef1be483dc93ec4,0xbf62bf7bbf7fbf6d,0x3e483ec43f0e3f35,0xbf7bbf6dbf55bf35,0x3f463f553f623f6d,0xbf22bf0ebef1bec4
.quad 0xbf8000003f80,0x3f800000bf800000,0xbf62bf0e3f463f35,0x3ef1bf55bf223f35,0xbf553ec43f7b0000,0xbf0ebf6d3e483f80,0x3dc93f7b3ef1bf35,0xbf7fbe483f623f35,0x3f6d3f35bec4bf80,0xbec43f353f6d0000,0x3f46be48bf75bf35,0x3f223f7b3e95bf35,0xbe48bf6dbf550000,0x3f7b3ec4bf0ebf80,0xbf75bf55bdc93f35,0x3e95bf0ebf7fbf35
.quad 0xbf3500003f353f80,0xbf35bf80bf350000,0x3e953f553f7f3f35,0xbf75bf0e3dc93f35,0x3f7b3f6d3f0e0000,0xbe483ec43f553f80,0x3f223e48be95bf35,0x3f463f7b3f753f35,0xbec4bf35bf6dbf80,0x3f6d3f353ec40000,0xbf7fbf7bbf62bf35,0x3dc9be48bef1bf35,0xbf0ebec4be480000,0xbf55bf6dbf7bbf80,0x3ef13f0e3f223f35,0xbf62bf55bf46bf35
.quad 0xbf8000003f80,0x3f800000bf800000,0xbf7fbe483f753ec4,0x3dc9bf7bbe953f6d,0xbe483f6d3f0ebf35,0xbf7bbec43f553f35,0x3f753f0ebf22bf6d,0xbe953f553f46bec4,0x3ec4bf35bf6d0000,0x3f6d3f35bec4bf80,0xbf62bf553dc93f6d,0x3ef1bf0ebf7fbec4,0xbf0e3ec43f7b3f35,0xbf55bf6dbe483f35,0x3f463f7b3ef1bec4,0xbf223e483f623f6d
.quad 0x3f350000bf35bf80,0x3f353f803f350000,0xbf22bf7bbf62bec4,0x3f463e48bef1bf6d,0xbf55bec43e483f35,0xbf0ebf6dbf7bbf35,0x3ef13f553f7f3f6d,0xbf62bf0ebdc93ec4,0x3f6d3f353ec40000,0x3ec43f353f6d3f80,0xbe95bf0ebf46bf6d,0x3f753f553f223ec4,0xbf7bbf6dbf55bf35,0xbe48bec4bf0ebf35,0x3dc93e483e953ec4,0xbf7fbf7bbf75bf6d
.quad 0xbf8000003f80,0xbf8080003f808000,0xbe95bf7b3dc93f80,0xbf753e483f7f8000,0xbf0ebf6d3e483f80,0xbf553ec43f7b8000,0xbf46bf553e953f80,0xbf223f0e3f758000,0xbf6dbf353ec43f80,0xbec43f353f6d8000,0xbf7fbf0e3ef13f80,0xbdc93f553f628000,0xbf7bbec43f0e3f80,0x3e483f6d3f558000,0xbf62be483f223f80,0x3ef13f7b3f468000
.quad 0xbf3500003f353f80,0x3f353f803f358000,0xbef13e483f463f80,0x3f623f7b3f228000,0xbe483ec43f553f80,0x3f7b3f6d3f0e8000,0x3dc93f0e3f623f80,0x3f7f3f553ef18000,0x3ec43f353f6d3f80,0x3f6d3f353ec48000,0x3f223f553f753f80,0x3f463f0e3e958000,0x3f553f6d3f7b3f80,0x3f0e3ec43e488000,0x3f753f7b3f7f3f80,0x3e953e483dc98000
.quad 0xbf8000003f80,0xbf8080003f808000,0xbf22bf553ef13f6d,0xbf463f0e3f62bec4,0xbf7bbec43f553f35,0xbe483f6d3f0ebf35,0xbf623e483f7f3ec4,0x3ef13f7b3dc9bf6d,0xbec43f353f6d0000,0x3f6d3f35bec4bf80,0x3e953f7b3f22bec4,0x3f753e48bf46bf6d,0x3f553f6d3e48bf35,0x3f0ebec4bf7bbf35,0x3f7f3f0ebe95bf6d,0xbdc9bf55bf75bec4
.quad 0x3f350000bf35bf80,0xbf35bf80bf358000,0x3dc9bf0ebf75bf6d,0xbf7fbf55be953ec4,0xbf0ebf6dbf7bbf35,0xbf55bec43e483f35,0xbf75bf7bbf46bec4,0xbe953e483f223f6d,0xbf6dbf35bec40000,0x3ec43f353f6d3f80,0xbef1be483dc93ec4,0x3f623f7b3f7f3f6d,0x3e483ec43f0e3f35,0x3f7b3f6d3f553f35,0x3f463f553f623f6d,0x3f223f0e3ef13ec4
.quad 0xbf8000003f80,0xbf8080003f808000,0xbf62bf0e3f463f35,0xbef13f553f22bf35,0xbf553ec43f7b0000,0x3f0e3f6dbe48bf80,0x3dc93f7b3ef1bf35,0x3f7f3e48bf62bf35,0x3f6d3f35bec4bf80,0x3ec4bf35bf6d8000,0x3f46be48bf75bf35,0xbf22bf7bbe953f35,0xbe48bf6dbf550000,0xbf7bbec43f0e3f80,0xbf75bf55bdc93f35,0xbe953f0e3f7f3f35
.quad 0xbf3500003f353f80,0x3f353f803f358000,0x3e953f553f7f3f35,0x3f753f0ebdc9bf35,0x3f7b3f6d3f0e0000,0x3e48bec4bf55bf80,0x3f223e48be95bf35,0xbf46bf7bbf75bf35,0xbec4bf35bf6dbf80,0xbf6dbf35bec48000,0xbf7fbf7bbf62bf35,0xbdc93e483ef13f35,0xbf0ebec4be480000,0x3f553f6d3f7b3f80,0x3ef13f0e3f223f35,0x3f623f553f463f35
.quad 0xbf8000003f80,0xbf8080003f808000,0xbf7fbe483f753ec4,0xbdc93f7b3e95bf6d,0xbe483f6d3f0ebf35,0x3f7b3ec4bf55bf35,0x3f753f0ebf22bf6d,0x3e95bf55bf463ec4,0x3ec4bf35bf6d0000,0xbf6dbf353ec43f80,0xbf62bf553dc93f6d,0xbef13f0e3f7f3ec4,0xbf0e3ec43f7b3f35,0x3f553f6d3e48bf35,0x3f463f7b3ef1bec4,0x3f22be48bf62bf6d
.quad 0x3f350000bf35bf80,0xbf35bf80bf358000,0xbf22bf7bbf62bec4,0xbf46be483ef13f6d,0xbf55bec43e483f35,0x3f0e3f6d3f7b3f35,0x3ef13f553f7f3f6d,0x3f623f0e3dc9bec4,0x3f6d3f353ec40000,0xbec4bf35bf6dbf80,0xbe95bf0ebf46bf6d,0xbf75bf55bf22bec4,0xbf7bbf6dbf55bf35,0x3e483ec43f0e3f35,0x3dc93e483e953ec4,0x3f7f3f7b3f753f6d
.quad 0xbf8000003f80,0xbf8000003f80,0xbe95bf7b3dc93f80,0xbf753e483f7f0000,0xbf0ebf6d3e483f80,0x3f0e3f6dbe48bf80,0xbf46bf553e953f80,0x3f22bf0ebf750000,0xbf6dbf353ec43f80,0xbf6dbf353ec43f80,0xbf7fbf0e3ef13f80,0xbdc93f553f620000,0xbf7bbec43f0e3f80,0x3f7b3ec4bf0ebf80,0xbf62be483f223f80,0xbef1bf7bbf460000
.quad 0xbf3500003f353f80,0xbf3500003f353f80,0xbef13e483f463f80,0x3f623f7b3f220000,0xbe483ec43f553f80,0x3e48bec4bf55bf80,0x3dc93f0e3f623f80,0xbf7fbf55bef10000,0x3ec43f353f6d3f80,0x3ec43f353f6d3f80,0x3f223f553f753f80,0x3f463f0e3e950000,0x3f553f6d3f7b3f80,0xbf55bf6dbf7bbf80,0x3f753f7b3f7f3f80,0xbe95be48bdc90000
.quad 0xbf8000003f80,0xbf8000003f80,0xbf22bf553ef13f6d,0xbf463f0e3f62bec4,0xbf7bbec43f553f35,0x3f7b3ec4bf55bf35,0xbf623e483f7f3ec4,0xbef1bf7bbdc93f6d,0xbec43f353f6d0000,0xbec43f353f6d0000,0x3e953f7b3f22bec4,0x3f753e48bf46bf6d,0x3f553f6d3e48bf35,0xbf55bf6dbe483f35,0x3f7f3f0ebe95bf6d,0x3dc93f553f753ec4
.quad 0x3f350000bf35bf80,0x3f350000bf35bf80,0x3dc9bf0ebf75bf6d,0xbf7fbf55be953ec4,0xbf0ebf6dbf7bbf35,0x3f0e3f6d3f7b3f35,0xbf75bf7bbf46bec4,0x3e95be48bf22bf6d,0xbf6dbf35bec40000,0xbf6dbf35bec40000,0xbef1be483dc93ec4,0x3f623f7b3f7f3f6d,0x3e483ec43f0e3f35,0xbe48bec4bf0ebf35,0x3f463f553f623f6d,0xbf22bf0ebef1bec4
.quad 0xbf8000003f80,0xbf8000003f80,0xbf62bf0e3f463f35,0xbef13f553f22bf35,0xbf553ec43f7b0000,0x3f55bec4bf7b0000,0x3dc93f7b3ef1bf35,0xbf7fbe483f623f35,0x3f6d3f35bec4bf80,0x3f6d3f35bec4bf80,0x3f46be48bf75bf35,0xbf22bf7bbe953f35,0xbe48bf6dbf550000,0x3e483f6d3f550000,0xbf75bf55bdc93f35,0x3e95bf0ebf7fbf35
.quad 0xbf3500003f353f80,0xbf3500003f353f80,0x3e953f553f7f3f35,0x3f753f0ebdc9bf35,0x3f7b3f6d3f0e0000,0xbf7bbf6dbf0e0000,0x3f223e48be95bf35,0x3f463f7b3f753f35,0xbec4bf35bf6dbf80,0xbec4bf35bf6dbf80,0xbf7fbf7bbf62bf35,0xbdc93e483ef13f35,0xbf0ebec4be480000,0x3f0e3ec43e480000,0x3ef13f0e3f223f35,0xbf62bf55bf46bf35
.quad 0xbf8000003f80,0xbf8000003f80,0xbf7fbe483f753ec4,0xbdc93f7b3e95bf6d,0xbe483f6d3f0ebf35,0x3e48bf6dbf0e3f35,0x3f753f0ebf22bf6d,0xbe953f553f46bec4,0x3ec4bf35bf6d0000,0x3ec4bf35bf6d0000,0xbf62bf553dc93f6d,0xbef13f0e3f7f3ec4,0xbf0e3ec43f7b3f35,0x3f0ebec4bf7bbf35,0x3f463f7b3ef1bec4,0xbf223e483f623f6d
.quad 0x3f350000bf35bf80,0x3f350000bf35bf80,0xbf22bf7bbf62bec4,0xbf46be483ef13f6d,0xbf55bec43e483f35,0x3f553ec4be48bf35,0x3ef13f553f7f3f6d,0xbf62bf0ebdc93ec4,0x3f6d3f353ec40000,0x3f6d3f353ec40000,0xbe95bf0ebf46bf6d,0xbf75bf55bf22bec4,0xbf7bbf6dbf55bf35,0x3f7b3f6d3f553f35,0x3dc93e483e953ec4,0xbf7fbf7bbf75bf6d
.quad 0x3f800000bf800000,0xbf8000003f80,0xbe95bf7b3dc93f80,0xbf753e483f7f0000,0xbf553ec43f7b0000,0x3f0e3f6dbe48bf80,0x3f463f55be95bf80,0x3f22bf0ebf750000,0x3ec4bf35bf6d0000,0xbf6dbf353ec43f80,0xbf7fbf0e3ef13f80,0xbdc93f553f620000,0x3e483f6d3f550000,0x3f7b3ec4bf0ebf80,0x3f623e48bf22bf80,0xbef1bf7bbf460000
.quad 0xbf35bf80bf350000,0xbf3500003f353f80,0xbef13e483f463f80,0x3f623f7b3f220000,0x3f7b3f6d3f0e0000,0x3e48bec4bf55bf80,0xbdc9bf0ebf62bf80,0xbf7fbf55bef10000,0xbf6dbf35bec40000,0x3ec43f353f6d3f80,0x3f223f553f753f80,0x3f463f0e3e950000,0x3f0e3ec43e480000,0xbf55bf6dbf7bbf80,0xbf75bf7bbf7fbf80,0xbe95be48bdc90000
.quad 0x3f800000bf800000,0xbf8000003f80,0xbf22bf553ef13f6d,0xbf463f0e3f62bec4,0xbe483f6d3f0ebf35,0x3f7b3ec4bf55bf35,0x3f62be48bf7fbec4,0xbef1bf7bbdc93f6d,0xbf6dbf353ec43f80,0xbec43f353f6d0000,0x3e953f7b3f22bec4,0x3f753e48bf46bf6d,0x3f0ebec4bf7bbf35,0xbf55bf6dbe483f35,0xbf7fbf0e3e953f6d,0x3dc93f553f753ec4
.quad 0x3f353f803f350000,0x3f350000bf35bf80,0x3dc9bf0ebf75bf6d,0xbf7fbf55be953ec4,0xbf55bec43e483f35,0x3f0e3f6d3f7b3f35,0x3f753f7b3f463ec4,0x3e95be48bf22bf6d,0xbec4bf35bf6dbf80,0xbf6dbf35bec40000,0xbef1be483dc93ec4,0x3f623f7b3f7f3f6d,0x3f7b3f6d3f553f35,0xbe48bec4bf0ebf35,0xbf46bf55bf62bf6d,0xbf22bf0ebef1bec4
.quad 0x3f800000bf800000,0xbf8000003f80,0xbf62bf0e3f463f35,0xbef13f553f22bf35,0x3f0e3f6dbe48bf80,0x3f55bec4bf7b0000,0xbdc9bf7bbef13f35,0xbf7fbe483f623f35,0xbec43f353f6d0000,0x3f6d3f35bec4bf80,0x3f46be48bf75bf35,0xbf22bf7bbe953f35,0xbf7bbec43f0e3f80,0x3e483f6d3f550000,0x3f753f553dc9bf35,0x3e95bf0ebf7fbf35
.quad 0xbf35bf80bf350000,0xbf3500003f353f80,0x3e953f553f7f3f35,0x3f753f0ebdc9bf35,0x3e48bec4bf55bf80,0xbf7bbf6dbf0e0000,0xbf22be483e953f35,0x3f463f7b3f753f35,0x3f6d3f353ec40000,0xbec4bf35bf6dbf80,0xbf7fbf7bbf62bf35,0xbdc93e483ef13f35,0x3f553f6d3f7b3f80,0x3f0e3ec43e480000,0xbef1bf0ebf22bf35,0xbf62bf55bf46bf35
.quad 0x3f800000bf800000,0xbf8000003f80,0xbf7fbe483f753ec4,0xbdc93f7b3e95bf6d,0x3f7b3ec4bf55bf35,0x3e48bf6dbf0e3f35,0xbf75bf0e3f223f6d,0xbe953f553f46bec4,0x3f6d3f35bec4bf80,0x3ec4bf35bf6d0000,0xbf62bf553dc93f6d,0xbef13f0e3f7f3ec4,0x3f553f6d3e48bf35,0x3f0ebec4bf7bbf35,0xbf46bf7bbef13ec4,0xbf223e483f623f6d
.quad 0x3f353f803f350000,0x3f350000bf35bf80,0xbf22bf7bbf62bec4,0xbf46be483ef13f6d,0x3f0e3f6d3f7b3f35,0x3f553ec4be48bf35,0xbef1bf55bf7fbf6d,0xbf62bf0ebdc93ec4,0x3ec43f353f6d3f80,0x3f6d3f353ec40000,0xbe95bf0ebf46bf6d,0xbf75bf55bf22bec4,0x3e483ec43f0e3f35,0x3f7b3f6d3f553f35,0xbdc9be48be95bec4,0xbf7fbf7bbf75bf6d
.quad 0xbf8080003f808000,0xbf8000003f80,0x3e953f7bbdc9bf80,0xbf753e483f7f0000,0x3f55bec4bf7b8000,0x3f0e3f6dbe48bf80,0xbf46bf553e953f80,0x3f22bf0ebf750000,0xbec43f353f6d8000,0xbf6dbf353ec43f80,0x3f7f3f0ebef1bf80,0xbdc93f553f620000,0xbe48bf6dbf558000,0x3f7b3ec4bf0ebf80,0xbf62be483f223f80,0xbef1bf7bbf460000
.quad 0x3f353f803f358000,0xbf3500003f353f80,0x3ef1be48bf46bf80,0x3f623f7b3f220000,0xbf7bbf6dbf0e8000,0x3e48bec4bf55bf80,0x3dc93f0e3f623f80,0xbf7fbf55bef10000,0x3f6d3f353ec48000,0x3ec43f353f6d3f80,0xbf22bf55bf75bf80,0x3f463f0e3e950000,0xbf0ebec4be488000,0xbf55bf6dbf7bbf80,0x3f753f7b3f7f3f80,0xbe95be48bdc90000
.quad 0xbf8080003f808000,0xbf8000003f80,0x3f223f55bef1bf6d,0xbf463f0e3f62bec4,0x3e48bf6dbf0e3f35,0x3f7b3ec4bf55bf35,0xbf623e483f7f3ec4,0xbef1bf7bbdc93f6d,0x3f6d3f35bec4bf80,0xbec43f353f6d0000,0xbe95bf7bbf223ec4,0x3f753e48bf46bf6d,0xbf0e3ec43f7b3f35,0xbf55bf6dbe483f35,0x3f7f3f0ebe95bf6d,0x3dc93f553f753ec4
.quad 0xbf35bf80bf358000,0x3f350000bf35bf80,0xbdc93f0e3f753f6d,0xbf7fbf55be953ec4,0x3f553ec4be48bf35,0x3f0e3f6d3f7b3f35,0xbf75bf7bbf46bec4,0x3e95be48bf22bf6d,0x3ec43f353f6d3f80,0xbf6dbf35bec40000,0x3ef13e48bdc9bec4,0x3f623f7b3f7f3f6d,0xbf7bbf6dbf55bf35,0xbe48bec4bf0ebf35,0x3f463f553f623f6d,0xbf22bf0ebef1bec4
.quad 0xbf8080003f808000,0xbf8000003f80,0x3f623f0ebf46bf35,0xbef13f553f22bf35,0xbf0ebf6d3e483f80,0x3f55bec4bf7b0000,0x3dc93f7b3ef1bf35,0xbf7fbe483f623f35,0x3ec4bf35bf6d8000,0x3f6d3f35bec4bf80,0xbf463e483f753f35,0xbf22bf7bbe953f35,0x3f7b3ec4bf0ebf80,0x3e483f6d3f550000,0xbf75bf55bdc93f35,0x3e95bf0ebf7fbf35
.quad 0x3f353f803f358000,0xbf3500003f353f80,0xbe95bf55bf7fbf35,0x3f753f0ebdc9bf35,0xbe483ec43f553f80,0xbf7bbf6dbf0e0000,0x3f223e48be95bf35,0x3f463f7b3f753f35,0xbf6dbf35bec48000,0xbec4bf35bf6dbf80,0x3f7f3f7b3f623f35,0xbdc93e483ef13f35,0xbf55bf6dbf7bbf80,0x3f0e3ec43e480000,0x3ef13f0e3f223f35,0xbf62bf55bf46bf35
.quad 0xbf8080003f808000,0xbf8000003f80,0x3f7f3e48bf75bec4,0xbdc93f7b3e95bf6d,0xbf7bbec43f553f35,0x3e48bf6dbf0e3f35,0x3f753f0ebf22bf6d,0xbe953f553f46bec4,0xbf6dbf353ec43f80,0x3ec4bf35bf6d0000,0x3f623f55bdc9bf6d,0xbef13f0e3f7f3ec4,0xbf55bf6dbe483f35,0x3f0ebec4bf7bbf35,0x3f463f7b3ef1bec4,0xbf223e483f623f6d
.quad 0xbf35bf80bf358000,0x3f350000bf35bf80,0x3f223f7b3f623ec4,0xbf46be483ef13f6d,0xbf0ebf6dbf7bbf35,0x3f553ec4be48bf35,0x3ef13f553f7f3f6d,0xbf62bf0ebdc93ec4,0xbec4bf35bf6dbf80,0x3f6d3f353ec40000,0x3e953f0e3f463f6d,0xbf75bf55bf22bec4,0xbe48bec4bf0ebf35,0x3f7b3f6d3f553f35,0x3dc93e483e953ec4,0xbf7fbf7bbf75bf6d
.quad 0xbf8000003f80,0x3f800000bf800000,0x3e953f7bbdc9bf80,0xbf753e483f7f0000,0xbf0ebf6d3e483f80,0x3f55bec4bf7b0000,0x3f463f55be95bf80,0xbf223f0e3f750000,0xbf6dbf353ec43f80,0x3ec4bf35bf6d0000,0x3f7f3f0ebef1bf80,0xbdc93f553f620000,0xbf7bbec43f0e3f80,0xbe48bf6dbf550000,0x3f623e48bf22bf80,0x3ef13f7b3f460000
.quad 0xbf3500003f353f80,0xbf35bf80bf350000,0x3ef1be48bf46bf80,0x3f623f7b3f220000,0xbe483ec43f553f80,0xbf7bbf6dbf0e0000,0xbdc9bf0ebf62bf80,0x3f7f3f553ef10000,0x3ec43f353f6d3f80,0xbf6dbf35bec40000,0xbf22bf55bf75bf80,0x3f463f0e3e950000,0x3f553f6d3f7b3f80,0xbf0ebec4be480000,0xbf75bf7bbf7fbf80,0x3e953e483dc90000
.quad 0xbf8000003f80,0x3f800000bf800000,0x3f223f55bef1bf6d,0xbf463f0e3f62bec4,0xbf7bbec43f553f35,0x3e48bf6dbf0e3f35,0x3f62be48bf7fbec4,0x3ef13f7b3dc9bf6d,0xbec43f353f6d0000,0xbf6dbf353ec43f80,0xbe95bf7bbf223ec4,0x3f753e48bf46bf6d,0x3f553f6d3e48bf35,0xbf0e3ec43f7b3f35,0xbf7fbf0e3e953f6d,0xbdc9bf55bf75bec4
.quad 0x3f350000bf35bf80,0x3f353f803f350000,0xbdc93f0e3f753f6d,0xbf7fbf55be953ec4,0xbf0ebf6dbf7bbf35,0x3f553ec4be48bf35,0x3f753f7b3f463ec4,0xbe953e483f223f6d,0xbf6dbf35bec40000,0xbec4bf35bf6dbf80,0x3ef13e48bdc9bec4,0x3f623f7b3f7f3f6d,0x3e483ec43f0e3f35,0xbf7bbf6dbf55bf35,0xbf46bf55bf62bf6d,0x3f223f0e3ef13ec4
.quad 0xbf8000003f80,0x3f800000bf800000,0x3f623f0ebf46bf35,0xbef13f553f22bf35,0xbf553ec43f7b0000,0xbf0ebf6d3e483f80,0xbdc9bf7bbef13f35,0x3f7f3e48bf62bf35,0x3f6d3f35bec4bf80,0xbec43f353f6d0000,0xbf463e483f753f35,0xbf22bf7bbe953f35,0xbe48bf6dbf550000,0x3f7b3ec4bf0ebf80,0x3f753f553dc9bf35,0xbe953f0e3f7f3f35
.quad 0xbf3500003f353f80,0xbf35bf80bf350000,0xbe95bf55bf7fbf35,0x3f753f0ebdc9bf35,0x3f7b3f6d3f0e0000,0xbe483ec43f553f80,0xbf22be483e953f35,0xbf46bf7bbf75bf35,0xbec4bf35bf6dbf80,0x3f6d3f353ec40000,0x3f7f3f7b3f623f35,0xbdc93e483ef13f35,0xbf0ebec4be480000,0xbf55bf6dbf7bbf80,0xbef1bf0ebf22bf35,0x3f623f553f463f35
.quad 0xbf8000003f80,0x3f800000bf800000,0x3f7f3e48bf75bec4,0xbdc93f7b3e95bf6d,0xbe483f6d3f0ebf35,0xbf7bbec43f553f35,0xbf75bf0e3f223f6d,0x3e95bf55bf463ec4,0x3ec4bf35bf6d0000,0x3f6d3f35bec4bf80,0x3f623f55bdc9bf6d,0xbef13f0e3f7f3ec4,0xbf0e3ec43f7b3f35,0xbf55bf6dbe483f35,0xbf46bf7bbef13ec4,0x3f22be48bf62bf6d
.quad 0x3f350000bf35bf80,0x3f353f803f350000,0x3f223f7b3f623ec4,0xbf46be483ef13f6d,0xbf55bec43e483f35,0xbf0ebf6dbf7bbf35,0xbef1bf55bf7fbf6d,0x3f623f0e3dc9bec4,0x3f6d3f353ec40000,0x3ec43f353f6d3f80,0x3e953f0e3f463f6d,0xbf75bf55bf22bec4,0xbf7bbf6dbf55bf35,0xbe48bec4bf0ebf35,0xbdc9be48be95bec4,0x3f7f3f7b3f753f6d
.quad 0xbf8000003f80,0xbf8080003f808000,0x3e953f7bbdc9bf80,0x3f75be48bf7f8000,0xbf0ebf6d3e483f80,0xbf553ec43f7b8000,0x3f463f55be95bf80,0x3f22bf0ebf758000,0xbf6dbf353ec43f80,0xbec43f353f6d8000,0x3f7f3f0ebef1bf80,0x3dc9bf55bf628000,0xbf7bbec43f0e3f80,0x3e483f6d3f558000,0x3f623e48bf22bf80,0xbef1bf7bbf468000
.quad 0xbf3500003f353f80,0x3f353f803f358000,0x3ef1be48bf46bf80,0xbf62bf7bbf228000,0xbe483ec43f553f80,0x3f7b3f6d3f0e8000,0xbdc9bf0ebf62bf80,0xbf7fbf55bef18000,0x3ec43f353f6d3f80,0x3f6d3f353ec48000,0xbf22bf55bf75bf80,0xbf46bf0ebe958000,0x3f553f6d3f7b3f80,0x3f0e3ec43e488000,0xbf75bf7bbf7fbf80,0xbe95be48bdc98000
.quad 0xbf8000003f80,0xbf8080003f808000,0x3f223f55bef1bf6d,0x3f46bf0ebf623ec4,0xbf7bbec43f553f35,0xbe483f6d3f0ebf35,0x3f62be48bf7fbec4,0xbef1bf7bbdc93f6d,0xbec43f353f6d0000,0x3f6d3f35bec4bf80,0xbe95bf7bbf223ec4,0xbf75be483f463f6d,0x3f553f6d3e48bf35,0x3f0ebec4bf7bbf35,0xbf7fbf0e3e953f6d,0x3dc93f553f753ec4
.quad 0x3f350000bf35bf80,0xbf35bf80bf358000,0xbdc93f0e3f753f6d,0x3f7f3f553e95bec4,0xbf0ebf6dbf7bbf35,0xbf55bec43e483f35,0x3f753f7b3f463ec4,0x3e95be48bf22bf6d,0xbf6dbf35bec40000,0x3ec43f353f6d3f80,0x3ef13e48bdc9bec4,0xbf62bf7bbf7fbf6d,0x3e483ec43f0e3f35,0x3f7b3f6d3f553f35,0xbf46bf55bf62bf6d,0xbf22bf0ebef1bec4
.quad 0xbf8000003f80,0xbf8080003f808000,0x3f623f0ebf46bf35,0x3ef1bf55bf223f35,0xbf553ec43f7b0000,0x3f0e3f6dbe48bf80,0xbdc9bf7bbef13f35,0xbf7fbe483f623f35,0x3f6d3f35bec4bf80,0x3ec4bf35bf6d8000,0xbf463e483f753f35,0x3f223f7b3e95bf35,0xbe48bf6dbf550000,0xbf7bbec43f0e3f80,0x3f753f553dc9bf35,0x3e95bf0ebf7fbf35
.quad 0xbf3500003f353f80,0x3f353f803f358000,0xbe95bf55bf7fbf35,0xbf75bf0e3dc93f35,0x3f7b3f6d3f0e0000,0x3e48bec4bf55bf80,0xbf22be483e953f35,0x3f463f7b3f753f35,0xbec4bf35bf6dbf80,0xbf6dbf35bec48000,0x3f7f3f7b3f623f35,0x3dc9be48bef1bf35,0xbf0ebec4be480000,0x3f553f6d3f7b3f80,0xbef1bf0ebf22bf35,0xbf62bf55bf46bf35
.quad 0xbf8000003f80,0xbf8080003f808000,0x3f7f3e48bf75bec4,0x3dc9bf7bbe953f6d,0xbe483f6d3f0ebf35,0x3f7b3ec4bf55bf35,0xbf75bf0e3f223f6d,0xbe953f553f46bec4,0x3ec4bf35bf6d0000,0xbf6dbf353ec43f80,0x3f623f55bdc9bf6d,0x3ef1bf0ebf7fbec4,0xbf0e3ec43f7b3f35,0x3f553f6d3e48bf35,0xbf46bf7bbef13ec4,0xbf223e483f623f6d
.quad 0x3f350000bf35bf80,0xbf35bf80bf358000,0x3f223f7b3f623ec4,0x3f463e48bef1bf6d,0xbf55bec43e483f35,0x3f0e3f6d3f7b3f35,0xbef1bf55bf7fbf6d,0xbf62bf0ebdc93ec4,0x3f6d3f353ec40000,0xbec4bf35bf6dbf80,0x3e953f0e3f463f6d,0x3f753f553f223ec4,0xbf7bbf6dbf55bf35,0x3e483ec43f0e3f35,0xbdc9be48be95bec4,0xbf7fbf7bbf75bf6d
.quad 0xbf8000003f80,0xbf8000003f80,0x3e953f7bbdc9bf80,0x3f75be48bf7f0000,0xbf0ebf6d3e483f80,0x3f0e3f6dbe48bf80,0x3f463f55be95bf80,0xbf223f0e3f750000,0xbf6dbf353ec43f80,0xbf6dbf353ec43f80,0x3f7f3f0ebef1bf80,0x3dc9bf55bf620000,0xbf7bbec43f0e3f80,0x3f7b3ec4bf0ebf80,0x3f623e48bf22bf80,0x3ef13f7b3f460000
.quad 0xbf3500003f353f80,0xbf3500003f353f80,0x3ef1be48bf46bf80,0xbf62bf7bbf220000,0xbe483ec43f553f80,0x3e48bec4bf55bf80,0xbdc9bf0ebf62bf80,0x3f7f3f553ef10000,0x3ec43f353f6d3f80,0x3ec43f353f6d3f80,0xbf22bf55bf75bf80,0xbf46bf0ebe950000,0x3f553f6d3f7b3f80,0xbf55bf6dbf7bbf80,0xbf75bf7bbf7fbf80,0x3e953e483dc90000
.quad 0xbf8000003f80,0xbf8000003f80,0x3f223f55bef1bf6d,0x3f46bf0ebf623ec4,0xbf7bbec43f553f35,0x3f7b3ec4bf55bf35,0x3f62be48bf7fbec4,0x3ef13f7b3dc9bf6d,0xbec43f353f6d0000,0xbec43f353f6d0000,0xbe95bf7bbf223ec4,0xbf75be483f463f6d,0x3f553f6d3e48bf35,0xbf55bf6dbe483f35,0xbf7fbf0e3e953f6d,0xbdc9bf55bf75bec4
.quad 0x3f350000bf35bf80,0x3f350000bf35bf80,0xbdc93f0e3f753f6d,0x3f7f3f553e95bec4,0xbf0ebf6dbf7bbf35,0x3f0e3f6d3f7b3f35,0x3f753f7b3f463ec4,0xbe953e483f223f6d,0xbf6dbf35bec40000,0xbf6dbf35bec40000,0x3ef13e48bdc9bec4,0xbf62bf7bbf7fbf6d,0x3e483ec43f0e3f35,0xbe48bec4bf0ebf35,0xbf46bf55bf62bf6d,0x3f223f0e3ef13ec4
.quad 0xbf8000003f80,0xbf8000003f80,0x3f623f0ebf46bf35,0x3ef1bf55bf223f35,0xbf553ec43f7b0000,0x3f55bec4bf7b0000,0xbdc9bf7bbef13f35,0x3f7f3e48bf62bf35,0x3f6d3f35bec4bf80,0x3f6d3f35bec4bf80,0xbf463e483f753f35,0x3f223f7b3e95bf35,0xbe48bf6dbf550000,0x3e483f6d3f550000,0x3f753f553dc9bf35,0xbe953f0e3f7f3f35
.quad 0xbf3500003f353f80,0xbf3500003f353f80,0xbe95bf55bf7fbf35,0xbf75bf0e3dc93f35,0x3f7b3f6d3f0e0000,0xbf7bbf6dbf0e0000,0xbf22be483e953f35,0xbf46bf7bbf75bf35,0xbec4bf35bf6dbf80,0xbec4bf35bf6dbf80,0x3f7f3f7b3f623f35,0x3dc9be48bef1bf35,0xbf0ebec4be480000,0x3f0e3ec43e480000,0xbef1bf0ebf22bf35,0x3f623f553f463f35
.quad 0xbf8000003f80,0xbf8000003f80,0x3f7f3e48bf75bec4,0x3dc9bf7bbe953f6d,0xbe483f6d3f0ebf35,0x3e48bf6dbf0e3f35,0xbf75bf0e3f223f6d,0x3e95bf55bf463ec4,0x3ec4bf35bf6d0000,0x3ec4bf35bf6d0000,0x3f623f55bdc9bf6d,0x3ef1bf0ebf7fbec4,0xbf0e3ec43f7b3f35,0x3f0ebec4bf7bbf35,0xbf46bf7bbef13ec4,0x3f22be48bf62bf6d
.quad 0x3f350000bf35bf80,0x3f350000bf35bf80,0x3f223f7b3f623ec4,0x3f463e48bef1bf6d,0xbf55bec43e483f35,0x3f553ec4be48bf35,0xbef1bf55bf7fbf6d,0x3f623f0e3dc9bec4,0x3f6d3f353ec40000,0x3f6d3f353ec40000,0x3e953f0e3f463f6d,0x3f753f553f223ec4,0xbf7bbf6dbf55bf35,0x3f7b3f6d3f553f35,0xbdc9be48be95bec4,0x3f7f3f7b3f753f6d
.quad 0x3f800000bf800000,0xbf8000003f80,0x3e953f7bbdc9bf80,0x3f75be48bf7f0000,0xbf553ec43f7b0000,0x3f0e3f6dbe48bf80,0xbf46bf553e953f80,0xbf223f0e3f750000,0x3ec4bf35bf6d0000,0xbf6dbf353ec43f80,0x3f7f3f0ebef1bf80,0x3dc9bf55bf620000,0x3e483f6d3f550000,0x3f7b3ec4bf0ebf80,0xbf62be483f223f80,0x3ef13f7b3f460000
.quad 0xbf35bf80bf350000,0xbf3500003f353f80,0x3ef1be48bf46bf80,0xbf62bf7bbf220000,0x3f7b3f6d3f0e0000,0x3e48bec4bf55bf80,0x3dc93f0e3f623f80,0x3f7f3f553ef10000,0xbf6dbf35bec40000,0x3ec43f353f6d3f80,0xbf22bf55bf75bf80,0xbf46bf0ebe950000,0x3f0e3ec43e480000,0xbf55bf6dbf7bbf80,0x3f753f7b3f7f3f80,0x3e953e483dc90000
.quad 0x3f800000bf800000,0xbf8000003f80,0x3f223f55bef1bf6d,0x3f46bf0ebf623ec4,0xbe483f6d3f0ebf35,0x3f7b3ec4bf55bf35,0xbf623e483f7f3ec4,0x3ef13f7b3dc9bf6d,0xbf6dbf353ec43f80,0xbec43f353f6d0000,0xbe95bf7bbf223ec4,0xbf75be483f463f6d,0x3f0ebec4bf7bbf35,0xbf55bf6dbe483f35,0x3f7f3f0ebe95bf6d,0xbdc9bf55bf75bec4
.quad 0x3f353f803f350000,0x3f350000bf35bf80,0xbdc93f0e3f753f6d,0x3f7f3f553e95bec4,0xbf55bec43e483f35,0x3f0e3f6d3f7b3f35,0xbf75bf7bbf46bec4,0xbe953e483f223f6d,0xbec4bf35bf6dbf80,0xbf6dbf35bec40000,0x3ef13e48bdc9bec4,0xbf62bf7bbf7fbf6d,0x3f7b3f6d3f553f35,0xbe48bec4bf0ebf35,0x3f463f553f623f6d,0x3f223f0e3ef13ec4
.quad 0x3f800000bf800000,0xbf8000003f80,0x3f623f0ebf46bf35,0x3ef1bf55bf223f35,0x3f0e3f6dbe48bf80,0x3f55bec4bf7b0000,0x3dc93f7b3ef1bf35,0x3f7f3e48bf62bf35,0xbec43f353f6d0000,0x3f6d3f35bec4bf80,0xbf463e483f753f35,0x3f223f7b3e95bf35,0xbf7bbec43f0e3f80,0x3e483f6d3f550000,0xbf75bf55bdc93f35,0xbe953f0e3f7f3f35
.quad 0xbf35bf80bf350000,0xbf3500003f353f80,0xbe95bf55bf7fbf35,0xbf75bf0e3dc93f35,0x3e48bec4bf55bf80,0xbf7bbf6dbf0e0000,0x3f223e48be95bf35,0xbf46bf7bbf75bf35,0x3f6d3f353ec40000,0xbec4bf35bf6dbf80,0x3f7f3f7b3f623f35,0x3dc9be48bef1bf35,0x3f553f6d3f7b3f80,0x3f0e3ec43e480000,0x3ef13f0e3f223f35,0x3f623f553f463f35
.quad 0x3f800000bf800000,0xbf8000003f80,0x3f7f3e48bf75bec4,0x3dc9bf7bbe953f6d,0x3f7b3ec4bf55bf35,0x3e48bf6dbf0e3f35,0x3f753f0ebf22bf6d,0x3e95bf55bf463ec4,0x3f6d3f35bec4bf80,0x3ec4bf35bf6d0000,0x3f623f55bdc9bf6d,0x3ef1bf0ebf7fbec4,0x3f553f6d3e48bf35,0x3f0ebec4bf7bbf35,0x3f463f7b3ef1bec4,0x3f22be48bf62bf6d
.quad 0x3f353f803f350000,0x3f350000bf35bf80,0x3f223f7b3f623ec4,0x3f463e48bef1bf6d,0x3f0e3f6d3f7b3f35,0x3f553ec4be48bf35,0x3ef13f553f7f3f6d,0x3f623f0e3dc9bec4,0x3ec43f353f6d3f80,0x3f6d3f353ec40000,0x3e953f0e3f463f6d,0x3f753f553f223ec4,0x3e483ec43f0e3f35,0x3f7b3f6d3f553f35,0x3dc93e483e953ec4,0x3f7f3f7b3f753f6d
.quad 0xbf8080003f808000,0xbf8000003f80,0xbe95bf7b3dc93f80,0x3f75be48bf7f0000,0x3f55bec4bf7b8000,0x3f0e3f6dbe48bf80,0x3f463f55be95bf80,0xbf223f0e3f750000,0xbec43f353f6d8000,0xbf6dbf353ec43f80,0xbf7fbf0e3ef13f80,0x3dc9bf55bf620000,0xbe48bf6dbf558000,0x3f7b3ec4bf0ebf80,0x3f623e48bf22bf80,0x3ef13f7b3f460000
.quad 0x3f353f803f358000,0xbf3500003f353f80,0xbef13e483f463f80,0xbf62bf7bbf220000,0xbf7bbf6dbf0e8000,0x3e48bec4bf55bf80,0xbdc9bf0ebf62bf80,0x3f7f3f553ef10000,0x3f6d3f353ec48000,0x3ec43f353f6d3f80,0x3f223f553f753f80,0xbf46bf0ebe950000,0xbf0ebec4be488000,0xbf55bf6dbf7bbf80,0xbf75bf7bbf7fbf80,0x3e953e483dc90000
.quad 0xbf8080003f808000,0xbf8000003f80,0xbf22bf553ef13f6d,0x3f46bf0ebf623ec4,0x3e48bf6dbf0e3f35,0x3f7b3ec4bf55bf35,0x3f62be48bf7fbec4,0x3ef13f7b3dc9bf6d,0x3f6d3f35bec4bf80,0xbec43f353f6d0000,0x3e953f7b3f22bec4,0xbf75be483f463f6d,0xbf0e3ec43f7b3f35,0xbf55bf6dbe483f35,0xbf7fbf0e3e953f6d,0xbdc9bf55bf75bec4
.quad 0xbf35bf80bf358000,0x3f350000bf35bf80,0x3dc9bf0ebf75bf6d,0x3f7f3f553e95bec4,0x3f553ec4be48bf35,0x3f0e3f6d3f7b3f35,0x3f753f7b3f463ec4,0xbe953e483f223f6d,0x3ec43f353f6d3f80,0xbf6dbf35bec40000,0xbef1be483dc93ec4,0xbf62bf7bbf7fbf6d,0xbf7bbf6dbf55bf35,0xbe48bec4bf0ebf35,0xbf46bf55bf62bf6d,0x3f223f0e3ef13ec4
.quad 0xbf8080003f808000,0xbf8000003f80,0xbf62bf0e3f463f35,0x3ef1bf55bf223f35,0xbf0ebf6d3e483f80,0x3f55bec4bf7b0000,0xbdc9bf7bbef13f35,0x3f7f3e48bf62bf35,0x3ec4bf35bf6d8000,0x3f6d3f35bec4bf80,0x3f46be48bf75bf35,0x3f223f7b3e95bf35,0x3f7b3ec4bf0ebf80,0x3e483f6d3f550000,0x3f753f553dc9bf35,0xbe953f0e3f7f3f35
.quad 0x3f353f803f358000,0xbf3500003f353f80,0x3e953f553f7f3f35,0xbf75bf0e3dc93f35,0xbe483ec43f553f80,0xbf7bbf6dbf0e0000,0xbf22be483e953f35,0xbf46bf7bbf75bf35,0xbf6dbf35bec48000,0xbec4bf35bf6dbf80,0xbf7fbf7bbf62bf35,0x3dc9be48bef1bf35,0xbf55bf6dbf7bbf80,0x3f0e3ec43e480000,0xbef1bf0ebf22bf35,0x3f623f553f463f35
.quad 0xbf8080003f808000,0xbf8000003f80,0xbf7fbe483f753ec4,0x3dc9bf7bbe953f6d,0xbf7bbec43f553f35,0x3e48bf6dbf0e3f35,0xbf75bf0e3f223f6d,0x3e95bf55bf463ec4,0xbf6dbf353ec43f80,0x3ec4bf35bf6d0000,0xbf62bf553dc93f6d,0x3ef1bf0ebf7fbec4,0xbf55bf6dbe483f35,0x3f0ebec4bf7bbf35,0xbf46bf7bbef13ec4,0x3f22be48bf62bf6d
.quad 0xbf35bf80bf358000,0x3f350000bf35bf80,0xbf22bf7bbf62bec4,0x3f463e48bef1bf6d,0xbf0ebf6dbf7bbf35,0x3f553ec4be48bf35,0xbef1bf55bf7fbf6d,0x3f623f0e3dc9bec4,0xbec4bf35bf6dbf80,0x3f6d3f353ec40000,0xbe95bf0ebf46bf6d,0x3f753f553f223ec4,0xbe48bec4bf0ebf35,0x3f7b3f6d3f553f35,0xbdc9be48be95bec4,0x3f7f3f7b3f753f6d
.quad 0x3f7d3aac3f800000,0x3f676bd83f74fa0b,0x3f7d1cdd3f800000,0x3f6667713f748422,0x3f7cfe733f800000,0x3f655e0b3f740bdd,0x3f7cdf6c3f800000,0x3f644fac3f73913f,0x3f7cbfc93f800000,0x3f633c5a3f731447,0x3f7c9f8a3f800000,0x3f62241a3f7294f8,0x3f7c7eb03f800000,0x3f6106f23f721352,0x3f7c5d3a3f800000,0x3f5fe4e93f718f57
.quad 0x3f7c3b283f800000,0x3f5ebe053f710908,0x3f7c187a3f800000,0x3f5d924d3f708066,0x3f7bf5313f800000,0x3f5c61c73f6ff573,0x3f7bd14d3f800000,0x3f5b2c793f6f6830,0x3f7baccd3f800000,0x3f59f26a3f6ed89e,0x3f7b87b23f800000,0x3f58b3a13f6e46be,0x3f7b61fc3f800000,0x3f5770263f6db293,0x3f7b3bab3f800000,0x3f5627fe3f6d1c1d
.quad 0x3f3daef93f54db31,0x3f039c3d3f226799,0x3f3b06293f531849,0x3efdbabb3f1ebc12,0x3f3852163f514d3d,0x3ef41f073f1b02c6,0x3f3592e73f4f7a1f,0x3eea66813f173c07,0x3f32c8c93f4d9f02,0x3ee0924f3f13682a,0x3f2ff3e63f4bbbf8,0x3ed6a3993f0f8784,0x3f2d14693f49d112,0x3ecc9b8b3f0b9a6b,0x3f2a2a803f47de65,0x3ec27b553f07a136
.quad 0x3f2736563f45e403,0x3eb8442a3f039c3d,0x3f24381a3f43e200,0x3eadf73c3eff17b2,0x3f212ff93f41d870,0x3ea395c53ef6e0cb,0x3f1e1e223f3fc767,0x3e9920fe3eee9479,0x3f1b02c63f3daef9,0x3e8e9a223ee63375,0x3f17de123f3b8f3b,0x3e8402703eddbe79,0x3f14b0393f396842,0x3e72b6513ed53641,0x3f11796b3f373a23,0x3e5d4b1a3ecc9b8b
.quad 0x3e78cfcc3ec3ef15,0xbd48fb303dc8bd36,0x3e5d4b1a3eb8442a,0xbda973ba3d8a200a,0x3e419b373eac7cd4,0xbdee38763d16c32c,0x3e25c58c3ea09ae5,0xbe195be03bc90f88,0x3e09cf863e94a031,0xbe3b6ecfbcc90ab0,0x3ddb7d373e888e93,0xbe5d4b1abd621469,0x3da3308c3e78cfcc,0xbe7ee6e1bdafb680,0x3d55880e3e605c13,0xbe901c2cbdee3876
.quad 0x3cc90ab03e47c5c2,0xbea09ae5be164083,0xbb490fc63e2f10a2,0xbeb0eacbbe354098,0xbcfb49ba3e164083,0xbec1071ebe541501,0xbd6ea0383dfab273,0xbed0eb2abe72b651,0xbdafb6803dc8bd36,0xbee0924fbe888e93,0xbde7fa9a3d96a905,0xbeeff7fbbe97a117,0xbe1008b73d48fb30,0xbeff17b2bea68f12,0xbe2bf8043cc90ab0,0xbf06f686beb554ec
.quad 0xbeac7cd4be47c5c2,0xbf187fc0bef15aea,0xbebf926fbe6c9a7f,0xbf21cbfbbf0242b1,0xbed25a09be888e93,0xbf2ac082bf0b9a6b,0xbee4cbfebe9aa086,0xbf33587abf14b039,0xbef6e0cbbeac7cd4,0xbf3b8f3bbf1d7fd1,0xbf044889bebe1d4a,0xbf436051bf26050a,0xbf0cead0becf7bca,0xbf4ac77fbf2e3bde,0xbf1553b7bee0924f,0xbf51c0c2bf36206c
.quad 0xbf1d7fd1bef15aea,0xbf584853bf3daef9,0xbf256bcbbf00e7e4,0xbf5e5aa6bf44e3f5,0xbf2d1469bf08f59b,0xbf63f473bf4bbbf8,0xbf34768fbf10d3cd,0xbf6912aebf5233c6,0xbf3b8f3bbf187fc0,0xbf6db293bf584853,0xbf425b89bf1ff6cb,0xbf71d19fbf5df6be,0xbf48d8b3bf273656,0xbf756d97bf633c5a,0xbf4f0417bf2e3bde,0xbf788486bf6816a8
.quad 0xbf4d9f02bf3504f3,0xbf710908bf61c598,0xbf554aa4bf3daef9,0xbf75a67bbf6816a8,0xbf5c61c7bf45e403,0xbf796e4ebf6db293,0xbf62df7bbf4d9f02,0xbf7c5d3abf7294f8,0xbf68bf3cbf54db31,0xbf7e70b0bf76ba07,0xbf6dfcf2bf5b941a,0xbf7fa6e3bf7a1e84,0xbf7294f8bf61c598,0xbf7ffec4bf7cbfc9,0xbf76841bbf676bd8,0xbf7f7808bf7e9bc9
.quad 0xbf79c79dbf6c835e,0xbf7e1324bf7fb10f,0xbf7c5d3abf710908,0xbf7bd14dbf7ffec4,0xbf7e4323bf74fa0b,0xbf78b47bbf7f84ab,0xbf7f7808bf7853f8,0xbf74bf62bf7e4323,0xbf7ffb11bf7b14be,0xbf6ff573bf7c3b28,0xbf7fcbe2bf7d3aac,0xbf6a5ad9bf796e4e,0xbf7eea9dbf7ec46d,0xbf63f473bf75dec6,0xbf7d57debf7fb10f,0xbf5cc7d1bf718f57
.quad 0xbf7fb10fbf7b14be,0xbf7853f8bf7ec46d,0xbf7ff84abf7dabcc,0xbf73530ebf7c7eb0,0xbf7f2f9dbf7f4e6d,0xbf6d1c1dbf791298,0xbf7d57debf7ffb11,0xbf65b710bf748422,0xbf7a7302bf7fb10f,0xbf5d2d53bf6ed89e,0xbf76841bbf7e70b0,0xbf5389c7bf6816a8,0xbf718f57bf7c3b28,0xbf48d8b3bf604621,0xbf6b99fbbf791298,0xbf3d27b8bf577026
.quad 0xbf64aa59bf74fa0b,0xbf3085bbbf4d9f02,0xbf5cc7d1bf6ff573,0xbf2302d3bf42de29,0xbf53fac3bf6a09a7,0xbf14b039bf373a23,0xbf4a4c87bf633c5a,0xbf05a02cbf2ac082,0xbf3fc767bf5b941a,0xbeebcbbbbf1d7fd1,0xbf34768fbf531849,0xbecb2aaebf0f8784,0xbf286605bf49d112,0xbea986c4bf00e7e4,0xbf1ba299bf3fc767,0xbe870adabee363fa
.quad 0xbf5b941abf6c835e,0xbf2beb4abf45e403,0xbf50d937bf64aa59,0xbf1ba299bf385216,0xbf44e3f5bf5b941a,0xbf0a48adbf299415,0xbf37c655bf514d3d,0xbeeff7fbbf19c200,0xbf299415bf45e403,0xbec9b953bf08f59b,0xbf1a6293bf396842,0xbea21887beee9479,0xbf0a48adbf2beb4a,0xbe72b651bec9b953,0xbef2bd43bf1d7fd1,0xbe1f917bbea395c5
.quad 0xbecf7bcabf0e39da,0xbd96a905be78cfcc,0xbeab0201befc5d27,0x3c16cb58be28defc,0xbe8586cebedae880,0x3dbc3ac3bdafb680,0xbe3e853ebeb8442a,0x3e3228d4bbc90f88,0xbde1bc2ebe94a031,0x3e827dc03d96a905,0xbd0a342fbe605c13,0x3eab02013e1c76de,0x3d2fe007be164083,0x3ed25a093e6c9a7f,0x3df475c0bd96a905,0x3ef840c83e9d9e78
.quad 0xbedae880bf0e39da,0xbe164083be94a031,0xbeb0eacbbef6e0cb,0xbd55880ebe4dee60,0xbe8586cebecf7bca,0x3d2fe007bde1bc2e,0xbe3228d4bea68f12,0x3e0cec4abc96c9b6,0xbdafb680be78cfcc,0x3e6c9a7f3d96a905,0x3b490fc6be22abb6,0x3ea5129f3e28defc,0x3dbc3ac3bd96a905,0x3ed25a093e827dc0,0x3e3857ec3c490e90,0x3efdbabb3eaf713a
.quad 0x3e888e933dc8bd36,0x3f13682a3edae880,0x3eb3dca53e3b6ecf,0x3f269de33f0242b1,0x3eddbe793e888e93,0x3f3852163f15f6d9,0x3f02ef9f3eb263ef,0x3f485bca3f286605,0x3f15f6d93edae880,0x3f5695e53f396842,0x3f27ce613f00e7e4,0x3f62df7b3f48d8b3,0x3f3852163f13682a,0x3f6d1c1d3f5695e5,0x3f4760853f24d225,0x3f75341d3f628210
.quad 0x3e16408300000000,0x3edae8803e94a031,0x3e195be000000000,0x3edf28a93e97a117,0x3e1c76de00000000,0x3ee363fa3e9aa086,0x3e1f917b00000000,0x3ee79a5d3e9d9e78,0x3e22abb600000000,0x3eebcbbb3ea09ae5,0x3e25c58c00000000,0x3eeff7fb3ea395c5,0x3e28defc00000000,0x3ef41f073ea68f12,0x3e2bf80400000000,0x3ef840c83ea986c4
.quad 0x3e2f10a200000000,0x3efc5d273eac7cd4,0x3e3228d400000000,0x3f003a063eaf713a,0x3e35409800000000,0x3f0242b13eb263ef,0x3e3857ec00000000,0x3f0448893eb554ec,0x3e3b6ecf00000000,0x3f064b823eb8442a,0x3e3e853e00000000,0x3f084b923ebb31a0,0x3e419b3700000000,0x3f0a48ad3ebe1d4a,0x3e44b0b900000000,0x3f0c42c93ec1071e
.quad 0x3f2beb4a3f0e39da,0x3f5b941a3f45e403,0x3f2ecef73f10d3cd,0x3f5e5aa63f48d8b3,0x3f31a81d3f13682a,0x3f6106f23f4bbbf8,0x3f34768f3f15f6d9,0x3f6398ac3f4e8d90,0x3f373a233f187fc0,0x3f660f883f514d3d,0x3f39f2ac3f1b02c6,0x3f686b393f53fac3,0x3f3ca0033f1d7fd1,0x3f6aab7b3f5695e5,0x3f3f41fc3f1ff6cb,0x3f6cd0073f591e6a
.quad 0x3f41d8703f226799,0x3f6ed89e3f5b941a,0x3f4463373f24d225,0x3f70c5013f5df6be,0x3f46e22a3f273656,0x3f7294f83f604621,0x3f4955213f299415,0x3f74484b3f628210,0x3f4bbbf83f2beb4a,0x3f75dec63f64aa59,0x3f4e16893f2e3bde,0x3f77583a3f66becc,0x3f5064af3f3085bb,0x3f78b47b3f68bf3c,0x3f52a6493f32c8c9,0x3f79f35e3f6aab7b
.quad 0x3f7853f83f6c835e,0x3f7fb10f3f7ec46d,0x3f79f35e3f6ed89e,0x3f7f1f493f7f6ac7,0x3f7b61fc3f710908,0x3f7e43233f7fd397,0x3f7c9f8a3f731447,0x3f7d1cdd3f7ffec4,0x3f7dabcc3f74fa0b,0x3f7baccd3f7fec43,0x3f7e868b3f76ba07,0x3f79f35e3f7f9c18,0x3f7f2f9d3f7853f8,0x3f77f1103f7f0e58,0x3f7fa6e33f79c79d,0x3f75a67b3f7e4323
.quad 0x3f7fec433f7b14be,0x3f7314473f7d3aac,0x3f7fffb13f7c3b28,0x3f703b373f7bf531,0x3f7fe1293f7d3aac,0x3f6d1c1d3f7a7302,0x3f7f90b13f7e1324,0x3f69b7e43f78b47b,0x3f7f0e583f7ec46d,0x3f660f883f76ba07,0x3f7e5a383f7f4e6d,0x3f62241a3f748422,0x3f7d74743f7fb10f,0x3f5df6be3f721352,0x3f7c5d3a3f7fec43,0x3f5988ad3f6f6830
.quad 0x3f7109083f7b14be,0x3f4d9f023f61c598,0x3f6d67a13f791298,0x3f4663543f5c61c7,0x3f6965913f76ba07,0x3f3ebc1b3f5695e5,0x3f6504793f740bdd,0x3f36ad7f3f5064af,0x3f6046213f710908,0x3f2e3bde3f49d112,0x3f5b2c793f6db293,0x3f256bcb3f42de29,0x3f55b9933f6a09a7,0x3f1c420c3f3b8f3b,0x3f4fefa83f660f88,0x3f12c39a3f33e7bc
.quad 0x3f49d1123f61c598,0x3f08f59b3f2beb4a,0x3f4360513f5d2d53,0x3efdbabb3f239da9,0x3f3ca0033f584853,0x3ee900b73f1b02c6,0x3f3592e73f531849,0x3ed3c8673f121eb0,0x3f2e3bde3f4d9f02,0x3ebe1d4a3f08f59b,0x3f269de33f47de65,0x3ea80b1f3eff17b2,0x3f1ebc123f41d870,0x3e919ddd3eebcbbb,0x3f16999f3f3b8f3b,0x3e75c35a3ed8106b
.quad 0x3f187fc03f3504f3,0x3eac7cd43ef15aea,0x3f0d92813f2beb4a,0x3e901c2c3ed8106b,0x3f0242b13f226799,0x3e667c663ebe1d4a,0x3eed30633f187fc0,0x3e2bf8043ea395c5,0x3ed536413f0e39da,0x3de1bc2e3e888e93,0x3ebca7af3f039c3d,0x3d55880e3e5a3997,0x3ea395c53ef15aea,0xbbc90f883e22abb6,0x3e8a11f73edae880,0xbd83db0a3dd53db9
.quad 0x3e605c133ec3ef15,0xbdfab2733d48fb30,0x3e2bf8043eac7cd4,0xbe3857ecbbc90f88,0x3dee38763e94a031,0xbe72b651bd7b2b74,0x3d83db0a3e78cfcc,0xbe9620d2bdee3876,0x3c490e903e47c5c2,0xbeb263efbe2f10a2,0xbd2351cb3e164083,0xbece0beabe667c66,0xbdbc3ac33dc8bd36,0xbee900b7be8e9a22,0xbe1324ca3d48fb30,0xbf019573bea986c4
.quad 0x3d48fb303e47c5c2,0xbe78cfccbdc8bd36,0xbc7b514b3e09cf86,0xbe9f1cdfbe28defc,0xbda3308c3d96a905,0xbec1071ebe6c9a7f,0xbe1324ca3c490e90,0xbee1fb6abe97a117,0xbe541501bd48fb30,0xbf00e7e4beb8442a,0xbe8a11f7bde1bc2e,0xbf102dd5bed8106b,0xbea986c4be2f10a2,0xbf1ebc12bef6e0cb,0xbec8477cbe6c9a7f,0xbf2c800fbf0a48ad
.quad 0xbee63375be94a031,0xbf396842bf187fc0,0xbf019573beb263ef,0xbf456439bf26050a,0xbf0f8784becf7bca,0xbf5064afbf32c8c9,0xbf1ce11fbeebcbbb,0xbf5a5ba0bf3ebc1b,0xbf299415bf039c3d,0xbf633c5abf49d112,0xbf3592e7bf10d3cd,0xbf6afb8cbf53fac3,0xbf40d0dabf1d7fd1,0xbf718f57bf5d2d53,0xbf4b41fabf299415,0xbf76ef5bbf655e0b
.quad 0xbf039c3dbec3ef15,0xbf3daef9bf226799,0xbf140c5fbee63375,0xbf4b41fabf31a81d,0xbf239da9bf039c3d,0xbf577026bf3fc767,0xbf3238aabf13682a,0xbf62241abf4cae79,0xbf3fc767bf226799,0xbf6b4b0cbf584853,0xbf4c3578bf3085bb,0xbf72d4ebbf628210,0xbf577026bf3daef9,0xbf78b47bbf6b4b0c,0xbf61668abf49d112,0xbf7cdf6cbf7294f8
.quad 0xbf6a09a7bf54db31,0xbf7f4e6dbf7853f8,0xbf714c7abf5ebe05,0xbf7ffd39bf7c7eb0,0xbf772417bf676bd8,0xbf7eea9dbf7f0e58,0xbf7b87b2bf6ed89e,0xbf7c187abf7ffec4,0xbf7e70b0bf74fa0b,0xbf778bc5bf7f4e6d,0xbf7fdaafbf79c79d,0xbf714c7abf7cfe73,0xbf7fc38fbf7d3aac,0xbf696591bf791298,0xbf7e2b72bf7f4e6d,0xbf5fe4e9bf73913f
.quad 0xbf676bd8bf54db31,0xbf7d3aacbf74fa0b,0xbf703b37bf604621,0xbf7fa6e3bf7ac516,0xbf772417bf6a09a7,0xbf7fc38fbf7e70b0,0xbf7c187abf721352,0xbf7d906ebf7ff4e6,0xbf7f0e58bf7853f8,0xbf791298bf7f4e6d,0xbf7fffb1bf7cbfc9,0xbf725470bf7c7eb0,0xbf7eea9dbf7f4e6d,0xbf696591bf778bc5,0xbf7bd14dbf7ffb11,0xbf5e5aa6bf708066
.quad 0xbf76ba07bf7ec46d,0xbf514d3dbf676bd8,0xbf6faf1bbf7baccd,0xbf425b89bf5c61c7,0xbf66beccbf76ba07,0xbf31a81dbf4f7a1f,0xbf5bfb34bf6ff573,0xbf1f599fbf40d0da,0xbf4f7a1fbf676bd8,0xbf0b9a6bbf3085bb,0xbf4154e1bf5d2d53,0xbeed3063bf1ebc12,0xbf31a81dbf514d3d,0xbec1071ebf0b9a6b,0xbf209393bf43e200,0xbe931f35beee9479
.quad 0x3f8000003f800000,0x3f8000003f800000,0x3f7d1cdd3f7d3aac,0x3f7cdf6c3f7cfe73,0x3f7484223f74fa0b,0x3f73913f3f740bdd,0x3f6667713f676bd8,0x3f644fac3f655e0b,0x3f5318493f54db31,0x3f4f7a1f3f514d3d,0x3f3b06293f3daef9,0x3f3592e73f385216,0x3f1ebc123f226799,0x3f173c073f1b02c6,0x3efdbabb3f039c3d,0x3eea66813ef41f07
.quad 0x3eb8442a3ec3ef15,0x3ea09ae53eac7cd4,0x3e5d4b1a3e78cfcc,0x3e25c58c3e419b37,0x3d8a200a3dc8bd36,0x3bc90f883d16c32c,0xbda973babd48fb30,0xbe195be0bdee3876,0xbe6c9a7fbe47c5c2,0xbe9aa086be888e93,0xbebf926fbeac7cd4,0xbee4cbfebed25a09,0xbf0242b1bef15aea,0xbf14b039bf0b9a6b,0xbf21cbfbbf187fc0,0xbf33587abf2ac082
.quad 0x3f8000003f800000,0x3f8000003f800000,0x3f7c9f8a3f7cbfc9,0x3f7c5d3a3f7c7eb0,0x3f7294f83f731447,0x3f718f573f721352,0x3f62241a3f633c5a,0x3f5fe4e93f6106f2,0x3f4bbbf83f4d9f02,0x3f47de653f49d112,0x3f2ff3e63f32c8c9,0x3f2a2a803f2d1469,0x3f0f87843f13682a,0x3f07a1363f0b9a6b,0x3ed6a3993ee0924f,0x3ec27b553ecc9b8b
.quad 0x3e888e933e94a031,0x3e605c133e78cfcc,0x3ddb7d373e09cf86,0x3d55880e3da3308c,0xbd621469bcc90ab0,0xbdee3876bdafb680,0xbe5d4b1abe3b6ecf,0xbe901c2cbe7ee6e1,0xbebe1d4abeac7cd4,0xbee0924fbecf7bca,0xbf044889bef6e0cb,0xbf1553b7bf0cead0,0xbf26050abf1d7fd1,0xbf36206cbf2e3bde,0xbf436051bf3b8f3b,0xbf51c0c2bf4ac77f
.quad 0x3f8000003f800000,0x3f8000003f800000,0x3f7c187a3f7c3b28,0x3f7bd14d3f7bf531,0x3f7080663f710908,0x3f6f68303f6ff573,0x3f5d924d3f5ebe05,0x3f5b2c793f5c61c7,0x3f43e2003f45e403,0x3f3fc7673f41d870,0x3f24381a3f273656,0x3f1e1e223f212ff9,0x3eff17b23f039c3d,0x3eee94793ef6e0cb,0x3eadf73c3eb8442a,0x3e9920fe3ea395c5
.quad 0x3e2f10a23e47c5c2,0x3dfab2733e164083,0xbb490fc63cc90ab0,0xbd6ea038bcfb49ba,0xbe354098be164083,0xbe72b651be541501,0xbeb0eacbbea09ae5,0xbed0eb2abec1071e,0xbf00e7e4bef15aea,0xbf10d3cdbf08f59b,0xbf256bcbbf1d7fd1,0xbf34768fbf2d1469,0xbf44e3f5bf3daef9,0xbf5233c6bf4bbbf8,0xbf5e5aa6bf584853,0xbf6912aebf63f473
.quad 0x3f8000003f800000,0x3f8000003f800000,0x3f7b87b23f7baccd,0x3f7b3bab3f7b61fc,0x3f6e46be3f6ed89e,0x3f6d1c1d3f6db293,0x3f58b3a13f59f26a,0x3f5627fe3f577026,0x3f3b8f3b3f3daef9,0x3f373a233f396842,0x3f17de123f1b02c6,0x3f11796b3f14b039,0x3eddbe793ee63375,0x3ecc9b8b3ed53641,0x3e8402703e8e9a22,0x3e5d4b1a3e72b651
.quad 0x3d96a9053dc8bd36,0x3cc90ab03d48fb30,0xbde7fa9abdafb680,0xbe2bf804be1008b7,0xbe97a117be888e93,0xbeb554ecbea68f12,0xbeeff7fbbee0924f,0xbf06f686beff17b2,0xbf1ff6cbbf187fc0,0xbf2e3bdebf273656,0xbf425b89bf3b8f3b,0xbf4f0417bf48d8b3,0xbf5df6bebf584853,0xbf6816a8bf633c5a,0xbf71d19fbf6db293,0xbf788486bf756d97
.quad 0xbf3daef9bf3504f3,0xbf4d9f02bf45e403,0xbf554aa4bf4d9f02,0xbf62df7bbf5c61c7,0xbf6816a8bf61c598,0xbf7294f8bf6db293,0xbf75a67bbf710908,0xbf7c5d3abf796e4e,0xbf7dabccbf7b14be,0xbf7ffb11bf7f4e6d,0xbf7ff84abf7fb10f,0xbf7d57debf7f2f9d,0xbf7c7eb0bf7ec46d,0xbf748422bf791298,0xbf73530ebf7853f8,0xbf65b710bf6d1c1d
.quad 0xbf64aa59bf6c835e,0xbf514d3dbf5b941a,0xbf50d937bf5b941a,0xbf37c655bf44e3f5,0xbf385216bf45e403,0xbf19c200bf299415,0xbf1ba299bf2beb4a,0xbeeff7fbbf0a48ad,0xbef6e0cbbf0e39da,0xbea68f12becf7bca,0xbeb0eacbbedae880,0xbe3228d4be8586ce,0xbe4dee60be94a031,0xbc96c9b6bde1bc2e,0xbd55880ebe164083,0x3e0cec4a3d2fe007
.quad 0xbf5b941abf54db31,0xbf676bd8bf61c598,0xbf6dfcf2bf68bf3c,0xbf76841bbf7294f8,0xbf7a1e84bf76ba07,0xbf7e9bc9bf7cbfc9,0xbf7fa6e3bf7e70b0,0xbf7f7808bf7ffec4,0xbf7e70b0bf7fb10f,0xbf791298bf7c3b28,0xbf76841bbf7a7302,0xbf6b99fbbf718f57,0xbf6816a8bf6ed89e,0xbf577026bf604621,0xbf5389c7bf5d2d53,0xbf3d27b8bf48d8b3
.quad 0xbf396842bf45e403,0xbf1d7fd1bf2beb4a,0xbf1a6293bf299415,0xbef2bd43bf0a48ad,0xbeee9479bf08f59b,0xbea395c5bec9b953,0xbea21887bec9b953,0xbe1f917bbe72b651,0xbe22abb6be78cfcc,0x3c490e90bd96a905,0x3b490fc6bdafb680,0x3e3857ec3dbc3ac3,0x3e28defc3d96a905,0x3eaf713a3e827dc0,0x3ea5129f3e6c9a7f,0x3efdbabb3ed25a09
.quad 0xbf710908bf6c835e,0xbf7853f8bf74fa0b,0xbf7c5d3abf79c79d,0xbf7f7808bf7e4323,0xbf7ffec4bf7fb10f,0xbf7e4323bf7f84ab,0xbf7bd14dbf7e1324,0xbf74bf62bf78b47b,0xbf6ff573bf74fa0b,0xbf633c5abf6a09a7,0xbf5cc7d1bf64aa59,0xbf4a4c87bf53fac3,0xbf42de29bf4d9f02,0xbf2ac082bf373a23,0xbf2302d3bf3085bb,0xbf05a02cbf14b039
.quad 0xbefc5d27bf0e39da,0xbeb8442abedae880,0xbeab0201becf7bca,0xbe3e853ebe8586ce,0xbe28defcbe78cfcc,0xbbc90f88bdafb680,0x3c16cb58bd96a905,0x3e3228d43dbc3ac3,0x3e3b6ecf3dc8bd36,0x3eb263ef3e888e93,0x3eb3dca53e888e93,0x3f02ef9f3eddbe79,0x3f0242b13edae880,0x3f2866053f15f6d9,0x3f269de33f13682a,0x3f485bca3f385216
.quad 0xbf7d3aacbf7b14be,0xbf7fb10fbf7ec46d,0xbf7fcbe2bf7ffb11,0xbf7d57debf7eea9d,0xbf796e4ebf7c3b28,0xbf718f57bf75dec6,0xbf6a5ad9bf6ff573,0xbf5cc7d1bf63f473,0xbf531849bf5b941a,0xbf3fc767bf49d112,0xbf34768fbf3fc767,0xbf1ba299bf286605,0xbf0f8784bf1d7fd1,0xbee363fabf00e7e4,0xbecb2aaebeebcbbb,0xbe870adabea986c4
.quad 0xbe605c13be94a031,0xbd96a905be164083,0xbd0a342fbde1bc2e,0x3df475c03d2fe007,0x3e1c76de3d96a905,0x3e9d9e783e6c9a7f,0x3eab02013e827dc0,0x3ef840c83ed25a09,0x3f00e7e43edae880,0x3f24d2253f13682a,0x3f27ce613f15f6d9,0x3f4760853f385216,0x3f48d8b33f396842,0x3f6282103f5695e5,0x3f62df7b3f5695e5,0x3f75341d3f6d1c1d
.quad 0,0,0x3e195be03e164083,0x3e1f917b3e1c76de,0x3e97a1173e94a031,0x3e9d9e783e9aa086,0x3edf28a93edae880,0x3ee79a5d3ee363fa,0x3f10d3cd3f0e39da,0x3f15f6d93f13682a,0x3f2ecef73f2beb4a,0x3f34768f3f31a81d,0x3f48d8b33f45e403,0x3f4e8d903f4bbbf8,0x3f5e5aa63f5b941a,0x3f6398ac3f6106f2
.quad 0x3f6ed89e3f6c835e,0x3f7314473f710908,0x3f79f35e3f7853f8,0x3f7c9f8a3f7b61fc,0x3f7f6ac73f7ec46d,0x3f7ffec43f7fd397,0x3f7f1f493f7fb10f,0x3f7d1cdd3f7e4323,0x3f7912983f7b14be,0x3f740bdd3f76ba07,0x3f6d67a13f710908,0x3f6504793f696591,0x3f5c61c73f61c598,0x3f5064af3f5695e5,0x3f4663543f4d9f02,0x3f36ad7f3f3ebc1b
.quad 0,0,0x3e25c58c3e22abb6,0x3e2bf8043e28defc,0x3ea395c53ea09ae5,0x3ea986c43ea68f12,0x3eeff7fb3eebcbbb,0x3ef840c83ef41f07,0x3f1b02c63f187fc0,0x3f1ff6cb3f1d7fd1,0x3f39f2ac3f373a23,0x3f3f41fc3f3ca003,0x3f53fac33f514d3d,0x3f591e6a3f5695e5,0x3f686b393f660f88,0x3f6cd0073f6aab7b
.quad 0x3f76ba073f74fa0b,0x3f79c79d3f7853f8,0x3f7e868b3f7dabcc,0x3f7fa6e33f7f2f9d,0x3f7f9c183f7fec43,0x3f7e43233f7f0e58,0x3f79f35e3f7baccd,0x3f75a67b3f77f110,0x3f6db2933f710908,0x3f660f883f6a09a7,0x3f5b2c793f604621,0x3f4fefa83f55b993,0x3f42de293f49d112,0x3f33e7bc3f3b8f3b,0x3f256bcb3f2e3bde,0x3f12c39a3f1c420c
.quad 0,0,0x3e3228d43e2f10a2,0x3e3857ec3e354098,0x3eaf713a3eac7cd4,0x3eb554ec3eb263ef,0x3f003a063efc5d27,0x3f0448893f0242b1,0x3f24d2253f226799,0x3f2994153f273656,0x3f4463373f41d870,0x3f4955213f46e22a,0x3f5df6be3f5b941a,0x3f6282103f604621,0x3f70c5013f6ed89e,0x3f74484b3f7294f8
.quad 0x3f7c3b283f7b14be,0x3f7e13243f7d3aac,0x3f7fffb13f7fec43,0x3f7f90b13f7fe129,0x3f7bf5313f7d3aac,0x3f78b47b3f7a7302,0x3f703b373f731447,0x3f69b7e43f6d1c1d,0x3f5d2d533f61c598,0x3f5318493f584853,0x3f4360513f49d112,0x3f3592e73f3ca003,0x3f239da93f2beb4a,0x3f121eb03f1b02c6,0x3efdbabb3f08f59b,0x3ed3c8673ee900b7
.quad 0,0,0x3e3e853e3e3b6ecf,0x3e44b0b93e419b37,0x3ebb31a03eb8442a,0x3ec1071e3ebe1d4a,0x3f084b923f064b82,0x3f0c42c93f0a48ad,0x3f2e3bde3f2beb4a,0x3f32c8c93f3085bb,0x3f4e16893f4bbbf8,0x3f52a6493f5064af,0x3f66becc3f64aa59,0x3f6aab7b3f68bf3c,0x3f77583a3f75dec6,0x3f79f35e3f78b47b
.quad 0x3f7f4e6d3f7ec46d,0x3f7fec433f7fb10f,0x3f7e5a383f7f0e58,0x3f7c5d3a3f7d7474,0x3f7484223f76ba07,0x3f6f68303f721352,0x3f62241a3f660f88,0x3f5988ad3f5df6be,0x3f47de653f4d9f02,0x3f3b8f3b3f41d870,0x3f269de33f2e3bde,0x3f16999f3f1ebc12,0x3eff17b23f08f59b,0x3ed8106b3eebcbbb,0x3ea80b1f3ebe1d4a,0x3e75c35a3e919ddd
.quad 0x3f2beb4a3f3504f3,0x3f187fc03f226799,0x3f0d92813f187fc0,0x3eed30633f0242b1,0x3ed8106b3ef15aea,0x3ea395c53ebe1d4a,0x3e901c2c3eac7cd4,0x3e2bf8043e667c66,0x3e09cf863e47c5c2,0x3c490e903d96a905,0xbc7b514b3d48fb30,0xbe1324cabda3308c,0xbe28defcbdc8bd36,0xbe97a117be6c9a7f,0xbe9f1cdfbe78cfcc,0xbee1fb6abec1071e
.quad 0xbee63375bec3ef15,0xbf13682abf039c3d,0xbf140c5fbf039c3d,0xbf3238aabf239da9,0xbf31a81dbf226799,0xbf4cae79bf3fc767,0xbf4b41fabf3daef9,0xbf62241abf577026,0xbf604621bf54db31,0xbf721352bf6a09a7,0xbf703b37bf676bd8,0xbf7c187abf772417,0xbf7ac516bf74fa0b,0xbf7ff4e6bf7e70b0,0xbf7fa6e3bf7d3aac,0xbf7d906ebf7fc38f
.quad 0x3f039c3d3f0e39da,0x3edae8803ef15aea,0x3ebca7af3ed53641,0x3e8a11f73ea395c5,0x3e5a39973e888e93,0x3dd53db93e22abb6,0x3d55880e3de1bc2e,0xbd83db0abbc90f88,0xbde1bc2ebd48fb30,0xbe6c9a7fbe2f10a2,0xbe8a11f7be541501,0xbec8477cbea986c4,0xbed8106bbeb8442a,0xbf0a48adbef6e0cb,0xbf102dd5bf00e7e4,0xbf2c800fbf1ebc12
.quad 0xbf3085bbbf226799,0xbf49d112bf3daef9,0xbf4c3578bf3fc767,0xbf61668abf577026,0xbf628210bf584853,0xbf7294f8bf6b4b0c,0xbf72d4ebbf6b4b0c,0xbf7cdf6cbf78b47b,0xbf7cbfc9bf7853f8,0xbf7ffb11bf7f4e6d,0xbf7fffb1bf7f0e58,0xbf7bd14dbf7eea9d,0xbf7c7eb0bf7f4e6d,0xbf708066bf778bc5,0xbf725470bf791298,0xbf5e5aa6bf696591
.quad 0x3eac7cd43ec3ef15,0x3e78cfcc3e94a031,0x3e2bf8043e605c13,0x3d83db0a3dee3876,0xbbc90f883d48fb30,0xbdee3876bd7b2b74,0xbe3857ecbdfab273,0xbe9620d2be72b651,0xbeb263efbe94a031,0xbeebcbbbbecf7bca,0xbf019573bee63375,0xbf1ce11fbf0f8784,0xbf26050abf187fc0,0xbf3ebc1bbf32c8c9,0xbf456439bf396842,0xbf5a5ba0bf5064af
.quad 0xbf5ebe05bf54db31,0xbf6ed89ebf676bd8,0xbf714c7abf6a09a7,0xbf7b87b2bf772417,0xbf7c7eb0bf7853f8,0xbf7ffec4bf7f0e58,0xbf7ffd39bf7f4e6d,0xbf7c187abf7eea9d,0xbf7baccdbf7ec46d,0xbf6ff573bf76ba07,0xbf6faf1bbf76ba07,0xbf5bfb34bf66becc,0xbf5c61c7bf676bd8,0xbf40d0dabf4f7a1f,0xbf425b89bf514d3d,0xbf1f599fbf31a81d
.quad 0x3e1640833e47c5c2,0x3d48fb303dc8bd36,0xbd2351cb3c490e90,0xbe1324cabdbc3ac3,0xbe667c66be2f10a2,0xbea986c4be8e9a22,0xbece0beabeb263ef,0xbf019573bee900b7,0xbf10d3cdbf039c3d,0xbf299415bf1d7fd1,0xbf3592e7bf299415,0xbf4b41fabf40d0da,0xbf53fac3bf49d112,0xbf655e0bbf5d2d53,0xbf6afb8cbf633c5a,0xbf76ef5bbf718f57
.quad 0xbf79c79dbf74fa0b,0xbf7f4e6dbf7d3aac,0xbf7fdaafbf7e70b0,0xbf7e2b72bf7fc38f,0xbf7cfe73bf7f4e6d,0xbf73913fbf791298,0xbf714c7abf778bc5,0xbf5fe4e9bf696591,0xbf5d2d53bf676bd8,0xbf43e200bf514d3d,0xbf4154e1bf4f7a1f,0xbf209393bf31a81d,0xbf1ebc12bf3085bb,0xbeee9479bf0b9a6b,0xbeed3063bf0b9a6b,0xbe931f35bec1071e
.quad 0x3d97bf80bcc93f80,0x3e2fbf7dbdfb3f7f,0xbe60bf7d3d973f80,0xbefcbf673eb83f75,0xbefcbf713e2f3f80,0xbf6fbf043f423f46,0xbf39bf5c3e893f80,0xbf733d493f7a3ef1,0xbf65bf3e3eb83f80,0xbf093f183f773dc9,0xbf7cbf183ee63f80,0x3dfb3f713f39be95,0xbf7ebedb3f093f80,0x3f393f783ea1bf22,0xbf6abe793f1d3f80,0x3f7f3f2cbe2fbf62
.quad 0xbf42bd493f313f80,0x3f513e16bf1dbf7f,0xbf093e163f423f80,0x3e89bedbbf6abf75,0xbe893eac3f513f80,0xbecfbf5cbf7fbf46,0x3cc93f043f5f3f80,0xbf65bf80bf58bef1,0x3ea13f2c3f6a3f80,0xbf7abf4ebefcbdc9,0x3f133f4e3f733f80,0xbf1dbeacbcc93e95,0x3f4a3f673f7a3f80,0x3cc93e793ee63f22,0x3f6f3f783f7e3f80,0x3f273f3e3f513f62
.quad 0x3e89bf78be603f7b,0x3eb8bf71bea13f75,0xbf39bf3e3f1d3f55,0xbf65bf043f513f22,0xbf733e163f803e48,0xbf093f3e3f4abef1,0xbe2f3f673f27bf0e,0x3f4a3f4ebeb8bf7f,0x3f4a3f5cbe2fbf7b,0x3f31bedbbf7fbe95,0x3f6a3d49bf5fbf55,0xbf27bf78be603f46,0x3d97bf4ebf6fbe48,0xbf513d493f5f3f62,0xbf58bf71bea13f0e,0x3efc3f7d3f39bdc9
.quad 0xbf5fbe793f093f7b,0x3f6a3eacbee6bf75,0x3cc93f2c3f7e3f55,0xbea1bf5cbf7cbf22,0x3f653f7d3f393e48,0xbf7abf2cbdfb3ef1,0x3f513edbbd97bf0e,0x3dfb3f183f6a3f7f,0xbdfbbf04bf51bf7b,0x3f803f673f273e95,0xbf6fbf80bf77bf55,0x3d97be79bf09bf46,0xbf42bf18becfbe48,0xbf7cbf80bf77bf62,0x3e603eac3ee63f0e,0xbe89be16bcc93dc9
.quad 0x3ee6bf67becf3f6d,0x3f09bf5cbefc3f62,0xbf7cbe793f733ec4,0xbf7e3d493f803dc9,0x3dfb3f803e60bf6d,0x3f393f4ebee6bf75,0x3f6abe16bf7ebec4,0x3d97bf71bf133f22,0xbf27bf71bcc93f6d,0xbf513e793f7e3ef1,0xbf093f043f7f3ec4,0x3f773f2cbeb8bf7f,0x3f773f3ebe2fbf6d,0xbecfbf7dbf273e95,0xbcc9bf4ebf77bec4,0xbee63edb3f7a3f46
.quad 0xbf73bedb3eb83f6d,0x3f7a3f04be89bf62,0x3f133f783f653ec4,0xbf4abf80bf39bdc9,0x3f1d3d49bf09bf6d,0x3cc93f183f733f75,0xbf6fbf7dbf4abec4,0x3f423eacbe2fbf22,0xbd973eac3f313f6d,0xbf7cbf78bf4abef1,0x3f7a3f5c3f273ec4,0x3efc3f3e3f6a3f7f,0xbefcbf2cbf51bf6d,0x3eb83e16bd97be95,0xbf31bf18befcbec4,0xbf73bf67bf58bf46
.quad 0x3f1dbf4ebf133f55,0x3f31bf3ebf273f46,0xbf6a3eac3f77be48,0xbf423f183f58bef1,0x3f7f3e79bf6abf0e,0x3f51bedbbf773dc9,0xbf58bf3e3ee63f7b,0xbf5f3e793f803e95,0x3efc3f7d3e60bf55,0x3f6abd49bf73bf22,0xbcc9bf67bf4a3e48,0xbf73be163f513f62,0xbee63f043f803f0e,0x3f7a3eacbf1dbf7f,0x3f513d49bf42bf7b,0xbf7ebf043eb83f75
.quad 0xbf7ebf183e2f3f55,0x3f803f2cbd97bf46,0x3f6f3f713efcbe48,0xbf7fbf4ebe603ef1,0xbf27bf78bf6fbf0e,0x3f7c3f673efcbdc9,0x3e603f2c3f733f7b,0xbf77bf78bf39be95,0x3e89be16bf09bf55,0x3f6f3f803f653f22,0xbf31bedbbdfb3e48,0xbf65bf7dbf7cbf62,0x3f733f5c3f393f0e,0x3f583f713f7e3f7f,0xbf7cbf80bf7fbf7b,0xbf4abf5cbf6abf75
.quad 0xbf7fbd493f808000,0xbf7cbe163f7e3dc9,0xbf7a3e163f7f8000,0xbf5f3edb3f6fbe95,0xbf5f3eac3f7c8000,0xbeb83f5c3f27bf22,0xbf313f043f778000,0x3ea13f803e60bf62,0xbee63f2c3f6f8000,0x3f583f4ebe89bf7f,0xbe2f3f4e3f658000,0x3f7e3eacbf31bf75,0x3dfb3f673f588000,0x3f31be79bf73bf46,0x3ecf3f783f4a8000,0x3d97bf3ebf7cbef1
.quad 0x3f273f803f398000,0xbf13bf7dbf4abdc9,0x3f583f7d3f278000,0xbf77bf67becf3e95,0x3f773f713f138000,0xbf6abf043d973f22,0x3f803f5c3efc8000,0xbee63d493f093f62,0x3f733f3e3ecf8000,0x3e603f183f5f3f7f,0x3f513f183ea18000,0x3f4a3f713f803f75,0x3f1d3edb3e608000,0x3f803f783f653f46,0x3eb83e793dfb8000,0x3f423f2c3f133ef1
.quad 0xbf77be793f7a3e48,0xbf6fbeac3f733e95,0xbf313f2c3f4abf0e,0xbee63f5c3f13bf46,0x3ea13f7d3cc9bf7b,0x3f583f2cbf1dbf62,0x3f7c3edbbf42bf55,0x3f1dbf18bf6f3dc9,0x3f1dbf04bf7cbe48,0xbf39bf673d973f75,0xbecfbf80befc3f0e,0xbf423e793f7a3f22,0xbf7fbf183eb83f7b,0x3f133f803efcbef1,0xbf093eac3f733f55,0x3f5f3e16bf31bf7f
.quad 0x3efc3f783f583e48,0xbecfbf71bf65be95,0x3f803f3e3dfbbf0e,0xbf73bf043e2f3f46,0x3ee6be16bf31bf7b,0x3e603f3e3f7e3f62,0xbf13bf67bf7fbf55,0x3f7e3f4e3ecfbdc9,0xbf7ebf5cbf13be48,0xbcc9bedbbf42bf75,0xbeb8bd493e893f0e,0xbf7fbf78bf58bf22,0x3f273f4e3f6a3f7b,0xbe2f3d493e893ef1,0x3f7a3f713f653f55,0x3f773f7d3f803f7f
.quad 0xbf65bedb3f6a3ec4,0xbf58bf043f5f3ef1,0xbe2f3f783ea1bf6d,0x3dfb3f803cc9bf7f,0x3f7e3d49bf7abec4,0x3f31bf18bf653e95,0xbecfbf7dbdfb3f6d,0xbf7fbeac3f513f46,0xbf423eac3f803ec4,0x3f133f783dfbbf62,0x3f583f5cbd97bf6d,0x3e89bf3ebf6fbdc9,0x3e89bf2cbf7cbec4,0xbf6abe163f423f75,0xbf80bf183e893f6d,0x3f653f673e60bf22
.quad 0x3ea13f673f6f3ec4,0xbe60bf5cbf77bef1,0x3f513e79bee6bf6d,0xbf1d3d493f313f7f,0xbf4abf80bf58bec4,0x3f803f4e3ea1be95,0xbeb83e163f1d3f6d,0xbf27bf71bf7cbf46,0x3f7f3f713f393ec4,0xbe2f3e793f1d3f62,0xbe60bf04bf42bf6d,0x3f5f3f2c3ecf3dc9,0xbf5fbf3ebf13bec4,0xbf6fbf7dbf7fbf75,0x3f393f4e3f5f3f6d,0x3ea13edb3f093f22
.quad 0xbf4abf183f513f0e,0xbf39bf2c3f423f22,0x3ecf3f71be89bf7b,0x3f273f4ebf09bf62,0x3d97bf78becf3f55,0xbf13bf673e893f7f,0xbf093f2c3f65be48,0x3efc3f783cc9bf75,0x3f5fbe16bf7abf0e,0xbecfbf80bea13f46,0xbf80bedb3f1d3f7b,0x3ea13f7d3f13bef1,0x3f653f5c3cc9bf55,0xbe60bf71bf4a3dc9,0xbf13bf80bf273e48,0x3dfb3f5c3f6f3e95
.quad 0x3dfb3f4e3f7c3f0e,0xbcc9bf3ebf7fbf22,0x3eb8beacbf5fbf7b,0xbd973f183f7a3f62,0xbf42be793eb83f55,0x3e2fbedbbf5fbf7f,0x3f7a3f3e3ea1be48,0xbe893e793f313f75,0xbf77bf7dbf58bf0e,0x3eb8bd49bee6bf46,0x3f393f673f7e3f7b,0xbee6be163e2f3ef1,0xbea1bf04bf31bf55,0x3f093eac3dfbbdc9,0xbe2fbd493d973e48,0xbf1dbf04becfbe95
.quad 0x3f42bf2cbf393f35,0x3f51bf18bf4a3f22,0xbf093f4e3f27bf35,0xbe893f713ecfbf62,0x3e89bf67bf133f35,0xbecfbf783d973f7f,0x3cc93f783efcbf35,0x3f653f2cbf09bf75,0xbea1bf80becf3f35,0xbf7abe163f5f3f46,0x3f133f7d3ea1bf35,0x3f1dbedbbf80bef1,0xbf4abf71be603f35,0x3cc93f5c3f653dc9,0x3f6f3f5c3dfbbf35,0xbf27bf80bf133e95
.quad 0xbf7fbf3ebcc93f35,0x3f7c3f4e3dfbbf22,0x3f7a3f18bd97bf35,0xbf5fbeac3eb83f62,0xbf5fbedb3e2f3f35,0x3eb8be79bf42bf7f,0x3f313e79be89bf35,0x3ea13f3e3f7a3f75,0xbee6bd493eb83f35,0xbf58bf7dbf77bf46,0x3e2fbe16bee6bf35,0x3f7e3f673f393ef1,0x3dfb3eac3f093f35,0xbf31bf04bea1bdc9,0xbecfbf04bf1dbf35,0x3d97bd49be2fbe95
.quad 0x3f5fbf04bf583f0e,0x3f6abedbbf653ef1,0x3cc93f803dfbbf7b,0x3ea13f78be2fbf7f,0xbf65bf183f313f55,0xbf7a3d493f7e3e95,0x3f51beacbf7fbe48,0xbdfbbf7dbecf3f46,0x3dfb3f783f13bf0e,0x3f803eacbf42bf62,0xbf6fbf3e3e893f7b,0xbd973f5c3f58bdc9,0x3f42be16bf6abf55,0xbf7cbf2c3e893f75,0x3e603f673f653e48,0x3e89bf18bf80bf22
.quad 0xbf77bf5cbe603f0e,0x3f6f3f673ea1bef1,0x3f313d49bf1dbf7b,0xbee63e793f513f7f,0x3ea13f4e3f803f55,0xbf58bf80bf4abe95,0xbf7cbf71bf27be48,0x3f1d3e16beb8bf46,0x3f1d3e79be2fbf0e,0x3f393f713f7f3f62,0x3ecf3f2c3f5f3f7b,0xbf42bf04be603dc9,0xbf7fbf7dbf6fbf55,0xbf13bf3ebf5fbf75,0x3f093edb3ea13e48,0x3f5f3f4e3f393f22
.quad 0x3f73beacbf6f3ec4,0x3f7abe79bf773e95,0x3f133f5cbee6bf6d,0x3f4a3f2cbf31bf46,0xbf1d3f2c3f58bec4,0x3cc93f7d3ea1bf62,0xbf6fbf183f1d3f6d,0xbf423edb3f7c3dc9,0x3d97bf67bf393ec4,0xbf7cbf043f1d3f75,0x3f7a3e79bf42bf6d,0xbefcbf80becf3f22,0x3efc3f803f13bec4,0x3eb8bf18bf7fbef1,0xbf313e163f5f3f6d,0x3f733eacbf09bf7f
.quad 0xbf65bf71becf3ec4,0x3f583f783efcbe95,0x3e2fbf04bf73bf6d,0x3dfb3f3e3f803f46,0x3f7e3f3e3e60bec4,0xbf31be163ee63f62,0x3ecf3f4e3f7e3f6d,0xbf7fbf67bf13bdc9,0xbf42bedbbcc93ec4,0xbf13bf5cbf7ebf75,0xbf58bf78bf7fbf6d,0x3e89bd49beb8bf22,0x3e893d49be2fbec4,0x3f6a3f4e3f273ef1,0x3f803f7d3f773f6d,0x3f653f713f7a3f7f
.quad 0x3f7ebe16bf7c3e48,0x3f80bd49bf7f3dc9,0x3f6f3edbbf5fbf0e,0x3f7f3e16bf7abe95,0x3f273f5cbeb8bf7b,0x3f7c3eacbf5fbf22,0x3e603f803ea1bf55,0x3f773f04bf31bf62,0xbe893f4e3f58be48,0x3f6f3f2cbee6bf7f,0xbf313eac3f7e3f0e,0x3f653f4ebe2fbf75,0xbf73be793f313f7b,0x3f583f673dfbbf46,0xbf7cbf3e3d973f55,0x3f4a3f783ecfbef1
.quad 0xbf4abf7dbf133e48,0x3f393f803f27bdc9,0xbecfbf67bf77bf0e,0x3f273f7d3f583e95,0x3d97bf04bf6abf7b,0x3f133f713f773f22,0x3f093d49bee6bf55,0x3efc3f5c3f803f62,0x3f5f3f183e60be48,0x3ecf3f3e3f733f7f,0x3f803f713f4a3f0e,0x3ea13f183f513f75,0x3f653f783f803f7b,0x3e603edb3f1d3f46,0x3f133f2c3f423f55,0x3dfb3e793eb83ef1
.quad 0xbf27bf3e3f313f35,0xbf13bf4e3f1d3f46,0x3f583f18bf42bf35,0x3f773eacbf6abef1,0xbf77bedb3f513f35,0xbf6a3e793f7f3dc9,0x3f803e79bf5fbf35,0x3ee6bf3ebf583e95,0xbf73bd493f6a3f35,0x3e603f7d3efcbf22,0x3f51be16bf73bf35,0xbf4abf67bcc93f62,0xbf1d3eac3f7a3f35,0x3f803f04bee6bf7f,0x3eb8bf04bf7ebf35,0xbf423d493f513f75
.quad 0xbd973f2c3f803f35,0x3e2fbf18bf7ebf46,0xbe60bf4ebf7fbf35,0x3efc3f713f6f3ef1,0x3efc3f673f7c3f35,0xbf6fbf78bf27bdc9,0xbf39bf78bf77bf35,0x3f733f2c3e60be95,0x3f653f803f6f3f35,0xbf09be163e893f22,0xbf7cbf7dbf65bf35,0xbdfbbedbbf31bf62,0x3f7e3f713f583f35,0x3f393f5c3f733f7f,0xbf6abf5cbf4abf35,0xbf7fbf80bf7cbf75
.quad 0xbefcbf5c3f093f55,0xbecfbf673ee63f62,0x3f803d49bf7ebe48,0x3f73be79bf7c3dc9,0xbee63f4e3f39bf0e,0x3e603f803dfbbf75,0xbf13bf713d973f7b,0xbf7ebe163f6a3f22,0x3f7e3e79bf51bf55,0xbcc9bf71bf273ef1,0xbeb83f2c3f773e48,0x3f7f3f04bf09bf7f,0xbf27bf7dbecf3f0e,0xbe2f3f3e3f773e95,0x3f7a3edbbee6bf7b,0xbf77bf4ebcc93f46
.quad 0xbe893f043f7a3f55,0x3eb8bedbbf73bf62,0xbf39bf80bf4abe48,0x3f653f783f13bdc9,0x3f733f183cc9bf0e,0xbf093d493f1d3f75,0xbe2f3eac3f423f7b,0xbf4abf7dbf6fbf22,0xbf4abf78bf7cbf55,0x3f313eacbd97bef1,0x3f6a3f3e3efc3e48,0x3f273f5c3f7a3f7f,0xbd973e163eb83f0e,0xbf51bf2cbefcbe95,0xbf58bf67bf73bf7b,0xbefcbf18bf31bf46
.quad 0xbea1bf713eb83f6d,0xbe60bf783e893f75,0x3f51bf04bf653ec4,0x3f1dbf3ebf393f22,0x3f4a3f3ebf09bf6d,0x3f803e16bf73bef1,0xbeb83f4e3f4abec4,0x3f273f67be2fbf7f,0xbf7fbedb3f313f6d,0xbe2f3f5c3f4abe95,0xbe60bf78bf273ec4,0xbf5f3d493f6a3f46,0x3f5f3d49bf51bf6d,0xbf6fbf4e3d973f62,0x3f393f7d3efcbec4,0xbea1bf71bf58bdc9
.quad 0xbee63eac3f6a3f6d,0x3f09be79bf5fbf75,0xbf7cbf5cbea13ec4,0x3f7e3f2c3cc9bf22,0xbdfbbf2cbf7abf6d,0x3f393f7d3f653ef1,0x3f6a3f183dfbbec4,0xbd973edb3f513f7f,0x3f273f673f803f6d,0xbf51bf04bdfb3e95,0xbf09be793d973ec4,0xbf77bf80bf6fbf46,0xbf77bf80bf7cbf6d,0xbecfbf18bf42bf62,0xbcc9be16be89bec4,0x3ee63eac3e603dc9
.quad 0xbdfbbf7d3e2f3f7b,0xbcc9bf803d973f7f,0x3eb8bf67befc3f55,0x3d97bf7dbe603f75,0x3f42bf04bf6f3e48,0x3e2fbf71befc3f46,0x3f7a3d49bf73bf0e,0x3e89bf5cbf393ef1,0x3f773f18bf09bf7b,0x3eb8bf3ebf653dc9,0x3f393f713dfbbf55,0x3ee6bf18bf7cbe95,0x3ea13f783f39be48,0x3f09bedbbf7ebf22,0xbe2f3f2c3f7f3f0e,0x3f1dbe79bf6abf62
.quad 0xbf1d3e163f513f7b,0x3f31bd49bf42bf7f,0xbf6abedb3e893f55,0x3f423e16bf09bf75,0xbf7fbf5cbecf3e48,0x3f513eacbe89bf46,0xbf58bf80bf65bf0e,0x3f5f3f043cc9bef1,0xbefcbf4ebf7abf7b,0x3f6a3f2c3ea1bdc9,0xbcc9beacbf1dbf55,0x3f733f4e3f133e95,0x3ee63e793cc9be48,0x3f7a3f673f4a3f22,0x3f513f3e3f273f0e,0x3f7e3f783f6f3f62
.quad 0x3f6dbec4bf6d3ec4,0xbec4bf6d3ec43f6d,0x3f4abf09bf653eb8,0xbf1dbf583ee63f6f,0x3f18bf2cbf5c3eac,0xbf4ebf3e3f043f71,0x3eb8bf4abf513ea1,0xbf6fbf1d3f133f73,0x3dc9bf62bf463e95,0xbf7fbef13f223f75,0xbe2fbf73bf393e89,0xbf7cbea13f313f77,0xbedbbf7dbf2c3e79,0xbf67be163f3e3f78,0xbf27bf80bf1d3e60,0xbf423cc93f4a3f7a
.quad 0xbf55bf7bbf0e3e48,0xbf0e3e483f553f7b,0xbf73bf6fbefc3e2f,0xbea13eb83f5f3f7c,0xbf80bf5cbedb3e16,0xbd493f043f673f7d,0xbf7abf42beb83dfb,0x3e603f273f6f3f7e,0xbf62bf22be953dc9,0x3ef13f463f753f7f,0xbf39befcbe603d97,0x3f313f5f3f7a3f7f,0xbf04beacbe163d49,0x3f5c3f713f7d3f80,0xbe89be2fbd973cc9,0x3f773f7c3f7f3f80
.quad 0x3f6dbec4bf6d3ec4,0xbec4bf6d3ec43f6d,0x3efcbf51bf273f31,0xbf5fbf133f423f39,0xbe16bf80be793f67,0xbf7dbd493f783edb,0xbf39bf5f3e603f7f,0xbf313efc3f7a3d97,0xbf7fbef13f223f75,0xbdc93f623f46be95,0xbf583d973f6a3f4a,0x3f093f7f3ecfbf1d,0xbeac3f183f803f04,0x3f713f4ebd49bf5c,0x3ea13f6f3f5f3e2f,0x3f733eb8befcbf7c
.quad 0x3f553f7b3f0ebe48,0x3f0ebe48bf55bf7b,0x3f7f3f393dfbbf09,0xbd97bf31bf7ebf58,0x3f3e3e79beacbf4e,0xbf2cbf78bf71bf18,0x3e2fbea1bf39bf77,0xbf7cbf73bf31be89,0xbef1bf46bf75bf7f,0xbf62bf22be953dc9,0xbf6abf7ebf7cbf65,0xbecfbdfb3e2f3ee6,0xbf78bf67bf4ebf2c,0x3e793edb3f183f3e,0xbf1dbf09bee6beb8,0x3f4a3f583f653f6f
.quad 0x3f6dbec4bf6d3ec4,0xbec4bf6d3ec43f6d,0x3dfbbf7abea13f6a,0xbf7ebe603f733ecf,0xbf4ebf3e3f043f71,0xbf183f2c3f5cbeac,0xbf6a3dfb3f7c3ee6,0x3ecf3f7e3e2fbf65,0xbdc93f623f46be95,0x3f7f3ef1bf22bf75,0x3f513f653cc9bf5f,0x3f13bee6bf80befc,0x3f673e16bf3ebf78,0xbedbbf7dbf2c3e79,0x3d97bf39bf7ebf09,0xbf7fbf313dfb3f58
.quad 0xbf55bf7bbf0e3e48,0xbf0e3e483f553f7b,0xbf65becf3e893f51,0x3ee63f6a3f773f13,0xbd493f043f673f7d,0x3f803f5c3edbbe16,0x3f583f7f3f6a3f1d,0x3f093d97becfbf4a,0x3f623f223e95bdc9,0xbef1bf46bf75bf7f,0x3cc9be89bf09bf42,0xbf80bf77bf58bf27,0xbf5cbf71bf7dbf80,0xbf04beacbe163d49,0xbf5fbf51bf42bf31,0x3efc3f133f273f39
.quad 0x3f6dbec4bf6d3ec4,0xbec4bf6d3ec43f6d,0xbe89bf7c3d973f80,0xbf773e2f3f7f3cc9,0xbf7dbd493f783edb,0x3e163f803e79bf67,0x3cc93f773f09bf27,0x3f803e89bf58bf42,0x3f7f3ef1bf22bf75,0x3dc9bf62bf463e95,0x3e60bf42bf6fbdfb,0xbf7abf273eb83f7e,0xbf71bf4e3d493f5c,0xbeac3f183f803f04,0xbee63ecf3f773f51,0x3f653f6a3e89bf13
.quad 0x3f553f7b3f0ebe48,0x3f0ebe48bf55bf7b,0x3f273cc9bf1dbf7a,0xbf42bf80bf4abe60,0xbf2cbf78bf71bf18,0xbf3ebe793eac3f4e,0xbf51bee63cc93efc,0x3f133f653f803f5f,0x3ef13f463f753f7f,0x3f623f223e95bdc9,0x3f6f3f4a3f133ea1,0xbeb8bf1dbf51bf73,0xbe79bedbbf18bf3e,0xbf78bf67bf4ebf2c,0xbf7ebf7abf73bf6a,0x3dfb3e603ea13ecf
.quad 0x3f6dbec4bf6d3ec4,0xbec4bf6d3ec43f6d,0xbf1dbf583ee63f6f,0xbf4a3f093f65beb8,0xbf183f2c3f5cbeac,0x3f4e3f3ebf04bf71,0x3f6f3f1dbf13bf73,0x3eb8bf4abf513ea1,0x3dc9bf62bf463e95,0xbf7fbef13f223f75,0xbf7cbea13f313f77,0x3e2f3f733f39be89,0x3edb3f7d3f2cbe79,0x3f673e16bf3ebf78,0x3f42bcc9bf4abf7a,0xbf27bf80bf1d3e60
.quad 0xbf55bf7bbf0e3e48,0xbf0e3e483f553f7b,0xbea13eb83f5f3f7c,0x3f733f6f3efcbe2f,0x3f803f5c3edbbe16,0x3d49bf04bf67bf7d,0xbe60bf27bf6fbf7e,0xbf7abf42beb83dfb,0xbf62bf22be953dc9,0x3ef13f463f753f7f,0x3f313f5f3f7a3f7f,0x3f393efc3e60bd97,0x3f043eac3e16bd49,0xbf5cbf71bf7dbf80,0xbf77bf7cbf7fbf80,0xbe89be2fbd973cc9
.quad 0x3f6dbec4bf6d3ec4,0xbec4bf6d3ec43f6d,0xbf5fbf133f423f39,0xbefc3f513f27bf31,0x3e163f803e79bf67,0x3f7d3d49bf78bedb,0x3f31befcbf7abd97,0xbf39bf5f3e603f7f,0xbf7fbef13f223f75,0xbdc93f623f46be95,0x3f093f7f3ecfbf1d,0x3f58bd97bf6abf4a,0x3eacbf18bf80bf04,0xbf71bf4e3d493f5c,0xbf73beb83efc3f7c,0x3ea13f6f3f5f3e2f
.quad 0x3f553f7b3f0ebe48,0x3f0ebe48bf55bf7b,0xbd97bf31bf7ebf58,0xbf7fbf39bdfb3f09,0xbf3ebe793eac3f4e,0x3f2c3f783f713f18,0x3f7c3f733f313e89,0x3e2fbea1bf39bf77,0xbef1bf46bf75bf7f,0xbf62bf22be953dc9,0xbecfbdfb3e2f3ee6,0x3f6a3f7e3f7c3f65,0x3f783f673f4e3f2c,0xbe79bedbbf18bf3e,0xbf4abf58bf65bf6f,0xbf1dbf09bee6beb8
.quad 0x3f6dbec4bf6d3ec4,0xbec4bf6d3ec43f6d,0xbf7ebe603f733ecf,0xbdfb3f7a3ea1bf6a,0x3f4e3f3ebf04bf71,0x3f18bf2cbf5c3eac,0xbecfbf7ebe2f3f65,0xbf6a3dfb3f7c3ee6,0xbdc93f623f46be95,0x3f7f3ef1bf22bf75,0x3f13bee6bf80befc,0xbf51bf65bcc93f5f,0xbf67be163f3e3f78,0x3edb3f7d3f2cbe79,0x3f7f3f31bdfbbf58,0x3d97bf39bf7ebf09
.quad 0xbf55bf7bbf0e3e48,0xbf0e3e483f553f7b,0x3ee63f6a3f773f13,0x3f653ecfbe89bf51,0x3d49bf04bf67bf7d,0xbf80bf5cbedb3e16,0xbf09bd973ecf3f4a,0x3f583f7f3f6a3f1d,0x3f623f223e95bdc9,0xbef1bf46bf75bf7f,0xbf80bf77bf58bf27,0xbcc93e893f093f42,0x3f5c3f713f7d3f80,0x3f043eac3e16bd49,0xbefcbf13bf27bf39,0xbf5fbf51bf42bf31
.quad 0x3f6dbec4bf6d3ec4,0xbec4bf6d3ec43f6d,0xbf773e2f3f7f3cc9,0x3e893f7cbd97bf80,0x3f7d3d49bf78bedb,0xbe16bf80be793f67,0xbf80be893f583f42,0x3cc93f773f09bf27,0x3f7f3ef1bf22bf75,0x3dc9bf62bf463e95,0xbf7abf273eb83f7e,0xbe603f423f6f3dfb,0x3f713f4ebd49bf5c,0x3eacbf18bf80bf04,0xbf65bf6abe893f13,0xbee63ecf3f773f51
.quad 0x3f553f7b3f0ebe48,0x3f0ebe48bf55bf7b,0xbf42bf80bf4abe60,0xbf27bcc93f1d3f7a,0x3f2c3f783f713f18,0x3f3e3e79beacbf4e,0xbf13bf65bf80bf5f,0xbf51bee63cc93efc,0x3ef13f463f753f7f,0x3f623f223e95bdc9,0xbeb8bf1dbf51bf73,0xbf6fbf4abf13bea1,0x3e793edb3f183f3e,0x3f783f673f4e3f2c,0xbdfbbe60bea1becf,0xbf7ebf7abf73bf6a
.quad 0x3f6dbec4bf6d3ec4,0xbec4bf6d3ec43f6d,0xbf4a3f093f65beb8,0x3f1d3f58bee6bf6f,0x3f18bf2cbf5c3eac,0xbf4ebf3e3f043f71,0xbeb83f4a3f51bea1,0x3f6f3f1dbf13bf73,0x3dc9bf62bf463e95,0xbf7fbef13f223f75,0x3e2f3f733f39be89,0x3f7c3ea1bf31bf77,0xbedbbf7dbf2c3e79,0xbf67be163f3e3f78,0x3f273f803f1dbe60,0x3f42bcc9bf4abf7a
.quad 0xbf55bf7bbf0e3e48,0xbf0e3e483f553f7b,0x3f733f6f3efcbe2f,0x3ea1beb8bf5fbf7c,0xbf80bf5cbedb3e16,0xbd493f043f673f7d,0x3f7a3f423eb8bdfb,0xbe60bf27bf6fbf7e,0xbf62bf22be953dc9,0x3ef13f463f753f7f,0x3f393efc3e60bd97,0xbf31bf5fbf7abf7f,0xbf04beacbe163d49,0x3f5c3f713f7d3f80,0x3e893e2f3d97bcc9,0xbf77bf7cbf7fbf80
.quad 0x3f6dbec4bf6d3ec4,0xbec4bf6d3ec43f6d,0xbefc3f513f27bf31,0x3f5f3f13bf42bf39,0xbe16bf80be793f67,0xbf7dbd493f783edb,0x3f393f5fbe60bf7f,0x3f31befcbf7abd97,0xbf7fbef13f223f75,0xbdc93f623f46be95,0x3f58bd97bf6abf4a,0xbf09bf7fbecf3f1d,0xbeac3f183f803f04,0x3f713f4ebd49bf5c,0xbea1bf6fbf5fbe2f,0xbf73beb83efc3f7c
.quad 0x3f553f7b3f0ebe48,0x3f0ebe48bf55bf7b,0xbf7fbf39bdfb3f09,0x3d973f313f7e3f58,0x3f3e3e79beacbf4e,0xbf2cbf78bf71bf18,0xbe2f3ea13f393f77,0x3f7c3f733f313e89,0xbef1bf46bf75bf7f,0xbf62bf22be953dc9,0x3f6a3f7e3f7c3f65,0x3ecf3dfbbe2fbee6,0xbf78bf67bf4ebf2c,0x3e793edb3f183f3e,0x3f1d3f093ee63eb8,0xbf4abf58bf65bf6f
.quad 0x3f6dbec4bf6d3ec4,0xbec4bf6d3ec43f6d,0xbdfb3f7a3ea1bf6a,0x3f7e3e60bf73becf,0xbf4ebf3e3f043f71,0xbf183f2c3f5cbeac,0x3f6abdfbbf7cbee6,0xbecfbf7ebe2f3f65,0xbdc93f623f46be95,0x3f7f3ef1bf22bf75,0xbf51bf65bcc93f5f,0xbf133ee63f803efc,0x3f673e16bf3ebf78,0xbedbbf7dbf2c3e79,0xbd973f393f7e3f09,0x3f7f3f31bdfbbf58
.quad 0xbf55bf7bbf0e3e48,0xbf0e3e483f553f7b,0x3f653ecfbe89bf51,0xbee6bf6abf77bf13,0xbd493f043f673f7d,0x3f803f5c3edbbe16,0xbf58bf7fbf6abf1d,0xbf09bd973ecf3f4a,0x3f623f223e95bdc9,0xbef1bf46bf75bf7f,0xbcc93e893f093f42,0x3f803f773f583f27,0xbf5cbf71bf7dbf80,0xbf04beacbe163d49,0x3f5f3f513f423f31,0xbefcbf13bf27bf39
.quad 0x3f6dbec4bf6d3ec4,0xbec4bf6d3ec43f6d,0x3e893f7cbd97bf80,0x3f77be2fbf7fbcc9,0xbf7dbd493f783edb,0x3e163f803e79bf67,0xbcc9bf77bf093f27,0xbf80be893f583f42,0x3f7f3ef1bf22bf75,0x3dc9bf62bf463e95,0xbe603f423f6f3dfb,0x3f7a3f27beb8bf7e,0xbf71bf4e3d493f5c,0xbeac3f183f803f04,0x3ee6becfbf77bf51,0xbf65bf6abe893f13
.quad 0x3f553f7b3f0ebe48,0x3f0ebe48bf55bf7b,0xbf27bcc93f1d3f7a,0x3f423f803f4a3e60,0xbf2cbf78bf71bf18,0xbf3ebe793eac3f4e,0x3f513ee6bcc9befc,0xbf13bf65bf80bf5f,0x3ef13f463f753f7f,0x3f623f223e95bdc9,0xbf6fbf4abf13bea1,0x3eb83f1d3f513f73,0xbe79bedbbf18bf3e,0xbf78bf67bf4ebf2c,0x3f7e3f7a3f733f6a,0xbdfbbe60bea1becf
.quad 0x3f6dbec4bf6d3ec4,0xbec4bf6d3ec43f6d,0x3f1d3f58bee6bf6f,0x3f4abf09bf653eb8,0xbf183f2c3f5cbeac,0x3f4e3f3ebf04bf71,0xbf6fbf1d3f133f73,0xbeb83f4a3f51bea1,0x3dc9bf62bf463e95,0xbf7fbef13f223f75,0x3f7c3ea1bf31bf77,0xbe2fbf73bf393e89,0x3edb3f7d3f2cbe79,0x3f673e16bf3ebf78,0xbf423cc93f4a3f7a,0x3f273f803f1dbe60
.quad 0xbf55bf7bbf0e3e48,0xbf0e3e483f553f7b,0x3ea1beb8bf5fbf7c,0xbf73bf6fbefc3e2f,0x3f803f5c3edbbe16,0x3d49bf04bf67bf7d,0x3e603f273f6f3f7e,0x3f7a3f423eb8bdfb,0xbf62bf22be953dc9,0x3ef13f463f753f7f,0xbf31bf5fbf7abf7f,0xbf39befcbe603d97,0x3f043eac3e16bd49,0xbf5cbf71bf7dbf80,0x3f773f7c3f7f3f80,0x3e893e2f3d97bcc9
.quad 0x3f6dbec4bf6d3ec4,0xbec4bf6d3ec43f6d,0x3f5f3f13bf42bf39,0x3efcbf51bf273f31,0x3e163f803e79bf67,0x3f7d3d49bf78bedb,0xbf313efc3f7a3d97,0x3f393f5fbe60bf7f,0xbf7fbef13f223f75,0xbdc93f623f46be95,0xbf09bf7fbecf3f1d,0xbf583d973f6a3f4a,0x3eacbf18bf80bf04,0xbf71bf4e3d493f5c,0x3f733eb8befcbf7c,0xbea1bf6fbf5fbe2f
.quad 0x3f553f7b3f0ebe48,0x3f0ebe48bf55bf7b,0x3d973f313f7e3f58,0x3f7f3f393dfbbf09,0xbf3ebe793eac3f4e,0x3f2c3f783f713f18,0xbf7cbf73bf31be89,0xbe2f3ea13f393f77,0xbef1bf46bf75bf7f,0xbf62bf22be953dc9,0x3ecf3dfbbe2fbee6,0xbf6abf7ebf7cbf65,0x3f783f673f4e3f2c,0xbe79bedbbf18bf3e,0x3f4a3f583f653f6f,0x3f1d3f093ee63eb8
.quad 0x3f6dbec4bf6d3ec4,0xbec4bf6d3ec43f6d,0x3f7e3e60bf73becf,0x3dfbbf7abea13f6a,0x3f4e3f3ebf04bf71,0x3f18bf2cbf5c3eac,0x3ecf3f7e3e2fbf65,0x3f6abdfbbf7cbee6,0xbdc93f623f46be95,0x3f7f3ef1bf22bf75,0xbf133ee63f803efc,0x3f513f653cc9bf5f,0xbf67be163f3e3f78,0x3edb3f7d3f2cbe79,0xbf7fbf313dfb3f58,0xbd973f393f7e3f09
.quad 0xbf55bf7bbf0e3e48,0xbf0e3e483f553f7b,0xbee6bf6abf77bf13,0xbf65becf3e893f51,0x3d49bf04bf67bf7d,0xbf80bf5cbedb3e16,0x3f093d97becfbf4a,0xbf58bf7fbf6abf1d,0x3f623f223e95bdc9,0xbef1bf46bf75bf7f,0x3f803f773f583f27,0x3cc9be89bf09bf42,0x3f5c3f713f7d3f80,0x3f043eac3e16bd49,0x3efc3f133f273f39,0x3f5f3f513f423f31
.quad 0x3f6dbec4bf6d3ec4,0xbec4bf6d3ec43f6d,0x3f77be2fbf7fbcc9,0xbe89bf7c3d973f80,0x3f7d3d49bf78bedb,0xbe16bf80be793f67,0x3f803e89bf58bf42,0xbcc9bf77bf093f27,0x3f7f3ef1bf22bf75,0x3dc9bf62bf463e95,0x3f7a3f27beb8bf7e,0x3e60bf42bf6fbdfb,0x3f713f4ebd49bf5c,0x3eacbf18bf80bf04,0x3f653f6a3e89bf13,0x3ee6becfbf77bf51
.quad 0x3f553f7b3f0ebe48,0x3f0ebe48bf55bf7b,0x3f423f803f4a3e60,0x3f273cc9bf1dbf7a,0x3f2c3f783f713f18,0x3f3e3e79beacbf4e,0x3f133f653f803f5f,0x3f513ee6bcc9befc,0x3ef13f463f753f7f,0x3f623f223e95bdc9,0x3eb83f1d3f513f73,0x3f6f3f4a3f133ea1,0x3e793edb3f183f3e,0x3f783f673f4e3f2c,0x3dfb3e603ea13ecf,0x3f7e3f7a3f733f6a
.quad 0x3f7d42073f800000,0x3f67ac293f751727,0x3f7d24603f800000,0x3f66a9033f74a1d5,0x3f7d061c3f800000,0x3f65a0dc3f742a27,0x3f7ce73c3f800000,0x3f6493bb3f73b01f,0x3f7cc7c03f800000,0x3f6381a53f7333be,0x3f7ca7a93f800000,0x3f626aa03f72b504,0x3f7c86f53f800000,0x3f614eb13f7233f4,0x3f7c65a63f800000,0x3f602de03f71b08e
.quad 0x3f7c43bb3f800000,0x3f5f08333f712ad4,0x3f7c21343f800000,0x3f5dddaf3f70a2c6,0x3f7bfe123f800000,0x3f5cae5b3f701867,0x3f7bda553f800000,0x3f5b7a3e3f6f8bb8,0x3f7bb5fc3f800000,0x3f5a415f3f6efcba,0x3f7b91073f800000,0x3f5903c53f6e6b6d,0x3f7b6b783f800000,0x3f57c1753f6dd7d5,0x3f7b454e3f800000,0x3f567a783f6d41f2
.quad 0x3f3e57663f554aa4,0x3f04c98d3f23504b,0x3f3bb16d3f5389c7,0x3f000e823f1fa841,0x3f3900273f51c0c2,0x3ef688b33f1bf25f,0x3f3643bb3f4fefa8,0x3eecd7473f182ef5,0x3f337c553f4e1689,0x3ee309e33f145e58,0x3f30aa1f3f4c3578,0x3ed921b23f1080dc,0x3f2dcd443f4a4c87,0x3ecf1fde3f0c96d7,0x3f2ae5f23f485bca,0x3ec505963f08a0a1
.quad 0x3f27f4543f466354,0x3ebad40b3f049e91,0x3f24f8983f446337,0x3eb08c713f0090ff,0x3f21f2ec3f425b89,0x3ea62fff3ef8f08e,0x3f1ee37e3f404c5c,0x3e9bbfee3ef0a985,0x3f1bca7f3f3e35c5,0x3e913d793ee84d9c,0x3f18a81d3f3c17d9,0x3e86a9df3edfdd8d,0x3f157c883f39f2ac,0x3e780cbe3ed75a13,0x3f1247f33f37c655,0x3e62a8743ecec3ea
.quad 0x3e7fa9983ec6d529,0xbd2675643dd85d89,0x3e6430893ebb31a0,0xbd983a0a3d99cb0a,0x3e488af13eaf713a,0xbddd0d023d3626fc,0x3e2cbe363ea395c5,0xbe10cfc43c622fff,0x3e10cfc43e97a117,0xbe32eecfbc8a3938,0x3de98a1f3e8b9507,0xbe54d9b1bd42b491,0x3db147213e7ee6e1,0xbe768685bda00ecf,0x3d71c3153e667c66,0xbe8bf5bdbdde9cc4
.quad 0x3d00c8b93e4dee60,0xbe9c7f6abe0e7a8b,0x3b7b53a93e354098,0xbeacdb78be2d8461,0xbcc2c2a93e1c76de,0xbebd0521be4c6467,0xbd5264e23e039502,0xbeccf7afbe6b132f,0xbda19fb03dd53db9,0xbedcae7cbe84c4aa,0xbdd9ed643da3308c,0xbeec24f3be93dfbf,0xbe0908483d621469,0xbefb5692bea2d733,0xbe24ff203cfb49ba,0xbf051f75beb1a76b
.quad 0xbea7ac25be3e853e,0xbf161f93beec7e21,0xbebad40bbe636c83,0xbf1f80f3beffc5f3,0xbecdafdebe840270,0xbf288bdebf094a7f,0xbee037f2be9620d2,0xbf313b6bbf127130,0xbef264bbbea80b1f,0xbf398ae7bf1b52bb,0xbf021769beb9bb1e,0xbf4175d0bf23eaee,0xbf0ac77dbecb2aae,0xbf48f7dabf2c35b9,0xbf133f0fbedc53c1,0xbf500cf6bf342f34
.quad 0xbf1b7aadbeed3063,0xbf56b14abf3bd398,0xbf2376fdbefdbabb,0xbf5ce13ebf431f4c,0xbf2b30bebf06f686,0xbf629978bf4a0edc,0xbf32a4ccbf0ee0db,0xbf67d6ddbf509f03,0xbf39d01dbf16999f,0xbf6c9696bf56cca7,0xbf40afc5bf1e1e22,0xbf70d611bf5c94dd,0xbf4740fabf256bcb,0xbf749300bf61f4ea,0xbf4d810dbf2c800f,0xbf77cb5cbf66ea45
.quad 0xbf4b9d84bf32c8c9,0xbf6fc0bfbf601596,0xbf536d74bf3b8f3b,0xbf749300bf669330,0xbf5aaa31bf43e200,0xbf789091bf6c5cd4,0xbf614eb1bf4bbbf8,0xbf7bb5fcbf716dfb,0xbf675655bf531849,0xbf7e0082bf75c2b3,0xbf6cbceabf59f26a,0xbf7f6e26bf79579a,0xbf717eaebf604621,0xbf7ffdabbf7c29e5,0xbf759850bf660f88,0xbf7fae93bf7e375e
.quad 0xbf7906f6bf6b4b0c,0xbf7e8123bf7f7e6d,0xbf7bc83bbf6ff573,0xbf7c7661bf7ffe13,0xbf7dda36bf740bdd,0xbf799014bf7fb5ea,0xbf7f3b75bf778bc5,0xbf75d0c2bf7ea62d,0xbf7feb02bf7a7302,0xbf713bacbf7ccfae,0xbf7fe863bf7cbfc9,0xbf6bd4cebf7a33dd,0xbf7f339abf7e70b0,0xbf65a0dcbf76d4c4,0xbf7dcd24bf7f84ab,0xbf5ea53abf72b504
.quad 0xbf7f74c7bf7a4910,0xbf7962f9bf7f2787,0xbf7ffffbbf7d1cdd,0xbf74b0a0bf7d2bd8,0xbf7f7b40bf7efcc9,0xbf6ec682bf7a0904,0xbf7de721bf7fe705,0xbf67ac29bf75c2b3,0xbf7b454ebf7fdaaf,0xbf5f6aa1bf705de1,0xbf779890bf7ed7d4,0xbf560c70bf69e0d7,0xbf72e4d0bf7cdf6c,0xbf4b9d84bf625326,0xbf6d2f0cbf79f35e,0xbf402b2abf59bd9c
.quad 0xbf667d55bf76167a,0xbf33c3f6bf502a3b,0xbf5ed6c8bf714c7a,0xbf2677b7bf45a42d,0xbf564384bf6b99fb,0xbf18575dbf3a37b7,0xbf4ccca6bf650479,0xbf0974e9bf2df229,0xbf427c3cbf5d924d,0xbef3c6a4bf20e1d2,0xbf375d3abf554aa4,0xbed36cdbbf1315ee,0xbf2b7b70bf4c3578,0xbeb205b0bf049e91,0xbf1ee37ebf425b89,0xbe8fbbb2beeb1930
.quad 0xbf5e0fc5bf6e46be,0xbf2fcf60bf4916fa,0xbf53a612bf66becc,0xbf1fcf89bf3bd398,0xbf47fdcabf5df6be,0xbf0eb723bf2d5e6f,0xbf3b2879bf53fac3,0xbef94862bf1dcf06,0xbf2d396fbf48d8b3,0xbed36cdbbf0d3eb3,0xbf1e45a7bf3ca003,0xbeac1e29bef790dc,0xbf0e63a2bf2f61a5,0xbe83a14cbed31148,0xbefb5692bf212ff9,0xbe347ab2bead3a15
.quad 0xbed86b8bbf121eb0,0xbdc0ebe6be8648df,0xbeb43ac1bf0242b1,0xbc3c7dccbe3cfa15,0xbe8efaadbee363fa,0x3d91f5d0bdd85d89,0xbe51c6c1bec1071e,0x3e1d3d8ebcd59aa6,0xbe045c65be9d9e78,0x3e706c283d5bce4c,0xbd58ab31be72b651,0x3ea0fa573e084105,0x3cc2c2a9be28defc,0x3ec8a3fd3e58b0a4,0x3dcd6da3bdbc3ac3,0x3eeeed673e93dfbf
.quad 0xbee525e9bf12c39a,0xbe2e4a85be9fdbee,0xbebb8f2fbf003a06,0xbd9b5c05be64f486,0xbe907ca1bed97cb9,0x3c9d11ecbe084105,0xbe488af1beb0eacb,0x3de98a1fbd2998f6,0xbddd0d02be870ada,0x3e54d9b13d4f41af,0xbc9d11ecbe3857ec,0x3e9980e93e1196cc,0x3d8ed391bdc27c39,0x3ec731ca3e6e21ab,0x3e21e530bc16cb58,0x3ef315c23ea4543f
.quad 0x3e7b18bc3d9cecf9,0x3f0e63a23ed0338a,0x3ea927e53e25c58c,0x3f21f2ec3efa4fa5,0x3ed36cdb3e7bdba4,0x3f340b7b3f1126a7,0x3efc05aa3ea80b1f,0x3f4483723f23eaee,0x3f11500c3ed0eb2a,0x3f5334b53f354bfb,0x3f2376fd3ef840c8,0x3f5ffd443f452426,0x3f3452e53f0ee0db,0x3f6abf8c3f535118,0x3f43c1a03f209393,0x3f7362a83f5fb419
.quad 0x3e15799e00000000,0x3ed9d7b73e93dfbf,0x3e18951100000000,0x3ede19123e96e100,0x3e1bb02700000000,0x3ee2559b3e99e0ce,0x3e1ecadd00000000,0x3ee68d3c3e9cdf20,0x3e21e53000000000,0x3eeabfdd3e9fdbee,0x3e24ff2000000000,0x3eeeed673ea2d733,0x3e2818aa00000000,0x3ef315c23ea5d0e5,0x3e2b31cc00000000,0x3ef738d83ea8c8fe
.quad 0x3e2e4a8500000000,0x3efb56923eabbf77,0x3e3162d200000000,0x3eff6ed83eaeb449,0x3e347ab200000000,0x3f01c0ca3eb1a76b,0x3e37922200000000,0x3f03c7573eb498d6,0x3e3aa92100000000,0x3f05cb0a3eb78884,0x3e3dbfad00000000,0x3f07cbd53eba766e,0x3e40d5c400000000,0x3f09c9ae3ebd628b,0x3e43eb6400000000,0x3f0bc48b3ec04cd5
.quad 0x3f2b30be3f0d9281,0x3f5ade673f452426,0x3f2e17073f102dd5,0x3f5dab763f481d27,0x3f30f2d33f12c39a,0x3f605e5a3f4b04cc,0x3f33c3f63f1553b7,0x3f62f6c03f4ddad5,0x3f368a453f17de12,0x3f65745a3f509f03,0x3f3945953f1a6293,0x3f67d6dd3f535118,0x3f3bf5bc3f1ce11f,0x3f6a1e013f55f0d9,0x3f3e9a913f1f599f,0x3f6c49803f587e0b
.quad 0x3f4133ea3f21cbfb,0x3f6e591a3f5af875,0x3f43c1a03f24381a,0x3f704c913f5d5fe1,0x3f46438b3f269de3,0x3f7223a83f5fb419,0x3f48b9853f28fd41,0x3f73de283f61f4ea,0x3f4b23673f2b561b,0x3f757bde3f642221,0x3f4d810d3f2da859,0x3f76fc993f663b8e,0x3f4fd2523f2ff3e6,0x3f78602a3f684103,0x3f5217113f3238aa,0x3f79a6683f6a3252
.quad 0x3f77e4883f6be858,0x3f7fc9dc3f7e913d,0x3f7990143f6e46be,0x3f7f4ab63f7f46f4,0x3f7b0aeb3f708066,0x3f7e81233f7fbf2a,0x3f7c54c43f7294f8,0x3f7d6d5e3f7ff9c1,0x3f7d6d5e3f748422,0x3f7c0fb73f7ff6ac,0x3f7e54823f764d97,0x3f7a68943f7fb5ea,0x3f7f0a033f77f110,0x3f7878713f7f378c,0x3f7f8dbe3f796e4e,0x3f763fde3f7e7bb1
.quad 0x3f7fdf993f7ac516,0x3f73bf813f7d8285,0x3f7fff853f7bf531,0x3f70f8143f7c4c44,0x3f7fed7a3f7cfe73,0x3f6dea683f7ad93a,0x3f7fa97d3f7de0b1,0x3f6a97603f7929bf,0x3f7f339a3f7e9bc9,0x3f66fff33f773e3c,0x3f7e8be93f7f2f9d,0x3f63252f3f751727,0x3f7db28a3f7f9c18,0x3f5f08333f72b504,0x3f7ca7a93f7fe129,0x3f5aaa313f701867
.quad 0x3f71e21a3f7b87b2,0x3f4f5ca93f630dfc,0x3f6e591a3f799b43,0x3f483c7c3f5dc497,0x3f6a6f0f3f77583a,0x3f40afc53f581279,0x3f66258f3f74bf62,0x3f38ba9c3f51fa54,0x3f617e5b3f71d19f,0x3f3061503f4b7f09,0x3f5c7b563f6e8ff8,0x3f27a8683f44a3a5,0x3f571e8c3f6afb8c,0x3f1e949f3f3d6b67,0x3f516a2a3f671599,0x3f152ae03f35d9b8
.quad 0x3f4b60853f62df7b,0x3f0b70463f2df229,0x3f4504113f5e5aa6,0x3f016a173f25b877,0x3f3e57663f5988ad,0x3eee3b813f1d3084,0x3f375d3a3f546b3b,0x3ed921b23f145e58,0x3f3018653f4f0417,0x3ec392313f0b461c,0x3f288bde3f495521,0x3ead98ac3f01ec1c,0x3f20bab63f436051,0x3e97410e3ef0a985,0x3f18a81d3f3d27b8,0x3e8097743edd092e
.quad 0x3f1b2ac33f373a23,0x3eb37e823ef790dc,0x3f10575b3f2e3bde,0x3e97410e3ede73a2,0x3f051f753f24d225,0x3e7500263ec4a8c8,0x3ef315c23f1b02c6,0x3e3aa9213eaa446f,0x3edb435d3f10d3cd,0x3dff5f943e8f5b32,0x3ec2d8513f064b82,0x3d888ed23e680422,0x3ea9e59d3ef6e0cb,0x3c0a3a7b3e309cc9,0x3e907ca13ee0924f,0xbd4c1e733df1572e
.quad 0x3e6d5e1a3ec9b953,0xbddd0d023d80b86c,0x3e391db03eb263ef,0xbe29a5483bfb5330,0x3e045c653e9aa086,0xbe643089bd42b491,0x3d9e7de73e827dc0,0xbe8efaadbdd21dc8,0x3ccf52af3e541501,0xbeab60bfbe211ea5,0xbcdbe2943e22abb6,0xbec731cabe58b0a4,0xbda19fb03de1bc2e,0xbee2559bbe87ccc1,0xbe05eb1b3d7b2b74,0xbefcb49bbea2d733
.quad 0x3d856c523e57278f,0xbe674048bda65230,0x3a490fd93e195be0,0xbe9680ecbe17ce3d,0xbd8249be3db5f8da,0xbeb8a1f1be5bc26a,0xbe02cd9b3ce22a7a,0xbed9d7b7be8f5b32,0xbe43eb64bd0a342f,0xbef9f7eebeb02e10,0xbe821c88bdc27c39,0xbf0c6cd3bed0338a,0xbea1b928be1f917b,0xbf1b2ac3beef464c,0xbec0a9fdbe5d4b1a,0xbf292300bf06a10e
.quad 0xbedece2abe8d17c0,0xbf3643bbbf150204,0xbefc05aabeab0201,0xbf427c3cbf22b543,0xbf0c18babec8477c,0xbf4dbcf0bf2faad3,0xbf1999cdbee4cbfe,0xbf57f780bf3bd398,0xbf2677b7bf003a06,0xbf611ee5bf472167,0xbf32a4ccbf0d9281,0xbf692774bf518710,0xbf3e141dbf1a6293,0xbf7006f2bf5af875,0xbf48b985bf269de3,0xbf75b49cbf636a95
.quad 0xbefec083bebb31a0,0xbf3a1535bf1e6d26,0xbf100449beddbe79,0xbf47fdcabf2df229,0xbf1fcf89beff17b2,0xbf548745bf3c5bfc,0xbf2eaa3bbf0f8784,0xbf5f9ba5bf499329,0xbf3c7e03bf1ebc12,0xbf692774bf55822c,0xbf493611bf2d1469,0xbf7119f3bf601596,0xbf54bf40bf3a7ca4,0xbf77652bbf693c32,0xbf5f0833bf46e22a,0xbf7bfe12bf70e717
.quad 0xbf68016dbf5233c6,0xbf7edc95bf7709cc,0xbf6f9d6ebf5c61c7,0xbf7ffbaabf7b9a53,0xbf75d0c2bf655e0b,0xbf7f5959bf7e913d,0xbf7a9212bf6d1c1d,0xbf7cf6c0bf7fe9b8,0xbf7dda36bf73913f,0xbf78d80ebf7fa191,0xbf7fa43fbf78b47b,0xbf73047ebf7db940,0xbf7fed7abf7c7eb0,0xbf6b864cbf7a33dd,0xbf7eb579bf7eea9d,0xbf626aa0bf751727
.quad 0xbf64edfebf51c0c2,0xbf7c43bbbf7333be,0xbf6e3459bf5d924d,0xbf7f4329bf7984dc,0xbf759850bf67c187,0xbf7ff3f4bf7db940,0xbf7b0aebbf703b37,0xbf7e5482bf7fc7cc,0xbf7e8123bf76ef5b,0xbf7a6894bf7fac0d,0xbf7ff3f4bf7bd14d,0xbf74393ebf7d663d,0xbf7f606fbf7ed7d4,0xbf6bd4cebf78fb4a,0xbf7cc7c0bf7ffd39,0xbf614eb1bf7274c7
.quad 0xbf782f29bf7f3f54,0xbf54bf40bf69e0d7,0xbf719ff7bf7c9f8a,0xbf46438bbf5f5212,0xbf692774bf7822d1,0xbf35fd15bf52df59,0xbf5ed6c8bf71d19f,0xbf241187bf44a3a5,0xbf52c2d5bf69b7e4,0xbf10aa57bf34bdcf,0xbf450411bf5fe4e9,0xbef7e8d7bf23504b,0xbf35b653bf546b3b,0xbecc3f60bf1080dc,0xbf24f898bf476085,0xbe9ebd4fbef8f08e
.quad 0x3f8000003f800000,0x3f8000003f800000,0x3f7d24603f7d4207,0x3f7ce73c3f7d061c,0x3f74a1d53f751727,0x3f73b01f3f742a27,0x3f66a9033f67ac29,0x3f6493bb3f65a0dc,0x3f5389c73f554aa4,0x3f4fefa83f51c0c2,0x3f3bb16d3f3e5766,0x3f3643bb3f390027,0x3f1fa8413f23504b,0x3f182ef53f1bf25f,0x3f000e823f04c98d,0x3eecd7473ef688b3
.quad 0x3ebb31a03ec6d529,0x3ea395c53eaf713a,0x3e6430893e7fa998,0x3e2cbe363e488af1,0x3d99cb0a3dd85d89,0x3c622fff3d3626fc,0xbd983a0abd267564,0xbe10cfc4bddd0d02,0xbe636c83be3e853e,0xbe9620d2be840270,0xbebad40bbea7ac25,0xbee037f2becdafde,0xbeffc5f3beec7e21,0xbf127130bf094a7f,0xbf1f80f3bf161f93,0xbf313b6bbf288bde
.quad 0x3f8000003f800000,0x3f8000003f800000,0x3f7ca7a93f7cc7c0,0x3f7c65a63f7c86f5,0x3f72b5043f7333be,0x3f71b08e3f7233f4,0x3f626aa03f6381a5,0x3f602de03f614eb1,0x3f4c35783f4e1689,0x3f485bca3f4a4c87,0x3f30aa1f3f337c55,0x3f2ae5f23f2dcd44,0x3f1080dc3f145e58,0x3f08a0a13f0c96d7,0x3ed921b23ee309e3,0x3ec505963ecf1fde
.quad 0x3e8b95073e97a117,0x3e667c663e7ee6e1,0x3de98a1f3e10cfc4,0x3d71c3153db14721,0xbd42b491bc8a3938,0xbdde9cc4bda00ecf,0xbe54d9b1be32eecf,0xbe8bf5bdbe768685,0xbeb9bb1ebea80b1f,0xbedc53c1becb2aae,0xbf021769bef264bb,0xbf133f0fbf0ac77d,0xbf23eaeebf1b52bb,0xbf342f34bf2c35b9,0xbf4175d0bf398ae7,0xbf500cf6bf48f7da
.quad 0x3f8000003f800000,0x3f8000003f800000,0x3f7c21343f7c43bb,0x3f7bda553f7bfe12,0x3f70a2c63f712ad4,0x3f6f8bb83f701867,0x3f5dddaf3f5f0833,0x3f5b7a3e3f5cae5b,0x3f4463373f466354,0x3f404c5c3f425b89,0x3f24f8983f27f454,0x3f1ee37e3f21f2ec,0x3f0090ff3f049e91,0x3ef0a9853ef8f08e,0x3eb08c713ebad40b,0x3e9bbfee3ea62fff
.quad 0x3e3540983e4dee60,0x3e0395023e1c76de,0x3b7b53a93d00c8b9,0xbd5264e2bcc2c2a9,0xbe2d8461be0e7a8b,0xbe6b132fbe4c6467,0xbeacdb78be9c7f6a,0xbeccf7afbebd0521,0xbefdbabbbeed3063,0xbf0ee0dbbf06f686,0xbf2376fdbf1b7aad,0xbf32a4ccbf2b30be,0xbf431f4cbf3bd398,0xbf509f03bf4a0edc,0xbf5ce13ebf56b14a,0xbf67d6ddbf629978
.quad 0x3f8000003f800000,0x3f8000003f800000,0x3f7b91073f7bb5fc,0x3f7b454e3f7b6b78,0x3f6e6b6d3f6efcba,0x3f6d41f23f6dd7d5,0x3f5903c53f5a415f,0x3f567a783f57c175,0x3f3c17d93f3e35c5,0x3f37c6553f39f2ac,0x3f18a81d3f1bca7f,0x3f1247f33f157c88,0x3edfdd8d3ee84d9c,0x3ecec3ea3ed75a13,0x3e86a9df3e913d79,0x3e62a8743e780cbe
.quad 0x3da3308c3dd53db9,0x3cfb49ba3d621469,0xbdd9ed64bda19fb0,0xbe24ff20be090848,0xbe93dfbfbe84c4aa,0xbeb1a76bbea2d733,0xbeec24f3bedcae7c,0xbf051f75befb5692,0xbf1e1e22bf16999f,0xbf2c800fbf256bcb,0xbf40afc5bf39d01d,0xbf4d810dbf4740fa,0xbf5c94ddbf56cca7,0xbf66ea45bf61f4ea,0xbf70d611bf6c9696,0xbf77cb5cbf749300
.quad 0xbf3b8f3bbf32c8c9,0xbf4bbbf8bf43e200,0xbf536d74bf4b9d84,0xbf614eb1bf5aaa31,0xbf669330bf601596,0xbf716dfbbf6c5cd4,0xbf749300bf6fc0bf,0xbf7bb5fcbf789091,0xbf7d1cddbf7a4910,0xbf7fe705bf7efcc9,0xbf7ffffbbf7f74c7,0xbf7de721bf7f7b40,0xbf7d2bd8bf7f2787,0xbf75c2b3bf7a0904,0xbf74b0a0bf7962f9,0xbf67ac29bf6ec682
.quad 0xbf66beccbf6e46be,0xbf53fac3bf5df6be,0xbf53a612bf5e0fc5,0xbf3b2879bf47fdca,0xbf3bd398bf4916fa,0xbf1dcf06bf2d5e6f,0xbf1fcf89bf2fcf60,0xbef94862bf0eb723,0xbf003a06bf12c39a,0xbeb0eacbbed97cb9,0xbebb8f2fbee525e9,0xbe488af1be907ca1,0xbe64f486be9fdbee,0xbd2998f6be084105,0xbd9b5c05be2e4a85,0x3de98a1f3c9d11ec
.quad 0xbf59f26abf531849,0xbf660f88bf604621,0xbf6cbceabf675655,0xbf759850bf717eae,0xbf79579abf75c2b3,0xbf7e375ebf7c29e5,0xbf7f6e26bf7e0082,0xbf7fae93bf7ffdab,0xbf7ed7d4bf7fdaaf,0xbf79f35ebf7cdf6c,0xbf779890bf7b454e,0xbf6d2f0cbf72e4d0,0xbf69e0d7bf705de1,0xbf59bd9cbf625326,0xbf560c70bf5f6aa1,0xbf402b2abf4b9d84
.quad 0xbf3ca003bf48d8b3,0xbf212ff9bf2f61a5,0xbf1e45a7bf2d396f,0xbefb5692bf0e63a2,0xbef790dcbf0d3eb3,0xbead3a15bed31148,0xbeac1e29bed36cdb,0xbe347ab2be83a14c,0xbe3857ecbe870ada,0xbc16cb58bdc27c39,0xbc9d11ecbddd0d02,0x3e21e5303d8ed391,0x3e1196cc3d4f41af,0x3ea4543f3e6e21ab,0x3e9980e93e54d9b1,0x3ef315c23ec731ca
.quad 0xbf6ff573bf6b4b0c,0xbf778bc5bf740bdd,0xbf7bc83bbf7906f6,0xbf7f3b75bf7dda36,0xbf7ffe13bf7f7e6d,0xbf7ea62dbf7fb5ea,0xbf7c7661bf7e8123,0xbf75d0c2bf799014,0xbf714c7abf76167a,0xbf650479bf6b99fb,0xbf5ed6c8bf667d55,0xbf4ccca6bf564384,0xbf45a42dbf502a3b,0xbf2df229bf3a37b7,0xbf2677b7bf33c3f6,0xbf0974e9bf18575d
.quad 0xbf0242b1bf121eb0,0xbec1071ebee363fa,0xbeb43ac1bed86b8b,0xbe51c6c1be8efaad,0xbe3cfa15be8648df,0xbcd59aa6bdd85d89,0xbc3c7dccbdc0ebe6,0x3e1d3d8e3d91f5d0,0x3e25c58c3d9cecf9,0x3ea80b1f3e7bdba4,0x3ea927e53e7b18bc,0x3efc05aa3ed36cdb,0x3efa4fa53ed0338a,0x3f23eaee3f1126a7,0x3f21f2ec3f0e63a2,0x3f4483723f340b7b
.quad 0xbf7cbfc9bf7a7302,0xbf7f84abbf7e70b0,0xbf7fe863bf7feb02,0xbf7dcd24bf7f339a,0xbf7a33ddbf7ccfae,0xbf72b504bf76d4c4,0xbf6bd4cebf713bac,0xbf5ea53abf65a0dc,0xbf554aa4bf5d924d,0xbf425b89bf4c3578,0xbf375d3abf427c3c,0xbf1ee37ebf2b7b70,0xbf1315eebf20e1d2,0xbeeb1930bf049e91,0xbed36cdbbef3c6a4,0xbe8fbbb2beb205b0
.quad 0xbe72b651be9d9e78,0xbdbc3ac3be28defc,0xbd58ab31be045c65,0x3dcd6da33cc2c2a9,0x3e0841053d5bce4c,0x3e93dfbf3e58b0a4,0x3ea0fa573e706c28,0x3eeeed673ec8a3fd,0x3ef840c83ed0eb2a,0x3f2093933f0ee0db,0x3f2376fd3f11500c,0x3f43c1a03f3452e5,0x3f4524263f354bfb,0x3f5fb4193f535118,0x3f5ffd443f5334b5,0x3f7362a83f6abf8c
.quad 0,0,0x3e1895113e15799e,0x3e1ecadd3e1bb027,0x3e96e1003e93dfbf,0x3e9cdf203e99e0ce,0x3ede19123ed9d7b7,0x3ee68d3c3ee2559b,0x3f102dd53f0d9281,0x3f1553b73f12c39a,0x3f2e17073f2b30be,0x3f33c3f63f30f2d3,0x3f481d273f452426,0x3f4ddad53f4b04cc,0x3f5dab763f5ade67,0x3f62f6c03f605e5a
.quad 0x3f6e46be3f6be858,0x3f7294f83f708066,0x3f7990143f77e488,0x3f7c54c43f7b0aeb,0x3f7f46f43f7e913d,0x3f7ff9c13f7fbf2a,0x3f7f4ab63f7fc9dc,0x3f7d6d5e3f7e8123,0x3f799b433f7b87b2,0x3f74bf623f77583a,0x3f6e591a3f71e21a,0x3f66258f3f6a6f0f,0x3f5dc4973f630dfc,0x3f51fa543f581279,0x3f483c7c3f4f5ca9,0x3f38ba9c3f40afc5
.quad 0,0,0x3e24ff203e21e530,0x3e2b31cc3e2818aa,0x3ea2d7333e9fdbee,0x3ea8c8fe3ea5d0e5,0x3eeeed673eeabfdd,0x3ef738d83ef315c2,0x3f1a62933f17de12,0x3f1f599f3f1ce11f,0x3f3945953f368a45,0x3f3e9a913f3bf5bc,0x3f5351183f509f03,0x3f587e0b3f55f0d9,0x3f67d6dd3f65745a,0x3f6c49803f6a1e01
.quad 0x3f764d973f748422,0x3f796e4e3f77f110,0x3f7e54823f7d6d5e,0x3f7f8dbe3f7f0a03,0x3f7fb5ea3f7ff6ac,0x3f7e7bb13f7f378c,0x3f7a68943f7c0fb7,0x3f763fde3f787871,0x3f6e8ff83f71d19f,0x3f6715993f6afb8c,0x3f5c7b563f617e5b,0x3f516a2a3f571e8c,0x3f44a3a53f4b7f09,0x3f35d9b83f3d6b67,0x3f27a8683f306150,0x3f152ae03f1e949f
.quad 0,0,0x3e3162d23e2e4a85,0x3e3792223e347ab2,0x3eaeb4493eabbf77,0x3eb498d63eb1a76b,0x3eff6ed83efb5692,0x3f03c7573f01c0ca,0x3f24381a3f21cbfb,0x3f28fd413f269de3,0x3f43c1a03f4133ea,0x3f48b9853f46438b,0x3f5d5fe13f5af875,0x3f61f4ea3f5fb419,0x3f704c913f6e591a,0x3f73de283f7223a8
.quad 0x3f7bf5313f7ac516,0x3f7de0b13f7cfe73,0x3f7fff853f7fdf99,0x3f7fa97d3f7fed7a,0x3f7c4c443f7d8285,0x3f7929bf3f7ad93a,0x3f70f8143f73bf81,0x3f6a97603f6dea68,0x3f5e5aa63f62df7b,0x3f546b3b3f5988ad,0x3f4504113f4b6085,0x3f375d3a3f3e5766,0x3f25b8773f2df229,0x3f145e583f1d3084,0x3f016a173f0b7046,0x3ed921b23eee3b81
.quad 0,0,0x3e3dbfad3e3aa921,0x3e43eb643e40d5c4,0x3eba766e3eb78884,0x3ec04cd53ebd628b,0x3f07cbd53f05cb0a,0x3f0bc48b3f09c9ae,0x3f2da8593f2b561b,0x3f3238aa3f2ff3e6,0x3f4d810d3f4b2367,0x3f5217113f4fd252,0x3f663b8e3f642221,0x3f6a32523f684103,0x3f76fc993f757bde,0x3f79a6683f78602a
.quad 0x3f7f2f9d3f7e9bc9,0x3f7fe1293f7f9c18,0x3f7e8be93f7f339a,0x3f7ca7a93f7db28a,0x3f7517273f773e3c,0x3f7018673f72b504,0x3f63252f3f66fff3,0x3f5aaa313f5f0833,0x3f4955213f4f0417,0x3f3d27b83f436051,0x3f288bde3f301865,0x3f18a81d3f20bab6,0x3f01ec1c3f0b461c,0x3edd092e3ef0a985,0x3ead98ac3ec39231,0x3e8097743e97410e
.quad 0x3f2e3bde3f373a23,0x3f1b02c63f24d225,0x3f10575b3f1b2ac3,0x3ef315c23f051f75,0x3ede73a23ef790dc,0x3eaa446f3ec4a8c8,0x3e97410e3eb37e82,0x3e3aa9213e750026,0x3e195be03e57278f,0x3ce22a7a3db5f8da,0x3a490fd93d856c52,0xbe02cd9bbd8249be,0xbe17ce3dbda65230,0xbe8f5b32be5bc26a,0xbe9680ecbe674048,0xbed9d7b7beb8a1f1
.quad 0xbeddbe79bebb31a0,0xbf0f8784beff17b2,0xbf100449befec083,0xbf2eaa3bbf1fcf89,0xbf2df229bf1e6d26,0xbf499329bf3c5bfc,0xbf47fdcabf3a1535,0xbf5f9ba5bf548745,0xbf5d924dbf51c0c2,0xbf703b37bf67c187,0xbf6e3459bf64edfe,0xbf7b0aebbf759850,0xbf7984dcbf7333be,0xbf7fc7ccbf7db940,0xbf7f4329bf7c43bb,0xbf7e5482bf7ff3f4
.quad 0x3f064b823f10d3cd,0x3ee0924f3ef6e0cb,0x3ec2d8513edb435d,0x3e907ca13ea9e59d,0x3e6804223e8f5b32,0x3df1572e3e309cc9,0x3d888ed23dff5f94,0xbd4c1e733c0a3a7b,0xbdc27c39bd0a342f,0xbe5d4b1abe1f917b,0xbe821c88be43eb64,0xbec0a9fdbea1b928,0xbed0338abeb02e10,0xbf06a10ebeef464c,0xbf0c6cd3bef9f7ee,0xbf292300bf1b2ac3
.quad 0xbf2d1469bf1ebc12,0xbf46e22abf3a7ca4,0xbf493611bf3c7e03,0xbf5f0833bf54bf40,0xbf601596bf55822c,0xbf70e717bf693c32,0xbf7119f3bf692774,0xbf7bfe12bf77652b,0xbf7bd14dbf76ef5b,0xbf7ffd39bf7ed7d4,0xbf7ff3f4bf7e8123,0xbf7cc7c0bf7f606f,0xbf7d663dbf7fac0d,0xbf7274c7bf78fb4a,0xbf74393ebf7a6894,0xbf614eb1bf6bd4ce
.quad 0x3eb263ef3ec9b953,0x3e827dc03e9aa086,0x3e391db03e6d5e1a,0x3d9e7de73e045c65,0x3bfb53303d80b86c,0xbdd21dc8bd42b491,0xbe29a548bddd0d02,0xbe8efaadbe643089,0xbeab0201be8d17c0,0xbee4cbfebec8477c,0xbefc05aabedece2a,0xbf1999cdbf0c18ba,0xbf22b543bf150204,0xbf3bd398bf2faad3,0xbf427c3cbf3643bb,0xbf57f780bf4dbcf0
.quad 0xbf5c61c7bf5233c6,0xbf6d1c1dbf655e0b,0xbf6f9d6ebf68016d,0xbf7a9212bf75d0c2,0xbf7b9a53bf7709cc,0xbf7fe9b8bf7e913d,0xbf7ffbaabf7edc95,0xbf7cf6c0bf7f5959,0xbf7c9f8abf7f3f54,0xbf71d19fbf7822d1,0xbf719ff7bf782f29,0xbf5ed6c8bf692774,0xbf5f5212bf69e0d7,0xbf44a3a5bf52df59,0xbf46438bbf54bf40,0xbf241187bf35fd15
.quad 0x3e22abb63e541501,0x3d7b2b743de1bc2e,0xbcdbe2943ccf52af,0xbe05eb1bbda19fb0,0xbe58b0a4be211ea5,0xbea2d733be87ccc1,0xbec731cabeab60bf,0xbefcb49bbee2559b,0xbf0d9281bf003a06,0xbf269de3bf1a6293,0xbf32a4ccbf2677b7,0xbf48b985bf3e141d,0xbf518710bf472167,0xbf636a95bf5af875,0xbf692774bf611ee5,0xbf75b49cbf7006f2
.quad 0xbf78b47bbf73913f,0xbf7eea9dbf7c7eb0,0xbf7fa43fbf7dda36,0xbf7eb579bf7fed7a,0xbf7db940bf7fa191,0xbf751727bf7a33dd,0xbf73047ebf78d80e,0xbf626aa0bf6b864c,0xbf5fe4e9bf69b7e4,0xbf476085bf546b3b,0xbf450411bf52c2d5,0xbf24f898bf35b653,0xbf23504bbf34bdcf,0xbef8f08ebf1080dc,0xbef7e8d7bf10aa57,0xbe9ebd4fbecc3f60
.size L_tables, 173056
L_tables_end:
.section .rodata,"a"
.p2align 6
.amdhsa_kernel interleave_layers__spectral_gfnet__ssm_conv_s4__prompt_kernel
  .amdhsa_next_free_vgpr 508
  .amdhsa_next_free_sgpr 94
  .amdhsa_accum_offset 256
  .amdhsa_group_segment_fixed_size 0
  .amdhsa_kernarg_size 120
  .amdhsa_user_sgpr_count 2
  .amdhsa_user_sgpr_kernarg_segment_ptr 1
  .amdhsa_system_sgpr_workgroup_id_x 1
  .amdhsa_float_denorm_mode_32 3
.end_amdhsa_kernel
```
